```python
import torch

def _softmax(x, axis=-1):
    return torch.softmax(x, dim=axis)

def _gelu(x):
    return torch.nn.functional.gelu(x, approximate='tanh')

def _silu(x):
    return torch.nn.functional.silu(x)

def _sigmoid(x):
    return torch.sigmoid(x)

def _layernorm(x, axis=-1, eps=1e-05):
    m = x.mean(dim=axis, keepdim=True)
    v = x.var(dim=axis, keepdim=True, unbiased=False)
    return (x - m) / torch.sqrt(v + eps)

def _scatter_add(tgt, idx, src, axis=0):
    return tgt.clone().index_add_(axis, idx, src)

def _segment_sum(src, seg, n):
    out = torch.zeros((n,) + src.shape[1:], dtype=src.dtype)
    return out.index_add_(0, seg, src)

def _pad(x, pw):
    flat = tuple((v for pair in reversed(pw) for v in pair))
    return torch.nn.functional.pad(x, flat)
kernel_name = 'adaLN_cond__gqa_block_cached__mixer_channel_mlp__prompt'

def setup_inputs():

    _w = lambda a: (lambda t: t.to(torch.bfloat16) if t.is_floating_point() else t)(torch.as_tensor(a))

    def _A_setup():
        B, Sq, D = (1, 2048, 448)
        Hq, Hkv, Sk, Dh = (16, 8, 2048, 256)
        assert Hq % Hkv == 0, (Hq, Hkv)
        return {'x': _w((lambda *s: torch.randn(*s, dtype=torch.bfloat16) * 0.1)(B, Sq, D)), 'k_cache': _w((lambda *s: torch.randn(*s, dtype=torch.bfloat16) * 0.8)(B, Hkv, Sk, Dh)), 'v_cache': _w((lambda *s: torch.randn(*s, dtype=torch.bfloat16) * 1.6)(B, Hkv, Sk, Dh)), 'wq': _w((lambda *s: torch.randn(*s, dtype=torch.bfloat16) * 0.8)(D, Hq * Dh) * D ** (-0.5)), 'wo': _w((lambda *s: torch.randn(*s, dtype=torch.bfloat16) * 1.6)(Hq * Dh, D) * (Hq * Dh) ** (-0.5))}
    _A_in = _A_setup()

    def _B_setup():
        B, S, D, F = (1, 2048, 448, 1792)
        return {'x': _w((lambda *s: torch.randn(*s, dtype=torch.bfloat16) * 0.1)(B, S, D)), 'w1': _w((lambda *s: torch.randn(*s, dtype=torch.bfloat16) * 3.2)(D, F) * D ** (-0.5)), 'b1': _w((lambda *s: torch.randn(*s, dtype=torch.bfloat16) * 3.2)(F)), 'w2': _w((lambda *s: torch.randn(*s, dtype=torch.bfloat16) * 3.2)(F, D) * F ** (-0.5)), 'b2': _w((lambda *s: torch.randn(*s, dtype=torch.bfloat16) * 3.2)(D))}
    _B_in = _B_setup()
    return {'A_x': _A_in['x'], 'A_k_cache': _A_in['k_cache'], 'A_v_cache': _A_in['v_cache'], 'A_wq': _A_in['wq'], 'A_wo': _A_in['wo'], 'B_x': _B_in['x'], 'B_w1': _B_in['w1'], 'B_b1': _B_in['b1'], 'B_w2': _B_in['w2'], 'B_b2': _B_in['b2'], 'c': _w((lambda *s: torch.randn(*s, dtype=torch.bfloat16) * 0.2)(1, 448) * 8.0), 'w_mod': _w((lambda *s: torch.randn(*s, dtype=torch.bfloat16) * 0.2)(448, 6 * 448) * 448 ** (-0.5) * 8.0)}

def reference(A_x, A_k_cache, A_v_cache, A_wq, A_wo, B_x, B_w1, B_b1, B_w2, B_b2, c, w_mod):

    def _A_ref(x, k_cache, v_cache, wq, wo):
        B, Sq, D = x.shape
        Hq, Dh = (16, 256)
        Hkv = k_cache.shape[1]
        rep = Hq // Hkv
        q = (lambda x, *d: x.permute(*d))((x @ wq).reshape(B, Sq, Hq, Dh), 0, 2, 1, 3)
        k = (lambda x, n, axis: torch.repeat_interleave(x, n, dim=axis))(k_cache, rep, axis=1)
        v = (lambda x, n, axis: torch.repeat_interleave(x, n, dim=axis))(v_cache, rep, axis=1)
        scores = torch.einsum('bhqd,bhkd->bhqk', q, k) * Dh ** (-0.5)
        p = _softmax(scores, axis=-1)
        o = torch.einsum('bhqk,bhkd->bhqd', p, v)
        return (lambda x, *d: x.permute(*d))(o, 0, 2, 1, 3).reshape(B, Sq, Hq * Dh) @ wo

    def _B_ref(x, w1, b1, w2, b2):
        y = _layernorm(x, axis=-1)
        h = _gelu(torch.einsum('bsd,df->bsf', y, w1) + b1)
        return torch.einsum('bsf,fd->bsd', h, w2) + b2
    x = A_x
    mod = (_silu(c) @ w_mod).reshape(c.shape[0], 6, 1, -1)
    sa, ca, ga, sb, cb, gb = (mod[:, 0].clone(), mod[:, 1].clone(), mod[:, 2].clone(), mod[:, 3].clone(), mod[:, 4].clone(), mod[:, 5].clone())
    h = _layernorm(x, axis=-1) * (1 + ca) + sa
    x = x + ga * _A_ref(h, A_k_cache, A_v_cache, A_wq, A_wo)
    h = _layernorm(x, axis=-1) * (1 + cb) + sb
    x = x + gb * _B_ref(h, B_w1, B_b1, B_w2, B_b2)
    return x
```

```asm
; @launch grid=(256,1,1) block=(256,1,1) lds=163840
.amdgcn_target "amdgcn-amd-amdhsa--gfx950"
.text
.p2align 8
L_code_begin:
.globl adaLN_cond__gqa_block_cached__mixer_channel_mlp__prompt_kernel
.p2align 8
.type adaLN_cond__gqa_block_cached__mixer_channel_mlp__prompt_kernel,@function
adaLN_cond__gqa_block_cached__mixer_channel_mlp__prompt_kernel:
    s_cmp_ge_u32 s2, 256
    s_cbranch_scc1 L_k2_end
    s_load_dwordx4 s[40:43], s[0:1], 80
    s_load_dwordx2 s[44:45], s[0:1], 104
    s_load_dwordx8 s[56:63], s[0:1], 0
    s_load_dwordx2 s[64:65], s[0:1], 32
    s_load_dwordx2 s[66:67], s[0:1], 112
    s_load_dwordx2 s[68:69], s[0:1], 48
    s_load_dwordx2 s[70:71], s[0:1], 64
    s_memrealtime s[48:49]
    s_and_b32 s3, s2, 7
    s_lshr_b32 s4, s2, 3
    v_lshrrev_b32 v17, 6, v0
    v_and_b32 v8, 63, v0
    v_readfirstlane_b32 s5, v17
    v_and_b32_e64 v9, 15, v0
    v_bfe_u32 v10, v0, 4, 2
    v_lshlrev_b32 v24, 6, v0
    v_lshlrev_b32 v16, 4, v8
    v_mov_b32 v28, v0
    v_mov_b32 v26, 0
    v_mul_u32_u24 v17, 896, v9
    v_lshl_add_u32 v17, v10, 4, v17
    v_and_b32 v252, 3, v0
    v_lshrrev_b32 v253, 2, v0
    v_lshlrev_b32_e64 v254, 1, v253
    v_mul_u32_u24 v255, 5376, v253
    v_lshl_add_u32 v255, v252, 4, v255
    s_lshr_b32 s6, s5, 1
    s_and_b32 s7, s5, 1
    s_lshl_b32 s53, s5, 12
    s_lshl_b32 s36, s4, 6
    s_lshl_b32 s37, s5, 4
    s_add_u32 s36, s36, s37
    s_mul_i32 s36, s36, 896
    s_mul_i32 s39, s5, 14336
    s_add_u32 s39, s39, 98304
    s_lshl_b32 s55, s3, 10
    s_mul_i32 s54, s3, 28
    s_add_u32 s54, s54, s4
    s_cmp_lt_u32 s4, 28
    s_cselect_b32 s54, s54, 0xffff
    s_lshl_b32 s46, s54, 6
    s_waitcnt lgkmcnt(0)
    s_mov_b32 s72, s44
    s_mov_b32 s73, s45
    s_mov_b32 s74, 256
    s_mov_b32 s75, 0x00020000
    s_mov_b32 s8, s56
    s_mov_b32 s9, s57
    s_mov_b32 s10, 1835008
    s_mov_b32 s11, 0x00020000
    s_cmp_lt_u32 s54, 28
    s_cbranch_scc1 L_fr_issue
    buffer_load_dwordx4 v[40:43], v17, s[8:11], s36 offen offset:0
    buffer_load_dwordx4 v[44:47], v17, s[8:11], s36 offen offset:64
    buffer_load_dwordx4 v[48:51], v17, s[8:11], s36 offen offset:128
    buffer_load_dwordx4 v[52:55], v17, s[8:11], s36 offen offset:192
    buffer_load_dwordx4 v[56:59], v17, s[8:11], s36 offen offset:256
    buffer_load_dwordx4 v[60:63], v17, s[8:11], s36 offen offset:320
    buffer_load_dwordx4 v[64:67], v17, s[8:11], s36 offen offset:384
    buffer_load_dwordx4 v[68:71], v17, s[8:11], s36 offen offset:448
    buffer_load_dwordx4 v[72:75], v17, s[8:11], s36 offen offset:512
    buffer_load_dwordx4 v[76:79], v17, s[8:11], s36 offen offset:576
    buffer_load_dwordx4 v[80:83], v17, s[8:11], s36 offen offset:640
    buffer_load_dwordx4 v[84:87], v17, s[8:11], s36 offen offset:704
    buffer_load_dwordx4 v[88:91], v17, s[8:11], s36 offen offset:768
    buffer_load_dwordx4 v[92:95], v17, s[8:11], s36 offen offset:832
    s_cmp_ge_u32 s54, 84
    s_cbranch_scc1 L_fr_issued
L_fr_issue:
    s_mov_b32 s24, s40
    s_mov_b32 s25, s41
    s_mov_b32 s26, 896
    s_mov_b32 s27, 0x00020000
    s_mov_b32 s32, s42
    s_mov_b32 s33, s43
    s_mov_b32 s34, 2408448
    s_mov_b32 s35, 0x00020000
    buffer_load_ushort v208, v254, s[24:27], 0 offen offset:0
    buffer_load_ushort v209, v254, s[24:27], 0 offen offset:128
    buffer_load_ushort v210, v254, s[24:27], 0 offen offset:256
    buffer_load_ushort v211, v254, s[24:27], 0 offen offset:384
    buffer_load_ushort v212, v254, s[24:27], 0 offen offset:512
    buffer_load_ushort v213, v254, s[24:27], 0 offen offset:640
    buffer_load_ushort v214, v254, s[24:27], 0 offen offset:768
    s_add_u32 s47, s46, 0
    buffer_load_dwordx4 v[216:219], v255, s[32:35], s47 offen
    s_add_u32 s47, s46, 344064
    buffer_load_dwordx4 v[220:223], v255, s[32:35], s47 offen
    s_add_u32 s47, s46, 688128
    buffer_load_dwordx4 v[224:227], v255, s[32:35], s47 offen
    s_add_u32 s47, s46, 1032192
    buffer_load_dwordx4 v[228:231], v255, s[32:35], s47 offen
    s_add_u32 s47, s46, 1376256
    buffer_load_dwordx4 v[232:235], v255, s[32:35], s47 offen
    s_add_u32 s47, s46, 1720320
    buffer_load_dwordx4 v[236:239], v255, s[32:35], s47 offen
    s_add_u32 s47, s46, 2064384
    buffer_load_dwordx4 v[240:243], v255, s[32:35], s47 offen
    s_or_b32 s47, s2, s5
    s_cmp_lg_u32 s47, 0
    s_cbranch_scc1 L_fr_issued
    s_or_b32 s48, s48, 1
    v_mov_b32 v32, s48
    v_mov_b32 v33, 0
    s_mov_b64 exec, 1
    buffer_atomic_cmpswap v[32:33], v26, s[72:75], 0 offen sc1
    s_mov_b64 exec, -1
L_fr_issued:
    v_mov_b32 v31, v17
    s_mov_b32 s50, s36
    v_mov_b32 v19, 0x7fffffff
    v_cmp_gt_u32 vcc, 64, v0
    s_nop 1
    v_cndmask_b32 v38, v19, v24, vcc
    s_mov_b32 s20, s62
    s_mov_b32 s21, s63
    s_mov_b32 s22, 3670016
    s_mov_b32 s23, 0x00020000
    v_lshrrev_b32 v18, 4, v0
    v_lshlrev_b32_e64 v18, 13, v18
    v_lshl_add_u32 v18, v9, 6, v18
    v_cmp_gt_u32 vcc, 224, v0
    s_nop 1
    v_cndmask_b32 v39, v19, v18, vcc
    v_cmp_gt_u32 vcc, 128, v0
    s_nop 1
    v_cndmask_b32 v25, v19, v24, vcc
    s_lshl_b32 s36, s3, 20
    s_add_u32 s12, s58, s36
    s_addc_u32 s13, s59, 0
    s_mov_b32 s14, 1048576
    s_mov_b32 s15, 0x00020000
    s_add_u32 s16, s60, s36
    s_addc_u32 s17, s61, 0
    s_mov_b32 s18, 1048576
    s_mov_b32 s19, 0x00020000
    v_lshrrev_b32 v18, 3, v8
    v_and_b32 v19, 7, v8
    v_and_b32 v20, 6, v18
    v_xor_b32 v20, v20, v19
    v_lshrrev_b32 v21, 2, v18
    v_lshlrev_b32 v21, 3, v21
    v_and_b32 v22, 3, v18
    v_add_u32 v21, v21, v22
    v_lshlrev_b32 v21, 13, v21
    v_lshl_add_u32 v11, v20, 4, v21
    s_lshl_b32 s37, s5, 8
    v_add_u32 v11, s37, v11
    v_lshlrev_b32 v21, 9, v18
    v_add_u32 v21, s53, v21
    v_lshl_add_u32 v7, v20, 4, v21
    v_lshrrev_b32 v22, 1, v18
    s_lshl_b32 s37, s7, 2
    v_or_b32 v22, s37, v22
    v_xor_b32 v22, v22, v19
    v_lshl_add_u32 v6, v22, 4, v21
    v_and_b32 v17, 1, v10
    v_lshlrev_b32 v17, 2, v17
    v_lshrrev_b32 v18, 2, v9
    v_add_u32 v17, v17, v18
    v_lshrrev_b32 v18, 1, v17
    v_and_b32 v19, 3, v9
    v_lshlrev_b32_e64 v19, 3, v19
    v_lshl_add_u32 v19, v17, 7, v19
    v_lshrrev_b32 v20, 1, v10
    s_lshl_b32 s36, s7, 14
    s_add_u32 s37, s36, 65536
    v_xor_b32_e64 v21, 0, v18
    v_lshl_add_u32 v21, v21, 5, v19
    v_lshl_add_u32 v12, v20, 11, v21
    v_add_u32_e64 v12, s53, v12
    v_lshl_add_u32 v2, v20, 12, v21
    v_add_u32 v2, s37, v2
    v_xor_b32 v21, 1, v18
    v_lshl_add_u32 v21, v21, 5, v19
    v_lshl_add_u32 v13, v20, 11, v21
    v_add_u32_e64 v13, s53, v13
    v_lshl_add_u32 v3, v20, 12, v21
    v_add_u32 v3, s37, v3
    v_xor_b32 v21, 2, v18
    v_lshl_add_u32 v21, v21, 5, v19
    v_lshl_add_u32 v14, v20, 11, v21
    v_add_u32_e64 v14, s53, v14
    v_lshl_add_u32 v4, v20, 12, v21
    v_add_u32 v4, s37, v4
    v_xor_b32 v21, 3, v18
    v_lshl_add_u32 v21, v21, 5, v19
    v_lshl_add_u32 v15, v20, 11, v21
    v_add_u32_e64 v15, s53, v15
    v_lshl_add_u32 v5, v20, 12, v21
    v_add_u32 v5, s37, v5
    v_lshrrev_b32 v17, 3, v9
    v_and_b32 v18, 7, v9
    v_lshrrev_b32 v19, 1, v18
    v_lshl_or_b32 v19, v17, 2, v19
    v_xor_b32 v19, v19, v10
    v_lshlrev_b32 v19, 4, v19
    v_lshl_add_u32 v19, v18, 7, v19
    v_lshl_add_u32 v19, v17, 12, v19
    v_add_u32 v0, s36, v19
    v_xor_b32 v1, 64, v0
    s_mov_b32 s45, 0
    s_mov_b32 s46, 16384
    s_mov_b32 s47, 0
    s_mov_b32 s48, 16384
    s_add_u32 s40, s53, 0
    s_add_u32 s41, s53, 32768
    s_add_u32 s42, s53, 65536
    s_add_u32 s43, s53, 98304
    s_add_u32 s44, s53, 131072
    s_mov_b32 s52, 0x4b800000
    s_mov_b32 s61, 0x3f803f80
    v_lshlrev_b32 v22, 5, v10
    v_add_u32 v22, 155648, v22
    v_add_u32 v23, s39, v16
    v_add_u32 v29, s53, v16
    v_add_u32 v30, 65536, v29
    s_lshl_b32 s36, s3, 5
    s_add_u32 s36, s36, s4
    s_mul_i32 s36, s36, 14336
    s_mul_i32 s37, s7, 7168
    s_add_u32 s36, s36, s37
    s_add_u32 s76, s64, s36
    s_addc_u32 s77, s65, 0
    s_mov_b32 s78, 7168
    s_mov_b32 s79, 0x00020000
    s_mov_b32 s58, 0
    s_mov_b32 s59, 2048
    s_mov_b32 s49, 1024
    s_cmp_ge_u32 s5, 2
    s_cbranch_scc1 L_k2_wm
    s_cmp_eq_u32 s5, 0
    s_cselect_b32 s76, s12, s16
    s_cselect_b32 s77, s13, s17
    s_mov_b32 s78, 1048576
    s_lshl_b32 s58, s4, 10
    s_add_u32 s58, s58, 262144
    s_mov_b32 s59, 65536
    s_mov_b32 s49, 32768
L_k2_wm:
    v_mul_lo_u32 v24, v10, s49
    v_lshl_add_u32 v24, v9, 6, v24
    v_cmp_gt_u32 vcc, 32, v8
    v_mov_b32 v17, 0x7fffffff
    s_nop 0
    v_cndmask_b32 v24, v17, v24, vcc
    s_mov_b32 s28, s66
    s_mov_b32 s29, s67
    s_mov_b32 s30, 65536
    s_mov_b32 s31, 0x00020000
    s_cmp_ge_u32 s54, 28
    s_cbranch_scc1 L_fr_sigd
    s_waitcnt vmcnt(7)
    v_lshlrev_b32_e64 v208, 16, v208
    v_mul_f32 v254, 0xbfb8aa3b, v208
    v_exp_f32 v254, v254
    s_nop 0
    v_add_f32 v254, 1.0, v254
    v_rcp_f32 v254, v254
    s_nop 0
    v_mul_f32 v254, v254, v208
    v_cvt_pk_bf16_f32 v254, v254, v26
    v_lshlrev_b32 v96, 16, v254
    v_mov_b32 v208, v254
    v_lshlrev_b32_e64 v209, 16, v209
    v_mul_f32 v254, 0xbfb8aa3b, v209
    v_exp_f32 v254, v254
    s_nop 0
    v_add_f32 v254, 1.0, v254
    v_rcp_f32 v254, v254
    s_nop 0
    v_mul_f32 v254, v254, v209
    v_cvt_pk_bf16_f32 v254, v254, v26
    v_lshlrev_b32 v97, 16, v254
    v_mov_b32 v209, v254
    v_lshlrev_b32_e64 v210, 16, v210
    v_mul_f32 v254, 0xbfb8aa3b, v210
    v_exp_f32 v254, v254
    s_nop 0
    v_add_f32 v254, 1.0, v254
    v_rcp_f32 v254, v254
    s_nop 0
    v_mul_f32 v254, v254, v210
    v_cvt_pk_bf16_f32 v254, v254, v26
    v_lshlrev_b32 v98, 16, v254
    v_mov_b32 v210, v254
    v_lshlrev_b32_e64 v211, 16, v211
    v_mul_f32 v254, 0xbfb8aa3b, v211
    v_exp_f32 v254, v254
    s_nop 0
    v_add_f32 v254, 1.0, v254
    v_rcp_f32 v254, v254
    s_nop 0
    v_mul_f32 v254, v254, v211
    v_cvt_pk_bf16_f32 v254, v254, v26
    v_lshlrev_b32 v99, 16, v254
    v_mov_b32 v211, v254
    v_lshlrev_b32_e64 v212, 16, v212
    v_mul_f32 v254, 0xbfb8aa3b, v212
    v_exp_f32 v254, v254
    s_nop 0
    v_add_f32 v254, 1.0, v254
    v_rcp_f32 v254, v254
    s_nop 0
    v_mul_f32 v254, v254, v212
    v_cvt_pk_bf16_f32 v254, v254, v26
    v_lshlrev_b32 v100, 16, v254
    v_mov_b32 v212, v254
    v_lshlrev_b32_e64 v213, 16, v213
    v_mul_f32 v254, 0xbfb8aa3b, v213
    v_exp_f32 v254, v254
    s_nop 0
    v_add_f32 v254, 1.0, v254
    v_rcp_f32 v254, v254
    s_nop 0
    v_mul_f32 v254, v254, v213
    v_cvt_pk_bf16_f32 v254, v254, v26
    v_lshlrev_b32 v101, 16, v254
    v_mov_b32 v213, v254
    v_lshlrev_b32_e64 v214, 16, v214
    v_mul_f32 v254, 0xbfb8aa3b, v214
    v_exp_f32 v254, v254
    s_nop 0
    v_add_f32 v254, 1.0, v254
    v_rcp_f32 v254, v254
    s_nop 0
    v_mul_f32 v254, v254, v214
    v_cvt_pk_bf16_f32 v254, v254, v26
    v_lshlrev_b32 v102, 16, v254
    v_mov_b32 v214, v254
    v_mov_b32 v244, 0
    v_mov_b32 v245, 0
    v_mov_b32 v246, 0
    v_mov_b32 v247, 0
    v_mov_b32 v248, 0
    v_mov_b32 v249, 0
    v_mov_b32 v250, 0
    v_mov_b32 v251, 0
    v_mul_u32_u24 v254, 144, v253
    v_lshl_add_u32 v254, v252, 5, v254
    v_add_u32 v254, 98304, v254
    v_and_b32 v252, 31, v28
    v_lshrrev_b32 v253, 5, v28
    v_mul_u32_u24 v255, 1152, v253
    v_lshl_add_u32 v255, v252, 2, v255
    v_add_u32 v255, 98304, v255
    s_cmp_eq_u32 s5, 0
    s_cselect_b32 s36, 0, 0x1000
    s_waitcnt vmcnt(6)
    buffer_load_dword v27, v26, s[72:75], s36 offen sc0 sc1
    v_dot2c_f32_bf16 v244, v216, v208
    v_dot2c_f32_bf16 v245, v216, v96
    v_dot2c_f32_bf16 v246, v217, v208
    v_dot2c_f32_bf16 v247, v217, v96
    v_dot2c_f32_bf16 v248, v218, v208
    v_dot2c_f32_bf16 v249, v218, v96
    v_dot2c_f32_bf16 v250, v219, v208
    v_dot2c_f32_bf16 v251, v219, v96
    s_waitcnt vmcnt(6)
    v_dot2c_f32_bf16 v244, v220, v209
    v_dot2c_f32_bf16 v245, v220, v97
    v_dot2c_f32_bf16 v246, v221, v209
    v_dot2c_f32_bf16 v247, v221, v97
    v_dot2c_f32_bf16 v248, v222, v209
    v_dot2c_f32_bf16 v249, v222, v97
    v_dot2c_f32_bf16 v250, v223, v209
    v_dot2c_f32_bf16 v251, v223, v97
    s_waitcnt vmcnt(5)
    v_dot2c_f32_bf16 v244, v224, v210
    v_dot2c_f32_bf16 v245, v224, v98
    v_dot2c_f32_bf16 v246, v225, v210
    v_dot2c_f32_bf16 v247, v225, v98
    v_dot2c_f32_bf16 v248, v226, v210
    v_dot2c_f32_bf16 v249, v226, v98
    v_dot2c_f32_bf16 v250, v227, v210
    v_dot2c_f32_bf16 v251, v227, v98
    s_waitcnt vmcnt(4)
    v_dot2c_f32_bf16 v244, v228, v211
    v_dot2c_f32_bf16 v245, v228, v99
    v_dot2c_f32_bf16 v246, v229, v211
    v_dot2c_f32_bf16 v247, v229, v99
    v_dot2c_f32_bf16 v248, v230, v211
    v_dot2c_f32_bf16 v249, v230, v99
    v_dot2c_f32_bf16 v250, v231, v211
    v_dot2c_f32_bf16 v251, v231, v99
    s_waitcnt vmcnt(3)
    v_dot2c_f32_bf16 v244, v232, v212
    v_dot2c_f32_bf16 v245, v232, v100
    v_dot2c_f32_bf16 v246, v233, v212
    v_dot2c_f32_bf16 v247, v233, v100
    v_dot2c_f32_bf16 v248, v234, v212
    v_dot2c_f32_bf16 v249, v234, v100
    v_dot2c_f32_bf16 v250, v235, v212
    v_dot2c_f32_bf16 v251, v235, v100
    s_waitcnt vmcnt(2)
    v_dot2c_f32_bf16 v244, v236, v213
    v_dot2c_f32_bf16 v245, v236, v101
    v_dot2c_f32_bf16 v246, v237, v213
    v_dot2c_f32_bf16 v247, v237, v101
    v_dot2c_f32_bf16 v248, v238, v213
    v_dot2c_f32_bf16 v249, v238, v101
    v_dot2c_f32_bf16 v250, v239, v213
    v_dot2c_f32_bf16 v251, v239, v101
    s_waitcnt vmcnt(1)
    v_dot2c_f32_bf16 v244, v240, v214
    v_dot2c_f32_bf16 v245, v240, v102
    v_dot2c_f32_bf16 v246, v241, v214
    v_dot2c_f32_bf16 v247, v241, v102
    v_dot2c_f32_bf16 v248, v242, v214
    v_dot2c_f32_bf16 v249, v242, v102
    v_dot2c_f32_bf16 v250, v243, v214
    v_dot2c_f32_bf16 v251, v243, v102
    ds_write_b128 v254, v[244:247]
    s_nop 1
    ds_write_b128 v254, v[248:251] offset:16
    v_lshlrev_b32 v254, 2, v28
    v_add_u32 v254, 98304, v254
    s_waitcnt lgkmcnt(0)
    s_barrier
    ds_read_b32 v216, v255 offset:0
    ds_read_b32 v217, v255 offset:144
    ds_read_b32 v218, v255 offset:288
    ds_read_b32 v219, v255 offset:432
    ds_read_b32 v220, v255 offset:576
    ds_read_b32 v221, v255 offset:720
    ds_read_b32 v222, v255 offset:864
    ds_read_b32 v223, v255 offset:1008
    s_waitcnt lgkmcnt(6)
    v_add_f32 v216, v216, v217
    s_waitcnt lgkmcnt(5)
    v_add_f32 v216, v216, v218
    s_waitcnt lgkmcnt(4)
    v_add_f32 v216, v216, v219
    s_waitcnt lgkmcnt(3)
    v_add_f32 v216, v216, v220
    s_waitcnt lgkmcnt(2)
    v_add_f32 v216, v216, v221
    s_waitcnt lgkmcnt(1)
    v_add_f32 v216, v216, v222
    s_waitcnt lgkmcnt(0)
    v_add_f32 v216, v216, v223
    ds_write_b32 v254, v216 offset:9216
    v_lshlrev_b32_e64 v252, 2, v252
    v_add_u32 v253, 98304, v252
    s_waitcnt lgkmcnt(0)
    s_barrier
    s_cmp_lg_u32 s5, 0
    s_cbranch_scc1 L_fr_pxe
    ds_read_b32 v224, v253 offset:9216
    ds_read_b32 v225, v253 offset:9344
    ds_read_b32 v226, v253 offset:9472
    ds_read_b32 v227, v253 offset:9600
    ds_read_b32 v228, v253 offset:9728
    ds_read_b32 v229, v253 offset:9856
    ds_read_b32 v230, v253 offset:9984
    ds_read_b32 v231, v253 offset:10112
    s_waitcnt lgkmcnt(6)
    v_add_f32 v224, v224, v225
    s_waitcnt lgkmcnt(5)
    v_add_f32 v224, v224, v226
    s_waitcnt lgkmcnt(4)
    v_add_f32 v224, v224, v227
    s_waitcnt lgkmcnt(3)
    v_add_f32 v224, v224, v228
    s_waitcnt lgkmcnt(2)
    v_add_f32 v224, v224, v229
    s_waitcnt lgkmcnt(1)
    v_add_f32 v224, v224, v230
    s_waitcnt lgkmcnt(0)
    v_add_f32 v224, v224, v231
    v_cvt_pk_bf16_f32 v224, v224, v224
    v_lshlrev_b32 v224, 16, v224
    v_add_f32 v225, 1.0, v224
    v_cvt_pk_bf16_f32 v225, v225, v225
    v_lshlrev_b32 v225, 16, v225
    s_sub_u32 s36, s54, 14
    s_cmp_lt_u32 s36, 14
    s_cselect_b64 vcc, -1, 0
    v_cndmask_b32 v224, v224, v225, vcc
    v_mul_f32 v226, 0x3db8aa3b, v224
    v_lshlrev_b32 v253, 1, v252
    s_waitcnt vmcnt(0)
    v_readfirstlane_b32 s60, v27
    s_cmp_lg_u32 s60, 0
    s_cbranch_scc1 L_fr_non
    s_mov_b32 s37, 65536
L_fr_non_l:
    buffer_load_dword v27, v26, s[72:75], 0 offen sc0 sc1
    s_waitcnt vmcnt(0)
    v_readfirstlane_b32 s60, v27
    s_cmp_lg_u32 s60, 0
    s_cbranch_scc1 L_fr_non
    s_sleep 2
    s_sub_u32 s37, s37, 1
    s_cmp_lg_u32 s37, 0
    s_cbranch_scc1 L_fr_non_l
L_fr_non:
    v_mov_b32 v227, s60
    s_lshl_b32 s36, s54, 8
    s_add_u32 s36, s36, 16384
    s_mov_b32 exec_hi, 0
    buffer_store_dwordx2 v[226:227], v253, s[28:31], s36 offen sc0 sc1
    s_mov_b64 exec, -1
L_fr_pxe:
    buffer_load_dwordx4 v[40:43], v31, s[8:11], s50 offen offset:0
    buffer_load_dwordx4 v[44:47], v31, s[8:11], s50 offen offset:64
    buffer_load_dwordx4 v[48:51], v31, s[8:11], s50 offen offset:128
    buffer_load_dwordx4 v[52:55], v31, s[8:11], s50 offen offset:192
    buffer_load_dwordx4 v[56:59], v31, s[8:11], s50 offen offset:256
    buffer_load_dwordx4 v[60:63], v31, s[8:11], s50 offen offset:320
    buffer_load_dwordx4 v[64:67], v31, s[8:11], s50 offen offset:384
    buffer_load_dwordx4 v[68:71], v31, s[8:11], s50 offen offset:448
    buffer_load_dwordx4 v[72:75], v31, s[8:11], s50 offen offset:512
    buffer_load_dwordx4 v[76:79], v31, s[8:11], s50 offen offset:576
    buffer_load_dwordx4 v[80:83], v31, s[8:11], s50 offen offset:640
    buffer_load_dwordx4 v[84:87], v31, s[8:11], s50 offen offset:704
    buffer_load_dwordx4 v[88:91], v31, s[8:11], s50 offen offset:768
    buffer_load_dwordx4 v[92:95], v31, s[8:11], s50 offen offset:832
L_fr_sigd:
    s_getpc_b64 s[24:25]
L_fr_pc:
    s_sub_u32 s24, s24, L_fr_pc-L_code_begin
    s_subb_u32 s25, s25, 0
    s_mov_b32 s26, L_code_end-L_code_begin
    s_mov_b32 s27, 0x00020000
    s_lshl_b32 s37, s4, 12
    buffer_load_dword a254, v38, s[24:27], s37 offen
    s_mul_i32 s36, s4, 114688
    s_add_u32 s36, s36, s55
    buffer_load_dword a255, v39, s[20:23], s36 offen
    s_cmp_eq_u32 s5, 0
    s_cselect_b32 s36, 0, 0x1000
    buffer_load_dword v27, v26, s[72:75], s36 offen sc0 sc1
    s_mov_b32 s24, s64
    s_mov_b32 s25, s65
    s_mov_b32 s26, 3670016
    s_mov_b32 s27, 0x00020000
    s_add_u32 s32, s66, 6422528
    s_addc_u32 s33, s67, 0
    s_mov_b32 s34, 14680064
    s_mov_b32 s35, 0x00020000
    s_waitcnt vmcnt(15)
    v_lshlrev_b32 v96, 16, v40
    v_and_b32 v97, 0xffff0000, v40
    v_lshlrev_b32_e64 v98, 16, v41
    v_and_b32 v99, 0xffff0000, v41
    v_pk_add_f32 v[32:33], v[96:97], v[98:99]
    v_lshlrev_b32_e64 v100, 16, v42
    v_and_b32 v101, 0xffff0000, v42
    v_lshlrev_b32_e64 v102, 16, v43
    v_and_b32 v103, 0xffff0000, v43
    v_pk_add_f32 v[34:35], v[100:101], v[102:103]
    s_waitcnt vmcnt(14)
    v_lshlrev_b32 v104, 16, v44
    v_and_b32 v105, 0xffff0000, v44
    v_lshlrev_b32_e64 v106, 16, v45
    v_and_b32 v107, 0xffff0000, v45
    v_pk_add_f32 v[36:37], v[104:105], v[106:107]
    v_lshlrev_b32_e64 v108, 16, v46
    v_and_b32 v109, 0xffff0000, v46
    v_lshlrev_b32_e64 v110, 16, v47
    v_and_b32 v111, 0xffff0000, v47
    v_pk_add_f32 v[38:39], v[108:109], v[110:111]
    s_add_u32 m0, s53, 32768
    s_add_u32 s38, s55, 0
    buffer_load_dwordx4 v11, s[20:23], s38 offen offset:0 lds
    s_waitcnt vmcnt(14)
    v_lshlrev_b32_e64 v112, 16, v48
    v_and_b32 v113, 0xffff0000, v48
    v_lshlrev_b32_e64 v114, 16, v49
    v_and_b32 v115, 0xffff0000, v49
    v_pk_add_f32 v[32:33], v[32:33], v[112:113]
    v_pk_add_f32 v[36:37], v[36:37], v[114:115]
    v_lshlrev_b32_e64 v116, 16, v50
    v_and_b32 v117, 0xffff0000, v50
    v_lshlrev_b32_e64 v118, 16, v51
    v_and_b32 v119, 0xffff0000, v51
    v_pk_add_f32 v[34:35], v[34:35], v[116:117]
    v_pk_add_f32 v[38:39], v[38:39], v[118:119]
    s_waitcnt vmcnt(13)
    v_lshlrev_b32 v120, 16, v52
    v_and_b32 v121, 0xffff0000, v52
    v_lshlrev_b32_e64 v122, 16, v53
    v_and_b32 v123, 0xffff0000, v53
    s_add_u32 m0, s53, 33664
    s_nop 0
    buffer_load_dwordx4 v11, s[20:23], s38 offen offset:128 lds
    v_pk_add_f32 v[36:37], v[36:37], v[120:121]
    v_pk_add_f32 v[32:33], v[32:33], v[122:123]
    v_lshlrev_b32 v124, 16, v54
    v_and_b32 v125, 0xffff0000, v54
    v_lshlrev_b32_e64 v126, 16, v55
    v_and_b32 v127, 0xffff0000, v55
    v_pk_add_f32 v[38:39], v[38:39], v[124:125]
    v_pk_add_f32 v[34:35], v[34:35], v[126:127]
    s_waitcnt vmcnt(13)
    v_lshlrev_b32 v128, 16, v56
    v_and_b32 v129, 0xffff0000, v56
    v_lshlrev_b32_e64 v130, 16, v57
    v_and_b32 v131, 0xffff0000, v57
    v_pk_add_f32 v[32:33], v[32:33], v[128:129]
    v_pk_add_f32 v[36:37], v[36:37], v[130:131]
    v_lshlrev_b32_e64 v132, 16, v58
    v_and_b32 v133, 0xffff0000, v58
    s_add_u32 m0, s53, 34816
    s_add_u32 s38, s55, 131072
    buffer_load_dwordx4 v11, s[20:23], s38 offen offset:0 lds
    v_lshlrev_b32_e64 v134, 16, v59
    v_and_b32 v135, 0xffff0000, v59
    v_pk_add_f32 v[34:35], v[34:35], v[132:133]
    v_pk_add_f32 v[38:39], v[38:39], v[134:135]
    s_waitcnt vmcnt(13)
    v_lshlrev_b32 v136, 16, v60
    v_and_b32 v137, 0xffff0000, v60
    v_lshlrev_b32_e64 v138, 16, v61
    v_and_b32 v139, 0xffff0000, v61
    v_pk_add_f32 v[36:37], v[36:37], v[136:137]
    v_pk_add_f32 v[32:33], v[32:33], v[138:139]
    v_lshlrev_b32_e64 v140, 16, v62
    v_and_b32 v141, 0xffff0000, v62
    v_lshlrev_b32_e64 v142, 16, v63
    v_and_b32 v143, 0xffff0000, v63
    v_pk_add_f32 v[38:39], v[38:39], v[140:141]
    v_pk_add_f32 v[34:35], v[34:35], v[142:143]
    s_add_u32 m0, s53, 35712
    s_nop 0
    buffer_load_dwordx4 v11, s[20:23], s38 offen offset:128 lds
    s_waitcnt vmcnt(13)
    v_lshlrev_b32_e64 v144, 16, v64
    v_and_b32 v145, 0xffff0000, v64
    v_lshlrev_b32_e64 v146, 16, v65
    v_and_b32 v147, 0xffff0000, v65
    v_pk_add_f32 v[32:33], v[32:33], v[144:145]
    v_pk_add_f32 v[36:37], v[36:37], v[146:147]
    v_lshlrev_b32_e64 v148, 16, v66
    v_and_b32 v149, 0xffff0000, v66
    v_lshlrev_b32_e64 v150, 16, v67
    v_and_b32 v151, 0xffff0000, v67
    v_pk_add_f32 v[34:35], v[34:35], v[148:149]
    v_pk_add_f32 v[38:39], v[38:39], v[150:151]
    s_waitcnt vmcnt(12)
    v_lshlrev_b32 v152, 16, v68
    v_and_b32 v153, 0xffff0000, v68
    v_lshlrev_b32_e64 v154, 16, v69
    v_and_b32 v155, 0xffff0000, v69
    s_add_u32 m0, s53, 49152
    s_add_u32 s38, s55, 32768
    buffer_load_dwordx4 v11, s[20:23], s38 offen offset:0 lds
    v_pk_add_f32 v[36:37], v[36:37], v[152:153]
    v_pk_add_f32 v[32:33], v[32:33], v[154:155]
    v_lshlrev_b32_e64 v156, 16, v70
    v_and_b32 v157, 0xffff0000, v70
    v_lshlrev_b32_e64 v158, 16, v71
    v_and_b32 v159, 0xffff0000, v71
    v_pk_add_f32 v[38:39], v[38:39], v[156:157]
    v_pk_add_f32 v[34:35], v[34:35], v[158:159]
    s_waitcnt vmcnt(12)
    v_lshlrev_b32 v160, 16, v72
    v_and_b32 v161, 0xffff0000, v72
    v_lshlrev_b32_e64 v162, 16, v73
    v_and_b32 v163, 0xffff0000, v73
    v_pk_add_f32 v[32:33], v[32:33], v[160:161]
    v_pk_add_f32 v[36:37], v[36:37], v[162:163]
    v_lshlrev_b32_e64 v164, 16, v74
    v_and_b32 v165, 0xffff0000, v74
    s_add_u32 m0, s53, 50048
    s_nop 0
    buffer_load_dwordx4 v11, s[20:23], s38 offen offset:128 lds
    v_lshlrev_b32 v166, 16, v75
    v_and_b32 v167, 0xffff0000, v75
    v_pk_add_f32 v[34:35], v[34:35], v[164:165]
    v_pk_add_f32 v[38:39], v[38:39], v[166:167]
    s_waitcnt vmcnt(12)
    v_lshlrev_b32 v168, 16, v76
    v_and_b32 v169, 0xffff0000, v76
    v_lshlrev_b32_e64 v170, 16, v77
    v_and_b32 v171, 0xffff0000, v77
    v_pk_add_f32 v[36:37], v[36:37], v[168:169]
    v_pk_add_f32 v[32:33], v[32:33], v[170:171]
    v_lshlrev_b32_e64 v172, 16, v78
    v_and_b32 v173, 0xffff0000, v78
    v_lshlrev_b32_e64 v174, 16, v79
    v_and_b32 v175, 0xffff0000, v79
    v_pk_add_f32 v[38:39], v[38:39], v[172:173]
    v_pk_add_f32 v[34:35], v[34:35], v[174:175]
    s_add_u32 m0, s53, 51200
    s_add_u32 s38, s55, 163840
    buffer_load_dwordx4 v11, s[20:23], s38 offen offset:0 lds
    s_waitcnt vmcnt(12)
    v_lshlrev_b32 v176, 16, v80
    v_and_b32 v177, 0xffff0000, v80
    v_lshlrev_b32_e64 v178, 16, v81
    v_and_b32 v179, 0xffff0000, v81
    v_pk_add_f32 v[32:33], v[32:33], v[176:177]
    v_pk_add_f32 v[36:37], v[36:37], v[178:179]
    v_lshlrev_b32_e64 v180, 16, v82
    v_and_b32 v181, 0xffff0000, v82
    v_lshlrev_b32_e64 v182, 16, v83
    v_and_b32 v183, 0xffff0000, v83
    v_pk_add_f32 v[34:35], v[34:35], v[180:181]
    v_pk_add_f32 v[38:39], v[38:39], v[182:183]
    s_waitcnt vmcnt(11)
    v_lshlrev_b32 v184, 16, v84
    v_and_b32 v185, 0xffff0000, v84
    v_lshlrev_b32_e64 v186, 16, v85
    v_and_b32 v187, 0xffff0000, v85
    s_add_u32 m0, s53, 52096
    s_nop 0
    buffer_load_dwordx4 v11, s[20:23], s38 offen offset:128 lds
    v_pk_add_f32 v[36:37], v[36:37], v[184:185]
    v_pk_add_f32 v[32:33], v[32:33], v[186:187]
    v_lshlrev_b32 v188, 16, v86
    v_and_b32 v189, 0xffff0000, v86
    v_lshlrev_b32_e64 v190, 16, v87
    v_and_b32 v191, 0xffff0000, v87
    v_pk_add_f32 v[38:39], v[38:39], v[188:189]
    v_pk_add_f32 v[34:35], v[34:35], v[190:191]
    s_waitcnt vmcnt(11)
    v_lshlrev_b32 v192, 16, v88
    v_and_b32 v193, 0xffff0000, v88
    v_lshlrev_b32_e64 v194, 16, v89
    v_and_b32 v195, 0xffff0000, v89
    v_pk_add_f32 v[32:33], v[32:33], v[192:193]
    v_pk_add_f32 v[36:37], v[36:37], v[194:195]
    v_lshlrev_b32_e64 v196, 16, v90
    v_and_b32 v197, 0xffff0000, v90
    s_add_u32 m0, s53, 65536
    s_add_u32 s38, s55, 262144
    buffer_load_dwordx4 v11, s[20:23], s38 offen offset:0 lds
    v_lshlrev_b32_e64 v198, 16, v91
    v_and_b32 v199, 0xffff0000, v91
    v_pk_add_f32 v[34:35], v[34:35], v[196:197]
    v_pk_add_f32 v[38:39], v[38:39], v[198:199]
    s_waitcnt vmcnt(11)
    v_lshlrev_b32 v200, 16, v92
    v_and_b32 v201, 0xffff0000, v92
    v_lshlrev_b32_e64 v202, 16, v93
    v_and_b32 v203, 0xffff0000, v93
    v_pk_add_f32 v[36:37], v[36:37], v[200:201]
    v_pk_add_f32 v[32:33], v[32:33], v[202:203]
    v_lshlrev_b32_e64 v204, 16, v94
    v_and_b32 v205, 0xffff0000, v94
    v_lshlrev_b32_e64 v206, 16, v95
    v_and_b32 v207, 0xffff0000, v95
    v_pk_add_f32 v[38:39], v[38:39], v[204:205]
    v_pk_add_f32 v[34:35], v[34:35], v[206:207]
    s_add_u32 m0, s53, 66432
    s_nop 0
    buffer_load_dwordx4 v11, s[20:23], s38 offen offset:128 lds
    v_pk_add_f32 v[32:33], v[32:33], v[34:35]
    v_pk_add_f32 v[36:37], v[36:37], v[38:39]
    v_pk_add_f32 v[32:33], v[32:33], v[36:37]
    v_add_f32 v32, v32, v33
    v_mov_b32 v33, v32
    s_nop 1
    v_permlane16_swap_b32 v32, v33
    v_add_f32 v32, v32, v33
    v_mov_b32 v33, v32
    s_nop 1
    v_permlane32_swap_b32 v32, v33
    v_add_f32 v32, v32, v33
    v_mul_f32 v32, 0xbb124925, v32
    v_mov_b32_e64 v33, v32
    v_pk_add_f32 v[96:97], v[96:97], v[32:33]
    v_pk_add_f32 v[98:99], v[98:99], v[32:33]
    v_pk_mul_f32 v[40:41], v[96:97], v[96:97]
    v_pk_add_f32 v[100:101], v[100:101], v[32:33]
    s_add_u32 m0, s53, 67584
    s_add_u32 s38, s55, 393216
    buffer_load_dwordx4 v11, s[20:23], s38 offen offset:0 lds
    v_pk_mul_f32 v[42:43], v[98:99], v[98:99]
    v_pk_add_f32 v[102:103], v[102:103], v[32:33]
    v_pk_mul_f32 v[44:45], v[100:101], v[100:101]
    v_pk_add_f32 v[104:105], v[104:105], v[32:33]
    v_pk_mul_f32 v[46:47], v[102:103], v[102:103]
    v_pk_add_f32 v[106:107], v[106:107], v[32:33]
    v_pk_fma_f32 v[40:41], v[104:105], v[104:105], v[40:41]
    v_pk_add_f32 v[108:109], v[108:109], v[32:33]
    v_pk_fma_f32 v[42:43], v[106:107], v[106:107], v[42:43]
    v_pk_add_f32 v[110:111], v[110:111], v[32:33]
    v_pk_fma_f32 v[44:45], v[108:109], v[108:109], v[44:45]
    v_pk_add_f32 v[112:113], v[112:113], v[32:33]
    v_pk_fma_f32 v[46:47], v[110:111], v[110:111], v[46:47]
    v_pk_add_f32 v[114:115], v[114:115], v[32:33]
    v_pk_fma_f32 v[40:41], v[112:113], v[112:113], v[40:41]
    v_pk_add_f32 v[116:117], v[116:117], v[32:33]
    s_add_u32 m0, s53, 68480
    s_nop 0
    buffer_load_dwordx4 v11, s[20:23], s38 offen offset:128 lds
    v_pk_fma_f32 v[42:43], v[114:115], v[114:115], v[42:43]
    v_pk_add_f32 v[118:119], v[118:119], v[32:33]
    v_pk_fma_f32 v[44:45], v[116:117], v[116:117], v[44:45]
    v_pk_add_f32 v[120:121], v[120:121], v[32:33]
    v_pk_fma_f32 v[46:47], v[118:119], v[118:119], v[46:47]
    v_pk_add_f32 v[122:123], v[122:123], v[32:33]
    v_pk_fma_f32 v[40:41], v[120:121], v[120:121], v[40:41]
    v_pk_add_f32 v[124:125], v[124:125], v[32:33]
    v_pk_fma_f32 v[42:43], v[122:123], v[122:123], v[42:43]
    v_pk_add_f32 v[126:127], v[126:127], v[32:33]
    v_pk_fma_f32 v[44:45], v[124:125], v[124:125], v[44:45]
    v_pk_add_f32 v[128:129], v[128:129], v[32:33]
    v_pk_fma_f32 v[46:47], v[126:127], v[126:127], v[46:47]
    v_pk_add_f32 v[130:131], v[130:131], v[32:33]
    v_pk_fma_f32 v[40:41], v[128:129], v[128:129], v[40:41]
    v_pk_add_f32 v[132:133], v[132:133], v[32:33]
    s_add_u32 m0, s53, 81920
    s_add_u32 s38, s55, 294912
    buffer_load_dwordx4 v11, s[20:23], s38 offen offset:0 lds
    v_pk_fma_f32 v[42:43], v[130:131], v[130:131], v[42:43]
    v_pk_add_f32 v[134:135], v[134:135], v[32:33]
    v_pk_fma_f32 v[44:45], v[132:133], v[132:133], v[44:45]
    v_pk_add_f32 v[136:137], v[136:137], v[32:33]
    v_pk_fma_f32 v[46:47], v[134:135], v[134:135], v[46:47]
    v_pk_add_f32 v[138:139], v[138:139], v[32:33]
    v_pk_fma_f32 v[40:41], v[136:137], v[136:137], v[40:41]
    v_pk_add_f32 v[140:141], v[140:141], v[32:33]
    v_pk_fma_f32 v[42:43], v[138:139], v[138:139], v[42:43]
    v_pk_add_f32 v[142:143], v[142:143], v[32:33]
    v_pk_fma_f32 v[44:45], v[140:141], v[140:141], v[44:45]
    v_pk_add_f32 v[144:145], v[144:145], v[32:33]
    v_pk_fma_f32 v[46:47], v[142:143], v[142:143], v[46:47]
    v_pk_add_f32 v[146:147], v[146:147], v[32:33]
    v_pk_fma_f32 v[40:41], v[144:145], v[144:145], v[40:41]
    v_pk_add_f32 v[148:149], v[148:149], v[32:33]
    s_add_u32 m0, s53, 82816
    s_nop 0
    buffer_load_dwordx4 v11, s[20:23], s38 offen offset:128 lds
    v_pk_fma_f32 v[42:43], v[146:147], v[146:147], v[42:43]
    v_pk_add_f32 v[150:151], v[150:151], v[32:33]
    v_pk_fma_f32 v[44:45], v[148:149], v[148:149], v[44:45]
    v_pk_add_f32 v[152:153], v[152:153], v[32:33]
    v_pk_fma_f32 v[46:47], v[150:151], v[150:151], v[46:47]
    v_pk_add_f32 v[154:155], v[154:155], v[32:33]
    v_pk_fma_f32 v[40:41], v[152:153], v[152:153], v[40:41]
    v_pk_add_f32 v[156:157], v[156:157], v[32:33]
    v_pk_fma_f32 v[42:43], v[154:155], v[154:155], v[42:43]
    v_pk_add_f32 v[158:159], v[158:159], v[32:33]
    v_pk_fma_f32 v[44:45], v[156:157], v[156:157], v[44:45]
    v_pk_add_f32 v[160:161], v[160:161], v[32:33]
    v_pk_fma_f32 v[46:47], v[158:159], v[158:159], v[46:47]
    v_pk_add_f32 v[162:163], v[162:163], v[32:33]
    v_pk_fma_f32 v[40:41], v[160:161], v[160:161], v[40:41]
    v_pk_add_f32 v[164:165], v[164:165], v[32:33]
    s_add_u32 m0, s53, 83968
    s_add_u32 s38, s55, 425984
    buffer_load_dwordx4 v11, s[20:23], s38 offen offset:0 lds
    v_pk_fma_f32 v[42:43], v[162:163], v[162:163], v[42:43]
    v_pk_add_f32 v[166:167], v[166:167], v[32:33]
    v_pk_fma_f32 v[44:45], v[164:165], v[164:165], v[44:45]
    v_pk_add_f32 v[168:169], v[168:169], v[32:33]
    v_pk_fma_f32 v[46:47], v[166:167], v[166:167], v[46:47]
    v_pk_add_f32 v[170:171], v[170:171], v[32:33]
    v_pk_fma_f32 v[40:41], v[168:169], v[168:169], v[40:41]
    v_pk_add_f32 v[172:173], v[172:173], v[32:33]
    v_pk_fma_f32 v[42:43], v[170:171], v[170:171], v[42:43]
    v_pk_add_f32 v[174:175], v[174:175], v[32:33]
    v_pk_fma_f32 v[44:45], v[172:173], v[172:173], v[44:45]
    v_pk_add_f32 v[176:177], v[176:177], v[32:33]
    v_pk_fma_f32 v[46:47], v[174:175], v[174:175], v[46:47]
    v_pk_add_f32 v[178:179], v[178:179], v[32:33]
    v_pk_fma_f32 v[40:41], v[176:177], v[176:177], v[40:41]
    v_pk_add_f32 v[180:181], v[180:181], v[32:33]
    s_add_u32 m0, s53, 84864
    s_nop 0
    buffer_load_dwordx4 v11, s[20:23], s38 offen offset:128 lds
    v_pk_fma_f32 v[42:43], v[178:179], v[178:179], v[42:43]
    v_pk_add_f32 v[182:183], v[182:183], v[32:33]
    v_pk_fma_f32 v[44:45], v[180:181], v[180:181], v[44:45]
    v_pk_add_f32 v[184:185], v[184:185], v[32:33]
    v_pk_fma_f32 v[46:47], v[182:183], v[182:183], v[46:47]
    v_pk_add_f32 v[186:187], v[186:187], v[32:33]
    v_pk_fma_f32 v[40:41], v[184:185], v[184:185], v[40:41]
    v_pk_add_f32 v[188:189], v[188:189], v[32:33]
    v_pk_fma_f32 v[42:43], v[186:187], v[186:187], v[42:43]
    v_pk_add_f32 v[190:191], v[190:191], v[32:33]
    v_pk_fma_f32 v[44:45], v[188:189], v[188:189], v[44:45]
    v_pk_add_f32 v[192:193], v[192:193], v[32:33]
    v_pk_fma_f32 v[46:47], v[190:191], v[190:191], v[46:47]
    v_pk_add_f32 v[194:195], v[194:195], v[32:33]
    v_pk_fma_f32 v[40:41], v[192:193], v[192:193], v[40:41]
    v_pk_add_f32 v[196:197], v[196:197], v[32:33]
    s_add_u32 m0, s53, 0
    s_add_u32 s38, s55, 524288
    buffer_load_dwordx4 v11, s[20:23], s38 offen offset:0 lds
    v_pk_fma_f32 v[42:43], v[194:195], v[194:195], v[42:43]
    v_pk_add_f32 v[198:199], v[198:199], v[32:33]
    v_pk_fma_f32 v[44:45], v[196:197], v[196:197], v[44:45]
    v_pk_add_f32 v[200:201], v[200:201], v[32:33]
    v_pk_fma_f32 v[46:47], v[198:199], v[198:199], v[46:47]
    v_pk_add_f32 v[202:203], v[202:203], v[32:33]
    v_pk_fma_f32 v[40:41], v[200:201], v[200:201], v[40:41]
    v_pk_add_f32 v[204:205], v[204:205], v[32:33]
    v_pk_fma_f32 v[42:43], v[202:203], v[202:203], v[42:43]
    v_pk_add_f32 v[206:207], v[206:207], v[32:33]
    v_pk_fma_f32 v[44:45], v[204:205], v[204:205], v[44:45]
    v_pk_fma_f32 v[46:47], v[206:207], v[206:207], v[46:47]
    v_pk_add_f32 v[40:41], v[40:41], v[42:43]
    v_pk_add_f32 v[44:45], v[44:45], v[46:47]
    v_pk_add_f32 v[40:41], v[40:41], v[44:45]
    v_add_f32_e64 v32, v40, v41
    s_add_u32 m0, s53, 896
    s_nop 0
    buffer_load_dwordx4 v11, s[20:23], s38 offen offset:128 lds
    v_mov_b32 v33, v32
    s_nop 1
    v_permlane16_swap_b32 v32, v33
    v_add_f32 v32, v32, v33
    v_mov_b32 v33, v32
    s_nop 1
    v_permlane32_swap_b32 v32, v33
    v_add_f32_e64 v32, v32, v33
    v_mov_b32 v34, 0x3727c5ac
    v_fmac_f32 v34, 0x3b124925, v32
    v_rsq_f32 v32, v34
    s_nop 0
    v_mov_b32_e64 v33, v32
    v_pk_mul_f32 v[96:97], v[96:97], v[32:33]
    v_pk_mul_f32 v[98:99], v[98:99], v[32:33]
    v_pk_mul_f32 v[100:101], v[100:101], v[32:33]
    v_pk_mul_f32 v[102:103], v[102:103], v[32:33]
    v_pk_mul_f32 v[104:105], v[104:105], v[32:33]
    v_pk_mul_f32 v[106:107], v[106:107], v[32:33]
    s_add_u32 m0, s53, 2048
    s_add_u32 s38, s55, 655360
    buffer_load_dwordx4 v11, s[20:23], s38 offen offset:0 lds
    v_pk_mul_f32 v[108:109], v[108:109], v[32:33]
    v_pk_mul_f32 v[110:111], v[110:111], v[32:33]
    v_pk_mul_f32 v[112:113], v[112:113], v[32:33]
    v_pk_mul_f32 v[114:115], v[114:115], v[32:33]
    v_pk_mul_f32 v[116:117], v[116:117], v[32:33]
    v_pk_mul_f32 v[118:119], v[118:119], v[32:33]
    v_pk_mul_f32 v[120:121], v[120:121], v[32:33]
    v_pk_mul_f32 v[122:123], v[122:123], v[32:33]
    v_pk_mul_f32 v[124:125], v[124:125], v[32:33]
    v_pk_mul_f32 v[126:127], v[126:127], v[32:33]
    v_pk_mul_f32 v[128:129], v[128:129], v[32:33]
    v_pk_mul_f32 v[130:131], v[130:131], v[32:33]
    v_pk_mul_f32 v[132:133], v[132:133], v[32:33]
    v_pk_mul_f32 v[134:135], v[134:135], v[32:33]
    v_pk_mul_f32 v[136:137], v[136:137], v[32:33]
    v_pk_mul_f32 v[138:139], v[138:139], v[32:33]
    s_add_u32 m0, s53, 2944
    s_nop 0
    buffer_load_dwordx4 v11, s[20:23], s38 offen offset:128 lds
    v_pk_mul_f32 v[140:141], v[140:141], v[32:33]
    v_pk_mul_f32 v[142:143], v[142:143], v[32:33]
    v_pk_mul_f32 v[144:145], v[144:145], v[32:33]
    v_pk_mul_f32 v[146:147], v[146:147], v[32:33]
    v_pk_mul_f32 v[148:149], v[148:149], v[32:33]
    v_pk_mul_f32 v[150:151], v[150:151], v[32:33]
    v_pk_mul_f32 v[152:153], v[152:153], v[32:33]
    v_pk_mul_f32 v[154:155], v[154:155], v[32:33]
    v_pk_mul_f32 v[156:157], v[156:157], v[32:33]
    v_pk_mul_f32 v[158:159], v[158:159], v[32:33]
    v_pk_mul_f32 v[160:161], v[160:161], v[32:33]
    v_pk_mul_f32 v[162:163], v[162:163], v[32:33]
    v_pk_mul_f32 v[164:165], v[164:165], v[32:33]
    v_pk_mul_f32 v[166:167], v[166:167], v[32:33]
    v_pk_mul_f32 v[168:169], v[168:169], v[32:33]
    v_pk_mul_f32 v[170:171], v[170:171], v[32:33]
    s_add_u32 m0, s53, 16384
    s_add_u32 s38, s55, 557056
    buffer_load_dwordx4 v11, s[20:23], s38 offen offset:0 lds
    v_pk_mul_f32 v[172:173], v[172:173], v[32:33]
    v_pk_mul_f32 v[174:175], v[174:175], v[32:33]
    v_pk_mul_f32 v[176:177], v[176:177], v[32:33]
    v_pk_mul_f32 v[178:179], v[178:179], v[32:33]
    v_pk_mul_f32 v[180:181], v[180:181], v[32:33]
    v_pk_mul_f32 v[182:183], v[182:183], v[32:33]
    v_pk_mul_f32 v[184:185], v[184:185], v[32:33]
    v_pk_mul_f32 v[186:187], v[186:187], v[32:33]
    v_pk_mul_f32 v[188:189], v[188:189], v[32:33]
    v_pk_mul_f32 v[190:191], v[190:191], v[32:33]
    v_pk_mul_f32 v[192:193], v[192:193], v[32:33]
    v_pk_mul_f32 v[194:195], v[194:195], v[32:33]
    v_pk_mul_f32 v[196:197], v[196:197], v[32:33]
    v_pk_mul_f32 v[198:199], v[198:199], v[32:33]
    v_pk_mul_f32 v[200:201], v[200:201], v[32:33]
    v_pk_mul_f32 v[202:203], v[202:203], v[32:33]
    s_add_u32 m0, s53, 17280
    s_nop 0
    buffer_load_dwordx4 v11, s[20:23], s38 offen offset:128 lds
    v_pk_mul_f32 v[204:205], v[204:205], v[32:33]
    v_pk_mul_f32 v[206:207], v[206:207], v[32:33]
    s_add_u32 m0, s53, 18432
    s_add_u32 s38, s55, 688128
    buffer_load_dwordx4 v11, s[20:23], s38 offen offset:0 lds
    s_add_u32 m0, s53, 19328
    s_nop 0
    buffer_load_dwordx4 v11, s[20:23], s38 offen offset:128 lds
    s_sub_u32 s36, s54, 28
    s_cmp_ge_u32 s36, 56
    s_cbranch_scc1 L_fr_pxl
    s_waitcnt vmcnt(27)
    v_lshlrev_b32 v208, 16, v208
    v_mul_f32 v254, 0xbfb8aa3b, v208
    v_exp_f32 v254, v254
    s_nop 0
    v_add_f32 v254, 1.0, v254
    v_rcp_f32 v254, v254
    s_nop 0
    v_mul_f32 v254, v254, v208
    v_cvt_pk_bf16_f32 v254, v254, v26
    v_lshlrev_b32 v48, 16, v254
    v_mov_b32 v208, v254
    v_lshlrev_b32_e64 v209, 16, v209
    v_mul_f32 v254, 0xbfb8aa3b, v209
    v_exp_f32 v254, v254
    s_nop 0
    v_add_f32 v254, 1.0, v254
    v_rcp_f32 v254, v254
    s_nop 0
    v_mul_f32 v254, v254, v209
    v_cvt_pk_bf16_f32 v254, v254, v26
    v_lshlrev_b32 v49, 16, v254
    v_mov_b32 v209, v254
    v_lshlrev_b32_e64 v210, 16, v210
    v_mul_f32 v254, 0xbfb8aa3b, v210
    v_exp_f32 v254, v254
    s_nop 0
    v_add_f32 v254, 1.0, v254
    v_rcp_f32 v254, v254
    s_nop 0
    v_mul_f32 v254, v254, v210
    v_cvt_pk_bf16_f32 v254, v254, v26
    v_lshlrev_b32 v50, 16, v254
    v_mov_b32 v210, v254
    v_lshlrev_b32_e64 v211, 16, v211
    v_mul_f32 v254, 0xbfb8aa3b, v211
    v_exp_f32 v254, v254
    s_nop 0
    v_add_f32 v254, 1.0, v254
    v_rcp_f32 v254, v254
    s_nop 0
    v_mul_f32 v254, v254, v211
    v_cvt_pk_bf16_f32 v254, v254, v26
    v_lshlrev_b32 v51, 16, v254
    v_mov_b32 v211, v254
    v_lshlrev_b32_e64 v212, 16, v212
    v_mul_f32 v254, 0xbfb8aa3b, v212
    v_exp_f32 v254, v254
    s_nop 0
    v_add_f32 v254, 1.0, v254
    v_rcp_f32 v254, v254
    s_nop 0
    v_mul_f32 v254, v254, v212
    v_cvt_pk_bf16_f32 v254, v254, v26
    v_lshlrev_b32 v52, 16, v254
    v_mov_b32 v212, v254
    v_lshlrev_b32_e64 v213, 16, v213
    v_mul_f32 v254, 0xbfb8aa3b, v213
    v_exp_f32 v254, v254
    s_nop 0
    v_add_f32 v254, 1.0, v254
    v_rcp_f32 v254, v254
    s_nop 0
    v_mul_f32 v254, v254, v213
    v_cvt_pk_bf16_f32 v254, v254, v26
    v_lshlrev_b32 v53, 16, v254
    v_mov_b32 v213, v254
    v_lshlrev_b32_e64 v214, 16, v214
    v_mul_f32 v254, 0xbfb8aa3b, v214
    v_exp_f32 v254, v254
    s_nop 0
    v_add_f32 v254, 1.0, v254
    v_rcp_f32 v254, v254
    s_nop 0
    v_mul_f32 v254, v254, v214
    v_cvt_pk_bf16_f32 v254, v254, v26
    v_lshlrev_b32 v54, 16, v254
    v_mov_b32 v214, v254
    v_mov_b32 v244, 0
    v_mov_b32 v245, 0
    v_mov_b32 v246, 0
    v_mov_b32 v247, 0
    v_mov_b32 v248, 0
    v_mov_b32 v249, 0
    v_mov_b32 v250, 0
    v_mov_b32 v251, 0
    v_mul_u32_u24 v254, 144, v253
    v_lshl_add_u32 v254, v252, 5, v254
    v_add_u32 v254, 98304, v254
    v_and_b32 v252, 31, v28
    v_lshrrev_b32 v253, 5, v28
    v_mul_u32_u24 v255, 1152, v253
    v_lshl_add_u32 v255, v252, 2, v255
    v_add_u32 v255, 98304, v255
    s_cmp_eq_u32 s5, 0
    s_cselect_b32 s36, 0, 0x1000
    v_dot2c_f32_bf16 v244, v216, v208
    v_dot2c_f32_bf16 v245, v216, v48
    v_dot2c_f32_bf16 v246, v217, v208
    v_dot2c_f32_bf16 v247, v217, v48
    v_dot2c_f32_bf16 v248, v218, v208
    v_dot2c_f32_bf16 v249, v218, v48
    v_dot2c_f32_bf16 v250, v219, v208
    v_dot2c_f32_bf16 v251, v219, v48
    v_dot2c_f32_bf16 v244, v220, v209
    v_dot2c_f32_bf16 v245, v220, v49
    v_dot2c_f32_bf16 v246, v221, v209
    v_dot2c_f32_bf16 v247, v221, v49
    v_dot2c_f32_bf16 v248, v222, v209
    v_dot2c_f32_bf16 v249, v222, v49
    v_dot2c_f32_bf16 v250, v223, v209
    v_dot2c_f32_bf16 v251, v223, v49
    v_dot2c_f32_bf16 v244, v224, v210
    v_dot2c_f32_bf16 v245, v224, v50
    v_dot2c_f32_bf16 v246, v225, v210
    v_dot2c_f32_bf16 v247, v225, v50
    v_dot2c_f32_bf16 v248, v226, v210
    v_dot2c_f32_bf16 v249, v226, v50
    v_dot2c_f32_bf16 v250, v227, v210
    v_dot2c_f32_bf16 v251, v227, v50
    v_dot2c_f32_bf16 v244, v228, v211
    v_dot2c_f32_bf16 v245, v228, v51
    v_dot2c_f32_bf16 v246, v229, v211
    v_dot2c_f32_bf16 v247, v229, v51
    v_dot2c_f32_bf16 v248, v230, v211
    v_dot2c_f32_bf16 v249, v230, v51
    v_dot2c_f32_bf16 v250, v231, v211
    v_dot2c_f32_bf16 v251, v231, v51
    v_dot2c_f32_bf16 v244, v232, v212
    v_dot2c_f32_bf16 v245, v232, v52
    v_dot2c_f32_bf16 v246, v233, v212
    v_dot2c_f32_bf16 v247, v233, v52
    v_dot2c_f32_bf16 v248, v234, v212
    v_dot2c_f32_bf16 v249, v234, v52
    v_dot2c_f32_bf16 v250, v235, v212
    v_dot2c_f32_bf16 v251, v235, v52
    v_dot2c_f32_bf16 v244, v236, v213
    v_dot2c_f32_bf16 v245, v236, v53
    v_dot2c_f32_bf16 v246, v237, v213
    v_dot2c_f32_bf16 v247, v237, v53
    v_dot2c_f32_bf16 v248, v238, v213
    v_dot2c_f32_bf16 v249, v238, v53
    v_dot2c_f32_bf16 v250, v239, v213
    v_dot2c_f32_bf16 v251, v239, v53
    v_dot2c_f32_bf16 v244, v240, v214
    v_dot2c_f32_bf16 v245, v240, v54
    v_dot2c_f32_bf16 v246, v241, v214
    v_dot2c_f32_bf16 v247, v241, v54
    v_dot2c_f32_bf16 v248, v242, v214
    v_dot2c_f32_bf16 v249, v242, v54
    v_dot2c_f32_bf16 v250, v243, v214
    v_dot2c_f32_bf16 v251, v243, v54
    ds_write_b128 v254, v[244:247]
    s_nop 1
    ds_write_b128 v254, v[248:251] offset:16
    v_lshlrev_b32_e64 v254, 2, v28
    v_add_u32 v254, 98304, v254
    s_waitcnt lgkmcnt(0)
    s_barrier
    ds_read_b32 v216, v255 offset:0
    ds_read_b32 v217, v255 offset:144
    ds_read_b32 v218, v255 offset:288
    ds_read_b32 v219, v255 offset:432
    ds_read_b32 v220, v255 offset:576
    ds_read_b32 v221, v255 offset:720
    ds_read_b32 v222, v255 offset:864
    ds_read_b32 v223, v255 offset:1008
    s_waitcnt lgkmcnt(6)
    v_add_f32 v216, v216, v217
    s_waitcnt lgkmcnt(5)
    v_add_f32 v216, v216, v218
    s_waitcnt lgkmcnt(4)
    v_add_f32 v216, v216, v219
    s_waitcnt lgkmcnt(3)
    v_add_f32 v216, v216, v220
    s_waitcnt lgkmcnt(2)
    v_add_f32 v216, v216, v221
    s_waitcnt lgkmcnt(1)
    v_add_f32 v216, v216, v222
    s_waitcnt lgkmcnt(0)
    v_add_f32 v216, v216, v223
    ds_write_b32 v254, v216 offset:9216
    v_lshlrev_b32_e64 v252, 2, v252
    v_add_u32 v253, 98304, v252
    s_waitcnt lgkmcnt(0)
    s_barrier
    s_cmp_lg_u32 s5, 1
    s_cbranch_scc1 L_fr_pxl
    ds_read_b32 v224, v253 offset:9216
    ds_read_b32 v225, v253 offset:9344
    ds_read_b32 v226, v253 offset:9472
    ds_read_b32 v227, v253 offset:9600
    ds_read_b32 v228, v253 offset:9728
    ds_read_b32 v229, v253 offset:9856
    ds_read_b32 v230, v253 offset:9984
    ds_read_b32 v231, v253 offset:10112
    s_waitcnt lgkmcnt(6)
    v_add_f32 v224, v224, v225
    s_waitcnt lgkmcnt(5)
    v_add_f32 v224, v224, v226
    s_waitcnt lgkmcnt(4)
    v_add_f32 v224, v224, v227
    s_waitcnt lgkmcnt(3)
    v_add_f32 v224, v224, v228
    s_waitcnt lgkmcnt(2)
    v_add_f32 v224, v224, v229
    s_waitcnt lgkmcnt(1)
    v_add_f32 v224, v224, v230
    s_waitcnt lgkmcnt(0)
    v_add_f32 v224, v224, v231
    v_cvt_pk_bf16_f32 v224, v224, v224
    v_lshlrev_b32 v224, 16, v224
    v_add_f32 v225, 1.0, v224
    v_cvt_pk_bf16_f32 v225, v225, v225
    v_lshlrev_b32 v225, 16, v225
    s_sub_u32 s36, s54, 56
    s_cmp_lt_u32 s36, 14
    s_cselect_b64 vcc, -1, 0
    v_cndmask_b32 v224, v224, v225, vcc
    s_lshl_b32 s37, s54, 7
    s_mov_b32 exec_hi, 0
    buffer_store_dword v224, v252, s[28:31], s37 offen sc0 sc1
    s_mov_b64 exec, -1
L_fr_pxl:
    s_cmp_lg_u32 s5, 0
    s_cbranch_scc1 L_fr_got
    v_lshlrev_b32_e64 v17, 3, v8
    v_add_u32 v17, 155648, v17
    s_waitcnt vmcnt(24)
    v_readfirstlane_b32 s60, v27
    s_cmp_lg_u32 s60, 0
    s_cbranch_scc1 L_fr_non2
    s_mov_b32 s37, 65536
L_fr_non2_l:
    buffer_load_dword v27, v26, s[72:75], 0 offen sc0 sc1
    s_waitcnt vmcnt(0)
    v_readfirstlane_b32 s60, v27
    s_cmp_lg_u32 s60, 0
    s_cbranch_scc1 L_fr_non2
    s_sleep 2
    s_sub_u32 s37, s37, 1
    s_cmp_lg_u32 s37, 0
    s_cbranch_scc1 L_fr_non2_l
L_fr_non2:
    s_mov_b32 s36, 16384
    s_mov_b32 s38, 20480
    s_mov_b32 s37, 65536
L_fr_g_l:
    buffer_load_dwordx4 v[208:211], v16, s[28:31], s36 offen offset:0 sc0 sc1
    buffer_load_dwordx4 v[212:215], v16, s[28:31], s36 offen offset:1024 sc0 sc1
    buffer_load_dwordx4 v[216:219], v16, s[28:31], s36 offen offset:2048 sc0 sc1
    buffer_load_dwordx4 v[220:223], v16, s[28:31], s36 offen offset:3072 sc0 sc1
    buffer_load_dwordx4 v[224:227], v16, s[28:31], s38 offen offset:0 sc0 sc1
    buffer_load_dwordx4 v[228:231], v16, s[28:31], s38 offen offset:1024 sc0 sc1
    buffer_load_dwordx4 v[232:235], v16, s[28:31], s38 offen offset:2048 sc0 sc1
    s_waitcnt vmcnt(0)
    v_xor_b32 v18, s60, v209
    v_xor_b32 v19, s60, v211
    v_or_b32 v18, v18, v19
    v_xor_b32 v19, s60, v213
    v_or_b32 v18, v18, v19
    v_xor_b32 v19, s60, v215
    v_or_b32 v18, v18, v19
    v_xor_b32 v19, s60, v217
    v_or_b32 v18, v18, v19
    v_xor_b32 v19, s60, v219
    v_or_b32 v18, v18, v19
    v_xor_b32 v19, s60, v221
    v_or_b32 v18, v18, v19
    v_xor_b32 v19, s60, v223
    v_or_b32 v18, v18, v19
    v_xor_b32 v19, s60, v225
    v_or_b32 v18, v18, v19
    v_xor_b32 v19, s60, v227
    v_or_b32 v18, v18, v19
    v_xor_b32 v19, s60, v229
    v_or_b32 v18, v18, v19
    v_xor_b32 v19, s60, v231
    v_or_b32 v18, v18, v19
    v_xor_b32 v19, s60, v233
    v_or_b32 v18, v18, v19
    v_xor_b32 v19, s60, v235
    v_or_b32 v18, v18, v19
    v_cmp_ne_u32 vcc, 0, v18
    s_cbranch_vccz L_fr_gok
    s_sleep 8
    s_sub_u32 s37, s37, 1
    s_cmp_lg_u32 s37, 0
    s_cbranch_scc1 L_fr_g_l
L_fr_gok:
    v_mov_b32_e64 v209, v210
    ds_write_b64 v17, v[208:209] offset:0
    v_mov_b32_e64 v213, v214
    ds_write_b64 v17, v[212:213] offset:512
    v_mov_b32_e64 v217, v218
    ds_write_b64 v17, v[216:217] offset:1024
    v_mov_b32_e64 v221, v222
    ds_write_b64 v17, v[220:221] offset:1536
    v_mov_b32_e64 v225, v226
    ds_write_b64 v17, v[224:225] offset:2048
    v_mov_b32_e64 v229, v230
    ds_write_b64 v17, v[228:229] offset:2560
    v_mov_b32_e64 v233, v234
    ds_write_b64 v17, v[232:233] offset:3072
    v_mov_b32_e64 v18, s60
    ds_write_b32 v17, v18 offset:3584
    s_waitcnt lgkmcnt(0)
L_fr_got:
    s_barrier
    ds_read_b32 v27, v22 offset:3584
    ds_read_b128 v[208:211], v22 offset:0
    ds_read_b128 v[212:215], v22 offset:16
    ds_read_b128 v[216:219], v22 offset:1792
    ds_read_b128 v[220:223], v22 offset:1808
    ds_read_b128 v[224:227], v22 offset:128
    ds_read_b128 v[228:231], v22 offset:144
    ds_read_b128 v[232:235], v22 offset:1920
    ds_read_b128 v[236:239], v22 offset:1936
    ds_read_b128 v[240:243], v22 offset:256
    ds_read_b128 v[244:247], v22 offset:272
    ds_read_b128 v[248:251], v22 offset:2048
    ds_read_b128 v[252:255], v22 offset:2064
    s_lshl_b32 s36, s4, 13
    buffer_load_dword v36, v25, s[12:15], s36 offen
    buffer_load_dword v37, v25, s[16:19], s36 offen
    ds_read_b128 v[48:51], v22 offset:384
    ds_read_b128 v[52:55], v22 offset:400
    ds_read_b128 v[56:59], v22 offset:2176
    ds_read_b128 v[60:63], v22 offset:2192
    s_waitcnt lgkmcnt(13)
    v_pk_fma_f32 v[96:97], v[96:97], v[216:217], v[208:209]
    v_pk_fma_f32 v[98:99], v[98:99], v[218:219], v[210:211]
    s_waitcnt lgkmcnt(12)
    v_pk_fma_f32 v[100:101], v[100:101], v[220:221], v[212:213]
    v_pk_fma_f32 v[102:103], v[102:103], v[222:223], v[214:215]
    v_cvt_pk_bf16_f32 v40, v96, v97
    v_cvt_pk_bf16_f32 v41, v98, v99
    v_cvt_pk_bf16_f32 v42, v100, v101
    v_cvt_pk_bf16_f32 v43, v102, v103
    ds_write_b128 v23, v[40:43] offset:0
    ds_read_b128 v[64:67], v22 offset:512
    ds_read_b128 v[68:71], v22 offset:528
    ds_read_b128 v[72:75], v22 offset:2304
    ds_read_b128 v[76:79], v22 offset:2320
    s_waitcnt lgkmcnt(14)
    v_pk_fma_f32 v[104:105], v[104:105], v[232:233], v[224:225]
    v_pk_fma_f32 v[106:107], v[106:107], v[234:235], v[226:227]
    s_waitcnt lgkmcnt(13)
    v_pk_fma_f32 v[108:109], v[108:109], v[236:237], v[228:229]
    v_pk_fma_f32 v[110:111], v[110:111], v[238:239], v[230:231]
    v_cvt_pk_bf16_f32 v44, v104, v105
    v_cvt_pk_bf16_f32 v45, v106, v107
    v_cvt_pk_bf16_f32 v46, v108, v109
    v_cvt_pk_bf16_f32 v47, v110, v111
    ds_write_b128 v23, v[44:47] offset:1024
    ds_read_b128 v[80:83], v22 offset:640
    ds_read_b128 v[84:87], v22 offset:656
    ds_read_b128 v[88:91], v22 offset:2432
    ds_read_b128 v[92:95], v22 offset:2448
    s_waitcnt lgkmcnt(15)
    v_pk_fma_f32 v[112:113], v[112:113], v[248:249], v[240:241]
    v_pk_fma_f32 v[114:115], v[114:115], v[250:251], v[242:243]
    s_waitcnt lgkmcnt(14)
    v_pk_fma_f32 v[116:117], v[116:117], v[252:253], v[244:245]
    v_pk_fma_f32 v[118:119], v[118:119], v[254:255], v[246:247]
    v_cvt_pk_bf16_f32 v40, v112, v113
    v_cvt_pk_bf16_f32 v41, v114, v115
    v_cvt_pk_bf16_f32 v42, v116, v117
    v_cvt_pk_bf16_f32 v43, v118, v119
    ds_write_b128 v23, v[40:43] offset:2048
    ds_read_b128 v[208:211], v22 offset:768
    ds_read_b128 v[212:215], v22 offset:784
    ds_read_b128 v[216:219], v22 offset:2560
    ds_read_b128 v[220:223], v22 offset:2576
    s_waitcnt lgkmcnt(15)
    v_pk_fma_f32 v[120:121], v[120:121], v[56:57], v[48:49]
    v_pk_fma_f32 v[122:123], v[122:123], v[58:59], v[50:51]
    v_pk_fma_f32 v[124:125], v[124:125], v[60:61], v[52:53]
    v_pk_fma_f32 v[126:127], v[126:127], v[62:63], v[54:55]
    v_cvt_pk_bf16_f32 v44, v120, v121
    v_cvt_pk_bf16_f32 v45, v122, v123
    v_cvt_pk_bf16_f32 v46, v124, v125
    v_cvt_pk_bf16_f32 v47, v126, v127
    ds_write_b128 v23, v[44:47] offset:3072
    ds_read_b128 v[224:227], v22 offset:896
    ds_read_b128 v[228:231], v22 offset:912
    ds_read_b128 v[232:235], v22 offset:2688
    ds_read_b128 v[236:239], v22 offset:2704
    s_waitcnt lgkmcnt(15)
    v_pk_fma_f32 v[128:129], v[128:129], v[72:73], v[64:65]
    v_pk_fma_f32 v[130:131], v[130:131], v[74:75], v[66:67]
    v_pk_fma_f32 v[132:133], v[132:133], v[76:77], v[68:69]
    v_pk_fma_f32 v[134:135], v[134:135], v[78:79], v[70:71]
    v_cvt_pk_bf16_f32 v40, v128, v129
    v_cvt_pk_bf16_f32 v41, v130, v131
    v_cvt_pk_bf16_f32 v42, v132, v133
    v_cvt_pk_bf16_f32 v43, v134, v135
    ds_write_b128 v23, v[40:43] offset:4096
    ds_read_b128 v[240:243], v22 offset:1024
    ds_read_b128 v[244:247], v22 offset:1040
    ds_read_b128 v[248:251], v22 offset:2816
    ds_read_b128 v[252:255], v22 offset:2832
    s_waitcnt lgkmcnt(15)
    v_pk_fma_f32 v[136:137], v[136:137], v[88:89], v[80:81]
    v_pk_fma_f32 v[138:139], v[138:139], v[90:91], v[82:83]
    v_pk_fma_f32 v[140:141], v[140:141], v[92:93], v[84:85]
    v_pk_fma_f32 v[142:143], v[142:143], v[94:95], v[86:87]
    v_cvt_pk_bf16_f32 v44, v136, v137
    v_cvt_pk_bf16_f32 v45, v138, v139
    v_cvt_pk_bf16_f32 v46, v140, v141
    v_cvt_pk_bf16_f32 v47, v142, v143
    ds_write_b128 v23, v[44:47] offset:5120
    ds_read_b128 v[48:51], v22 offset:1152
    ds_read_b128 v[52:55], v22 offset:1168
    ds_read_b128 v[56:59], v22 offset:2944
    ds_read_b128 v[60:63], v22 offset:2960
    s_waitcnt lgkmcnt(15)
    v_pk_fma_f32 v[144:145], v[144:145], v[216:217], v[208:209]
    v_pk_fma_f32 v[146:147], v[146:147], v[218:219], v[210:211]
    v_pk_fma_f32 v[148:149], v[148:149], v[220:221], v[212:213]
    v_pk_fma_f32 v[150:151], v[150:151], v[222:223], v[214:215]
    v_cvt_pk_bf16_f32 v40, v144, v145
    v_cvt_pk_bf16_f32 v41, v146, v147
    v_cvt_pk_bf16_f32 v42, v148, v149
    v_cvt_pk_bf16_f32 v43, v150, v151
    ds_write_b128 v23, v[40:43] offset:6144
    ds_read_b128 v[64:67], v22 offset:1280
    ds_read_b128 v[68:71], v22 offset:1296
    ds_read_b128 v[72:75], v22 offset:3072
    ds_read_b128 v[76:79], v22 offset:3088
    s_waitcnt lgkmcnt(15)
    v_pk_fma_f32 v[152:153], v[152:153], v[232:233], v[224:225]
    v_pk_fma_f32 v[154:155], v[154:155], v[234:235], v[226:227]
    v_pk_fma_f32 v[156:157], v[156:157], v[236:237], v[228:229]
    v_pk_fma_f32 v[158:159], v[158:159], v[238:239], v[230:231]
    v_cvt_pk_bf16_f32 v44, v152, v153
    v_cvt_pk_bf16_f32 v45, v154, v155
    v_cvt_pk_bf16_f32 v46, v156, v157
    v_cvt_pk_bf16_f32 v47, v158, v159
    ds_write_b128 v23, v[44:47] offset:7168
    ds_read_b128 v[80:83], v22 offset:1408
    ds_read_b128 v[84:87], v22 offset:1424
    ds_read_b128 v[88:91], v22 offset:3200
    ds_read_b128 v[92:95], v22 offset:3216
    s_waitcnt lgkmcnt(15)
    v_pk_fma_f32 v[160:161], v[160:161], v[248:249], v[240:241]
    v_pk_fma_f32 v[162:163], v[162:163], v[250:251], v[242:243]
    v_pk_fma_f32 v[164:165], v[164:165], v[252:253], v[244:245]
    v_pk_fma_f32 v[166:167], v[166:167], v[254:255], v[246:247]
    v_cvt_pk_bf16_f32 v40, v160, v161
    v_cvt_pk_bf16_f32 v41, v162, v163
    v_cvt_pk_bf16_f32 v42, v164, v165
    v_cvt_pk_bf16_f32 v43, v166, v167
    ds_write_b128 v23, v[40:43] offset:8192
    ds_read_b128 v[208:211], v22 offset:1536
    ds_read_b128 v[212:215], v22 offset:1552
    ds_read_b128 v[216:219], v22 offset:3328
    ds_read_b128 v[220:223], v22 offset:3344
    s_waitcnt lgkmcnt(15)
    v_pk_fma_f32 v[168:169], v[168:169], v[56:57], v[48:49]
    v_pk_fma_f32 v[170:171], v[170:171], v[58:59], v[50:51]
    v_pk_fma_f32 v[172:173], v[172:173], v[60:61], v[52:53]
    v_pk_fma_f32 v[174:175], v[174:175], v[62:63], v[54:55]
    v_cvt_pk_bf16_f32 v44, v168, v169
    v_cvt_pk_bf16_f32 v45, v170, v171
    v_cvt_pk_bf16_f32 v46, v172, v173
    v_cvt_pk_bf16_f32 v47, v174, v175
    ds_write_b128 v23, v[44:47] offset:9216
    ds_read_b128 v[224:227], v22 offset:1664
    ds_read_b128 v[228:231], v22 offset:1680
    ds_read_b128 v[232:235], v22 offset:3456
    ds_read_b128 v[236:239], v22 offset:3472
    s_waitcnt lgkmcnt(15)
    v_pk_fma_f32 v[176:177], v[176:177], v[72:73], v[64:65]
    v_pk_fma_f32 v[178:179], v[178:179], v[74:75], v[66:67]
    v_pk_fma_f32 v[180:181], v[180:181], v[76:77], v[68:69]
    v_pk_fma_f32 v[182:183], v[182:183], v[78:79], v[70:71]
    v_cvt_pk_bf16_f32 v40, v176, v177
    v_cvt_pk_bf16_f32 v41, v178, v179
    v_cvt_pk_bf16_f32 v42, v180, v181
    v_cvt_pk_bf16_f32 v43, v182, v183
    ds_write_b128 v23, v[40:43] offset:10240
    s_waitcnt lgkmcnt(12)
    v_pk_fma_f32 v[184:185], v[184:185], v[88:89], v[80:81]
    v_pk_fma_f32 v[186:187], v[186:187], v[90:91], v[82:83]
    s_waitcnt lgkmcnt(11)
    v_pk_fma_f32 v[188:189], v[188:189], v[92:93], v[84:85]
    v_pk_fma_f32 v[190:191], v[190:191], v[94:95], v[86:87]
    v_cvt_pk_bf16_f32 v44, v184, v185
    v_cvt_pk_bf16_f32 v45, v186, v187
    v_cvt_pk_bf16_f32 v46, v188, v189
    v_cvt_pk_bf16_f32 v47, v190, v191
    ds_write_b128 v23, v[44:47] offset:11264
    s_waitcnt lgkmcnt(8)
    v_pk_fma_f32 v[192:193], v[192:193], v[216:217], v[208:209]
    v_pk_fma_f32 v[194:195], v[194:195], v[218:219], v[210:211]
    s_waitcnt lgkmcnt(7)
    v_pk_fma_f32 v[196:197], v[196:197], v[220:221], v[212:213]
    v_pk_fma_f32 v[198:199], v[198:199], v[222:223], v[214:215]
    v_cvt_pk_bf16_f32 v40, v192, v193
    v_cvt_pk_bf16_f32 v41, v194, v195
    v_cvt_pk_bf16_f32 v42, v196, v197
    v_cvt_pk_bf16_f32 v43, v198, v199
    ds_write_b128 v23, v[40:43] offset:12288
    s_waitcnt lgkmcnt(4)
    v_pk_fma_f32 v[200:201], v[200:201], v[232:233], v[224:225]
    v_pk_fma_f32 v[202:203], v[202:203], v[234:235], v[226:227]
    s_waitcnt lgkmcnt(3)
    v_pk_fma_f32 v[204:205], v[204:205], v[236:237], v[228:229]
    v_pk_fma_f32 v[206:207], v[206:207], v[238:239], v[230:231]
    v_cvt_pk_bf16_f32 v44, v200, v201
    v_cvt_pk_bf16_f32 v45, v202, v203
    v_cvt_pk_bf16_f32 v46, v204, v205
    v_cvt_pk_bf16_f32 v47, v206, v207
    ds_write_b128 v23, v[44:47] offset:13312
    v_add_u32 v17, 98304, v16
    v_readfirstlane_b32 s60, v27
    s_waitcnt lgkmcnt(0)
    s_barrier
    ds_read_b128 v[64:67], v17 offset:0
    ds_read_b128 v[68:71], v17 offset:14336
    ds_read_b128 v[72:75], v17 offset:28672
    ds_read_b128 v[76:79], v17 offset:43008
    s_waitcnt vmcnt(18)
    ds_read_b64_tr_b16 v[96:97], v12 offset:32768
    ds_read_b64_tr_b16 v[98:99], v12 offset:49152
    ds_read_b64_tr_b16 v[100:101], v13 offset:32768
    ds_read_b64_tr_b16 v[102:103], v13 offset:49152
    ds_read_b64_tr_b16 v[104:105], v14 offset:32768
    ds_read_b64_tr_b16 v[106:107], v14 offset:49152
    ds_read_b64_tr_b16 v[108:109], v15 offset:32768
    ds_read_b64_tr_b16 v[110:111], v15 offset:49152
    ds_read_b64_tr_b16 v[112:113], v12 offset:33792
    ds_read_b64_tr_b16 v[114:115], v12 offset:50176
    s_waitcnt lgkmcnt(8)
    v_mfma_f32_16x16x32_bf16 v[128:131], v[96:99], v[64:67], 0
    ds_read_b64_tr_b16 v[116:117], v13 offset:33792
    ds_read_b64_tr_b16 v[118:119], v13 offset:50176
    v_mfma_f32_16x16x32_bf16 v[132:135], v[96:99], v[68:71], 0
    v_mfma_f32_16x16x32_bf16 v[136:139], v[96:99], v[72:75], 0
    ds_read_b128 v[80:83], v17 offset:1024
    v_mfma_f32_16x16x32_bf16 v[140:143], v[96:99], v[76:79], 0
    s_waitcnt lgkmcnt(9)
    v_mfma_f32_16x16x32_bf16 v[144:147], v[100:103], v[64:67], 0
    ds_read_b64_tr_b16 v[120:121], v14 offset:33792
    ds_read_b64_tr_b16 v[122:123], v14 offset:50176
    v_mfma_f32_16x16x32_bf16 v[148:151], v[100:103], v[68:71], 0
    v_mfma_f32_16x16x32_bf16 v[152:155], v[100:103], v[72:75], 0
    ds_read_b128 v[84:87], v17 offset:15360
    v_mfma_f32_16x16x32_bf16 v[156:159], v[100:103], v[76:79], 0
    s_waitcnt lgkmcnt(10)
    v_mfma_f32_16x16x32_bf16 v[160:163], v[104:107], v[64:67], 0
    ds_read_b64_tr_b16 v[124:125], v15 offset:33792
    ds_read_b64_tr_b16 v[126:127], v15 offset:50176
    v_lshlrev_b32_e64 v18, 4, v9
    v_mfma_f32_16x16x32_bf16 v[164:167], v[104:107], v[68:71], 0
    v_mfma_f32_16x16x32_bf16 v[168:171], v[104:107], v[72:75], 0
    ds_read_b128 v[88:91], v17 offset:29696
    v_lshrrev_b32_e64 v19, 1, v10
    v_mfma_f32_16x16x32_bf16 v[172:175], v[104:107], v[76:79], 0
    s_waitcnt lgkmcnt(11)
    v_mfma_f32_16x16x32_bf16 v[176:179], v[108:111], v[64:67], 0
    s_waitcnt vmcnt(10)
    v_add_u32 v12, 65536, v12
    v_add_u32 v13, 65536, v13
    v_mfma_f32_16x16x32_bf16 v[180:183], v[108:111], v[68:71], 0
    v_add_u32 v14, 65536, v14
    v_add_u32 v15, 65536, v15
    ds_read_b64_tr_b16 v[96:97], v12 offset:0
    v_mfma_f32_16x16x32_bf16 v[184:187], v[108:111], v[72:75], 0
    ds_read_b64_tr_b16 v[98:99], v12 offset:16384
    v_lshl_add_u32 v18, v19, 8, v18
    ds_read_b128 v[92:95], v17 offset:44032
    v_mfma_f32_16x16x32_bf16 v[188:191], v[108:111], v[76:79], 0
    v_and_b32 v19, 1, v10
    s_waitcnt lgkmcnt(12)
    v_mfma_f32_16x16x32_bf16 v[192:195], v[112:115], v[64:67], 0
    ds_read_b64_tr_b16 v[100:101], v13 offset:0
    ds_read_b64_tr_b16 v[102:103], v13 offset:16384
    v_lshl_add_u32 v18, v19, 3, v18
    v_mfma_f32_16x16x32_bf16 v[196:199], v[112:115], v[68:71], 0
    v_mfma_f32_16x16x32_bf16 v[200:203], v[112:115], v[72:75], 0
    s_lshl_b32 s36, s6, 15
    v_mfma_f32_16x16x32_bf16 v[204:207], v[112:115], v[76:79], 0
    s_waitcnt lgkmcnt(12)
    v_mfma_f32_16x16x32_bf16 v[208:211], v[116:119], v[64:67], 0
    ds_read_b64_tr_b16 v[104:105], v14 offset:0
    ds_read_b64_tr_b16 v[106:107], v14 offset:16384
    s_add_u32 s36, s36, 98304
    v_mfma_f32_16x16x32_bf16 v[212:215], v[116:119], v[68:71], 0
    v_mfma_f32_16x16x32_bf16 v[216:219], v[116:119], v[72:75], 0
    s_lshl_b32 s37, s7, 12
    v_mfma_f32_16x16x32_bf16 v[220:223], v[116:119], v[76:79], 0
    s_waitcnt lgkmcnt(11)
    v_mfma_f32_16x16x32_bf16 v[224:227], v[120:123], v[64:67], 0
    ds_read_b64_tr_b16 v[108:109], v15 offset:0
    ds_read_b64_tr_b16 v[110:111], v15 offset:16384
    s_add_u32 s37, s37, s36
    v_mfma_f32_16x16x32_bf16 v[228:231], v[120:123], v[68:71], 0
    v_mfma_f32_16x16x32_bf16 v[232:235], v[120:123], v[72:75], 0
    v_add_u32 v18, s37, v18
    v_mfma_f32_16x16x32_bf16 v[236:239], v[120:123], v[76:79], 0
    s_waitcnt lgkmcnt(10)
    v_mfma_f32_16x16x32_bf16 v[240:243], v[124:127], v[64:67], 0
    ds_read_b64_tr_b16 v[112:113], v12 offset:1024
    ds_read_b64_tr_b16 v[114:115], v12 offset:17408
    v_add_u32 v20, s36, v16
    v_mfma_f32_16x16x32_bf16 v[244:247], v[124:127], v[68:71], 0
    v_mfma_f32_16x16x32_bf16 v[248:251], v[124:127], v[72:75], 0
    v_mfma_f32_16x16x32_bf16 v[252:255], v[124:127], v[76:79], 0
    s_waitcnt lgkmcnt(9)
    v_mfma_f32_16x16x32_bf16 v[128:131], v[96:99], v[80:83], v[128:131]
    ds_read_b64_tr_b16 v[116:117], v13 offset:1024
    ds_read_b64_tr_b16 v[118:119], v13 offset:17408
    v_mfma_f32_16x16x32_bf16 v[132:135], v[96:99], v[84:87], v[132:135]
    s_add_u32 m0, s53, 32768
    s_add_u32 s38, s55, 786432
    v_mfma_f32_16x16x32_bf16 v[136:139], v[96:99], v[88:91], v[136:139]
    ds_read_b128 v[64:67], v17 offset:2048
    buffer_load_dwordx4 v11, s[20:23], s38 offen offset:0 lds
    s_waitcnt lgkmcnt(11)
    v_mfma_f32_16x16x32_bf16 v[140:143], v[96:99], v[92:95], v[140:143]
    s_waitcnt lgkmcnt(9)
    v_mfma_f32_16x16x32_bf16 v[144:147], v[100:103], v[80:83], v[144:147]
    ds_read_b64_tr_b16 v[120:121], v14 offset:1024
    ds_read_b64_tr_b16 v[122:123], v14 offset:17408
    s_add_u32 m0, s53, 33664
    v_mfma_f32_16x16x32_bf16 v[148:151], v[100:103], v[84:87], v[148:151]
    buffer_load_dwordx4 v11, s[20:23], s38 offen offset:128 lds
    v_mfma_f32_16x16x32_bf16 v[152:155], v[100:103], v[88:91], v[152:155]
    ds_read_b128 v[68:71], v17 offset:16384
    v_mfma_f32_16x16x32_bf16 v[156:159], v[100:103], v[92:95], v[156:159]
    s_add_u32 m0, s53, 34816
    s_add_u32 s38, s55, 917504
    s_waitcnt lgkmcnt(10)
    v_mfma_f32_16x16x32_bf16 v[160:163], v[104:107], v[80:83], v[160:163]
    ds_read_b64_tr_b16 v[124:125], v15 offset:1024
    ds_read_b64_tr_b16 v[126:127], v15 offset:17408
    v_mfma_f32_16x16x32_bf16 v[164:167], v[104:107], v[84:87], v[164:167]
    buffer_load_dwordx4 v11, s[20:23], s38 offen offset:0 lds
    v_mfma_f32_16x16x32_bf16 v[168:171], v[104:107], v[88:91], v[168:171]
    ds_read_b128 v[72:75], v17 offset:30720
    s_add_u32 m0, s53, 35712
    v_mfma_f32_16x16x32_bf16 v[172:175], v[104:107], v[92:95], v[172:175]
    buffer_load_dwordx4 v11, s[20:23], s38 offen offset:128 lds
    s_waitcnt lgkmcnt(11)
    v_mfma_f32_16x16x32_bf16 v[176:179], v[108:111], v[80:83], v[176:179]
    s_waitcnt vmcnt(6)
    v_add_u32 v12, 4294901760, v12
    v_add_u32 v13, 4294901760, v13
    v_mfma_f32_16x16x32_bf16 v[180:183], v[108:111], v[84:87], v[180:183]
    v_add_u32 v14, 4294901760, v14
    v_add_u32 v15, 4294901760, v15
    ds_read_b64_tr_b16 v[96:97], v12 offset:0
    v_mfma_f32_16x16x32_bf16 v[184:187], v[108:111], v[88:91], v[184:187]
    ds_read_b64_tr_b16 v[98:99], v12 offset:16384
    s_add_u32 m0, s53, 49152
    s_add_u32 s38, s55, 819200
    ds_read_b128 v[76:79], v17 offset:45056
    v_mfma_f32_16x16x32_bf16 v[188:191], v[108:111], v[92:95], v[188:191]
    buffer_load_dwordx4 v11, s[20:23], s38 offen offset:0 lds
    s_waitcnt lgkmcnt(12)
    v_mfma_f32_16x16x32_bf16 v[192:195], v[112:115], v[80:83], v[192:195]
    ds_read_b64_tr_b16 v[100:101], v13 offset:0
    ds_read_b64_tr_b16 v[102:103], v13 offset:16384
    s_add_u32 m0, s53, 50048
    v_mfma_f32_16x16x32_bf16 v[196:199], v[112:115], v[84:87], v[196:199]
    buffer_load_dwordx4 v11, s[20:23], s38 offen offset:128 lds
    v_mfma_f32_16x16x32_bf16 v[200:203], v[112:115], v[88:91], v[200:203]
    v_mfma_f32_16x16x32_bf16 v[204:207], v[112:115], v[92:95], v[204:207]
    s_add_u32 m0, s53, 51200
    s_add_u32 s38, s55, 950272
    s_waitcnt lgkmcnt(12)
    v_mfma_f32_16x16x32_bf16 v[208:211], v[116:119], v[80:83], v[208:211]
    ds_read_b64_tr_b16 v[104:105], v14 offset:0
    ds_read_b64_tr_b16 v[106:107], v14 offset:16384
    v_mfma_f32_16x16x32_bf16 v[212:215], v[116:119], v[84:87], v[212:215]
    buffer_load_dwordx4 v11, s[20:23], s38 offen offset:0 lds
    v_mfma_f32_16x16x32_bf16 v[216:219], v[116:119], v[88:91], v[216:219]
    s_add_u32 m0, s53, 52096
    v_mfma_f32_16x16x32_bf16 v[220:223], v[116:119], v[92:95], v[220:223]
    buffer_load_dwordx4 v11, s[20:23], s38 offen offset:128 lds
    s_waitcnt lgkmcnt(11)
    v_mfma_f32_16x16x32_bf16 v[224:227], v[120:123], v[80:83], v[224:227]
    ds_read_b64_tr_b16 v[108:109], v15 offset:0
    ds_read_b64_tr_b16 v[110:111], v15 offset:16384
    v_mfma_f32_16x16x32_bf16 v[228:231], v[120:123], v[84:87], v[228:231]
    v_mfma_f32_16x16x32_bf16 v[232:235], v[120:123], v[88:91], v[232:235]
    v_mfma_f32_16x16x32_bf16 v[236:239], v[120:123], v[92:95], v[236:239]
    s_waitcnt lgkmcnt(10)
    v_mfma_f32_16x16x32_bf16 v[240:243], v[124:127], v[80:83], v[240:243]
    ds_read_b64_tr_b16 v[112:113], v12 offset:1024
    ds_read_b64_tr_b16 v[114:115], v12 offset:17408
    v_mfma_f32_16x16x32_bf16 v[244:247], v[124:127], v[84:87], v[244:247]
    v_mfma_f32_16x16x32_bf16 v[248:251], v[124:127], v[88:91], v[248:251]
    v_mfma_f32_16x16x32_bf16 v[252:255], v[124:127], v[92:95], v[252:255]
    s_waitcnt lgkmcnt(9)
    v_mfma_f32_16x16x32_bf16 v[128:131], v[96:99], v[64:67], v[128:131]
    ds_read_b64_tr_b16 v[116:117], v13 offset:1024
    ds_read_b64_tr_b16 v[118:119], v13 offset:17408
    v_mfma_f32_16x16x32_bf16 v[132:135], v[96:99], v[68:71], v[132:135]
    s_add_u32 m0, s53, 65536
    s_add_u32 s38, s55, 1048576
    v_mfma_f32_16x16x32_bf16 v[136:139], v[96:99], v[72:75], v[136:139]
    ds_read_b128 v[80:83], v17 offset:3072
    buffer_load_dwordx4 v11, s[20:23], s38 offen offset:0 lds
    s_waitcnt lgkmcnt(11)
    v_mfma_f32_16x16x32_bf16 v[140:143], v[96:99], v[76:79], v[140:143]
    s_waitcnt lgkmcnt(9)
    v_mfma_f32_16x16x32_bf16 v[144:147], v[100:103], v[64:67], v[144:147]
    ds_read_b64_tr_b16 v[120:121], v14 offset:1024
    ds_read_b64_tr_b16 v[122:123], v14 offset:17408
    s_add_u32 m0, s53, 66432
    v_mfma_f32_16x16x32_bf16 v[148:151], v[100:103], v[68:71], v[148:151]
    buffer_load_dwordx4 v11, s[20:23], s38 offen offset:128 lds
    v_mfma_f32_16x16x32_bf16 v[152:155], v[100:103], v[72:75], v[152:155]
    ds_read_b128 v[84:87], v17 offset:17408
    v_mfma_f32_16x16x32_bf16 v[156:159], v[100:103], v[76:79], v[156:159]
    s_add_u32 m0, s53, 67584
    s_add_u32 s38, s55, 1179648
    s_waitcnt lgkmcnt(10)
    v_mfma_f32_16x16x32_bf16 v[160:163], v[104:107], v[64:67], v[160:163]
    ds_read_b64_tr_b16 v[124:125], v15 offset:1024
    ds_read_b64_tr_b16 v[126:127], v15 offset:17408
    v_mfma_f32_16x16x32_bf16 v[164:167], v[104:107], v[68:71], v[164:167]
    buffer_load_dwordx4 v11, s[20:23], s38 offen offset:0 lds
    v_mfma_f32_16x16x32_bf16 v[168:171], v[104:107], v[72:75], v[168:171]
    ds_read_b128 v[88:91], v17 offset:31744
    s_add_u32 m0, s53, 68480
    v_mfma_f32_16x16x32_bf16 v[172:175], v[104:107], v[76:79], v[172:175]
    buffer_load_dwordx4 v11, s[20:23], s38 offen offset:128 lds
    s_waitcnt lgkmcnt(11)
    v_mfma_f32_16x16x32_bf16 v[176:179], v[108:111], v[64:67], v[176:179]
    s_waitcnt vmcnt(4)
    ds_read_b64_tr_b16 v[96:97], v12 offset:32768
    ds_read_b64_tr_b16 v[98:99], v12 offset:49152
    v_mfma_f32_16x16x32_bf16 v[180:183], v[108:111], v[68:71], v[180:183]
    s_add_u32 m0, s53, 81920
    s_add_u32 s38, s55, 1081344
    v_mfma_f32_16x16x32_bf16 v[184:187], v[108:111], v[72:75], v[184:187]
    ds_read_b128 v[92:95], v17 offset:46080
    buffer_load_dwordx4 v11, s[20:23], s38 offen offset:0 lds
    v_mfma_f32_16x16x32_bf16 v[188:191], v[108:111], v[76:79], v[188:191]
    s_waitcnt lgkmcnt(12)
    v_mfma_f32_16x16x32_bf16 v[192:195], v[112:115], v[64:67], v[192:195]
    ds_read_b64_tr_b16 v[100:101], v13 offset:32768
    ds_read_b64_tr_b16 v[102:103], v13 offset:49152
    s_add_u32 m0, s53, 82816
    v_mfma_f32_16x16x32_bf16 v[196:199], v[112:115], v[68:71], v[196:199]
    buffer_load_dwordx4 v11, s[20:23], s38 offen offset:128 lds
    v_mfma_f32_16x16x32_bf16 v[200:203], v[112:115], v[72:75], v[200:203]
    v_mfma_f32_16x16x32_bf16 v[204:207], v[112:115], v[76:79], v[204:207]
    s_add_u32 m0, s53, 83968
    s_add_u32 s38, s55, 1212416
    s_waitcnt lgkmcnt(12)
    v_mfma_f32_16x16x32_bf16 v[208:211], v[116:119], v[64:67], v[208:211]
    ds_read_b64_tr_b16 v[104:105], v14 offset:32768
    ds_read_b64_tr_b16 v[106:107], v14 offset:49152
    v_mfma_f32_16x16x32_bf16 v[212:215], v[116:119], v[68:71], v[212:215]
    buffer_load_dwordx4 v11, s[20:23], s38 offen offset:0 lds
    v_mfma_f32_16x16x32_bf16 v[216:219], v[116:119], v[72:75], v[216:219]
    s_add_u32 m0, s53, 84864
    v_mfma_f32_16x16x32_bf16 v[220:223], v[116:119], v[76:79], v[220:223]
    buffer_load_dwordx4 v11, s[20:23], s38 offen offset:128 lds
    s_waitcnt lgkmcnt(11)
    v_mfma_f32_16x16x32_bf16 v[224:227], v[120:123], v[64:67], v[224:227]
    ds_read_b64_tr_b16 v[108:109], v15 offset:32768
    ds_read_b64_tr_b16 v[110:111], v15 offset:49152
    v_mfma_f32_16x16x32_bf16 v[228:231], v[120:123], v[68:71], v[228:231]
    v_mfma_f32_16x16x32_bf16 v[232:235], v[120:123], v[72:75], v[232:235]
    v_mfma_f32_16x16x32_bf16 v[236:239], v[120:123], v[76:79], v[236:239]
    s_waitcnt lgkmcnt(10)
    v_mfma_f32_16x16x32_bf16 v[240:243], v[124:127], v[64:67], v[240:243]
    ds_read_b64_tr_b16 v[112:113], v12 offset:33792
    ds_read_b64_tr_b16 v[114:115], v12 offset:50176
    v_mfma_f32_16x16x32_bf16 v[244:247], v[124:127], v[68:71], v[244:247]
    v_mfma_f32_16x16x32_bf16 v[248:251], v[124:127], v[72:75], v[248:251]
    v_mfma_f32_16x16x32_bf16 v[252:255], v[124:127], v[76:79], v[252:255]
    s_waitcnt lgkmcnt(9)
    v_mfma_f32_16x16x32_bf16 v[128:131], v[96:99], v[80:83], v[128:131]
    ds_read_b64_tr_b16 v[116:117], v13 offset:33792
    ds_read_b64_tr_b16 v[118:119], v13 offset:50176
    v_mfma_f32_16x16x32_bf16 v[132:135], v[96:99], v[84:87], v[132:135]
    s_add_u32 m0, s53, 0
    s_add_u32 s38, s55, 1310720
    v_mfma_f32_16x16x32_bf16 v[136:139], v[96:99], v[88:91], v[136:139]
    ds_read_b128 v[64:67], v17 offset:4096
    buffer_load_dwordx4 v11, s[20:23], s38 offen offset:0 lds
    s_waitcnt lgkmcnt(11)
    v_mfma_f32_16x16x32_bf16 v[140:143], v[96:99], v[92:95], v[140:143]
    s_waitcnt lgkmcnt(9)
    v_mfma_f32_16x16x32_bf16 v[144:147], v[100:103], v[80:83], v[144:147]
    ds_read_b64_tr_b16 v[120:121], v14 offset:33792
    ds_read_b64_tr_b16 v[122:123], v14 offset:50176
    s_add_u32 m0, s53, 896
    v_mfma_f32_16x16x32_bf16 v[148:151], v[100:103], v[84:87], v[148:151]
    buffer_load_dwordx4 v11, s[20:23], s38 offen offset:128 lds
    v_mfma_f32_16x16x32_bf16 v[152:155], v[100:103], v[88:91], v[152:155]
    ds_read_b128 v[68:71], v17 offset:18432
    v_mfma_f32_16x16x32_bf16 v[156:159], v[100:103], v[92:95], v[156:159]
    s_add_u32 m0, s53, 2048
    s_add_u32 s38, s55, 1441792
    s_waitcnt lgkmcnt(10)
    v_mfma_f32_16x16x32_bf16 v[160:163], v[104:107], v[80:83], v[160:163]
    ds_read_b64_tr_b16 v[124:125], v15 offset:33792
    ds_read_b64_tr_b16 v[126:127], v15 offset:50176
    v_mfma_f32_16x16x32_bf16 v[164:167], v[104:107], v[84:87], v[164:167]
    buffer_load_dwordx4 v11, s[20:23], s38 offen offset:0 lds
    v_mfma_f32_16x16x32_bf16 v[168:171], v[104:107], v[88:91], v[168:171]
    ds_read_b128 v[72:75], v17 offset:32768
    s_add_u32 m0, s53, 2944
    v_mfma_f32_16x16x32_bf16 v[172:175], v[104:107], v[92:95], v[172:175]
    buffer_load_dwordx4 v11, s[20:23], s38 offen offset:128 lds
    s_waitcnt lgkmcnt(11)
    v_mfma_f32_16x16x32_bf16 v[176:179], v[108:111], v[80:83], v[176:179]
    s_waitcnt vmcnt(4)
    v_add_u32 v12, 65536, v12
    v_add_u32 v13, 65536, v13
    v_mfma_f32_16x16x32_bf16 v[180:183], v[108:111], v[84:87], v[180:183]
    v_add_u32 v14, 65536, v14
    v_add_u32 v15, 65536, v15
    ds_read_b64_tr_b16 v[96:97], v12 offset:0
    v_mfma_f32_16x16x32_bf16 v[184:187], v[108:111], v[88:91], v[184:187]
    ds_read_b64_tr_b16 v[98:99], v12 offset:16384
    s_add_u32 m0, s53, 16384
    s_add_u32 s38, s55, 1343488
    ds_read_b128 v[76:79], v17 offset:47104
    v_mfma_f32_16x16x32_bf16 v[188:191], v[108:111], v[92:95], v[188:191]
    buffer_load_dwordx4 v11, s[20:23], s38 offen offset:0 lds
    s_waitcnt lgkmcnt(12)
    v_mfma_f32_16x16x32_bf16 v[192:195], v[112:115], v[80:83], v[192:195]
    ds_read_b64_tr_b16 v[100:101], v13 offset:0
    ds_read_b64_tr_b16 v[102:103], v13 offset:16384
    s_add_u32 m0, s53, 17280
    v_mfma_f32_16x16x32_bf16 v[196:199], v[112:115], v[84:87], v[196:199]
    buffer_load_dwordx4 v11, s[20:23], s38 offen offset:128 lds
    v_mfma_f32_16x16x32_bf16 v[200:203], v[112:115], v[88:91], v[200:203]
    v_mfma_f32_16x16x32_bf16 v[204:207], v[112:115], v[92:95], v[204:207]
    s_add_u32 m0, s53, 18432
    s_add_u32 s38, s55, 1474560
    s_waitcnt lgkmcnt(12)
    v_mfma_f32_16x16x32_bf16 v[208:211], v[116:119], v[80:83], v[208:211]
    ds_read_b64_tr_b16 v[104:105], v14 offset:0
    ds_read_b64_tr_b16 v[106:107], v14 offset:16384
    v_mfma_f32_16x16x32_bf16 v[212:215], v[116:119], v[84:87], v[212:215]
    buffer_load_dwordx4 v11, s[20:23], s38 offen offset:0 lds
    v_mfma_f32_16x16x32_bf16 v[216:219], v[116:119], v[88:91], v[216:219]
    s_add_u32 m0, s53, 19328
    v_mfma_f32_16x16x32_bf16 v[220:223], v[116:119], v[92:95], v[220:223]
    buffer_load_dwordx4 v11, s[20:23], s38 offen offset:128 lds
    s_waitcnt lgkmcnt(11)
    v_mfma_f32_16x16x32_bf16 v[224:227], v[120:123], v[80:83], v[224:227]
    ds_read_b64_tr_b16 v[108:109], v15 offset:0
    ds_read_b64_tr_b16 v[110:111], v15 offset:16384
    v_mfma_f32_16x16x32_bf16 v[228:231], v[120:123], v[84:87], v[228:231]
    v_mfma_f32_16x16x32_bf16 v[232:235], v[120:123], v[88:91], v[232:235]
    v_mfma_f32_16x16x32_bf16 v[236:239], v[120:123], v[92:95], v[236:239]
    s_waitcnt lgkmcnt(10)
    v_mfma_f32_16x16x32_bf16 v[240:243], v[124:127], v[80:83], v[240:243]
    ds_read_b64_tr_b16 v[112:113], v12 offset:1024
    ds_read_b64_tr_b16 v[114:115], v12 offset:17408
    v_mfma_f32_16x16x32_bf16 v[244:247], v[124:127], v[84:87], v[244:247]
    v_mfma_f32_16x16x32_bf16 v[248:251], v[124:127], v[88:91], v[248:251]
    v_mfma_f32_16x16x32_bf16 v[252:255], v[124:127], v[92:95], v[252:255]
    s_waitcnt lgkmcnt(9)
    v_mfma_f32_16x16x32_bf16 v[128:131], v[96:99], v[64:67], v[128:131]
    ds_read_b64_tr_b16 v[116:117], v13 offset:1024
    ds_read_b64_tr_b16 v[118:119], v13 offset:17408
    v_mfma_f32_16x16x32_bf16 v[132:135], v[96:99], v[68:71], v[132:135]
    s_add_u32 m0, s53, 32768
    s_add_u32 s38, s55, 1572864
    v_mfma_f32_16x16x32_bf16 v[136:139], v[96:99], v[72:75], v[136:139]
    ds_read_b128 v[80:83], v17 offset:5120
    buffer_load_dwordx4 v11, s[20:23], s38 offen offset:0 lds
    s_waitcnt lgkmcnt(11)
    v_mfma_f32_16x16x32_bf16 v[140:143], v[96:99], v[76:79], v[140:143]
    s_waitcnt lgkmcnt(9)
    v_mfma_f32_16x16x32_bf16 v[144:147], v[100:103], v[64:67], v[144:147]
    ds_read_b64_tr_b16 v[120:121], v14 offset:1024
    ds_read_b64_tr_b16 v[122:123], v14 offset:17408
    s_add_u32 m0, s53, 33664
    v_mfma_f32_16x16x32_bf16 v[148:151], v[100:103], v[68:71], v[148:151]
    buffer_load_dwordx4 v11, s[20:23], s38 offen offset:128 lds
    v_mfma_f32_16x16x32_bf16 v[152:155], v[100:103], v[72:75], v[152:155]
    ds_read_b128 v[84:87], v17 offset:19456
    v_mfma_f32_16x16x32_bf16 v[156:159], v[100:103], v[76:79], v[156:159]
    s_add_u32 m0, s53, 34816
    s_add_u32 s38, s55, 1703936
    s_waitcnt lgkmcnt(10)
    v_mfma_f32_16x16x32_bf16 v[160:163], v[104:107], v[64:67], v[160:163]
    ds_read_b64_tr_b16 v[124:125], v15 offset:1024
    ds_read_b64_tr_b16 v[126:127], v15 offset:17408
    v_mfma_f32_16x16x32_bf16 v[164:167], v[104:107], v[68:71], v[164:167]
    buffer_load_dwordx4 v11, s[20:23], s38 offen offset:0 lds
    v_mfma_f32_16x16x32_bf16 v[168:171], v[104:107], v[72:75], v[168:171]
    ds_read_b128 v[88:91], v17 offset:33792
    s_add_u32 m0, s53, 35712
    v_mfma_f32_16x16x32_bf16 v[172:175], v[104:107], v[76:79], v[172:175]
    buffer_load_dwordx4 v11, s[20:23], s38 offen offset:128 lds
    s_waitcnt lgkmcnt(11)
    v_mfma_f32_16x16x32_bf16 v[176:179], v[108:111], v[64:67], v[176:179]
    s_waitcnt vmcnt(4)
    v_add_u32 v12, 4294901760, v12
    v_add_u32 v13, 4294901760, v13
    v_mfma_f32_16x16x32_bf16 v[180:183], v[108:111], v[68:71], v[180:183]
    v_add_u32 v14, 4294901760, v14
    v_add_u32 v15, 4294901760, v15
    ds_read_b64_tr_b16 v[96:97], v12 offset:0
    v_mfma_f32_16x16x32_bf16 v[184:187], v[108:111], v[72:75], v[184:187]
    ds_read_b64_tr_b16 v[98:99], v12 offset:16384
    s_add_u32 m0, s53, 49152
    s_add_u32 s38, s55, 1605632
    ds_read_b128 v[92:95], v17 offset:48128
    v_mfma_f32_16x16x32_bf16 v[188:191], v[108:111], v[76:79], v[188:191]
    buffer_load_dwordx4 v11, s[20:23], s38 offen offset:0 lds
    s_waitcnt lgkmcnt(12)
    v_mfma_f32_16x16x32_bf16 v[192:195], v[112:115], v[64:67], v[192:195]
    ds_read_b64_tr_b16 v[100:101], v13 offset:0
    ds_read_b64_tr_b16 v[102:103], v13 offset:16384
    s_add_u32 m0, s53, 50048
    v_mfma_f32_16x16x32_bf16 v[196:199], v[112:115], v[68:71], v[196:199]
    buffer_load_dwordx4 v11, s[20:23], s38 offen offset:128 lds
    v_mfma_f32_16x16x32_bf16 v[200:203], v[112:115], v[72:75], v[200:203]
    v_mfma_f32_16x16x32_bf16 v[204:207], v[112:115], v[76:79], v[204:207]
    s_add_u32 m0, s53, 51200
    s_add_u32 s38, s55, 1736704
    s_waitcnt lgkmcnt(12)
    v_mfma_f32_16x16x32_bf16 v[208:211], v[116:119], v[64:67], v[208:211]
    ds_read_b64_tr_b16 v[104:105], v14 offset:0
    ds_read_b64_tr_b16 v[106:107], v14 offset:16384
    v_mfma_f32_16x16x32_bf16 v[212:215], v[116:119], v[68:71], v[212:215]
    buffer_load_dwordx4 v11, s[20:23], s38 offen offset:0 lds
    v_mfma_f32_16x16x32_bf16 v[216:219], v[116:119], v[72:75], v[216:219]
    s_add_u32 m0, s53, 52096
    v_mfma_f32_16x16x32_bf16 v[220:223], v[116:119], v[76:79], v[220:223]
    buffer_load_dwordx4 v11, s[20:23], s38 offen offset:128 lds
    s_waitcnt lgkmcnt(11)
    v_mfma_f32_16x16x32_bf16 v[224:227], v[120:123], v[64:67], v[224:227]
    ds_read_b64_tr_b16 v[108:109], v15 offset:0
    ds_read_b64_tr_b16 v[110:111], v15 offset:16384
    v_mfma_f32_16x16x32_bf16 v[228:231], v[120:123], v[68:71], v[228:231]
    v_mfma_f32_16x16x32_bf16 v[232:235], v[120:123], v[72:75], v[232:235]
    v_mfma_f32_16x16x32_bf16 v[236:239], v[120:123], v[76:79], v[236:239]
    s_waitcnt lgkmcnt(10)
    v_mfma_f32_16x16x32_bf16 v[240:243], v[124:127], v[64:67], v[240:243]
    ds_read_b64_tr_b16 v[112:113], v12 offset:1024
    ds_read_b64_tr_b16 v[114:115], v12 offset:17408
    v_mfma_f32_16x16x32_bf16 v[244:247], v[124:127], v[68:71], v[244:247]
    v_mfma_f32_16x16x32_bf16 v[248:251], v[124:127], v[72:75], v[248:251]
    v_mfma_f32_16x16x32_bf16 v[252:255], v[124:127], v[76:79], v[252:255]
    s_waitcnt lgkmcnt(9)
    v_mfma_f32_16x16x32_bf16 v[128:131], v[96:99], v[80:83], v[128:131]
    ds_read_b64_tr_b16 v[116:117], v13 offset:1024
    ds_read_b64_tr_b16 v[118:119], v13 offset:17408
    v_mfma_f32_16x16x32_bf16 v[132:135], v[96:99], v[84:87], v[132:135]
    s_add_u32 m0, s53, 65536
    s_add_u32 s38, s55, 1835008
    v_mfma_f32_16x16x32_bf16 v[136:139], v[96:99], v[88:91], v[136:139]
    ds_read_b128 v[64:67], v17 offset:6144
    buffer_load_dwordx4 v11, s[20:23], s38 offen offset:0 lds
    s_waitcnt lgkmcnt(11)
    v_mfma_f32_16x16x32_bf16 v[140:143], v[96:99], v[92:95], v[140:143]
    s_waitcnt lgkmcnt(9)
    v_mfma_f32_16x16x32_bf16 v[144:147], v[100:103], v[80:83], v[144:147]
    ds_read_b64_tr_b16 v[120:121], v14 offset:1024
    ds_read_b64_tr_b16 v[122:123], v14 offset:17408
    s_add_u32 m0, s53, 66432
    v_mfma_f32_16x16x32_bf16 v[148:151], v[100:103], v[84:87], v[148:151]
    buffer_load_dwordx4 v11, s[20:23], s38 offen offset:128 lds
    v_mfma_f32_16x16x32_bf16 v[152:155], v[100:103], v[88:91], v[152:155]
    ds_read_b128 v[68:71], v17 offset:20480
    v_mfma_f32_16x16x32_bf16 v[156:159], v[100:103], v[92:95], v[156:159]
    s_add_u32 m0, s53, 67584
    s_add_u32 s38, s55, 1966080
    s_waitcnt lgkmcnt(10)
    v_mfma_f32_16x16x32_bf16 v[160:163], v[104:107], v[80:83], v[160:163]
    ds_read_b64_tr_b16 v[124:125], v15 offset:1024
    ds_read_b64_tr_b16 v[126:127], v15 offset:17408
    v_mfma_f32_16x16x32_bf16 v[164:167], v[104:107], v[84:87], v[164:167]
    buffer_load_dwordx4 v11, s[20:23], s38 offen offset:0 lds
    v_mfma_f32_16x16x32_bf16 v[168:171], v[104:107], v[88:91], v[168:171]
    ds_read_b128 v[72:75], v17 offset:34816
    s_add_u32 m0, s53, 68480
    v_mfma_f32_16x16x32_bf16 v[172:175], v[104:107], v[92:95], v[172:175]
    buffer_load_dwordx4 v11, s[20:23], s38 offen offset:128 lds
    s_waitcnt lgkmcnt(11)
    v_mfma_f32_16x16x32_bf16 v[176:179], v[108:111], v[80:83], v[176:179]
    s_waitcnt vmcnt(4)
    ds_read_b64_tr_b16 v[96:97], v12 offset:32768
    ds_read_b64_tr_b16 v[98:99], v12 offset:49152
    v_mfma_f32_16x16x32_bf16 v[180:183], v[108:111], v[84:87], v[180:183]
    s_add_u32 m0, s53, 81920
    s_add_u32 s38, s55, 1867776
    v_mfma_f32_16x16x32_bf16 v[184:187], v[108:111], v[88:91], v[184:187]
    ds_read_b128 v[76:79], v17 offset:49152
    buffer_load_dwordx4 v11, s[20:23], s38 offen offset:0 lds
    v_mfma_f32_16x16x32_bf16 v[188:191], v[108:111], v[92:95], v[188:191]
    s_waitcnt lgkmcnt(12)
    v_mfma_f32_16x16x32_bf16 v[192:195], v[112:115], v[80:83], v[192:195]
    ds_read_b64_tr_b16 v[100:101], v13 offset:32768
    ds_read_b64_tr_b16 v[102:103], v13 offset:49152
    s_add_u32 m0, s53, 82816
    v_mfma_f32_16x16x32_bf16 v[196:199], v[112:115], v[84:87], v[196:199]
    buffer_load_dwordx4 v11, s[20:23], s38 offen offset:128 lds
    v_mfma_f32_16x16x32_bf16 v[200:203], v[112:115], v[88:91], v[200:203]
    v_mfma_f32_16x16x32_bf16 v[204:207], v[112:115], v[92:95], v[204:207]
    s_add_u32 m0, s53, 83968
    s_add_u32 s38, s55, 1998848
    s_waitcnt lgkmcnt(12)
    v_mfma_f32_16x16x32_bf16 v[208:211], v[116:119], v[80:83], v[208:211]
    ds_read_b64_tr_b16 v[104:105], v14 offset:32768
    ds_read_b64_tr_b16 v[106:107], v14 offset:49152
    v_mfma_f32_16x16x32_bf16 v[212:215], v[116:119], v[84:87], v[212:215]
    buffer_load_dwordx4 v11, s[20:23], s38 offen offset:0 lds
    v_mfma_f32_16x16x32_bf16 v[216:219], v[116:119], v[88:91], v[216:219]
    s_add_u32 m0, s53, 84864
    v_mfma_f32_16x16x32_bf16 v[220:223], v[116:119], v[92:95], v[220:223]
    buffer_load_dwordx4 v11, s[20:23], s38 offen offset:128 lds
    s_waitcnt lgkmcnt(11)
    v_mfma_f32_16x16x32_bf16 v[224:227], v[120:123], v[80:83], v[224:227]
    ds_read_b64_tr_b16 v[108:109], v15 offset:32768
    ds_read_b64_tr_b16 v[110:111], v15 offset:49152
    v_mfma_f32_16x16x32_bf16 v[228:231], v[120:123], v[84:87], v[228:231]
    v_mfma_f32_16x16x32_bf16 v[232:235], v[120:123], v[88:91], v[232:235]
    v_mfma_f32_16x16x32_bf16 v[236:239], v[120:123], v[92:95], v[236:239]
    s_waitcnt lgkmcnt(10)
    v_mfma_f32_16x16x32_bf16 v[240:243], v[124:127], v[80:83], v[240:243]
    ds_read_b64_tr_b16 v[112:113], v12 offset:33792
    ds_read_b64_tr_b16 v[114:115], v12 offset:50176
    v_mfma_f32_16x16x32_bf16 v[244:247], v[124:127], v[84:87], v[244:247]
    v_mfma_f32_16x16x32_bf16 v[248:251], v[124:127], v[88:91], v[248:251]
    v_mfma_f32_16x16x32_bf16 v[252:255], v[124:127], v[92:95], v[252:255]
    s_waitcnt lgkmcnt(9)
    v_mfma_f32_16x16x32_bf16 v[128:131], v[96:99], v[64:67], v[128:131]
    ds_read_b64_tr_b16 v[116:117], v13 offset:33792
    ds_read_b64_tr_b16 v[118:119], v13 offset:50176
    v_mfma_f32_16x16x32_bf16 v[132:135], v[96:99], v[68:71], v[132:135]
    s_add_u32 m0, s53, 0
    s_add_u32 s38, s55, 2097152
    v_mfma_f32_16x16x32_bf16 v[136:139], v[96:99], v[72:75], v[136:139]
    ds_read_b128 v[80:83], v17 offset:7168
    buffer_load_dwordx4 v11, s[20:23], s38 offen offset:0 lds
    s_waitcnt lgkmcnt(11)
    v_mfma_f32_16x16x32_bf16 v[140:143], v[96:99], v[76:79], v[140:143]
    s_waitcnt lgkmcnt(9)
    v_mfma_f32_16x16x32_bf16 v[144:147], v[100:103], v[64:67], v[144:147]
    ds_read_b64_tr_b16 v[120:121], v14 offset:33792
    ds_read_b64_tr_b16 v[122:123], v14 offset:50176
    s_add_u32 m0, s53, 896
    v_mfma_f32_16x16x32_bf16 v[148:151], v[100:103], v[68:71], v[148:151]
    buffer_load_dwordx4 v11, s[20:23], s38 offen offset:128 lds
    v_mfma_f32_16x16x32_bf16 v[152:155], v[100:103], v[72:75], v[152:155]
    ds_read_b128 v[84:87], v17 offset:21504
    v_mfma_f32_16x16x32_bf16 v[156:159], v[100:103], v[76:79], v[156:159]
    s_add_u32 m0, s53, 2048
    s_add_u32 s38, s55, 2228224
    s_waitcnt lgkmcnt(10)
    v_mfma_f32_16x16x32_bf16 v[160:163], v[104:107], v[64:67], v[160:163]
    ds_read_b64_tr_b16 v[124:125], v15 offset:33792
    ds_read_b64_tr_b16 v[126:127], v15 offset:50176
    v_mfma_f32_16x16x32_bf16 v[164:167], v[104:107], v[68:71], v[164:167]
    buffer_load_dwordx4 v11, s[20:23], s38 offen offset:0 lds
    v_mfma_f32_16x16x32_bf16 v[168:171], v[104:107], v[72:75], v[168:171]
    ds_read_b128 v[88:91], v17 offset:35840
    s_add_u32 m0, s53, 2944
    v_mfma_f32_16x16x32_bf16 v[172:175], v[104:107], v[76:79], v[172:175]
    buffer_load_dwordx4 v11, s[20:23], s38 offen offset:128 lds
    s_waitcnt lgkmcnt(11)
    v_mfma_f32_16x16x32_bf16 v[176:179], v[108:111], v[64:67], v[176:179]
    s_waitcnt vmcnt(4)
    v_add_u32 v12, 65536, v12
    v_add_u32 v13, 65536, v13
    v_mfma_f32_16x16x32_bf16 v[180:183], v[108:111], v[68:71], v[180:183]
    v_add_u32 v14, 65536, v14
    v_add_u32 v15, 65536, v15
    ds_read_b64_tr_b16 v[96:97], v12 offset:0
    v_mfma_f32_16x16x32_bf16 v[184:187], v[108:111], v[72:75], v[184:187]
    ds_read_b64_tr_b16 v[98:99], v12 offset:16384
    s_add_u32 m0, s53, 16384
    s_add_u32 s38, s55, 2129920
    ds_read_b128 v[92:95], v17 offset:50176
    v_mfma_f32_16x16x32_bf16 v[188:191], v[108:111], v[76:79], v[188:191]
    buffer_load_dwordx4 v11, s[20:23], s38 offen offset:0 lds
    s_waitcnt lgkmcnt(12)
    v_mfma_f32_16x16x32_bf16 v[192:195], v[112:115], v[64:67], v[192:195]
    ds_read_b64_tr_b16 v[100:101], v13 offset:0
    ds_read_b64_tr_b16 v[102:103], v13 offset:16384
    s_add_u32 m0, s53, 17280
    v_mfma_f32_16x16x32_bf16 v[196:199], v[112:115], v[68:71], v[196:199]
    buffer_load_dwordx4 v11, s[20:23], s38 offen offset:128 lds
    v_mfma_f32_16x16x32_bf16 v[200:203], v[112:115], v[72:75], v[200:203]
    v_mfma_f32_16x16x32_bf16 v[204:207], v[112:115], v[76:79], v[204:207]
    s_add_u32 m0, s53, 18432
    s_add_u32 s38, s55, 2260992
    s_waitcnt lgkmcnt(12)
    v_mfma_f32_16x16x32_bf16 v[208:211], v[116:119], v[64:67], v[208:211]
    ds_read_b64_tr_b16 v[104:105], v14 offset:0
    ds_read_b64_tr_b16 v[106:107], v14 offset:16384
    v_mfma_f32_16x16x32_bf16 v[212:215], v[116:119], v[68:71], v[212:215]
    buffer_load_dwordx4 v11, s[20:23], s38 offen offset:0 lds
    v_mfma_f32_16x16x32_bf16 v[216:219], v[116:119], v[72:75], v[216:219]
    s_add_u32 m0, s53, 19328
    v_mfma_f32_16x16x32_bf16 v[220:223], v[116:119], v[76:79], v[220:223]
    buffer_load_dwordx4 v11, s[20:23], s38 offen offset:128 lds
    s_waitcnt lgkmcnt(11)
    v_mfma_f32_16x16x32_bf16 v[224:227], v[120:123], v[64:67], v[224:227]
    ds_read_b64_tr_b16 v[108:109], v15 offset:0
    ds_read_b64_tr_b16 v[110:111], v15 offset:16384
    v_mfma_f32_16x16x32_bf16 v[228:231], v[120:123], v[68:71], v[228:231]
    v_mfma_f32_16x16x32_bf16 v[232:235], v[120:123], v[72:75], v[232:235]
    v_mfma_f32_16x16x32_bf16 v[236:239], v[120:123], v[76:79], v[236:239]
    s_waitcnt lgkmcnt(10)
    v_mfma_f32_16x16x32_bf16 v[240:243], v[124:127], v[64:67], v[240:243]
    ds_read_b64_tr_b16 v[112:113], v12 offset:1024
    ds_read_b64_tr_b16 v[114:115], v12 offset:17408
    v_mfma_f32_16x16x32_bf16 v[244:247], v[124:127], v[68:71], v[244:247]
    v_mfma_f32_16x16x32_bf16 v[248:251], v[124:127], v[72:75], v[248:251]
    v_mfma_f32_16x16x32_bf16 v[252:255], v[124:127], v[76:79], v[252:255]
    s_waitcnt lgkmcnt(9)
    v_mfma_f32_16x16x32_bf16 v[128:131], v[96:99], v[80:83], v[128:131]
    ds_read_b64_tr_b16 v[116:117], v13 offset:1024
    ds_read_b64_tr_b16 v[118:119], v13 offset:17408
    v_mfma_f32_16x16x32_bf16 v[132:135], v[96:99], v[84:87], v[132:135]
    s_add_u32 m0, s53, 32768
    s_add_u32 s38, s55, 2359296
    v_mfma_f32_16x16x32_bf16 v[136:139], v[96:99], v[88:91], v[136:139]
    ds_read_b128 v[64:67], v17 offset:8192
    buffer_load_dwordx4 v11, s[20:23], s38 offen offset:0 lds
    s_waitcnt lgkmcnt(11)
    v_mfma_f32_16x16x32_bf16 v[140:143], v[96:99], v[92:95], v[140:143]
    s_waitcnt lgkmcnt(9)
    v_mfma_f32_16x16x32_bf16 v[144:147], v[100:103], v[80:83], v[144:147]
    ds_read_b64_tr_b16 v[120:121], v14 offset:1024
    ds_read_b64_tr_b16 v[122:123], v14 offset:17408
    s_add_u32 m0, s53, 33664
    v_mfma_f32_16x16x32_bf16 v[148:151], v[100:103], v[84:87], v[148:151]
    buffer_load_dwordx4 v11, s[20:23], s38 offen offset:128 lds
    v_mfma_f32_16x16x32_bf16 v[152:155], v[100:103], v[88:91], v[152:155]
    ds_read_b128 v[68:71], v17 offset:22528
    v_mfma_f32_16x16x32_bf16 v[156:159], v[100:103], v[92:95], v[156:159]
    s_add_u32 m0, s53, 34816
    s_add_u32 s38, s55, 2490368
    s_waitcnt lgkmcnt(10)
    v_mfma_f32_16x16x32_bf16 v[160:163], v[104:107], v[80:83], v[160:163]
    ds_read_b64_tr_b16 v[124:125], v15 offset:1024
    ds_read_b64_tr_b16 v[126:127], v15 offset:17408
    v_mfma_f32_16x16x32_bf16 v[164:167], v[104:107], v[84:87], v[164:167]
    buffer_load_dwordx4 v11, s[20:23], s38 offen offset:0 lds
    v_mfma_f32_16x16x32_bf16 v[168:171], v[104:107], v[88:91], v[168:171]
    ds_read_b128 v[72:75], v17 offset:36864
    s_add_u32 m0, s53, 35712
    v_mfma_f32_16x16x32_bf16 v[172:175], v[104:107], v[92:95], v[172:175]
    buffer_load_dwordx4 v11, s[20:23], s38 offen offset:128 lds
    s_waitcnt lgkmcnt(11)
    v_mfma_f32_16x16x32_bf16 v[176:179], v[108:111], v[80:83], v[176:179]
    s_waitcnt vmcnt(4)
    v_add_u32 v12, 4294901760, v12
    v_add_u32 v13, 4294901760, v13
    v_mfma_f32_16x16x32_bf16 v[180:183], v[108:111], v[84:87], v[180:183]
    v_add_u32 v14, 4294901760, v14
    v_add_u32 v15, 4294901760, v15
    ds_read_b64_tr_b16 v[96:97], v12 offset:0
    v_mfma_f32_16x16x32_bf16 v[184:187], v[108:111], v[88:91], v[184:187]
    ds_read_b64_tr_b16 v[98:99], v12 offset:16384
    s_add_u32 m0, s53, 49152
    s_add_u32 s38, s55, 2392064
    ds_read_b128 v[76:79], v17 offset:51200
    v_mfma_f32_16x16x32_bf16 v[188:191], v[108:111], v[92:95], v[188:191]
    buffer_load_dwordx4 v11, s[20:23], s38 offen offset:0 lds
    s_waitcnt lgkmcnt(12)
    v_mfma_f32_16x16x32_bf16 v[192:195], v[112:115], v[80:83], v[192:195]
    ds_read_b64_tr_b16 v[100:101], v13 offset:0
    ds_read_b64_tr_b16 v[102:103], v13 offset:16384
    s_add_u32 m0, s53, 50048
    v_mfma_f32_16x16x32_bf16 v[196:199], v[112:115], v[84:87], v[196:199]
    buffer_load_dwordx4 v11, s[20:23], s38 offen offset:128 lds
    v_mfma_f32_16x16x32_bf16 v[200:203], v[112:115], v[88:91], v[200:203]
    v_mfma_f32_16x16x32_bf16 v[204:207], v[112:115], v[92:95], v[204:207]
    s_add_u32 m0, s53, 51200
    s_add_u32 s38, s55, 2523136
    s_waitcnt lgkmcnt(12)
    v_mfma_f32_16x16x32_bf16 v[208:211], v[116:119], v[80:83], v[208:211]
    ds_read_b64_tr_b16 v[104:105], v14 offset:0
    ds_read_b64_tr_b16 v[106:107], v14 offset:16384
    v_mfma_f32_16x16x32_bf16 v[212:215], v[116:119], v[84:87], v[212:215]
    buffer_load_dwordx4 v11, s[20:23], s38 offen offset:0 lds
    v_mfma_f32_16x16x32_bf16 v[216:219], v[116:119], v[88:91], v[216:219]
    s_add_u32 m0, s53, 52096
    v_mfma_f32_16x16x32_bf16 v[220:223], v[116:119], v[92:95], v[220:223]
    buffer_load_dwordx4 v11, s[20:23], s38 offen offset:128 lds
    s_waitcnt lgkmcnt(11)
    v_mfma_f32_16x16x32_bf16 v[224:227], v[120:123], v[80:83], v[224:227]
    ds_read_b64_tr_b16 v[108:109], v15 offset:0
    ds_read_b64_tr_b16 v[110:111], v15 offset:16384
    v_mfma_f32_16x16x32_bf16 v[228:231], v[120:123], v[84:87], v[228:231]
    v_mfma_f32_16x16x32_bf16 v[232:235], v[120:123], v[88:91], v[232:235]
    v_mfma_f32_16x16x32_bf16 v[236:239], v[120:123], v[92:95], v[236:239]
    s_waitcnt lgkmcnt(10)
    v_mfma_f32_16x16x32_bf16 v[240:243], v[124:127], v[80:83], v[240:243]
    ds_read_b64_tr_b16 v[112:113], v12 offset:1024
    ds_read_b64_tr_b16 v[114:115], v12 offset:17408
    v_mfma_f32_16x16x32_bf16 v[244:247], v[124:127], v[84:87], v[244:247]
    v_mfma_f32_16x16x32_bf16 v[248:251], v[124:127], v[88:91], v[248:251]
    v_mfma_f32_16x16x32_bf16 v[252:255], v[124:127], v[92:95], v[252:255]
    s_waitcnt lgkmcnt(9)
    v_mfma_f32_16x16x32_bf16 v[128:131], v[96:99], v[64:67], v[128:131]
    ds_read_b64_tr_b16 v[116:117], v13 offset:1024
    ds_read_b64_tr_b16 v[118:119], v13 offset:17408
    v_mfma_f32_16x16x32_bf16 v[132:135], v[96:99], v[68:71], v[132:135]
    s_add_u32 m0, s53, 65536
    s_add_u32 s38, s55, 2621440
    v_mfma_f32_16x16x32_bf16 v[136:139], v[96:99], v[72:75], v[136:139]
    ds_read_b128 v[80:83], v17 offset:9216
    buffer_load_dwordx4 v11, s[20:23], s38 offen offset:0 lds
    s_waitcnt lgkmcnt(11)
    v_mfma_f32_16x16x32_bf16 v[140:143], v[96:99], v[76:79], v[140:143]
    s_waitcnt lgkmcnt(9)
    v_mfma_f32_16x16x32_bf16 v[144:147], v[100:103], v[64:67], v[144:147]
    ds_read_b64_tr_b16 v[120:121], v14 offset:1024
    ds_read_b64_tr_b16 v[122:123], v14 offset:17408
    s_add_u32 m0, s53, 66432
    v_mfma_f32_16x16x32_bf16 v[148:151], v[100:103], v[68:71], v[148:151]
    buffer_load_dwordx4 v11, s[20:23], s38 offen offset:128 lds
    v_mfma_f32_16x16x32_bf16 v[152:155], v[100:103], v[72:75], v[152:155]
    ds_read_b128 v[84:87], v17 offset:23552
    v_mfma_f32_16x16x32_bf16 v[156:159], v[100:103], v[76:79], v[156:159]
    s_add_u32 m0, s53, 67584
    s_add_u32 s38, s55, 2752512
    s_waitcnt lgkmcnt(10)
    v_mfma_f32_16x16x32_bf16 v[160:163], v[104:107], v[64:67], v[160:163]
    ds_read_b64_tr_b16 v[124:125], v15 offset:1024
    ds_read_b64_tr_b16 v[126:127], v15 offset:17408
    v_mfma_f32_16x16x32_bf16 v[164:167], v[104:107], v[68:71], v[164:167]
    buffer_load_dwordx4 v11, s[20:23], s38 offen offset:0 lds
    v_mfma_f32_16x16x32_bf16 v[168:171], v[104:107], v[72:75], v[168:171]
    ds_read_b128 v[88:91], v17 offset:37888
    s_add_u32 m0, s53, 68480
    v_mfma_f32_16x16x32_bf16 v[172:175], v[104:107], v[76:79], v[172:175]
    buffer_load_dwordx4 v11, s[20:23], s38 offen offset:128 lds
    s_waitcnt lgkmcnt(11)
    v_mfma_f32_16x16x32_bf16 v[176:179], v[108:111], v[64:67], v[176:179]
    s_waitcnt vmcnt(4)
    ds_read_b64_tr_b16 v[96:97], v12 offset:32768
    ds_read_b64_tr_b16 v[98:99], v12 offset:49152
    v_mfma_f32_16x16x32_bf16 v[180:183], v[108:111], v[68:71], v[180:183]
    s_add_u32 m0, s53, 81920
    s_add_u32 s38, s55, 2654208
    v_mfma_f32_16x16x32_bf16 v[184:187], v[108:111], v[72:75], v[184:187]
    ds_read_b128 v[92:95], v17 offset:52224
    buffer_load_dwordx4 v11, s[20:23], s38 offen offset:0 lds
    v_mfma_f32_16x16x32_bf16 v[188:191], v[108:111], v[76:79], v[188:191]
    s_waitcnt lgkmcnt(12)
    v_mfma_f32_16x16x32_bf16 v[192:195], v[112:115], v[64:67], v[192:195]
    ds_read_b64_tr_b16 v[100:101], v13 offset:32768
    ds_read_b64_tr_b16 v[102:103], v13 offset:49152
    s_add_u32 m0, s53, 82816
    v_mfma_f32_16x16x32_bf16 v[196:199], v[112:115], v[68:71], v[196:199]
    buffer_load_dwordx4 v11, s[20:23], s38 offen offset:128 lds
    v_mfma_f32_16x16x32_bf16 v[200:203], v[112:115], v[72:75], v[200:203]
    v_mfma_f32_16x16x32_bf16 v[204:207], v[112:115], v[76:79], v[204:207]
    s_add_u32 m0, s53, 83968
    s_add_u32 s38, s55, 2785280
    s_waitcnt lgkmcnt(12)
    v_mfma_f32_16x16x32_bf16 v[208:211], v[116:119], v[64:67], v[208:211]
    ds_read_b64_tr_b16 v[104:105], v14 offset:32768
    ds_read_b64_tr_b16 v[106:107], v14 offset:49152
    v_mfma_f32_16x16x32_bf16 v[212:215], v[116:119], v[68:71], v[212:215]
    buffer_load_dwordx4 v11, s[20:23], s38 offen offset:0 lds
    v_mfma_f32_16x16x32_bf16 v[216:219], v[116:119], v[72:75], v[216:219]
    s_add_u32 m0, s53, 84864
    v_mfma_f32_16x16x32_bf16 v[220:223], v[116:119], v[76:79], v[220:223]
    buffer_load_dwordx4 v11, s[20:23], s38 offen offset:128 lds
    s_waitcnt lgkmcnt(11)
    v_mfma_f32_16x16x32_bf16 v[224:227], v[120:123], v[64:67], v[224:227]
    ds_read_b64_tr_b16 v[108:109], v15 offset:32768
    ds_read_b64_tr_b16 v[110:111], v15 offset:49152
    v_mfma_f32_16x16x32_bf16 v[228:231], v[120:123], v[68:71], v[228:231]
    v_mfma_f32_16x16x32_bf16 v[232:235], v[120:123], v[72:75], v[232:235]
    v_mfma_f32_16x16x32_bf16 v[236:239], v[120:123], v[76:79], v[236:239]
    s_waitcnt lgkmcnt(10)
    v_mfma_f32_16x16x32_bf16 v[240:243], v[124:127], v[64:67], v[240:243]
    ds_read_b64_tr_b16 v[112:113], v12 offset:33792
    ds_read_b64_tr_b16 v[114:115], v12 offset:50176
    v_mfma_f32_16x16x32_bf16 v[244:247], v[124:127], v[68:71], v[244:247]
    v_mfma_f32_16x16x32_bf16 v[248:251], v[124:127], v[72:75], v[248:251]
    v_mfma_f32_16x16x32_bf16 v[252:255], v[124:127], v[76:79], v[252:255]
    s_waitcnt lgkmcnt(9)
    v_mfma_f32_16x16x32_bf16 v[128:131], v[96:99], v[80:83], v[128:131]
    ds_read_b64_tr_b16 v[116:117], v13 offset:33792
    ds_read_b64_tr_b16 v[118:119], v13 offset:50176
    v_mfma_f32_16x16x32_bf16 v[132:135], v[96:99], v[84:87], v[132:135]
    s_add_u32 m0, s53, 0
    s_add_u32 s38, s55, 2883584
    v_mfma_f32_16x16x32_bf16 v[136:139], v[96:99], v[88:91], v[136:139]
    ds_read_b128 v[64:67], v17 offset:10240
    buffer_load_dwordx4 v11, s[20:23], s38 offen offset:0 lds
    s_waitcnt lgkmcnt(11)
    v_mfma_f32_16x16x32_bf16 v[140:143], v[96:99], v[92:95], v[140:143]
    s_waitcnt lgkmcnt(9)
    v_mfma_f32_16x16x32_bf16 v[144:147], v[100:103], v[80:83], v[144:147]
    ds_read_b64_tr_b16 v[120:121], v14 offset:33792
    ds_read_b64_tr_b16 v[122:123], v14 offset:50176
    s_add_u32 m0, s53, 896
    v_mfma_f32_16x16x32_bf16 v[148:151], v[100:103], v[84:87], v[148:151]
    buffer_load_dwordx4 v11, s[20:23], s38 offen offset:128 lds
    v_mfma_f32_16x16x32_bf16 v[152:155], v[100:103], v[88:91], v[152:155]
    ds_read_b128 v[68:71], v17 offset:24576
    v_mfma_f32_16x16x32_bf16 v[156:159], v[100:103], v[92:95], v[156:159]
    s_add_u32 m0, s53, 2048
    s_add_u32 s38, s55, 3014656
    s_waitcnt lgkmcnt(10)
    v_mfma_f32_16x16x32_bf16 v[160:163], v[104:107], v[80:83], v[160:163]
    ds_read_b64_tr_b16 v[124:125], v15 offset:33792
    ds_read_b64_tr_b16 v[126:127], v15 offset:50176
    v_mfma_f32_16x16x32_bf16 v[164:167], v[104:107], v[84:87], v[164:167]
    buffer_load_dwordx4 v11, s[20:23], s38 offen offset:0 lds
    v_mfma_f32_16x16x32_bf16 v[168:171], v[104:107], v[88:91], v[168:171]
    ds_read_b128 v[72:75], v17 offset:38912
    s_add_u32 m0, s53, 2944
    v_mfma_f32_16x16x32_bf16 v[172:175], v[104:107], v[92:95], v[172:175]
    buffer_load_dwordx4 v11, s[20:23], s38 offen offset:128 lds
    s_waitcnt lgkmcnt(11)
    v_mfma_f32_16x16x32_bf16 v[176:179], v[108:111], v[80:83], v[176:179]
    s_waitcnt vmcnt(4)
    v_add_u32 v12, 65536, v12
    v_add_u32 v13, 65536, v13
    v_mfma_f32_16x16x32_bf16 v[180:183], v[108:111], v[84:87], v[180:183]
    v_add_u32 v14, 65536, v14
    v_add_u32 v15, 65536, v15
    ds_read_b64_tr_b16 v[96:97], v12 offset:0
    v_mfma_f32_16x16x32_bf16 v[184:187], v[108:111], v[88:91], v[184:187]
    ds_read_b64_tr_b16 v[98:99], v12 offset:16384
    s_add_u32 m0, s53, 16384
    s_add_u32 s38, s55, 2916352
    ds_read_b128 v[76:79], v17 offset:53248
    v_mfma_f32_16x16x32_bf16 v[188:191], v[108:111], v[92:95], v[188:191]
    buffer_load_dwordx4 v11, s[20:23], s38 offen offset:0 lds
    s_waitcnt lgkmcnt(12)
    v_mfma_f32_16x16x32_bf16 v[192:195], v[112:115], v[80:83], v[192:195]
    ds_read_b64_tr_b16 v[100:101], v13 offset:0
    ds_read_b64_tr_b16 v[102:103], v13 offset:16384
    s_add_u32 m0, s53, 17280
    v_mfma_f32_16x16x32_bf16 v[196:199], v[112:115], v[84:87], v[196:199]
    buffer_load_dwordx4 v11, s[20:23], s38 offen offset:128 lds
    v_mfma_f32_16x16x32_bf16 v[200:203], v[112:115], v[88:91], v[200:203]
    v_mfma_f32_16x16x32_bf16 v[204:207], v[112:115], v[92:95], v[204:207]
    s_add_u32 m0, s53, 18432
    s_add_u32 s38, s55, 3047424
    s_waitcnt lgkmcnt(12)
    v_mfma_f32_16x16x32_bf16 v[208:211], v[116:119], v[80:83], v[208:211]
    ds_read_b64_tr_b16 v[104:105], v14 offset:0
    ds_read_b64_tr_b16 v[106:107], v14 offset:16384
    v_mfma_f32_16x16x32_bf16 v[212:215], v[116:119], v[84:87], v[212:215]
    buffer_load_dwordx4 v11, s[20:23], s38 offen offset:0 lds
    v_mfma_f32_16x16x32_bf16 v[216:219], v[116:119], v[88:91], v[216:219]
    s_add_u32 m0, s53, 19328
    v_mfma_f32_16x16x32_bf16 v[220:223], v[116:119], v[92:95], v[220:223]
    buffer_load_dwordx4 v11, s[20:23], s38 offen offset:128 lds
    s_waitcnt lgkmcnt(11)
    v_mfma_f32_16x16x32_bf16 v[224:227], v[120:123], v[80:83], v[224:227]
    ds_read_b64_tr_b16 v[108:109], v15 offset:0
    ds_read_b64_tr_b16 v[110:111], v15 offset:16384
    v_mfma_f32_16x16x32_bf16 v[228:231], v[120:123], v[84:87], v[228:231]
    v_mfma_f32_16x16x32_bf16 v[232:235], v[120:123], v[88:91], v[232:235]
    v_mfma_f32_16x16x32_bf16 v[236:239], v[120:123], v[92:95], v[236:239]
    s_waitcnt lgkmcnt(10)
    v_mfma_f32_16x16x32_bf16 v[240:243], v[124:127], v[80:83], v[240:243]
    ds_read_b64_tr_b16 v[112:113], v12 offset:1024
    ds_read_b64_tr_b16 v[114:115], v12 offset:17408
    v_mfma_f32_16x16x32_bf16 v[244:247], v[124:127], v[84:87], v[244:247]
    v_mfma_f32_16x16x32_bf16 v[248:251], v[124:127], v[88:91], v[248:251]
    v_mfma_f32_16x16x32_bf16 v[252:255], v[124:127], v[92:95], v[252:255]
    s_waitcnt lgkmcnt(9)
    v_mfma_f32_16x16x32_bf16 v[128:131], v[96:99], v[64:67], v[128:131]
    ds_read_b64_tr_b16 v[116:117], v13 offset:1024
    ds_read_b64_tr_b16 v[118:119], v13 offset:17408
    v_mfma_f32_16x16x32_bf16 v[132:135], v[96:99], v[68:71], v[132:135]
    s_add_u32 m0, s53, 32768
    s_add_u32 s38, s55, 3145728
    v_mfma_f32_16x16x32_bf16 v[136:139], v[96:99], v[72:75], v[136:139]
    ds_read_b128 v[80:83], v17 offset:11264
    buffer_load_dwordx4 v11, s[20:23], s38 offen offset:0 lds
    s_waitcnt lgkmcnt(11)
    v_mfma_f32_16x16x32_bf16 v[140:143], v[96:99], v[76:79], v[140:143]
    s_waitcnt lgkmcnt(9)
    v_mfma_f32_16x16x32_bf16 v[144:147], v[100:103], v[64:67], v[144:147]
    ds_read_b64_tr_b16 v[120:121], v14 offset:1024
    ds_read_b64_tr_b16 v[122:123], v14 offset:17408
    s_add_u32 m0, s53, 33664
    v_mfma_f32_16x16x32_bf16 v[148:151], v[100:103], v[68:71], v[148:151]
    buffer_load_dwordx4 v11, s[20:23], s38 offen offset:128 lds
    v_mfma_f32_16x16x32_bf16 v[152:155], v[100:103], v[72:75], v[152:155]
    ds_read_b128 v[84:87], v17 offset:25600
    v_mfma_f32_16x16x32_bf16 v[156:159], v[100:103], v[76:79], v[156:159]
    s_add_u32 m0, s53, 34816
    s_add_u32 s38, s55, 3276800
    s_waitcnt lgkmcnt(10)
    v_mfma_f32_16x16x32_bf16 v[160:163], v[104:107], v[64:67], v[160:163]
    ds_read_b64_tr_b16 v[124:125], v15 offset:1024
    ds_read_b64_tr_b16 v[126:127], v15 offset:17408
    v_mfma_f32_16x16x32_bf16 v[164:167], v[104:107], v[68:71], v[164:167]
    buffer_load_dwordx4 v11, s[20:23], s38 offen offset:0 lds
    v_mfma_f32_16x16x32_bf16 v[168:171], v[104:107], v[72:75], v[168:171]
    ds_read_b128 v[88:91], v17 offset:39936
    s_add_u32 m0, s53, 35712
    v_mfma_f32_16x16x32_bf16 v[172:175], v[104:107], v[76:79], v[172:175]
    buffer_load_dwordx4 v11, s[20:23], s38 offen offset:128 lds
    s_waitcnt lgkmcnt(11)
    v_mfma_f32_16x16x32_bf16 v[176:179], v[108:111], v[64:67], v[176:179]
    s_waitcnt vmcnt(4)
    v_add_u32 v12, 4294901760, v12
    v_add_u32 v13, 4294901760, v13
    v_mfma_f32_16x16x32_bf16 v[180:183], v[108:111], v[68:71], v[180:183]
    v_add_u32 v14, 4294901760, v14
    v_add_u32 v15, 4294901760, v15
    ds_read_b64_tr_b16 v[96:97], v12 offset:0
    v_mfma_f32_16x16x32_bf16 v[184:187], v[108:111], v[72:75], v[184:187]
    ds_read_b64_tr_b16 v[98:99], v12 offset:16384
    s_add_u32 m0, s53, 49152
    s_add_u32 s38, s55, 3178496
    ds_read_b128 v[92:95], v17 offset:54272
    v_mfma_f32_16x16x32_bf16 v[188:191], v[108:111], v[76:79], v[188:191]
    buffer_load_dwordx4 v11, s[20:23], s38 offen offset:0 lds
    s_waitcnt lgkmcnt(12)
    v_mfma_f32_16x16x32_bf16 v[192:195], v[112:115], v[64:67], v[192:195]
    ds_read_b64_tr_b16 v[100:101], v13 offset:0
    ds_read_b64_tr_b16 v[102:103], v13 offset:16384
    s_add_u32 m0, s53, 50048
    v_mfma_f32_16x16x32_bf16 v[196:199], v[112:115], v[68:71], v[196:199]
    buffer_load_dwordx4 v11, s[20:23], s38 offen offset:128 lds
    v_mfma_f32_16x16x32_bf16 v[200:203], v[112:115], v[72:75], v[200:203]
    v_mfma_f32_16x16x32_bf16 v[204:207], v[112:115], v[76:79], v[204:207]
    s_add_u32 m0, s53, 51200
    s_add_u32 s38, s55, 3309568
    s_waitcnt lgkmcnt(12)
    v_mfma_f32_16x16x32_bf16 v[208:211], v[116:119], v[64:67], v[208:211]
    ds_read_b64_tr_b16 v[104:105], v14 offset:0
    ds_read_b64_tr_b16 v[106:107], v14 offset:16384
    v_mfma_f32_16x16x32_bf16 v[212:215], v[116:119], v[68:71], v[212:215]
    buffer_load_dwordx4 v11, s[20:23], s38 offen offset:0 lds
    v_mfma_f32_16x16x32_bf16 v[216:219], v[116:119], v[72:75], v[216:219]
    s_add_u32 m0, s53, 52096
    v_mfma_f32_16x16x32_bf16 v[220:223], v[116:119], v[76:79], v[220:223]
    buffer_load_dwordx4 v11, s[20:23], s38 offen offset:128 lds
    s_waitcnt lgkmcnt(11)
    v_mfma_f32_16x16x32_bf16 v[224:227], v[120:123], v[64:67], v[224:227]
    ds_read_b64_tr_b16 v[108:109], v15 offset:0
    ds_read_b64_tr_b16 v[110:111], v15 offset:16384
    v_mfma_f32_16x16x32_bf16 v[228:231], v[120:123], v[68:71], v[228:231]
    v_mfma_f32_16x16x32_bf16 v[232:235], v[120:123], v[72:75], v[232:235]
    v_mfma_f32_16x16x32_bf16 v[236:239], v[120:123], v[76:79], v[236:239]
    s_waitcnt lgkmcnt(10)
    v_mfma_f32_16x16x32_bf16 v[240:243], v[124:127], v[64:67], v[240:243]
    ds_read_b64_tr_b16 v[112:113], v12 offset:1024
    ds_read_b64_tr_b16 v[114:115], v12 offset:17408
    v_mfma_f32_16x16x32_bf16 v[244:247], v[124:127], v[68:71], v[244:247]
    v_mfma_f32_16x16x32_bf16 v[248:251], v[124:127], v[72:75], v[248:251]
    v_mfma_f32_16x16x32_bf16 v[252:255], v[124:127], v[76:79], v[252:255]
    s_waitcnt lgkmcnt(9)
    v_mfma_f32_16x16x32_bf16 v[128:131], v[96:99], v[80:83], v[128:131]
    ds_read_b64_tr_b16 v[116:117], v13 offset:1024
    ds_read_b64_tr_b16 v[118:119], v13 offset:17408
    v_mfma_f32_16x16x32_bf16 v[132:135], v[96:99], v[84:87], v[132:135]
    s_add_u32 m0, s53, 65536
    s_add_u32 s38, s55, 3407872
    v_mfma_f32_16x16x32_bf16 v[136:139], v[96:99], v[88:91], v[136:139]
    ds_read_b128 v[64:67], v17 offset:12288
    buffer_load_dwordx4 v11, s[20:23], s38 offen offset:0 lds
    s_waitcnt lgkmcnt(11)
    v_mfma_f32_16x16x32_bf16 v[140:143], v[96:99], v[92:95], v[140:143]
    s_waitcnt lgkmcnt(9)
    v_mfma_f32_16x16x32_bf16 v[144:147], v[100:103], v[80:83], v[144:147]
    ds_read_b64_tr_b16 v[120:121], v14 offset:1024
    ds_read_b64_tr_b16 v[122:123], v14 offset:17408
    s_add_u32 m0, s53, 66432
    v_mfma_f32_16x16x32_bf16 v[148:151], v[100:103], v[84:87], v[148:151]
    buffer_load_dwordx4 v11, s[20:23], s38 offen offset:128 lds
    v_mfma_f32_16x16x32_bf16 v[152:155], v[100:103], v[88:91], v[152:155]
    ds_read_b128 v[68:71], v17 offset:26624
    v_mfma_f32_16x16x32_bf16 v[156:159], v[100:103], v[92:95], v[156:159]
    s_add_u32 m0, s53, 67584
    s_add_u32 s38, s55, 3538944
    s_waitcnt lgkmcnt(10)
    v_mfma_f32_16x16x32_bf16 v[160:163], v[104:107], v[80:83], v[160:163]
    ds_read_b64_tr_b16 v[124:125], v15 offset:1024
    ds_read_b64_tr_b16 v[126:127], v15 offset:17408
    v_mfma_f32_16x16x32_bf16 v[164:167], v[104:107], v[84:87], v[164:167]
    buffer_load_dwordx4 v11, s[20:23], s38 offen offset:0 lds
    v_mfma_f32_16x16x32_bf16 v[168:171], v[104:107], v[88:91], v[168:171]
    ds_read_b128 v[72:75], v17 offset:40960
    s_add_u32 m0, s53, 68480
    v_mfma_f32_16x16x32_bf16 v[172:175], v[104:107], v[92:95], v[172:175]
    buffer_load_dwordx4 v11, s[20:23], s38 offen offset:128 lds
    s_waitcnt lgkmcnt(11)
    v_mfma_f32_16x16x32_bf16 v[176:179], v[108:111], v[80:83], v[176:179]
    s_waitcnt vmcnt(4)
    ds_read_b64_tr_b16 v[96:97], v12 offset:32768
    ds_read_b64_tr_b16 v[98:99], v12 offset:49152
    v_mfma_f32_16x16x32_bf16 v[180:183], v[108:111], v[84:87], v[180:183]
    s_add_u32 m0, s53, 81920
    s_add_u32 s38, s55, 3440640
    v_mfma_f32_16x16x32_bf16 v[184:187], v[108:111], v[88:91], v[184:187]
    ds_read_b128 v[76:79], v17 offset:55296
    buffer_load_dwordx4 v11, s[20:23], s38 offen offset:0 lds
    v_mfma_f32_16x16x32_bf16 v[188:191], v[108:111], v[92:95], v[188:191]
    s_waitcnt lgkmcnt(12)
    v_mfma_f32_16x16x32_bf16 v[192:195], v[112:115], v[80:83], v[192:195]
    ds_read_b64_tr_b16 v[100:101], v13 offset:32768
    ds_read_b64_tr_b16 v[102:103], v13 offset:49152
    s_add_u32 m0, s53, 82816
    v_mfma_f32_16x16x32_bf16 v[196:199], v[112:115], v[84:87], v[196:199]
    buffer_load_dwordx4 v11, s[20:23], s38 offen offset:128 lds
    v_mfma_f32_16x16x32_bf16 v[200:203], v[112:115], v[88:91], v[200:203]
    v_mfma_f32_16x16x32_bf16 v[204:207], v[112:115], v[92:95], v[204:207]
    s_add_u32 m0, s53, 83968
    s_add_u32 s38, s55, 3571712
    s_waitcnt lgkmcnt(12)
    v_mfma_f32_16x16x32_bf16 v[208:211], v[116:119], v[80:83], v[208:211]
    ds_read_b64_tr_b16 v[104:105], v14 offset:32768
    ds_read_b64_tr_b16 v[106:107], v14 offset:49152
    v_mfma_f32_16x16x32_bf16 v[212:215], v[116:119], v[84:87], v[212:215]
    buffer_load_dwordx4 v11, s[20:23], s38 offen offset:0 lds
    v_mfma_f32_16x16x32_bf16 v[216:219], v[116:119], v[88:91], v[216:219]
    s_add_u32 m0, s53, 84864
    v_mfma_f32_16x16x32_bf16 v[220:223], v[116:119], v[92:95], v[220:223]
    buffer_load_dwordx4 v11, s[20:23], s38 offen offset:128 lds
    s_waitcnt lgkmcnt(11)
    v_mfma_f32_16x16x32_bf16 v[224:227], v[120:123], v[80:83], v[224:227]
    ds_read_b64_tr_b16 v[108:109], v15 offset:32768
    ds_read_b64_tr_b16 v[110:111], v15 offset:49152
    v_mfma_f32_16x16x32_bf16 v[228:231], v[120:123], v[84:87], v[228:231]
    v_mfma_f32_16x16x32_bf16 v[232:235], v[120:123], v[88:91], v[232:235]
    v_mfma_f32_16x16x32_bf16 v[236:239], v[120:123], v[92:95], v[236:239]
    s_waitcnt lgkmcnt(10)
    v_mfma_f32_16x16x32_bf16 v[240:243], v[124:127], v[80:83], v[240:243]
    ds_read_b64_tr_b16 v[112:113], v12 offset:33792
    ds_read_b64_tr_b16 v[114:115], v12 offset:50176
    v_mfma_f32_16x16x32_bf16 v[244:247], v[124:127], v[84:87], v[244:247]
    v_mfma_f32_16x16x32_bf16 v[248:251], v[124:127], v[88:91], v[248:251]
    v_mfma_f32_16x16x32_bf16 v[252:255], v[124:127], v[92:95], v[252:255]
    s_waitcnt lgkmcnt(9)
    v_mfma_f32_16x16x32_bf16 v[128:131], v[96:99], v[64:67], v[128:131]
    ds_read_b64_tr_b16 v[116:117], v13 offset:33792
    ds_read_b64_tr_b16 v[118:119], v13 offset:50176
    v_mfma_f32_16x16x32_bf16 v[132:135], v[96:99], v[68:71], v[132:135]
    s_add_u32 m0, s40, 0
    v_mfma_f32_16x16x32_bf16 v[136:139], v[96:99], v[72:75], v[136:139]
    ds_read_b128 v[80:83], v17 offset:13312
    buffer_load_dwordx4 v6, s[12:15], s45 offen offset:0 lds
    s_waitcnt lgkmcnt(11)
    v_mfma_f32_16x16x32_bf16 v[140:143], v[96:99], v[76:79], v[140:143]
    s_waitcnt lgkmcnt(9)
    v_mfma_f32_16x16x32_bf16 v[144:147], v[100:103], v[64:67], v[144:147]
    ds_read_b64_tr_b16 v[120:121], v14 offset:33792
    ds_read_b64_tr_b16 v[122:123], v14 offset:50176
    s_add_u32 m0, s40, 896
    v_mfma_f32_16x16x32_bf16 v[148:151], v[100:103], v[68:71], v[148:151]
    buffer_load_dwordx4 v6, s[12:15], s45 offen offset:128 lds
    v_mfma_f32_16x16x32_bf16 v[152:155], v[100:103], v[72:75], v[152:155]
    ds_read_b128 v[84:87], v17 offset:27648
    v_mfma_f32_16x16x32_bf16 v[156:159], v[100:103], v[76:79], v[156:159]
    s_add_u32 m0, s40, 1792
    s_waitcnt lgkmcnt(10)
    v_mfma_f32_16x16x32_bf16 v[160:163], v[104:107], v[64:67], v[160:163]
    ds_read_b64_tr_b16 v[124:125], v15 offset:33792
    ds_read_b64_tr_b16 v[126:127], v15 offset:50176
    v_mfma_f32_16x16x32_bf16 v[164:167], v[104:107], v[68:71], v[164:167]
    buffer_load_dwordx4 v6, s[12:15], s45 offen offset:256 lds
    v_mfma_f32_16x16x32_bf16 v[168:171], v[104:107], v[72:75], v[168:171]
    ds_read_b128 v[88:91], v17 offset:41984
    s_add_u32 m0, s40, 2688
    v_mfma_f32_16x16x32_bf16 v[172:175], v[104:107], v[76:79], v[172:175]
    buffer_load_dwordx4 v6, s[12:15], s45 offen offset:384 lds
    s_add_u32 s45, s45, 32768
    s_waitcnt lgkmcnt(11)
    v_mfma_f32_16x16x32_bf16 v[176:179], v[108:111], v[64:67], v[176:179]
    s_waitcnt vmcnt(4)
    v_add_u32 v12, 65536, v12
    v_add_u32 v13, 65536, v13
    v_mfma_f32_16x16x32_bf16 v[180:183], v[108:111], v[68:71], v[180:183]
    v_add_u32 v14, 65536, v14
    v_add_u32 v15, 65536, v15
    ds_read_b64_tr_b16 v[96:97], v12 offset:0
    v_mfma_f32_16x16x32_bf16 v[184:187], v[108:111], v[72:75], v[184:187]
    ds_read_b64_tr_b16 v[98:99], v12 offset:16384
    s_add_u32 m0, s40, 16384
    ds_read_b128 v[92:95], v17 offset:56320
    v_mfma_f32_16x16x32_bf16 v[188:191], v[108:111], v[76:79], v[188:191]
    buffer_load_dwordx4 v6, s[12:15], s46 offen offset:0 lds
    s_waitcnt lgkmcnt(12)
    v_mfma_f32_16x16x32_bf16 v[192:195], v[112:115], v[64:67], v[192:195]
    ds_read_b64_tr_b16 v[100:101], v13 offset:0
    ds_read_b64_tr_b16 v[102:103], v13 offset:16384
    s_add_u32 m0, s40, 17280
    v_mfma_f32_16x16x32_bf16 v[196:199], v[112:115], v[68:71], v[196:199]
    buffer_load_dwordx4 v6, s[12:15], s46 offen offset:128 lds
    v_mfma_f32_16x16x32_bf16 v[200:203], v[112:115], v[72:75], v[200:203]
    v_mfma_f32_16x16x32_bf16 v[204:207], v[112:115], v[76:79], v[204:207]
    s_add_u32 m0, s40, 18176
    s_waitcnt lgkmcnt(12)
    v_mfma_f32_16x16x32_bf16 v[208:211], v[116:119], v[64:67], v[208:211]
    ds_read_b64_tr_b16 v[104:105], v14 offset:0
    ds_read_b64_tr_b16 v[106:107], v14 offset:16384
    v_mfma_f32_16x16x32_bf16 v[212:215], v[116:119], v[68:71], v[212:215]
    buffer_load_dwordx4 v6, s[12:15], s46 offen offset:256 lds
    v_mfma_f32_16x16x32_bf16 v[216:219], v[116:119], v[72:75], v[216:219]
    s_add_u32 m0, s40, 19072
    v_mfma_f32_16x16x32_bf16 v[220:223], v[116:119], v[76:79], v[220:223]
    buffer_load_dwordx4 v6, s[12:15], s46 offen offset:384 lds
    s_add_u32 s46, s46, 32768
    s_waitcnt lgkmcnt(11)
    v_mfma_f32_16x16x32_bf16 v[224:227], v[120:123], v[64:67], v[224:227]
    ds_read_b64_tr_b16 v[108:109], v15 offset:0
    ds_read_b64_tr_b16 v[110:111], v15 offset:16384
    v_mfma_f32_16x16x32_bf16 v[228:231], v[120:123], v[68:71], v[228:231]
    v_mfma_f32_16x16x32_bf16 v[232:235], v[120:123], v[72:75], v[232:235]
    v_mfma_f32_16x16x32_bf16 v[236:239], v[120:123], v[76:79], v[236:239]
    s_waitcnt lgkmcnt(10)
    v_mfma_f32_16x16x32_bf16 v[240:243], v[124:127], v[64:67], v[240:243]
    ds_read_b64_tr_b16 v[112:113], v12 offset:1024
    ds_read_b64_tr_b16 v[114:115], v12 offset:17408
    v_mfma_f32_16x16x32_bf16 v[244:247], v[124:127], v[68:71], v[244:247]
    v_mfma_f32_16x16x32_bf16 v[248:251], v[124:127], v[72:75], v[248:251]
    v_mfma_f32_16x16x32_bf16 v[252:255], v[124:127], v[76:79], v[252:255]
    s_waitcnt lgkmcnt(9)
    v_mfma_f32_16x16x32_bf16 v[128:131], v[96:99], v[80:83], v[128:131]
    ds_read_b64_tr_b16 v[116:117], v13 offset:1024
    ds_read_b64_tr_b16 v[118:119], v13 offset:17408
    v_mfma_f32_16x16x32_bf16 v[132:135], v[96:99], v[84:87], v[132:135]
    s_add_u32 m0, s41, 0
    v_mfma_f32_16x16x32_bf16 v[136:139], v[96:99], v[88:91], v[136:139]
    buffer_load_dwordx4 v6, s[12:15], s45 offen offset:0 lds
    s_waitcnt lgkmcnt(10)
    v_mfma_f32_16x16x32_bf16 v[140:143], v[96:99], v[92:95], v[140:143]
    s_waitcnt lgkmcnt(8)
    v_mfma_f32_16x16x32_bf16 v[144:147], v[100:103], v[80:83], v[144:147]
    ds_read_b64_tr_b16 v[120:121], v14 offset:1024
    ds_read_b64_tr_b16 v[122:123], v14 offset:17408
    s_add_u32 m0, s41, 896
    v_mfma_f32_16x16x32_bf16 v[148:151], v[100:103], v[84:87], v[148:151]
    s_barrier
    buffer_load_dwordx4 v6, s[12:15], s45 offen offset:128 lds
    v_mfma_f32_16x16x32_bf16 v[152:155], v[100:103], v[88:91], v[152:155]
    v_cvt_pk_bf16_f32 v128, v128, v129
    v_cvt_pk_bf16_f32 v129, v130, v131
    ds_write_b64 v18, v[128:129] offset:0
    v_mfma_f32_16x16x32_bf16 v[156:159], v[100:103], v[92:95], v[156:159]
    s_add_u32 m0, s41, 1792
    v_cvt_pk_bf16_f32 v132, v132, v133
    v_cvt_pk_bf16_f32 v133, v134, v135
    s_waitcnt lgkmcnt(9)
    v_mfma_f32_16x16x32_bf16 v[160:163], v[104:107], v[80:83], v[160:163]
    ds_write_b64 v18, v[132:133] offset:8192
    ds_read_b64_tr_b16 v[124:125], v15 offset:1024
    ds_read_b64_tr_b16 v[126:127], v15 offset:17408
    v_mfma_f32_16x16x32_bf16 v[164:167], v[104:107], v[84:87], v[164:167]
    buffer_load_dwordx4 v6, s[12:15], s45 offen offset:256 lds
    v_cvt_pk_bf16_f32 v136, v136, v137
    v_mfma_f32_16x16x32_bf16 v[168:171], v[104:107], v[88:91], v[168:171]
    v_cvt_pk_bf16_f32 v137, v138, v139
    ds_write_b64 v18, v[136:137] offset:16384
    v_cvt_pk_bf16_f32 v140, v140, v141
    v_mfma_f32_16x16x32_bf16 v[172:175], v[104:107], v[92:95], v[172:175]
    v_cvt_pk_bf16_f32 v141, v142, v143
    ds_write_b64 v18, v[140:141] offset:24576
    s_add_u32 m0, s41, 2688
    s_waitcnt lgkmcnt(12)
    v_mfma_f32_16x16x32_bf16 v[176:179], v[108:111], v[80:83], v[176:179]
    v_cvt_pk_bf16_f32 v144, v144, v145
    v_cvt_pk_bf16_f32 v145, v146, v147
    ds_write_b64 v18, v[144:145] offset:512
    v_mfma_f32_16x16x32_bf16 v[180:183], v[108:111], v[84:87], v[180:183]
    buffer_load_dwordx4 v6, s[12:15], s45 offen offset:384 lds
    s_add_u32 s45, s45, 32768
    v_cvt_pk_bf16_f32 v148, v148, v149
    v_mfma_f32_16x16x32_bf16 v[184:187], v[108:111], v[88:91], v[184:187]
    v_cvt_pk_bf16_f32 v149, v150, v151
    ds_write_b64 v18, v[148:149] offset:8704
    v_cvt_pk_bf16_f32 v152, v152, v153
    v_mfma_f32_16x16x32_bf16 v[188:191], v[108:111], v[92:95], v[188:191]
    v_cvt_pk_bf16_f32 v153, v154, v155
    ds_write_b64 v18, v[152:153] offset:16896
    s_add_u32 m0, s41, 16384
    s_waitcnt lgkmcnt(13)
    v_mfma_f32_16x16x32_bf16 v[192:195], v[112:115], v[80:83], v[192:195]
    v_cvt_pk_bf16_f32 v156, v156, v157
    v_cvt_pk_bf16_f32 v157, v158, v159
    ds_write_b64 v18, v[156:157] offset:25088
    v_mfma_f32_16x16x32_bf16 v[196:199], v[112:115], v[84:87], v[196:199]
    buffer_load_dwordx4 v6, s[12:15], s46 offen offset:0 lds
    v_cvt_pk_bf16_f32 v160, v160, v161
    v_mfma_f32_16x16x32_bf16 v[200:203], v[112:115], v[88:91], v[200:203]
    v_cvt_pk_bf16_f32 v161, v162, v163
    ds_write_b64 v18, v[160:161] offset:1024
    v_cvt_pk_bf16_f32 v164, v164, v165
    v_mfma_f32_16x16x32_bf16 v[204:207], v[112:115], v[92:95], v[204:207]
    v_cvt_pk_bf16_f32 v165, v166, v167
    ds_write_b64 v18, v[164:165] offset:9216
    s_add_u32 m0, s41, 17280
    s_waitcnt lgkmcnt(14)
    v_mfma_f32_16x16x32_bf16 v[208:211], v[116:119], v[80:83], v[208:211]
    v_cvt_pk_bf16_f32 v168, v168, v169
    v_cvt_pk_bf16_f32 v169, v170, v171
    ds_write_b64 v18, v[168:169] offset:17408
    v_mfma_f32_16x16x32_bf16 v[212:215], v[116:119], v[84:87], v[212:215]
    buffer_load_dwordx4 v6, s[12:15], s46 offen offset:128 lds
    v_cvt_pk_bf16_f32 v172, v172, v173
    v_mfma_f32_16x16x32_bf16 v[216:219], v[116:119], v[88:91], v[216:219]
    v_cvt_pk_bf16_f32 v173, v174, v175
    ds_write_b64 v18, v[172:173] offset:25600
    v_cvt_pk_bf16_f32 v176, v176, v177
    v_mfma_f32_16x16x32_bf16 v[220:223], v[116:119], v[92:95], v[220:223]
    v_cvt_pk_bf16_f32 v177, v178, v179
    ds_write_b64 v18, v[176:177] offset:1536
    s_add_u32 m0, s41, 18176
    s_waitcnt lgkmcnt(15)
    v_mfma_f32_16x16x32_bf16 v[224:227], v[120:123], v[80:83], v[224:227]
    v_cvt_pk_bf16_f32 v180, v180, v181
    v_cvt_pk_bf16_f32 v181, v182, v183
    ds_write_b64 v18, v[180:181] offset:9728
    v_mfma_f32_16x16x32_bf16 v[228:231], v[120:123], v[84:87], v[228:231]
    buffer_load_dwordx4 v6, s[12:15], s46 offen offset:256 lds
    v_cvt_pk_bf16_f32 v184, v184, v185
    v_mfma_f32_16x16x32_bf16 v[232:235], v[120:123], v[88:91], v[232:235]
    v_cvt_pk_bf16_f32 v185, v186, v187
    ds_write_b64 v18, v[184:185] offset:17920
    v_cvt_pk_bf16_f32 v188, v188, v189
    v_mfma_f32_16x16x32_bf16 v[236:239], v[120:123], v[92:95], v[236:239]
    v_cvt_pk_bf16_f32 v189, v190, v191
    ds_write_b64 v18, v[188:189] offset:26112
    s_add_u32 m0, s41, 19072
    s_waitcnt lgkmcnt(14)
    v_mfma_f32_16x16x32_bf16 v[240:243], v[124:127], v[80:83], v[240:243]
    v_cvt_pk_bf16_f32 v192, v192, v193
    v_cvt_pk_bf16_f32 v193, v194, v195
    ds_write_b64 v18, v[192:193] offset:2048
    v_mfma_f32_16x16x32_bf16 v[244:247], v[124:127], v[84:87], v[244:247]
    buffer_load_dwordx4 v6, s[12:15], s46 offen offset:384 lds
    s_add_u32 s46, s46, 32768
    v_cvt_pk_bf16_f32 v196, v196, v197
    v_mfma_f32_16x16x32_bf16 v[248:251], v[124:127], v[88:91], v[248:251]
    v_cvt_pk_bf16_f32 v197, v198, v199
    ds_write_b64 v18, v[196:197] offset:10240
    v_cvt_pk_bf16_f32 v200, v200, v201
    v_mfma_f32_16x16x32_bf16 v[252:255], v[124:127], v[92:95], v[252:255]
    v_cvt_pk_bf16_f32 v201, v202, v203
    ds_write_b64 v18, v[200:201] offset:18432
    v_cvt_pk_bf16_f32 v204, v204, v205
    v_cvt_pk_bf16_f32 v205, v206, v207
    ds_write_b64 v18, v[204:205] offset:26624
    v_cvt_pk_bf16_f32 v208, v208, v209
    v_cvt_pk_bf16_f32 v209, v210, v211
    ds_write_b64 v18, v[208:209] offset:2560
    v_cvt_pk_bf16_f32 v212, v212, v213
    v_cvt_pk_bf16_f32 v213, v214, v215
    ds_write_b64 v18, v[212:213] offset:10752
    v_cvt_pk_bf16_f32 v216, v216, v217
    v_cvt_pk_bf16_f32 v217, v218, v219
    ds_write_b64 v18, v[216:217] offset:18944
    v_cvt_pk_bf16_f32 v220, v220, v221
    v_cvt_pk_bf16_f32 v221, v222, v223
    ds_write_b64 v18, v[220:221] offset:27136
    v_cvt_pk_bf16_f32 v224, v224, v225
    v_cvt_pk_bf16_f32 v225, v226, v227
    ds_write_b64 v18, v[224:225] offset:3072
    v_cvt_pk_bf16_f32 v228, v228, v229
    v_cvt_pk_bf16_f32 v229, v230, v231
    ds_write_b64 v18, v[228:229] offset:11264
    v_mov_b32 v120, v20
    v_mov_b32 v121, v16
    v_mov_b32 v126, v24
    v_cvt_pk_bf16_f32 v232, v232, v233
    v_cvt_pk_bf16_f32 v233, v234, v235
    ds_write_b64 v18, v[232:233] offset:19456
    v_cvt_pk_bf16_f32 v236, v236, v237
    v_cvt_pk_bf16_f32 v237, v238, v239
    ds_write_b64 v18, v[236:237] offset:27648
    v_cvt_pk_bf16_f32 v240, v240, v241
    v_cvt_pk_bf16_f32 v241, v242, v243
    ds_write_b64 v18, v[240:241] offset:3584
    v_cvt_pk_bf16_f32 v244, v244, v245
    v_cvt_pk_bf16_f32 v245, v246, v247
    ds_write_b64 v18, v[244:245] offset:11776
    v_cvt_pk_bf16_f32 v248, v248, v249
    v_cvt_pk_bf16_f32 v249, v250, v251
    ds_write_b64 v18, v[248:249] offset:19968
    v_cvt_pk_bf16_f32 v252, v252, v253
    v_cvt_pk_bf16_f32 v253, v254, v255
    ds_write_b64 v18, v[252:253] offset:28160
    s_sub_u32 s36, s54, 28
    s_cmp_ge_u32 s36, 56
    s_cbranch_scc1 L_fr_mf
    s_cmp_lg_u32 s5, 1
    s_cbranch_scc1 L_fr_mf
    s_lshl_b32 s36, s36, 2
    s_add_u32 s36, s36, 45056
    v_mov_b32 v27, s60
    s_mov_b64 exec, 1
    buffer_store_dword v27, v26, s[28:31], s36 offen sc0 sc1
    s_mov_b64 exec, -1
L_fr_mf:
    s_add_u32 m0, s42, 0
    s_nop 0
    buffer_load_dwordx4 v7, s[16:19], s47 offen offset:0 lds
    s_add_u32 m0, s42, 896
    s_nop 0
    buffer_load_dwordx4 v7, s[16:19], s47 offen offset:128 lds
    s_add_u32 m0, s42, 1792
    s_nop 0
    buffer_load_dwordx4 v7, s[16:19], s47 offen offset:256 lds
    s_add_u32 m0, s42, 2688
    s_nop 0
    buffer_load_dwordx4 v7, s[16:19], s47 offen offset:384 lds
    s_add_u32 s47, s47, 32768
    s_add_u32 m0, s42, 16128
    s_nop 0
    buffer_load_dwordx4 v7, s[16:19], s48 offen offset:256 lds
    s_add_u32 m0, s42, 17024
    s_nop 0
    buffer_load_dwordx4 v7, s[16:19], s48 offen offset:384 lds
    s_add_u32 m0, s42, 18432
    s_nop 0
    buffer_load_dwordx4 v7, s[16:19], s48 offen offset:0 lds
    s_add_u32 m0, s42, 19328
    s_nop 0
    buffer_load_dwordx4 v7, s[16:19], s48 offen offset:128 lds
    s_add_u32 s48, s48, 32768
    s_waitcnt vmcnt(8)
    s_waitcnt lgkmcnt(0)
    s_barrier
    ds_read_b128 v[112:115], v0 offset:0
    ds_read_b128 v[116:119], v1 offset:0
    ds_read_b128 v[96:99], v0 offset:1024
    ds_read_b128 v[100:103], v1 offset:1024
    ds_read_b128 v[128:131], v120 offset:0
    ds_read_b128 v[160:163], v120 offset:8192
    ds_read_b128 v[192:195], v120 offset:16384
    ds_read_b128 v[224:227], v120 offset:24576
    ds_read_b128 v[132:135], v120 offset:1024
    ds_read_b128 v[164:167], v120 offset:9216
    ds_read_b128 v[196:199], v120 offset:17408
    ds_read_b128 v[228:231], v120 offset:25600
    ds_read_b128 v[136:139], v120 offset:2048
    ds_read_b128 v[168:171], v120 offset:10240
    ds_read_b128 v[200:203], v120 offset:18432
    ds_read_b128 v[232:235], v120 offset:26624
    ds_read_b128 v[140:143], v120 offset:3072
    ds_read_b128 v[172:175], v120 offset:11264
    ds_read_b128 v[204:207], v120 offset:19456
    ds_read_b128 v[236:239], v120 offset:27648
    ds_read_b128 v[144:147], v120 offset:4096
    ds_read_b128 v[176:179], v120 offset:12288
    ds_read_b128 v[208:211], v120 offset:20480
    ds_read_b128 v[240:243], v120 offset:28672
    ds_read_b128 v[148:151], v120 offset:5120
    ds_read_b128 v[180:183], v120 offset:13312
    ds_read_b128 v[212:215], v120 offset:21504
    ds_read_b128 v[244:247], v120 offset:29696
    ds_read_b128 v[152:155], v120 offset:6144
    ds_read_b128 v[184:187], v120 offset:14336
    ds_read_b128 v[216:219], v120 offset:22528
    ds_read_b128 v[248:251], v120 offset:30720
    ds_read_b128 v[156:159], v120 offset:7168
    ds_read_b128 v[188:191], v120 offset:15360
    ds_read_b128 v[220:223], v120 offset:23552
    ds_read_b128 v[252:255], v120 offset:31744
    s_waitcnt lgkmcnt(15)
    v_mfma_f32_16x16x32_bf16 v[16:19], v[112:115], v[128:131], 0
    ds_read_b128 v[108:111], v0 offset:2048
    v_mfma_f32_16x16x32_bf16 v[20:23], v[112:115], v[160:163], 0
    v_mfma_f32_16x16x32_bf16 v[24:27], v[112:115], v[192:195], 0
    v_mfma_f32_16x16x32_bf16 v[28:31], v[112:115], v[224:227], 0
    v_mfma_f32_16x16x32_bf16 v[16:19], v[116:119], v[132:135], v[16:19]
    ds_read_b128 v[112:115], v1 offset:2048
    v_mfma_f32_16x16x32_bf16 v[20:23], v[116:119], v[164:167], v[20:23]
    v_mfma_f32_16x16x32_bf16 v[24:27], v[116:119], v[196:199], v[24:27]
    v_mfma_f32_16x16x32_bf16 v[28:31], v[116:119], v[228:231], v[28:31]
    v_mfma_f32_16x16x32_bf16 v[16:19], v[96:99], v[136:139], v[16:19]
    ds_read_b128 v[116:119], v0 offset:3072
    v_mfma_f32_16x16x32_bf16 v[20:23], v[96:99], v[168:171], v[20:23]
    v_mfma_f32_16x16x32_bf16 v[24:27], v[96:99], v[200:203], v[24:27]
    v_mfma_f32_16x16x32_bf16 v[28:31], v[96:99], v[232:235], v[28:31]
    v_mfma_f32_16x16x32_bf16 v[16:19], v[100:103], v[140:143], v[16:19]
    ds_read_b128 v[96:99], v1 offset:3072
    v_mfma_f32_16x16x32_bf16 v[20:23], v[100:103], v[172:175], v[20:23]
    v_mfma_f32_16x16x32_bf16 v[24:27], v[100:103], v[204:207], v[24:27]
    v_mfma_f32_16x16x32_bf16 v[28:31], v[100:103], v[236:239], v[28:31]
    s_waitcnt lgkmcnt(3)
    v_mfma_f32_16x16x32_bf16 v[16:19], v[108:111], v[144:147], v[16:19]
    ds_read_b128 v[104:107], v0 offset:8192
    v_mfma_f32_16x16x32_bf16 v[20:23], v[108:111], v[176:179], v[20:23]
    v_mfma_f32_16x16x32_bf16 v[24:27], v[108:111], v[208:211], v[24:27]
    v_mfma_f32_16x16x32_bf16 v[28:31], v[108:111], v[240:243], v[28:31]
    s_waitcnt lgkmcnt(3)
    v_mfma_f32_16x16x32_bf16 v[16:19], v[112:115], v[148:151], v[16:19]
    ds_read_b128 v[108:111], v1 offset:8192
    v_mfma_f32_16x16x32_bf16 v[20:23], v[112:115], v[180:183], v[20:23]
    v_mfma_f32_16x16x32_bf16 v[24:27], v[112:115], v[212:215], v[24:27]
    v_mfma_f32_16x16x32_bf16 v[28:31], v[112:115], v[244:247], v[28:31]
    s_waitcnt lgkmcnt(3)
    v_mfma_f32_16x16x32_bf16 v[16:19], v[116:119], v[152:155], v[16:19]
    ds_read_b128 v[112:115], v0 offset:9216
    v_mfma_f32_16x16x32_bf16 v[20:23], v[116:119], v[184:187], v[20:23]
    v_mfma_f32_16x16x32_bf16 v[24:27], v[116:119], v[216:219], v[24:27]
    v_mfma_f32_16x16x32_bf16 v[28:31], v[116:119], v[248:251], v[28:31]
    s_waitcnt lgkmcnt(3)
    v_mfma_f32_16x16x32_bf16 v[16:19], v[96:99], v[156:159], v[16:19]
    ds_read_b128 v[116:119], v1 offset:9216
    v_mfma_f32_16x16x32_bf16 v[20:23], v[96:99], v[188:191], v[20:23]
    v_mfma_f32_16x16x32_bf16 v[24:27], v[96:99], v[220:223], v[24:27]
    v_mfma_f32_16x16x32_bf16 v[28:31], v[96:99], v[252:255], v[28:31]
    s_waitcnt lgkmcnt(3)
    v_mfma_f32_16x16x32_bf16 v[32:35], v[104:107], v[128:131], 0
    ds_read_b128 v[100:103], v0 offset:10240
    v_mfma_f32_16x16x32_bf16 v[36:39], v[104:107], v[160:163], 0
    s_barrier
    v_mfma_f32_16x16x32_bf16 v[40:43], v[104:107], v[192:195], 0
    s_add_u32 m0, s43, 0
    v_mfma_f32_16x16x32_bf16 v[44:47], v[104:107], v[224:227], 0
    buffer_load_dwordx4 v6, s[12:15], s45 offen offset:0 lds
    s_waitcnt lgkmcnt(3)
    v_mfma_f32_16x16x32_bf16 v[32:35], v[108:111], v[132:135], v[32:35]
    ds_read_b128 v[104:107], v1 offset:10240
    v_mfma_f32_16x16x32_bf16 v[36:39], v[108:111], v[164:167], v[36:39]
    s_add_u32 m0, s43, 896
    v_mfma_f32_16x16x32_bf16 v[40:43], v[108:111], v[196:199], v[40:43]
    buffer_load_dwordx4 v6, s[12:15], s45 offen offset:128 lds
    v_mfma_f32_16x16x32_bf16 v[44:47], v[108:111], v[228:231], v[44:47]
    s_waitcnt lgkmcnt(3)
    v_mfma_f32_16x16x32_bf16 v[32:35], v[112:115], v[136:139], v[32:35]
    ds_read_b128 v[108:111], v0 offset:11264
    s_add_u32 m0, s43, 1792
    v_mfma_f32_16x16x32_bf16 v[36:39], v[112:115], v[168:171], v[36:39]
    buffer_load_dwordx4 v6, s[12:15], s45 offen offset:256 lds
    v_mfma_f32_16x16x32_bf16 v[40:43], v[112:115], v[200:203], v[40:43]
    v_mfma_f32_16x16x32_bf16 v[44:47], v[112:115], v[232:235], v[44:47]
    s_add_u32 m0, s43, 2688
    s_waitcnt lgkmcnt(3)
    v_mfma_f32_16x16x32_bf16 v[32:35], v[116:119], v[140:143], v[32:35]
    ds_read_b128 v[112:115], v1 offset:11264
    buffer_load_dwordx4 v6, s[12:15], s45 offen offset:384 lds
    s_add_u32 s45, s45, 32768
    v_mfma_f32_16x16x32_bf16 v[36:39], v[116:119], v[172:175], v[36:39]
    v_mfma_f32_16x16x32_bf16 v[40:43], v[116:119], v[204:207], v[40:43]
    s_add_u32 m0, s43, 16384
    v_mfma_f32_16x16x32_bf16 v[44:47], v[116:119], v[236:239], v[44:47]
    buffer_load_dwordx4 v6, s[12:15], s46 offen offset:0 lds
    s_waitcnt lgkmcnt(3)
    v_mfma_f32_16x16x32_bf16 v[32:35], v[100:103], v[144:147], v[32:35]
    v_mfma_f32_16x16x32_bf16 v[36:39], v[100:103], v[176:179], v[36:39]
    s_add_u32 m0, s43, 17280
    v_mfma_f32_16x16x32_bf16 v[40:43], v[100:103], v[208:211], v[40:43]
    buffer_load_dwordx4 v6, s[12:15], s46 offen offset:128 lds
    v_mfma_f32_16x16x32_bf16 v[44:47], v[100:103], v[240:243], v[44:47]
    s_waitcnt lgkmcnt(2)
    v_mfma_f32_16x16x32_bf16 v[32:35], v[104:107], v[148:151], v[32:35]
    s_add_u32 m0, s43, 18176
    v_mfma_f32_16x16x32_bf16 v[36:39], v[104:107], v[180:183], v[36:39]
    buffer_load_dwordx4 v6, s[12:15], s46 offen offset:256 lds
    v_mfma_f32_16x16x32_bf16 v[40:43], v[104:107], v[212:215], v[40:43]
    v_mfma_f32_16x16x32_bf16 v[44:47], v[104:107], v[244:247], v[44:47]
    s_add_u32 m0, s43, 19072
    s_waitcnt lgkmcnt(1)
    v_mfma_f32_16x16x32_bf16 v[32:35], v[108:111], v[152:155], v[32:35]
    buffer_load_dwordx4 v6, s[12:15], s46 offen offset:384 lds
    s_add_u32 s46, s46, 32768
    v_mfma_f32_16x16x32_bf16 v[36:39], v[108:111], v[184:187], v[36:39]
    v_mfma_f32_16x16x32_bf16 v[40:43], v[108:111], v[216:219], v[40:43]
    v_mfma_f32_16x16x32_bf16 v[44:47], v[108:111], v[248:251], v[44:47]
    s_waitcnt lgkmcnt(0)
    v_mfma_f32_16x16x32_bf16 v[32:35], v[112:115], v[156:159], v[32:35]
    v_mfma_f32_16x16x32_bf16 v[36:39], v[112:115], v[188:191], v[36:39]
    v_mfma_f32_16x16x32_bf16 v[40:43], v[112:115], v[220:223], v[40:43]
    v_mfma_f32_16x16x32_bf16 v[44:47], v[112:115], v[252:255], v[44:47]
    v_add_u32 v0, 32768, v0
    v_add_u32 v1, 32768, v1
    ds_read_b128 v[112:115], v0 offset:0
    ds_read_b128 v[116:119], v1 offset:0
    ds_read_b128 v[96:99], v0 offset:1024
    ds_read_b128 v[100:103], v1 offset:1024
    s_waitcnt vmcnt(8)
    s_barrier
    v_max3_f32 v120, v16, v17, v18
    v_max3_f32 v120, v120, v19, v32
    v_max3_f32 v120, v120, v33, v34
    v_max_f32 v120, v120, v35
    v_mov_b32 v121, v120
    s_nop 1
    v_permlane16_swap_b32 v120, v121
    v_max_f32 v120, v120, v121
    v_mov_b32 v121, v120
    s_nop 1
    v_permlane32_swap_b32 v120, v121
    v_max_f32 v120, v120, v121
    v_sub_f32 v80, 0, v120
    v_sub_f32 v81, 0, v120
    v_sub_f32 v82, 0, v120
    v_sub_f32 v83, 0, v120
    v_sub_f32 v16, v16, v120
    v_sub_f32 v17, v17, v120
    v_sub_f32 v18, v18, v120
    v_sub_f32 v19, v19, v120
    v_sub_f32 v32, v32, v120
    v_sub_f32 v33, v33, v120
    v_sub_f32 v34, v34, v120
    v_sub_f32 v35, v35, v120
    v_exp_f32 v122, v16
    v_exp_f32 v123, v17
    v_exp_f32 v124, v18
    v_exp_f32 v125, v19
    v_add_f32 v12, v122, v123
    v_cvt_pk_bf16_f32 v48, v122, v123
    v_add_f32_e64 v12, v12, v124
    v_cvt_pk_bf16_f32 v49, v124, v125
    v_add_f32 v12, v12, v125
    v_exp_f32 v122, v32
    v_exp_f32 v123, v33
    v_exp_f32 v124, v34
    v_exp_f32 v125, v35
    v_add_f32 v12, v12, v122
    v_add_f32_e64 v12, v12, v123
    v_cvt_pk_bf16_f32 v50, v122, v123
    v_add_f32_e64 v12, v12, v124
    v_cvt_pk_bf16_f32 v51, v124, v125
    v_add_f32_e64 v12, v12, v125
    v_max3_f32 v120, v20, v21, v22
    v_max3_f32 v120, v120, v23, v36
    v_max3_f32 v120, v120, v37, v38
    v_max_f32 v120, v120, v39
    v_mov_b32 v121, v120
    s_nop 1
    v_permlane16_swap_b32 v120, v121
    v_max_f32 v120, v120, v121
    v_mov_b32 v121, v120
    s_nop 1
    v_permlane32_swap_b32 v120, v121
    v_max_f32 v120, v120, v121
    v_sub_f32 v84, 0, v120
    v_sub_f32 v85, 0, v120
    v_sub_f32 v86, 0, v120
    v_sub_f32 v87, 0, v120
    v_sub_f32 v20, v20, v120
    v_sub_f32 v21, v21, v120
    v_sub_f32 v22, v22, v120
    v_sub_f32 v23, v23, v120
    v_sub_f32 v36, v36, v120
    v_sub_f32 v37, v37, v120
    v_sub_f32 v38, v38, v120
    v_sub_f32 v39, v39, v120
    v_exp_f32 v122, v20
    v_exp_f32 v123, v21
    v_exp_f32 v124, v22
    v_exp_f32 v125, v23
    v_add_f32 v13, v122, v123
    v_cvt_pk_bf16_f32 v52, v122, v123
    v_add_f32_e64 v13, v13, v124
    v_cvt_pk_bf16_f32 v53, v124, v125
    v_add_f32 v13, v13, v125
    v_exp_f32 v122, v36
    v_exp_f32 v123, v37
    v_exp_f32 v124, v38
    v_exp_f32 v125, v39
    v_add_f32 v13, v13, v122
    v_add_f32_e64 v13, v13, v123
    v_cvt_pk_bf16_f32 v54, v122, v123
    v_add_f32_e64 v13, v13, v124
    v_cvt_pk_bf16_f32 v55, v124, v125
    v_add_f32_e64 v13, v13, v125
    v_max3_f32 v120, v24, v25, v26
    v_max3_f32 v120, v120, v27, v40
    v_max3_f32 v120, v120, v41, v42
    v_max_f32 v120, v120, v43
    v_mov_b32 v121, v120
    s_nop 1
    v_permlane16_swap_b32 v120, v121
    v_max_f32 v120, v120, v121
    v_mov_b32 v121, v120
    s_nop 1
    v_permlane32_swap_b32 v120, v121
    v_max_f32 v120, v120, v121
    v_sub_f32 v88, 0, v120
    v_sub_f32 v89, 0, v120
    v_sub_f32 v90, 0, v120
    v_sub_f32 v91, 0, v120
    v_sub_f32 v24, v24, v120
    v_sub_f32 v25, v25, v120
    v_sub_f32 v26, v26, v120
    v_sub_f32 v27, v27, v120
    v_sub_f32 v40, v40, v120
    v_sub_f32 v41, v41, v120
    v_sub_f32 v42, v42, v120
    v_sub_f32 v43, v43, v120
    v_exp_f32 v122, v24
    v_exp_f32 v123, v25
    v_exp_f32 v124, v26
    v_exp_f32 v125, v27
    v_add_f32 v14, v122, v123
    v_cvt_pk_bf16_f32 v56, v122, v123
    v_add_f32_e64 v14, v14, v124
    v_cvt_pk_bf16_f32 v57, v124, v125
    v_add_f32 v14, v14, v125
    v_exp_f32 v122, v40
    v_exp_f32 v123, v41
    v_exp_f32 v124, v42
    v_exp_f32 v125, v43
    v_add_f32 v14, v14, v122
    v_add_f32_e64 v14, v14, v123
    v_cvt_pk_bf16_f32 v58, v122, v123
    v_add_f32_e64 v14, v14, v124
    v_cvt_pk_bf16_f32 v59, v124, v125
    v_add_f32_e64 v14, v14, v125
    v_max3_f32 v120, v28, v29, v30
    v_max3_f32 v120, v120, v31, v44
    v_max3_f32 v120, v120, v45, v46
    v_max_f32 v120, v120, v47
    v_mov_b32 v121, v120
    s_nop 1
    v_permlane16_swap_b32 v120, v121
    v_max_f32 v120, v120, v121
    v_mov_b32 v121, v120
    s_nop 1
    v_permlane32_swap_b32 v120, v121
    v_max_f32 v120, v120, v121
    v_sub_f32 v92, 0, v120
    v_sub_f32 v93, 0, v120
    v_sub_f32 v94, 0, v120
    v_sub_f32 v95, 0, v120
    v_sub_f32 v28, v28, v120
    v_sub_f32 v29, v29, v120
    v_sub_f32 v30, v30, v120
    v_sub_f32 v31, v31, v120
    v_sub_f32 v44, v44, v120
    v_sub_f32 v45, v45, v120
    v_sub_f32 v46, v46, v120
    v_sub_f32 v47, v47, v120
    v_exp_f32 v122, v28
    v_exp_f32 v123, v29
    v_exp_f32 v124, v30
    v_exp_f32 v125, v31
    v_add_f32 v15, v122, v123
    v_cvt_pk_bf16_f32 v60, v122, v123
    v_add_f32_e64 v15, v15, v124
    v_cvt_pk_bf16_f32 v61, v124, v125
    v_add_f32 v15, v15, v125
    v_exp_f32 v122, v44
    v_exp_f32 v123, v45
    v_exp_f32 v124, v46
    v_exp_f32 v125, v47
    v_add_f32 v15, v15, v122
    v_add_f32_e64 v15, v15, v123
    v_cvt_pk_bf16_f32 v62, v122, v123
    v_add_f32_e64 v15, v15, v124
    v_cvt_pk_bf16_f32 v63, v124, v125
    v_add_f32 v15, v15, v125
    v_mov_b32 v8, 0
    v_mov_b32 v9, 0
    v_mov_b32 v10, 0
    v_mov_b32 v11, 0
    s_mov_b32 s51, 0
    s_waitcnt lgkmcnt(3)
    v_mfma_f32_16x16x32_bf16 v[16:19], v[112:115], v[128:131], v[80:83]
    ds_read_b128 v[108:111], v0 offset:2048
    s_sub_u32 s49, s43, s41
    v_mfma_f32_16x16x32_bf16 v[20:23], v[112:115], v[160:163], v[84:87]
    s_add_u32 m0, s44, 0
    s_sub_u32 s50, s44, s42
    v_mfma_f32_16x16x32_bf16 v[24:27], v[112:115], v[192:195], v[88:91]
    buffer_load_dwordx4 v7, s[16:19], s47 offen offset:0 lds
    v_mfma_f32_16x16x32_bf16 v[28:31], v[112:115], v[224:227], v[92:95]
    s_waitcnt lgkmcnt(3)
    v_mfma_f32_16x16x32_bf16 v[16:19], v[116:119], v[132:135], v[16:19]
    ds_read_b128 v[112:115], v1 offset:2048
    v_add_f32 v8, v8, v12
    v_mfma_f32_16x16x32_bf16 v[20:23], v[116:119], v[164:167], v[20:23]
    s_add_u32 m0, s44, 896
    v_add_f32_e64 v9, v9, v13
    v_mfma_f32_16x16x32_bf16 v[24:27], v[116:119], v[196:199], v[24:27]
    buffer_load_dwordx4 v7, s[16:19], s47 offen offset:128 lds
    v_mfma_f32_16x16x32_bf16 v[28:31], v[116:119], v[228:231], v[28:31]
    s_waitcnt lgkmcnt(3)
    v_mfma_f32_16x16x32_bf16 v[16:19], v[96:99], v[136:139], v[16:19]
    ds_read_b128 v[116:119], v0 offset:3072
    v_add_f32 v10, v10, v14
    v_mfma_f32_16x16x32_bf16 v[20:23], v[96:99], v[168:171], v[20:23]
    v_add_f32_e64 v11, v11, v15
    v_mfma_f32_16x16x32_bf16 v[24:27], v[96:99], v[200:203], v[24:27]
    v_mfma_f32_16x16x32_bf16 v[28:31], v[96:99], v[232:235], v[28:31]
    s_waitcnt lgkmcnt(3)
    v_mfma_f32_16x16x32_bf16 v[16:19], v[100:103], v[140:143], v[16:19]
    ds_read_b128 v[96:99], v1 offset:3072
    v_mfma_f32_16x16x32_bf16 v[20:23], v[100:103], v[172:175], v[20:23]
    s_add_u32 m0, s44, 1792
    v_mfma_f32_16x16x32_bf16 v[24:27], v[100:103], v[204:207], v[24:27]
    buffer_load_dwordx4 v7, s[16:19], s47 offen offset:256 lds
    v_mfma_f32_16x16x32_bf16 v[28:31], v[100:103], v[236:239], v[28:31]
    s_waitcnt lgkmcnt(3)
    v_mfma_f32_16x16x32_bf16 v[16:19], v[108:111], v[144:147], v[16:19]
    ds_read_b128 v[104:107], v0 offset:8192
    v_mfma_f32_16x16x32_bf16 v[20:23], v[108:111], v[176:179], v[20:23]
    s_add_u32 m0, s44, 2688
    v_mfma_f32_16x16x32_bf16 v[24:27], v[108:111], v[208:211], v[24:27]
    buffer_load_dwordx4 v7, s[16:19], s47 offen offset:384 lds
    v_mfma_f32_16x16x32_bf16 v[28:31], v[108:111], v[240:243], v[28:31]
    s_add_u32 s47, s47, 32768
    s_waitcnt lgkmcnt(3)
    v_mfma_f32_16x16x32_bf16 v[16:19], v[112:115], v[148:151], v[16:19]
    ds_read_b128 v[108:111], v1 offset:8192
    v_mfma_f32_16x16x32_bf16 v[20:23], v[112:115], v[180:183], v[20:23]
    v_mfma_f32_16x16x32_bf16 v[24:27], v[112:115], v[212:215], v[24:27]
    v_mfma_f32_16x16x32_bf16 v[28:31], v[112:115], v[244:247], v[28:31]
    s_waitcnt lgkmcnt(3)
    v_mfma_f32_16x16x32_bf16 v[16:19], v[116:119], v[152:155], v[16:19]
    ds_read_b128 v[112:115], v0 offset:9216
    v_mfma_f32_16x16x32_bf16 v[20:23], v[116:119], v[184:187], v[20:23]
    s_add_u32 m0, s44, 16128
    v_mfma_f32_16x16x32_bf16 v[24:27], v[116:119], v[216:219], v[24:27]
    buffer_load_dwordx4 v7, s[16:19], s48 offen offset:256 lds
    v_mfma_f32_16x16x32_bf16 v[28:31], v[116:119], v[248:251], v[28:31]
    s_waitcnt lgkmcnt(3)
    v_mfma_f32_16x16x32_bf16 v[16:19], v[96:99], v[156:159], v[16:19]
    ds_read_b128 v[116:119], v1 offset:9216
    v_mfma_f32_16x16x32_bf16 v[20:23], v[96:99], v[188:191], v[20:23]
    s_add_u32 m0, s44, 17024
    v_mfma_f32_16x16x32_bf16 v[24:27], v[96:99], v[220:223], v[24:27]
    buffer_load_dwordx4 v7, s[16:19], s48 offen offset:384 lds
    v_mfma_f32_16x16x32_bf16 v[28:31], v[96:99], v[252:255], v[28:31]
    s_waitcnt lgkmcnt(3)
    v_mfma_f32_16x16x32_bf16 v[32:35], v[104:107], v[128:131], v[80:83]
    ds_read_b128 v[100:103], v0 offset:10240
    v_mfma_f32_16x16x32_bf16 v[36:39], v[104:107], v[160:163], v[84:87]
    v_exp_f32_e64 v120, v16
    v_mfma_f32_16x16x32_bf16 v[40:43], v[104:107], v[192:195], v[88:91]
    v_exp_f32_e64 v121, v17
    v_mfma_f32_16x16x32_bf16 v[44:47], v[104:107], v[224:227], v[92:95]
    v_add_f32_e64 v12, v120, v121
    v_cvt_pk_bf16_f32 v64, v120, v121
    s_waitcnt lgkmcnt(3)
    v_mfma_f32_16x16x32_bf16 v[32:35], v[108:111], v[132:135], v[32:35]
    ds_read_b128 v[104:107], v1 offset:10240
    v_mfma_f32_16x16x32_bf16 v[36:39], v[108:111], v[164:167], v[36:39]
    s_add_u32 m0, s44, 18432
    v_exp_f32 v122, v18
    v_mfma_f32_16x16x32_bf16 v[40:43], v[108:111], v[196:199], v[40:43]
    buffer_load_dwordx4 v7, s[16:19], s48 offen offset:0 lds
    v_mfma_f32_16x16x32_bf16 v[44:47], v[108:111], v[228:231], v[44:47]
    v_add_f32 v12, v12, v122
    s_waitcnt lgkmcnt(3)
    v_mfma_f32_16x16x32_bf16 v[32:35], v[112:115], v[136:139], v[32:35]
    ds_read_b128 v[108:111], v0 offset:11264
    v_exp_f32_e64 v123, v19
    v_mfma_f32_16x16x32_bf16 v[36:39], v[112:115], v[168:171], v[36:39]
    v_add_f32_e64 v12, v12, v123
    v_cvt_pk_bf16_f32 v65, v122, v123
    v_mfma_f32_16x16x32_bf16 v[40:43], v[112:115], v[200:203], v[40:43]
    v_exp_f32_e64 v124, v20
    v_mfma_f32_16x16x32_bf16 v[44:47], v[112:115], v[232:235], v[44:47]
    v_exp_f32 v125, v21
    s_waitcnt lgkmcnt(3)
    v_mfma_f32_16x16x32_bf16 v[32:35], v[116:119], v[140:143], v[32:35]
    ds_read_b128 v[112:115], v1 offset:11264
    v_add_f32_e64 v13, v124, v125
    v_mfma_f32_16x16x32_bf16 v[36:39], v[116:119], v[172:175], v[36:39]
    s_add_u32 m0, s44, 19328
    v_add_u32 v0, s49, v0
    v_add_u32 v1, s49, v1
    v_mfma_f32_16x16x32_bf16 v[40:43], v[116:119], v[204:207], v[40:43]
    buffer_load_dwordx4 v7, s[16:19], s48 offen offset:128 lds
    v_mfma_f32_16x16x32_bf16 v[44:47], v[116:119], v[236:239], v[44:47]
    s_add_u32 s48, s48, 32768
    v_cvt_pk_bf16_f32 v68, v124, v125
    s_waitcnt lgkmcnt(3)
    v_mfma_f32_16x16x32_bf16 v[32:35], v[100:103], v[144:147], v[32:35]
    ds_read_b64_tr_b16 v[96:97], v2 offset:0
    v_mfma_f32_16x16x32_bf16 v[36:39], v[100:103], v[176:179], v[36:39]
    ds_read_b64_tr_b16 v[98:99], v2 offset:8192
    v_exp_f32 v120, v22
    v_mfma_f32_16x16x32_bf16 v[40:43], v[100:103], v[208:211], v[40:43]
    v_add_f32_e64 v13, v13, v120
    v_mfma_f32_16x16x32_bf16 v[44:47], v[100:103], v[240:243], v[44:47]
    v_exp_f32 v121, v23
    s_waitcnt lgkmcnt(4)
    v_mfma_f32_16x16x32_bf16 v[32:35], v[104:107], v[148:151], v[32:35]
    ds_read_b64_tr_b16 v[100:101], v3 offset:0
    v_add_f32_e64 v13, v13, v121
    v_mfma_f32_16x16x32_bf16 v[36:39], v[104:107], v[180:183], v[36:39]
    ds_read_b64_tr_b16 v[102:103], v3 offset:8192
    s_add_u32 m0, s40, 0
    v_cvt_pk_bf16_f32 v69, v120, v121
    v_mfma_f32_16x16x32_bf16 v[40:43], v[104:107], v[212:215], v[40:43]
    buffer_load_dwordx4 v6, s[12:15], s45 offen offset:0 lds
    v_mfma_f32_16x16x32_bf16 v[44:47], v[104:107], v[244:247], v[44:47]
    v_exp_f32 v122, v24
    s_waitcnt lgkmcnt(5)
    v_mfma_f32_16x16x32_bf16 v[32:35], v[108:111], v[152:155], v[32:35]
    ds_read_b64_tr_b16 v[104:105], v4 offset:0
    v_mfma_f32_16x16x32_bf16 v[36:39], v[108:111], v[184:187], v[36:39]
    ds_read_b64_tr_b16 v[106:107], v4 offset:8192
    v_exp_f32 v123, v25
    v_mfma_f32_16x16x32_bf16 v[40:43], v[108:111], v[216:219], v[40:43]
    v_add_f32_e64 v14, v122, v123
    v_cvt_pk_bf16_f32 v72, v122, v123
    v_mfma_f32_16x16x32_bf16 v[44:47], v[108:111], v[248:251], v[44:47]
    v_exp_f32 v124, v26
    s_waitcnt lgkmcnt(6)
    v_mfma_f32_16x16x32_bf16 v[32:35], v[112:115], v[156:159], v[32:35]
    ds_read_b64_tr_b16 v[108:109], v5 offset:0
    v_add_f32_e64 v14, v14, v124
    v_mfma_f32_16x16x32_bf16 v[36:39], v[112:115], v[188:191], v[36:39]
    ds_read_b64_tr_b16 v[110:111], v5 offset:8192
    s_add_u32 m0, s40, 896
    v_mfma_f32_16x16x32_bf16 v[40:43], v[112:115], v[220:223], v[40:43]
    buffer_load_dwordx4 v6, s[12:15], s45 offen offset:128 lds
    v_mfma_f32_16x16x32_bf16 v[44:47], v[112:115], v[252:255], v[44:47]
    v_exp_f32 v125, v27
    s_waitcnt lgkmcnt(4)
    v_mfma_f32_16x16x32_bf16 a[16:19], v[100:103], v[48:51], 0
    ds_read_b64_tr_b16 v[112:113], v2 offset:1024
    v_add_f32_e64 v14, v14, v125
    v_mfma_f32_16x16x32_bf16 a[0:3], v[96:99], v[48:51], 0
    ds_read_b64_tr_b16 v[114:115], v2 offset:9216
    v_cvt_pk_bf16_f32 v73, v124, v125
    v_mfma_f32_16x16x32_bf16 a[4:7], v[96:99], v[52:55], 0
    ds_read_b64_tr_b16 v[116:117], v3 offset:1024
    v_exp_f32_e64 v120, v28
    v_mfma_f32_16x16x32_bf16 a[20:23], v[100:103], v[52:55], 0
    ds_read_b64_tr_b16 v[118:119], v3 offset:9216
    v_mfma_f32_16x16x32_bf16 a[24:27], v[100:103], v[56:59], 0
    v_exp_f32_e64 v121, v29
    v_mfma_f32_16x16x32_bf16 a[8:11], v[96:99], v[56:59], 0
    s_add_u32 m0, s40, 1792
    v_add_f32_e64 v15, v120, v121
    v_cvt_pk_bf16_f32 v76, v120, v121
    v_mfma_f32_16x16x32_bf16 a[12:15], v[96:99], v[60:63], 0
    buffer_load_dwordx4 v6, s[12:15], s45 offen offset:256 lds
    v_mfma_f32_16x16x32_bf16 a[28:31], v[100:103], v[60:63], 0
    v_exp_f32 v122, v30
    s_waitcnt lgkmcnt(4)
    v_mfma_f32_16x16x32_bf16 a[48:51], v[108:111], v[48:51], 0
    ds_read_b64_tr_b16 v[96:97], v4 offset:1024
    v_add_f32_e64 v15, v15, v122
    v_mfma_f32_16x16x32_bf16 a[32:35], v[104:107], v[48:51], 0
    ds_read_b64_tr_b16 v[98:99], v4 offset:9216
    v_exp_f32_e64 v123, v31
    v_mfma_f32_16x16x32_bf16 a[36:39], v[104:107], v[52:55], 0
    ds_read_b64_tr_b16 v[100:101], v5 offset:1024
    v_add_f32_e64 v15, v15, v123
    v_mfma_f32_16x16x32_bf16 a[52:55], v[108:111], v[52:55], 0
    ds_read_b64_tr_b16 v[102:103], v5 offset:9216
    v_cvt_pk_bf16_f32 v77, v122, v123
    v_mfma_f32_16x16x32_bf16 a[56:59], v[108:111], v[56:59], 0
    v_exp_f32_e64 v124, v32
    v_mfma_f32_16x16x32_bf16 a[40:43], v[104:107], v[56:59], 0
    s_add_u32 m0, s40, 2688
    v_add_f32_e64 v12, v12, v124
    v_mfma_f32_16x16x32_bf16 a[44:47], v[104:107], v[60:63], 0
    buffer_load_dwordx4 v6, s[12:15], s45 offen offset:384 lds
    v_mfma_f32_16x16x32_bf16 a[60:63], v[108:111], v[60:63], 0
    s_add_u32 s45, s45, 32768
    s_waitcnt lgkmcnt(4)
    v_mfma_f32_16x16x32_bf16 a[80:83], v[116:119], v[48:51], 0
    ds_read_b64_tr_b16 v[104:105], v2 offset:2048
    v_exp_f32 v125, v33
    v_mfma_f32_16x16x32_bf16 a[64:67], v[112:115], v[48:51], 0
    ds_read_b64_tr_b16 v[106:107], v2 offset:10240
    v_add_f32_e64 v12, v12, v125
    v_mfma_f32_16x16x32_bf16 a[68:71], v[112:115], v[52:55], 0
    ds_read_b64_tr_b16 v[108:109], v3 offset:2048
    v_cvt_pk_bf16_f32 v66, v124, v125
    v_mfma_f32_16x16x32_bf16 a[84:87], v[116:119], v[52:55], 0
    ds_read_b64_tr_b16 v[110:111], v3 offset:10240
    v_exp_f32_e64 v120, v34
    v_mfma_f32_16x16x32_bf16 a[88:91], v[116:119], v[56:59], 0
    v_add_f32_e64 v12, v12, v120
    v_mfma_f32_16x16x32_bf16 a[72:75], v[112:115], v[56:59], 0
    s_add_u32 m0, s40, 16384
    v_exp_f32_e64 v121, v35
    v_mfma_f32_16x16x32_bf16 a[76:79], v[112:115], v[60:63], 0
    buffer_load_dwordx4 v6, s[12:15], s46 offen offset:0 lds
    v_mfma_f32_16x16x32_bf16 a[92:95], v[116:119], v[60:63], 0
    v_add_f32_e64 v12, v12, v121
    v_cvt_pk_bf16_f32 v67, v120, v121
    s_waitcnt lgkmcnt(4)
    v_mfma_f32_16x16x32_bf16 a[112:115], v[100:103], v[48:51], 0
    ds_read_b64_tr_b16 v[112:113], v4 offset:2048
    v_mfma_f32_16x16x32_bf16 a[96:99], v[96:99], v[48:51], 0
    ds_read_b64_tr_b16 v[114:115], v4 offset:10240
    v_exp_f32 v122, v36
    v_mfma_f32_16x16x32_bf16 a[100:103], v[96:99], v[52:55], 0
    ds_read_b64_tr_b16 v[116:117], v5 offset:2048
    v_add_f32_e64 v13, v13, v122
    v_mfma_f32_16x16x32_bf16 a[116:119], v[100:103], v[52:55], 0
    ds_read_b64_tr_b16 v[118:119], v5 offset:10240
    v_exp_f32_e64 v123, v37
    v_mfma_f32_16x16x32_bf16 a[120:123], v[100:103], v[56:59], 0
    v_add_f32_e64 v13, v13, v123
    v_cvt_pk_bf16_f32 v70, v122, v123
    v_mfma_f32_16x16x32_bf16 a[104:107], v[96:99], v[56:59], 0
    s_add_u32 m0, s40, 17280
    v_exp_f32_e64 v124, v38
    v_mfma_f32_16x16x32_bf16 a[108:111], v[96:99], v[60:63], 0
    buffer_load_dwordx4 v6, s[12:15], s46 offen offset:128 lds
    v_mfma_f32_16x16x32_bf16 a[124:127], v[100:103], v[60:63], 0
    v_add_f32 v13, v13, v124
    s_waitcnt lgkmcnt(4)
    v_mfma_f32_16x16x32_bf16 a[144:147], v[108:111], v[48:51], 0
    ds_read_b64_tr_b16 v[96:97], v2 offset:3072
    v_exp_f32_e64 v125, v39
    v_mfma_f32_16x16x32_bf16 a[128:131], v[104:107], v[48:51], 0
    ds_read_b64_tr_b16 v[98:99], v2 offset:11264
    v_add_f32_e64 v13, v13, v125
    v_mfma_f32_16x16x32_bf16 a[132:135], v[104:107], v[52:55], 0
    ds_read_b64_tr_b16 v[100:101], v3 offset:3072
    v_cvt_pk_bf16_f32 v71, v124, v125
    v_mfma_f32_16x16x32_bf16 a[148:151], v[108:111], v[52:55], 0
    ds_read_b64_tr_b16 v[102:103], v3 offset:11264
    v_exp_f32_e64 v120, v40
    v_mfma_f32_16x16x32_bf16 a[152:155], v[108:111], v[56:59], 0
    v_add_f32_e64 v14, v14, v120
    v_mfma_f32_16x16x32_bf16 a[136:139], v[104:107], v[56:59], 0
    s_add_u32 m0, s40, 18176
    v_exp_f32_e64 v121, v41
    v_mfma_f32_16x16x32_bf16 a[140:143], v[104:107], v[60:63], 0
    buffer_load_dwordx4 v6, s[12:15], s46 offen offset:256 lds
    v_mfma_f32_16x16x32_bf16 a[156:159], v[108:111], v[60:63], 0
    v_add_f32_e64 v14, v14, v121
    v_cvt_pk_bf16_f32 v74, v120, v121
    s_waitcnt lgkmcnt(4)
    v_mfma_f32_16x16x32_bf16 a[176:179], v[116:119], v[48:51], 0
    ds_read_b64_tr_b16 v[104:105], v4 offset:3072
    v_mfma_f32_16x16x32_bf16 a[160:163], v[112:115], v[48:51], 0
    ds_read_b64_tr_b16 v[106:107], v4 offset:11264
    s_add_u32 m0, s40, 19072
    v_mfma_f32_16x16x32_bf16 a[164:167], v[112:115], v[52:55], 0
    ds_read_b64_tr_b16 v[108:109], v5 offset:3072
    buffer_load_dwordx4 v6, s[12:15], s46 offen offset:384 lds
    v_mfma_f32_16x16x32_bf16 a[180:183], v[116:119], v[52:55], 0
    ds_read_b64_tr_b16 v[110:111], v5 offset:11264
    s_add_u32 s46, s46, 32768
    v_mfma_f32_16x16x32_bf16 a[184:187], v[116:119], v[56:59], 0
    v_exp_f32 v122, v42
    v_mfma_f32_16x16x32_bf16 a[168:171], v[112:115], v[56:59], 0
    v_add_f32 v14, v14, v122
    v_exp_f32 v123, v43
    v_mfma_f32_16x16x32_bf16 a[172:175], v[112:115], v[60:63], 0
    v_add_f32_e64 v14, v14, v123
    v_cvt_pk_bf16_f32 v75, v122, v123
    v_mfma_f32_16x16x32_bf16 a[188:191], v[116:119], v[60:63], 0
    v_exp_f32 v124, v44
    s_waitcnt lgkmcnt(4)
    v_mfma_f32_16x16x32_bf16 a[208:211], v[100:103], v[48:51], 0
    s_waitcnt vmcnt(8)
    s_barrier
    ds_read_b128 v[112:115], v0 offset:0
    v_mfma_f32_16x16x32_bf16 a[192:195], v[96:99], v[48:51], 0
    v_add_f32 v15, v15, v124
    v_exp_f32 v125, v45
    v_mfma_f32_16x16x32_bf16 a[196:199], v[96:99], v[52:55], 0
    ds_read_b128 v[116:119], v1 offset:0
    v_add_f32_e64 v15, v15, v125
    v_mfma_f32_16x16x32_bf16 a[212:215], v[100:103], v[52:55], 0
    v_cvt_pk_bf16_f32 v78, v124, v125
    v_exp_f32_e64 v120, v46
    v_mfma_f32_16x16x32_bf16 a[216:219], v[100:103], v[56:59], 0
    v_add_f32 v15, v15, v120
    v_add_u32 v2, s50, v2
    v_mfma_f32_16x16x32_bf16 a[200:203], v[96:99], v[56:59], 0
    v_exp_f32 v121, v47
    v_add_u32 v3, s50, v3
    v_mfma_f32_16x16x32_bf16 a[204:207], v[96:99], v[60:63], 0
    v_add_f32_e64 v15, v15, v121
    v_cvt_pk_bf16_f32 v79, v120, v121
    v_mfma_f32_16x16x32_bf16 a[220:223], v[100:103], v[60:63], 0
    v_add_u32 v4, s50, v4
    v_add_u32 v5, s50, v5
    s_waitcnt lgkmcnt(2)
    v_mfma_f32_16x16x32_bf16 a[240:243], v[108:111], v[48:51], 0
    ds_read_b128 v[96:99], v0 offset:1024
    v_max3_f32 v120, v12, v13, v14
    v_mfma_f32_16x16x32_bf16 a[224:227], v[104:107], v[48:51], 0
    v_mfma_f32_16x16x32_bf16 a[228:231], v[104:107], v[52:55], 0
    ds_read_b128 v[100:103], v1 offset:1024
    v_max_f32 v120, v120, v15
    v_cmp_nge_f32 vcc, s52, v120
    v_mfma_f32_16x16x32_bf16 a[244:247], v[108:111], v[52:55], 0
    v_mfma_f32_16x16x32_bf16 a[248:251], v[108:111], v[56:59], 0
    v_mfma_f32_16x16x32_bf16 a[232:235], v[104:107], v[56:59], 0
    v_mfma_f32_16x16x32_bf16 a[236:239], v[104:107], v[60:63], 0
    v_mfma_f32_16x16x32_bf16 a[252:255], v[108:111], v[60:63], 0
    s_cbranch_vccnz L_rare_f
L_back_f:
    s_waitcnt lgkmcnt(3)
    v_mfma_f32_16x16x32_bf16 v[16:19], v[112:115], v[128:131], v[80:83]
    ds_read_b128 v[108:111], v0 offset:2048
    s_sub_u32 s49, s40, s43
    v_mfma_f32_16x16x32_bf16 v[20:23], v[112:115], v[160:163], v[84:87]
    s_add_u32 m0, s41, 0
    s_sub_u32 s50, s41, s44
    v_mfma_f32_16x16x32_bf16 v[24:27], v[112:115], v[192:195], v[88:91]
    buffer_load_dwordx4 v7, s[16:19], s47 offen offset:0 lds
    v_mfma_f32_16x16x32_bf16 v[28:31], v[112:115], v[224:227], v[92:95]
    s_waitcnt lgkmcnt(3)
    v_mfma_f32_16x16x32_bf16 v[16:19], v[116:119], v[132:135], v[16:19]
    ds_read_b128 v[112:115], v1 offset:2048
    v_add_f32 v8, v8, v12
    v_mfma_f32_16x16x32_bf16 v[20:23], v[116:119], v[164:167], v[20:23]
    s_add_u32 m0, s41, 896
    v_add_f32_e64 v9, v9, v13
    v_mfma_f32_16x16x32_bf16 v[24:27], v[116:119], v[196:199], v[24:27]
    buffer_load_dwordx4 v7, s[16:19], s47 offen offset:128 lds
    v_mfma_f32_16x16x32_bf16 v[28:31], v[116:119], v[228:231], v[28:31]
    s_waitcnt lgkmcnt(3)
    v_mfma_f32_16x16x32_bf16 v[16:19], v[96:99], v[136:139], v[16:19]
    ds_read_b128 v[116:119], v0 offset:3072
    v_add_f32 v10, v10, v14
    v_mfma_f32_16x16x32_bf16 v[20:23], v[96:99], v[168:171], v[20:23]
    v_add_f32_e64 v11, v11, v15
    v_mfma_f32_16x16x32_bf16 v[24:27], v[96:99], v[200:203], v[24:27]
    v_mfma_f32_16x16x32_bf16 v[28:31], v[96:99], v[232:235], v[28:31]
    s_waitcnt lgkmcnt(3)
    v_mfma_f32_16x16x32_bf16 v[16:19], v[100:103], v[140:143], v[16:19]
    ds_read_b128 v[96:99], v1 offset:3072
    v_mfma_f32_16x16x32_bf16 v[20:23], v[100:103], v[172:175], v[20:23]
    s_add_u32 m0, s41, 1792
    v_mfma_f32_16x16x32_bf16 v[24:27], v[100:103], v[204:207], v[24:27]
    buffer_load_dwordx4 v7, s[16:19], s47 offen offset:256 lds
    v_mfma_f32_16x16x32_bf16 v[28:31], v[100:103], v[236:239], v[28:31]
    s_waitcnt lgkmcnt(3)
    v_mfma_f32_16x16x32_bf16 v[16:19], v[108:111], v[144:147], v[16:19]
    ds_read_b128 v[104:107], v0 offset:8192
    v_mfma_f32_16x16x32_bf16 v[20:23], v[108:111], v[176:179], v[20:23]
    s_add_u32 m0, s41, 2688
    v_mfma_f32_16x16x32_bf16 v[24:27], v[108:111], v[208:211], v[24:27]
    buffer_load_dwordx4 v7, s[16:19], s47 offen offset:384 lds
    v_mfma_f32_16x16x32_bf16 v[28:31], v[108:111], v[240:243], v[28:31]
    s_add_u32 s47, s47, 32768
    s_waitcnt lgkmcnt(3)
    v_mfma_f32_16x16x32_bf16 v[16:19], v[112:115], v[148:151], v[16:19]
    ds_read_b128 v[108:111], v1 offset:8192
    v_mfma_f32_16x16x32_bf16 v[20:23], v[112:115], v[180:183], v[20:23]
    v_mfma_f32_16x16x32_bf16 v[24:27], v[112:115], v[212:215], v[24:27]
    v_mfma_f32_16x16x32_bf16 v[28:31], v[112:115], v[244:247], v[28:31]
    s_waitcnt lgkmcnt(3)
    v_mfma_f32_16x16x32_bf16 v[16:19], v[116:119], v[152:155], v[16:19]
    ds_read_b128 v[112:115], v0 offset:9216
    v_mfma_f32_16x16x32_bf16 v[20:23], v[116:119], v[184:187], v[20:23]
    s_add_u32 m0, s41, 16128
    v_mfma_f32_16x16x32_bf16 v[24:27], v[116:119], v[216:219], v[24:27]
    buffer_load_dwordx4 v7, s[16:19], s48 offen offset:256 lds
    v_mfma_f32_16x16x32_bf16 v[28:31], v[116:119], v[248:251], v[28:31]
    s_waitcnt lgkmcnt(3)
    v_mfma_f32_16x16x32_bf16 v[16:19], v[96:99], v[156:159], v[16:19]
    ds_read_b128 v[116:119], v1 offset:9216
    v_mfma_f32_16x16x32_bf16 v[20:23], v[96:99], v[188:191], v[20:23]
    s_add_u32 m0, s41, 17024
    v_mfma_f32_16x16x32_bf16 v[24:27], v[96:99], v[220:223], v[24:27]
    buffer_load_dwordx4 v7, s[16:19], s48 offen offset:384 lds
    v_mfma_f32_16x16x32_bf16 v[28:31], v[96:99], v[252:255], v[28:31]
    s_waitcnt lgkmcnt(3)
    v_mfma_f32_16x16x32_bf16 v[32:35], v[104:107], v[128:131], v[80:83]
    ds_read_b128 v[100:103], v0 offset:10240
    v_mfma_f32_16x16x32_bf16 v[36:39], v[104:107], v[160:163], v[84:87]
    v_exp_f32_e64 v120, v16
    v_mfma_f32_16x16x32_bf16 v[40:43], v[104:107], v[192:195], v[88:91]
    v_exp_f32_e64 v121, v17
    v_mfma_f32_16x16x32_bf16 v[44:47], v[104:107], v[224:227], v[92:95]
    v_add_f32_e64 v12, v120, v121
    v_cvt_pk_bf16_f32 v48, v120, v121
    s_waitcnt lgkmcnt(3)
    v_mfma_f32_16x16x32_bf16 v[32:35], v[108:111], v[132:135], v[32:35]
    ds_read_b128 v[104:107], v1 offset:10240
    v_mfma_f32_16x16x32_bf16 v[36:39], v[108:111], v[164:167], v[36:39]
    s_add_u32 m0, s41, 18432
    v_exp_f32 v122, v18
    v_mfma_f32_16x16x32_bf16 v[40:43], v[108:111], v[196:199], v[40:43]
    buffer_load_dwordx4 v7, s[16:19], s48 offen offset:0 lds
    v_mfma_f32_16x16x32_bf16 v[44:47], v[108:111], v[228:231], v[44:47]
    v_add_f32 v12, v12, v122
    s_waitcnt lgkmcnt(3)
    v_mfma_f32_16x16x32_bf16 v[32:35], v[112:115], v[136:139], v[32:35]
    ds_read_b128 v[108:111], v0 offset:11264
    v_exp_f32_e64 v123, v19
    v_mfma_f32_16x16x32_bf16 v[36:39], v[112:115], v[168:171], v[36:39]
    v_add_f32_e64 v12, v12, v123
    v_cvt_pk_bf16_f32 v49, v122, v123
    v_mfma_f32_16x16x32_bf16 v[40:43], v[112:115], v[200:203], v[40:43]
    v_exp_f32_e64 v124, v20
    v_mfma_f32_16x16x32_bf16 v[44:47], v[112:115], v[232:235], v[44:47]
    v_exp_f32 v125, v21
    s_waitcnt lgkmcnt(3)
    v_mfma_f32_16x16x32_bf16 v[32:35], v[116:119], v[140:143], v[32:35]
    ds_read_b128 v[112:115], v1 offset:11264
    v_add_f32_e64 v13, v124, v125
    v_mfma_f32_16x16x32_bf16 v[36:39], v[116:119], v[172:175], v[36:39]
    s_add_u32 m0, s41, 19328
    v_add_u32 v0, s49, v0
    v_add_u32 v1, s49, v1
    v_mfma_f32_16x16x32_bf16 v[40:43], v[116:119], v[204:207], v[40:43]
    buffer_load_dwordx4 v7, s[16:19], s48 offen offset:128 lds
    v_mfma_f32_16x16x32_bf16 v[44:47], v[116:119], v[236:239], v[44:47]
    s_add_u32 s48, s48, 32768
    v_cvt_pk_bf16_f32 v52, v124, v125
    s_waitcnt lgkmcnt(3)
    v_mfma_f32_16x16x32_bf16 v[32:35], v[100:103], v[144:147], v[32:35]
    ds_read_b64_tr_b16 v[96:97], v2 offset:0
    v_mfma_f32_16x16x32_bf16 v[36:39], v[100:103], v[176:179], v[36:39]
    ds_read_b64_tr_b16 v[98:99], v2 offset:8192
    v_exp_f32 v120, v22
    v_mfma_f32_16x16x32_bf16 v[40:43], v[100:103], v[208:211], v[40:43]
    v_add_f32_e64 v13, v13, v120
    v_mfma_f32_16x16x32_bf16 v[44:47], v[100:103], v[240:243], v[44:47]
    v_exp_f32 v121, v23
    s_waitcnt lgkmcnt(4)
    v_mfma_f32_16x16x32_bf16 v[32:35], v[104:107], v[148:151], v[32:35]
    ds_read_b64_tr_b16 v[100:101], v3 offset:0
    v_add_f32_e64 v13, v13, v121
    v_mfma_f32_16x16x32_bf16 v[36:39], v[104:107], v[180:183], v[36:39]
    ds_read_b64_tr_b16 v[102:103], v3 offset:8192
    s_add_u32 m0, s42, 0
    v_cvt_pk_bf16_f32 v53, v120, v121
    v_mfma_f32_16x16x32_bf16 v[40:43], v[104:107], v[212:215], v[40:43]
    buffer_load_dwordx4 v6, s[12:15], s45 offen offset:0 lds
    v_mfma_f32_16x16x32_bf16 v[44:47], v[104:107], v[244:247], v[44:47]
    v_exp_f32 v122, v24
    s_waitcnt lgkmcnt(5)
    v_mfma_f32_16x16x32_bf16 v[32:35], v[108:111], v[152:155], v[32:35]
    ds_read_b64_tr_b16 v[104:105], v4 offset:0
    v_mfma_f32_16x16x32_bf16 v[36:39], v[108:111], v[184:187], v[36:39]
    ds_read_b64_tr_b16 v[106:107], v4 offset:8192
    v_exp_f32 v123, v25
    v_mfma_f32_16x16x32_bf16 v[40:43], v[108:111], v[216:219], v[40:43]
    v_add_f32_e64 v14, v122, v123
    v_cvt_pk_bf16_f32 v56, v122, v123
    v_mfma_f32_16x16x32_bf16 v[44:47], v[108:111], v[248:251], v[44:47]
    v_exp_f32 v124, v26
    s_waitcnt lgkmcnt(6)
    v_mfma_f32_16x16x32_bf16 v[32:35], v[112:115], v[156:159], v[32:35]
    ds_read_b64_tr_b16 v[108:109], v5 offset:0
    v_add_f32_e64 v14, v14, v124
    v_mfma_f32_16x16x32_bf16 v[36:39], v[112:115], v[188:191], v[36:39]
    ds_read_b64_tr_b16 v[110:111], v5 offset:8192
    s_add_u32 m0, s42, 896
    v_mfma_f32_16x16x32_bf16 v[40:43], v[112:115], v[220:223], v[40:43]
    buffer_load_dwordx4 v6, s[12:15], s45 offen offset:128 lds
    v_mfma_f32_16x16x32_bf16 v[44:47], v[112:115], v[252:255], v[44:47]
    v_exp_f32 v125, v27
    s_waitcnt lgkmcnt(4)
    v_mfma_f32_16x16x32_bf16 a[16:19], v[100:103], v[64:67], a[16:19]
    ds_read_b64_tr_b16 v[112:113], v2 offset:1024
    v_add_f32_e64 v14, v14, v125
    v_mfma_f32_16x16x32_bf16 a[0:3], v[96:99], v[64:67], a[0:3]
    ds_read_b64_tr_b16 v[114:115], v2 offset:9216
    v_cvt_pk_bf16_f32 v57, v124, v125
    v_mfma_f32_16x16x32_bf16 a[4:7], v[96:99], v[68:71], a[4:7]
    ds_read_b64_tr_b16 v[116:117], v3 offset:1024
    v_exp_f32_e64 v120, v28
    v_mfma_f32_16x16x32_bf16 a[20:23], v[100:103], v[68:71], a[20:23]
    ds_read_b64_tr_b16 v[118:119], v3 offset:9216
    v_mfma_f32_16x16x32_bf16 a[24:27], v[100:103], v[72:75], a[24:27]
    v_exp_f32_e64 v121, v29
    v_mfma_f32_16x16x32_bf16 a[8:11], v[96:99], v[72:75], a[8:11]
    s_add_u32 m0, s42, 1792
    v_add_f32_e64 v15, v120, v121
    v_cvt_pk_bf16_f32 v60, v120, v121
    v_mfma_f32_16x16x32_bf16 a[12:15], v[96:99], v[76:79], a[12:15]
    buffer_load_dwordx4 v6, s[12:15], s45 offen offset:256 lds
    v_mfma_f32_16x16x32_bf16 a[28:31], v[100:103], v[76:79], a[28:31]
    v_exp_f32 v122, v30
    s_waitcnt lgkmcnt(4)
    v_mfma_f32_16x16x32_bf16 a[48:51], v[108:111], v[64:67], a[48:51]
    ds_read_b64_tr_b16 v[96:97], v4 offset:1024
    v_add_f32_e64 v15, v15, v122
    v_mfma_f32_16x16x32_bf16 a[32:35], v[104:107], v[64:67], a[32:35]
    ds_read_b64_tr_b16 v[98:99], v4 offset:9216
    v_exp_f32_e64 v123, v31
    v_mfma_f32_16x16x32_bf16 a[36:39], v[104:107], v[68:71], a[36:39]
    ds_read_b64_tr_b16 v[100:101], v5 offset:1024
    v_add_f32_e64 v15, v15, v123
    v_mfma_f32_16x16x32_bf16 a[52:55], v[108:111], v[68:71], a[52:55]
    ds_read_b64_tr_b16 v[102:103], v5 offset:9216
    v_cvt_pk_bf16_f32 v61, v122, v123
    v_mfma_f32_16x16x32_bf16 a[56:59], v[108:111], v[72:75], a[56:59]
    v_exp_f32_e64 v124, v32
    v_mfma_f32_16x16x32_bf16 a[40:43], v[104:107], v[72:75], a[40:43]
    s_add_u32 m0, s42, 2688
    v_add_f32_e64 v12, v12, v124
    v_mfma_f32_16x16x32_bf16 a[44:47], v[104:107], v[76:79], a[44:47]
    buffer_load_dwordx4 v6, s[12:15], s45 offen offset:384 lds
    v_mfma_f32_16x16x32_bf16 a[60:63], v[108:111], v[76:79], a[60:63]
    s_add_u32 s45, s45, 32768
    s_waitcnt lgkmcnt(4)
    v_mfma_f32_16x16x32_bf16 a[80:83], v[116:119], v[64:67], a[80:83]
    ds_read_b64_tr_b16 v[104:105], v2 offset:2048
    v_exp_f32 v125, v33
    v_mfma_f32_16x16x32_bf16 a[64:67], v[112:115], v[64:67], a[64:67]
    ds_read_b64_tr_b16 v[106:107], v2 offset:10240
    v_add_f32_e64 v12, v12, v125
    v_mfma_f32_16x16x32_bf16 a[68:71], v[112:115], v[68:71], a[68:71]
    ds_read_b64_tr_b16 v[108:109], v3 offset:2048
    v_cvt_pk_bf16_f32 v50, v124, v125
    v_mfma_f32_16x16x32_bf16 a[84:87], v[116:119], v[68:71], a[84:87]
    ds_read_b64_tr_b16 v[110:111], v3 offset:10240
    v_exp_f32_e64 v120, v34
    v_mfma_f32_16x16x32_bf16 a[88:91], v[116:119], v[72:75], a[88:91]
    v_add_f32_e64 v12, v12, v120
    v_mfma_f32_16x16x32_bf16 a[72:75], v[112:115], v[72:75], a[72:75]
    s_add_u32 m0, s42, 16384
    v_exp_f32_e64 v121, v35
    v_mfma_f32_16x16x32_bf16 a[76:79], v[112:115], v[76:79], a[76:79]
    buffer_load_dwordx4 v6, s[12:15], s46 offen offset:0 lds
    v_mfma_f32_16x16x32_bf16 a[92:95], v[116:119], v[76:79], a[92:95]
    v_add_f32_e64 v12, v12, v121
    v_cvt_pk_bf16_f32 v51, v120, v121
    s_waitcnt lgkmcnt(4)
    v_mfma_f32_16x16x32_bf16 a[112:115], v[100:103], v[64:67], a[112:115]
    ds_read_b64_tr_b16 v[112:113], v4 offset:2048
    v_mfma_f32_16x16x32_bf16 a[96:99], v[96:99], v[64:67], a[96:99]
    ds_read_b64_tr_b16 v[114:115], v4 offset:10240
    v_exp_f32 v122, v36
    v_mfma_f32_16x16x32_bf16 a[100:103], v[96:99], v[68:71], a[100:103]
    ds_read_b64_tr_b16 v[116:117], v5 offset:2048
    v_add_f32_e64 v13, v13, v122
    v_mfma_f32_16x16x32_bf16 a[116:119], v[100:103], v[68:71], a[116:119]
    ds_read_b64_tr_b16 v[118:119], v5 offset:10240
    v_exp_f32_e64 v123, v37
    v_mfma_f32_16x16x32_bf16 a[120:123], v[100:103], v[72:75], a[120:123]
    v_add_f32_e64 v13, v13, v123
    v_cvt_pk_bf16_f32 v54, v122, v123
    v_mfma_f32_16x16x32_bf16 a[104:107], v[96:99], v[72:75], a[104:107]
    s_add_u32 m0, s42, 17280
    v_exp_f32_e64 v124, v38
    v_mfma_f32_16x16x32_bf16 a[108:111], v[96:99], v[76:79], a[108:111]
    buffer_load_dwordx4 v6, s[12:15], s46 offen offset:128 lds
    v_mfma_f32_16x16x32_bf16 a[124:127], v[100:103], v[76:79], a[124:127]
    v_add_f32 v13, v13, v124
    s_waitcnt lgkmcnt(4)
    v_mfma_f32_16x16x32_bf16 a[144:147], v[108:111], v[64:67], a[144:147]
    ds_read_b64_tr_b16 v[96:97], v2 offset:3072
    v_exp_f32_e64 v125, v39
    v_mfma_f32_16x16x32_bf16 a[128:131], v[104:107], v[64:67], a[128:131]
    ds_read_b64_tr_b16 v[98:99], v2 offset:11264
    v_add_f32_e64 v13, v13, v125
    v_mfma_f32_16x16x32_bf16 a[132:135], v[104:107], v[68:71], a[132:135]
    ds_read_b64_tr_b16 v[100:101], v3 offset:3072
    v_cvt_pk_bf16_f32 v55, v124, v125
    v_mfma_f32_16x16x32_bf16 a[148:151], v[108:111], v[68:71], a[148:151]
    ds_read_b64_tr_b16 v[102:103], v3 offset:11264
    v_exp_f32_e64 v120, v40
    v_mfma_f32_16x16x32_bf16 a[152:155], v[108:111], v[72:75], a[152:155]
    v_add_f32_e64 v14, v14, v120
    v_mfma_f32_16x16x32_bf16 a[136:139], v[104:107], v[72:75], a[136:139]
    s_add_u32 m0, s42, 18176
    v_exp_f32_e64 v121, v41
    v_mfma_f32_16x16x32_bf16 a[140:143], v[104:107], v[76:79], a[140:143]
    buffer_load_dwordx4 v6, s[12:15], s46 offen offset:256 lds
    v_mfma_f32_16x16x32_bf16 a[156:159], v[108:111], v[76:79], a[156:159]
    v_add_f32_e64 v14, v14, v121
    v_cvt_pk_bf16_f32 v58, v120, v121
    s_waitcnt lgkmcnt(4)
    v_mfma_f32_16x16x32_bf16 a[176:179], v[116:119], v[64:67], a[176:179]
    ds_read_b64_tr_b16 v[104:105], v4 offset:3072
    v_mfma_f32_16x16x32_bf16 a[160:163], v[112:115], v[64:67], a[160:163]
    ds_read_b64_tr_b16 v[106:107], v4 offset:11264
    s_add_u32 m0, s42, 19072
    v_mfma_f32_16x16x32_bf16 a[164:167], v[112:115], v[68:71], a[164:167]
    ds_read_b64_tr_b16 v[108:109], v5 offset:3072
    buffer_load_dwordx4 v6, s[12:15], s46 offen offset:384 lds
    v_mfma_f32_16x16x32_bf16 a[180:183], v[116:119], v[68:71], a[180:183]
    ds_read_b64_tr_b16 v[110:111], v5 offset:11264
    s_add_u32 s46, s46, 32768
    v_mfma_f32_16x16x32_bf16 a[184:187], v[116:119], v[72:75], a[184:187]
    v_exp_f32 v122, v42
    v_mfma_f32_16x16x32_bf16 a[168:171], v[112:115], v[72:75], a[168:171]
    v_add_f32 v14, v14, v122
    v_exp_f32 v123, v43
    v_mfma_f32_16x16x32_bf16 a[172:175], v[112:115], v[76:79], a[172:175]
    v_add_f32_e64 v14, v14, v123
    v_cvt_pk_bf16_f32 v59, v122, v123
    v_mfma_f32_16x16x32_bf16 a[188:191], v[116:119], v[76:79], a[188:191]
    v_exp_f32 v124, v44
    s_waitcnt lgkmcnt(4)
    v_mfma_f32_16x16x32_bf16 a[208:211], v[100:103], v[64:67], a[208:211]
    s_waitcnt vmcnt(8)
    s_barrier
    ds_read_b128 v[112:115], v0 offset:0
    v_mfma_f32_16x16x32_bf16 a[192:195], v[96:99], v[64:67], a[192:195]
    v_add_f32 v15, v15, v124
    v_exp_f32 v125, v45
    v_mfma_f32_16x16x32_bf16 a[196:199], v[96:99], v[68:71], a[196:199]
    ds_read_b128 v[116:119], v1 offset:0
    v_add_f32_e64 v15, v15, v125
    v_mfma_f32_16x16x32_bf16 a[212:215], v[100:103], v[68:71], a[212:215]
    v_cvt_pk_bf16_f32 v62, v124, v125
    v_exp_f32_e64 v120, v46
    v_mfma_f32_16x16x32_bf16 a[216:219], v[100:103], v[72:75], a[216:219]
    v_add_f32 v15, v15, v120
    v_add_u32 v2, s50, v2
    v_mfma_f32_16x16x32_bf16 a[200:203], v[96:99], v[72:75], a[200:203]
    v_exp_f32 v121, v47
    v_add_u32 v3, s50, v3
    v_mfma_f32_16x16x32_bf16 a[204:207], v[96:99], v[76:79], a[204:207]
    v_add_f32_e64 v15, v15, v121
    v_cvt_pk_bf16_f32 v63, v120, v121
    v_mfma_f32_16x16x32_bf16 a[220:223], v[100:103], v[76:79], a[220:223]
    v_add_u32 v4, s50, v4
    v_add_u32 v5, s50, v5
    s_waitcnt lgkmcnt(2)
    v_mfma_f32_16x16x32_bf16 a[240:243], v[108:111], v[64:67], a[240:243]
    ds_read_b128 v[96:99], v0 offset:1024
    v_max3_f32 v120, v12, v13, v14
    v_mfma_f32_16x16x32_bf16 a[224:227], v[104:107], v[64:67], a[224:227]
    v_mfma_f32_16x16x32_bf16 a[228:231], v[104:107], v[68:71], a[228:231]
    ds_read_b128 v[100:103], v1 offset:1024
    v_max_f32 v120, v120, v15
    v_cmp_nge_f32 vcc, s52, v120
    v_mfma_f32_16x16x32_bf16 a[244:247], v[108:111], v[68:71], a[244:247]
    v_mfma_f32_16x16x32_bf16 a[248:251], v[108:111], v[72:75], a[248:251]
    v_mfma_f32_16x16x32_bf16 a[232:235], v[104:107], v[72:75], a[232:235]
    v_mfma_f32_16x16x32_bf16 a[236:239], v[104:107], v[76:79], a[236:239]
    v_mfma_f32_16x16x32_bf16 a[252:255], v[108:111], v[76:79], a[252:255]
    s_cbranch_vccnz L_rare_g
L_back_g:
.p2align 6
L_k2_loop:
    s_waitcnt lgkmcnt(3)
    v_mfma_f32_16x16x32_bf16 v[16:19], v[112:115], v[128:131], v[80:83]
    ds_read_b128 v[108:111], v0 offset:2048
    s_sub_u32 s49, s42, s40
    v_mfma_f32_16x16x32_bf16 v[20:23], v[112:115], v[160:163], v[84:87]
    s_add_u32 m0, s43, 0
    s_sub_u32 s50, s43, s41
    v_mfma_f32_16x16x32_bf16 v[24:27], v[112:115], v[192:195], v[88:91]
    buffer_load_dwordx4 v7, s[16:19], s47 offen offset:0 lds
    v_mfma_f32_16x16x32_bf16 v[28:31], v[112:115], v[224:227], v[92:95]
    s_waitcnt lgkmcnt(3)
    v_mfma_f32_16x16x32_bf16 v[16:19], v[116:119], v[132:135], v[16:19]
    ds_read_b128 v[112:115], v1 offset:2048
    v_add_f32 v8, v8, v12
    v_mfma_f32_16x16x32_bf16 v[20:23], v[116:119], v[164:167], v[20:23]
    s_add_u32 m0, s43, 896
    v_add_f32_e64 v9, v9, v13
    v_mfma_f32_16x16x32_bf16 v[24:27], v[116:119], v[196:199], v[24:27]
    buffer_load_dwordx4 v7, s[16:19], s47 offen offset:128 lds
    v_mfma_f32_16x16x32_bf16 v[28:31], v[116:119], v[228:231], v[28:31]
    s_waitcnt lgkmcnt(3)
    v_mfma_f32_16x16x32_bf16 v[16:19], v[96:99], v[136:139], v[16:19]
    ds_read_b128 v[116:119], v0 offset:3072
    v_add_f32 v10, v10, v14
    v_mfma_f32_16x16x32_bf16 v[20:23], v[96:99], v[168:171], v[20:23]
    v_add_f32_e64 v11, v11, v15
    v_mfma_f32_16x16x32_bf16 v[24:27], v[96:99], v[200:203], v[24:27]
    v_mfma_f32_16x16x32_bf16 v[28:31], v[96:99], v[232:235], v[28:31]
    s_waitcnt lgkmcnt(3)
    v_mfma_f32_16x16x32_bf16 v[16:19], v[100:103], v[140:143], v[16:19]
    ds_read_b128 v[96:99], v1 offset:3072
    v_mfma_f32_16x16x32_bf16 v[20:23], v[100:103], v[172:175], v[20:23]
    s_add_u32 m0, s43, 1792
    v_mfma_f32_16x16x32_bf16 v[24:27], v[100:103], v[204:207], v[24:27]
    buffer_load_dwordx4 v7, s[16:19], s47 offen offset:256 lds
    v_mfma_f32_16x16x32_bf16 v[28:31], v[100:103], v[236:239], v[28:31]
    s_waitcnt lgkmcnt(3)
    v_mfma_f32_16x16x32_bf16 v[16:19], v[108:111], v[144:147], v[16:19]
    ds_read_b128 v[104:107], v0 offset:8192
    v_mfma_f32_16x16x32_bf16 v[20:23], v[108:111], v[176:179], v[20:23]
    s_add_u32 m0, s43, 2688
    v_mfma_f32_16x16x32_bf16 v[24:27], v[108:111], v[208:211], v[24:27]
    buffer_load_dwordx4 v7, s[16:19], s47 offen offset:384 lds
    v_mfma_f32_16x16x32_bf16 v[28:31], v[108:111], v[240:243], v[28:31]
    s_add_u32 s47, s47, 32768
    s_waitcnt lgkmcnt(3)
    v_mfma_f32_16x16x32_bf16 v[16:19], v[112:115], v[148:151], v[16:19]
    ds_read_b128 v[108:111], v1 offset:8192
    v_mfma_f32_16x16x32_bf16 v[20:23], v[112:115], v[180:183], v[20:23]
    v_mfma_f32_16x16x32_bf16 v[24:27], v[112:115], v[212:215], v[24:27]
    v_mfma_f32_16x16x32_bf16 v[28:31], v[112:115], v[244:247], v[28:31]
    s_waitcnt lgkmcnt(3)
    v_mfma_f32_16x16x32_bf16 v[16:19], v[116:119], v[152:155], v[16:19]
    ds_read_b128 v[112:115], v0 offset:9216
    v_mfma_f32_16x16x32_bf16 v[20:23], v[116:119], v[184:187], v[20:23]
    s_add_u32 m0, s43, 16128
    v_mfma_f32_16x16x32_bf16 v[24:27], v[116:119], v[216:219], v[24:27]
    buffer_load_dwordx4 v7, s[16:19], s48 offen offset:256 lds
    v_mfma_f32_16x16x32_bf16 v[28:31], v[116:119], v[248:251], v[28:31]
    s_waitcnt lgkmcnt(3)
    v_mfma_f32_16x16x32_bf16 v[16:19], v[96:99], v[156:159], v[16:19]
    ds_read_b128 v[116:119], v1 offset:9216
    v_mfma_f32_16x16x32_bf16 v[20:23], v[96:99], v[188:191], v[20:23]
    s_add_u32 m0, s43, 17024
    v_mfma_f32_16x16x32_bf16 v[24:27], v[96:99], v[220:223], v[24:27]
    buffer_load_dwordx4 v7, s[16:19], s48 offen offset:384 lds
    v_mfma_f32_16x16x32_bf16 v[28:31], v[96:99], v[252:255], v[28:31]
    s_waitcnt lgkmcnt(3)
    v_mfma_f32_16x16x32_bf16 v[32:35], v[104:107], v[128:131], v[80:83]
    ds_read_b128 v[100:103], v0 offset:10240
    v_mfma_f32_16x16x32_bf16 v[36:39], v[104:107], v[160:163], v[84:87]
    v_exp_f32_e64 v120, v16
    v_mfma_f32_16x16x32_bf16 v[40:43], v[104:107], v[192:195], v[88:91]
    v_exp_f32_e64 v121, v17
    v_mfma_f32_16x16x32_bf16 v[44:47], v[104:107], v[224:227], v[92:95]
    v_add_f32_e64 v12, v120, v121
    v_cvt_pk_bf16_f32 v64, v120, v121
    s_waitcnt lgkmcnt(3)
    v_mfma_f32_16x16x32_bf16 v[32:35], v[108:111], v[132:135], v[32:35]
    ds_read_b128 v[104:107], v1 offset:10240
    v_mfma_f32_16x16x32_bf16 v[36:39], v[108:111], v[164:167], v[36:39]
    s_add_u32 m0, s43, 18432
    v_exp_f32 v122, v18
    v_mfma_f32_16x16x32_bf16 v[40:43], v[108:111], v[196:199], v[40:43]
    buffer_load_dwordx4 v7, s[16:19], s48 offen offset:0 lds
    v_mfma_f32_16x16x32_bf16 v[44:47], v[108:111], v[228:231], v[44:47]
    v_add_f32 v12, v12, v122
    s_waitcnt lgkmcnt(3)
    v_mfma_f32_16x16x32_bf16 v[32:35], v[112:115], v[136:139], v[32:35]
    ds_read_b128 v[108:111], v0 offset:11264
    v_exp_f32_e64 v123, v19
    v_mfma_f32_16x16x32_bf16 v[36:39], v[112:115], v[168:171], v[36:39]
    v_add_f32_e64 v12, v12, v123
    v_cvt_pk_bf16_f32 v65, v122, v123
    v_mfma_f32_16x16x32_bf16 v[40:43], v[112:115], v[200:203], v[40:43]
    v_exp_f32_e64 v124, v20
    v_mfma_f32_16x16x32_bf16 v[44:47], v[112:115], v[232:235], v[44:47]
    v_exp_f32 v125, v21
    s_waitcnt lgkmcnt(3)
    v_mfma_f32_16x16x32_bf16 v[32:35], v[116:119], v[140:143], v[32:35]
    ds_read_b128 v[112:115], v1 offset:11264
    v_add_f32_e64 v13, v124, v125
    v_mfma_f32_16x16x32_bf16 v[36:39], v[116:119], v[172:175], v[36:39]
    s_add_u32 m0, s43, 19328
    v_add_u32 v0, s49, v0
    v_add_u32 v1, s49, v1
    v_mfma_f32_16x16x32_bf16 v[40:43], v[116:119], v[204:207], v[40:43]
    buffer_load_dwordx4 v7, s[16:19], s48 offen offset:128 lds
    v_mfma_f32_16x16x32_bf16 v[44:47], v[116:119], v[236:239], v[44:47]
    s_add_u32 s48, s48, 32768
    v_cvt_pk_bf16_f32 v68, v124, v125
    s_waitcnt lgkmcnt(3)
    v_mfma_f32_16x16x32_bf16 v[32:35], v[100:103], v[144:147], v[32:35]
    ds_read_b64_tr_b16 v[96:97], v2 offset:0
    v_mfma_f32_16x16x32_bf16 v[36:39], v[100:103], v[176:179], v[36:39]
    ds_read_b64_tr_b16 v[98:99], v2 offset:8192
    v_exp_f32 v120, v22
    v_mfma_f32_16x16x32_bf16 v[40:43], v[100:103], v[208:211], v[40:43]
    v_add_f32_e64 v13, v13, v120
    v_mfma_f32_16x16x32_bf16 v[44:47], v[100:103], v[240:243], v[44:47]
    v_exp_f32 v121, v23
    s_waitcnt lgkmcnt(4)
    v_mfma_f32_16x16x32_bf16 v[32:35], v[104:107], v[148:151], v[32:35]
    ds_read_b64_tr_b16 v[100:101], v3 offset:0
    v_add_f32_e64 v13, v13, v121
    v_mfma_f32_16x16x32_bf16 v[36:39], v[104:107], v[180:183], v[36:39]
    ds_read_b64_tr_b16 v[102:103], v3 offset:8192
    s_add_u32 m0, s44, 0
    v_cvt_pk_bf16_f32 v69, v120, v121
    v_mfma_f32_16x16x32_bf16 v[40:43], v[104:107], v[212:215], v[40:43]
    buffer_load_dwordx4 v6, s[12:15], s45 offen offset:0 lds
    v_mfma_f32_16x16x32_bf16 v[44:47], v[104:107], v[244:247], v[44:47]
    v_exp_f32 v122, v24
    s_waitcnt lgkmcnt(5)
    v_mfma_f32_16x16x32_bf16 v[32:35], v[108:111], v[152:155], v[32:35]
    ds_read_b64_tr_b16 v[104:105], v4 offset:0
    v_mfma_f32_16x16x32_bf16 v[36:39], v[108:111], v[184:187], v[36:39]
    ds_read_b64_tr_b16 v[106:107], v4 offset:8192
    v_exp_f32 v123, v25
    v_mfma_f32_16x16x32_bf16 v[40:43], v[108:111], v[216:219], v[40:43]
    v_add_f32_e64 v14, v122, v123
    v_cvt_pk_bf16_f32 v72, v122, v123
    v_mfma_f32_16x16x32_bf16 v[44:47], v[108:111], v[248:251], v[44:47]
    v_exp_f32 v124, v26
    s_waitcnt lgkmcnt(6)
    v_mfma_f32_16x16x32_bf16 v[32:35], v[112:115], v[156:159], v[32:35]
    ds_read_b64_tr_b16 v[108:109], v5 offset:0
    v_add_f32_e64 v14, v14, v124
    v_mfma_f32_16x16x32_bf16 v[36:39], v[112:115], v[188:191], v[36:39]
    ds_read_b64_tr_b16 v[110:111], v5 offset:8192
    s_add_u32 m0, s44, 896
    buffer_load_dword v127, v126, s[76:79], s58 offen
    v_mfma_f32_16x16x32_bf16 v[40:43], v[112:115], v[220:223], v[40:43]
    buffer_load_dwordx4 v6, s[12:15], s45 offen offset:128 lds
    s_add_u32 s58, s58, s59
    v_mfma_f32_16x16x32_bf16 v[44:47], v[112:115], v[252:255], v[44:47]
    s_waitcnt lgkmcnt(4)
    v_mfma_f32_16x16x32_bf16 a[16:19], v[100:103], v[48:51], a[16:19]
    ds_read_b64_tr_b16 v[112:113], v2 offset:1024
    v_exp_f32_e64 v125, v27
    v_mfma_f32_16x16x32_bf16 a[0:3], v[96:99], v[48:51], a[0:3]
    ds_read_b64_tr_b16 v[114:115], v2 offset:9216
    v_add_f32_e64 v14, v14, v125
    v_mfma_f32_16x16x32_bf16 a[4:7], v[96:99], v[52:55], a[4:7]
    ds_read_b64_tr_b16 v[116:117], v3 offset:1024
    v_cvt_pk_bf16_f32 v73, v124, v125
    v_mfma_f32_16x16x32_bf16 a[20:23], v[100:103], v[52:55], a[20:23]
    ds_read_b64_tr_b16 v[118:119], v3 offset:9216
    v_exp_f32_e64 v120, v28
    v_mfma_f32_16x16x32_bf16 a[24:27], v[100:103], v[56:59], a[24:27]
    v_exp_f32_e64 v121, v29
    v_mfma_f32_16x16x32_bf16 a[8:11], v[96:99], v[56:59], a[8:11]
    s_add_u32 m0, s44, 1792
    v_add_f32_e64 v15, v120, v121
    v_cvt_pk_bf16_f32 v76, v120, v121
    v_mfma_f32_16x16x32_bf16 a[12:15], v[96:99], v[60:63], a[12:15]
    buffer_load_dwordx4 v6, s[12:15], s45 offen offset:256 lds
    v_mfma_f32_16x16x32_bf16 a[28:31], v[100:103], v[60:63], a[28:31]
    v_exp_f32 v122, v30
    s_waitcnt lgkmcnt(4)
    v_mfma_f32_16x16x32_bf16 a[48:51], v[108:111], v[48:51], a[48:51]
    ds_read_b64_tr_b16 v[96:97], v4 offset:1024
    v_add_f32_e64 v15, v15, v122
    v_mfma_f32_16x16x32_bf16 a[32:35], v[104:107], v[48:51], a[32:35]
    ds_read_b64_tr_b16 v[98:99], v4 offset:9216
    v_exp_f32_e64 v123, v31
    v_mfma_f32_16x16x32_bf16 a[36:39], v[104:107], v[52:55], a[36:39]
    ds_read_b64_tr_b16 v[100:101], v5 offset:1024
    v_add_f32_e64 v15, v15, v123
    v_mfma_f32_16x16x32_bf16 a[52:55], v[108:111], v[52:55], a[52:55]
    ds_read_b64_tr_b16 v[102:103], v5 offset:9216
    v_cvt_pk_bf16_f32 v77, v122, v123
    v_mfma_f32_16x16x32_bf16 a[56:59], v[108:111], v[56:59], a[56:59]
    v_exp_f32_e64 v124, v32
    v_mfma_f32_16x16x32_bf16 a[40:43], v[104:107], v[56:59], a[40:43]
    s_add_u32 m0, s44, 2688
    v_add_f32_e64 v12, v12, v124
    v_mfma_f32_16x16x32_bf16 a[44:47], v[104:107], v[60:63], a[44:47]
    buffer_load_dwordx4 v6, s[12:15], s45 offen offset:384 lds
    v_mfma_f32_16x16x32_bf16 a[60:63], v[108:111], v[60:63], a[60:63]
    s_add_u32 s45, s45, 32768
    s_waitcnt lgkmcnt(4)
    v_mfma_f32_16x16x32_bf16 a[80:83], v[116:119], v[48:51], a[80:83]
    ds_read_b64_tr_b16 v[104:105], v2 offset:2048
    v_exp_f32 v125, v33
    v_mfma_f32_16x16x32_bf16 a[64:67], v[112:115], v[48:51], a[64:67]
    ds_read_b64_tr_b16 v[106:107], v2 offset:10240
    v_add_f32_e64 v12, v12, v125
    v_mfma_f32_16x16x32_bf16 a[68:71], v[112:115], v[52:55], a[68:71]
    ds_read_b64_tr_b16 v[108:109], v3 offset:2048
    v_cvt_pk_bf16_f32 v66, v124, v125
    v_mfma_f32_16x16x32_bf16 a[84:87], v[116:119], v[52:55], a[84:87]
    ds_read_b64_tr_b16 v[110:111], v3 offset:10240
    v_exp_f32_e64 v120, v34
    v_mfma_f32_16x16x32_bf16 a[88:91], v[116:119], v[56:59], a[88:91]
    v_add_f32_e64 v12, v12, v120
    v_mfma_f32_16x16x32_bf16 a[72:75], v[112:115], v[56:59], a[72:75]
    s_add_u32 m0, s44, 16384
    v_exp_f32_e64 v121, v35
    v_mfma_f32_16x16x32_bf16 a[76:79], v[112:115], v[60:63], a[76:79]
    buffer_load_dwordx4 v6, s[12:15], s46 offen offset:0 lds
    v_mfma_f32_16x16x32_bf16 a[92:95], v[116:119], v[60:63], a[92:95]
    v_add_f32_e64 v12, v12, v121
    v_cvt_pk_bf16_f32 v67, v120, v121
    s_waitcnt lgkmcnt(4)
    v_mfma_f32_16x16x32_bf16 a[112:115], v[100:103], v[48:51], a[112:115]
    ds_read_b64_tr_b16 v[112:113], v4 offset:2048
    v_mfma_f32_16x16x32_bf16 a[96:99], v[96:99], v[48:51], a[96:99]
    ds_read_b64_tr_b16 v[114:115], v4 offset:10240
    v_exp_f32 v122, v36
    v_mfma_f32_16x16x32_bf16 a[100:103], v[96:99], v[52:55], a[100:103]
    ds_read_b64_tr_b16 v[116:117], v5 offset:2048
    v_add_f32_e64 v13, v13, v122
    v_mfma_f32_16x16x32_bf16 a[116:119], v[100:103], v[52:55], a[116:119]
    ds_read_b64_tr_b16 v[118:119], v5 offset:10240
    v_exp_f32_e64 v123, v37
    v_mfma_f32_16x16x32_bf16 a[120:123], v[100:103], v[56:59], a[120:123]
    v_add_f32_e64 v13, v13, v123
    v_cvt_pk_bf16_f32 v70, v122, v123
    v_mfma_f32_16x16x32_bf16 a[104:107], v[96:99], v[56:59], a[104:107]
    s_add_u32 m0, s44, 17280
    v_exp_f32_e64 v124, v38
    v_mfma_f32_16x16x32_bf16 a[108:111], v[96:99], v[60:63], a[108:111]
    buffer_load_dwordx4 v6, s[12:15], s46 offen offset:128 lds
    v_mfma_f32_16x16x32_bf16 a[124:127], v[100:103], v[60:63], a[124:127]
    v_add_f32 v13, v13, v124
    s_waitcnt lgkmcnt(4)
    v_mfma_f32_16x16x32_bf16 a[144:147], v[108:111], v[48:51], a[144:147]
    ds_read_b64_tr_b16 v[96:97], v2 offset:3072
    v_exp_f32_e64 v125, v39
    v_mfma_f32_16x16x32_bf16 a[128:131], v[104:107], v[48:51], a[128:131]
    ds_read_b64_tr_b16 v[98:99], v2 offset:11264
    v_add_f32_e64 v13, v13, v125
    v_mfma_f32_16x16x32_bf16 a[132:135], v[104:107], v[52:55], a[132:135]
    ds_read_b64_tr_b16 v[100:101], v3 offset:3072
    v_cvt_pk_bf16_f32 v71, v124, v125
    v_mfma_f32_16x16x32_bf16 a[148:151], v[108:111], v[52:55], a[148:151]
    ds_read_b64_tr_b16 v[102:103], v3 offset:11264
    v_exp_f32_e64 v120, v40
    v_mfma_f32_16x16x32_bf16 a[152:155], v[108:111], v[56:59], a[152:155]
    v_add_f32_e64 v14, v14, v120
    v_mfma_f32_16x16x32_bf16 a[136:139], v[104:107], v[56:59], a[136:139]
    s_add_u32 m0, s44, 18176
    v_exp_f32_e64 v121, v41
    v_mfma_f32_16x16x32_bf16 a[140:143], v[104:107], v[60:63], a[140:143]
    buffer_load_dwordx4 v6, s[12:15], s46 offen offset:256 lds
    v_mfma_f32_16x16x32_bf16 a[156:159], v[108:111], v[60:63], a[156:159]
    v_add_f32_e64 v14, v14, v121
    v_cvt_pk_bf16_f32 v74, v120, v121
    s_waitcnt lgkmcnt(4)
    v_mfma_f32_16x16x32_bf16 a[176:179], v[116:119], v[48:51], a[176:179]
    ds_read_b64_tr_b16 v[104:105], v4 offset:3072
    v_mfma_f32_16x16x32_bf16 a[160:163], v[112:115], v[48:51], a[160:163]
    ds_read_b64_tr_b16 v[106:107], v4 offset:11264
    s_add_u32 m0, s44, 19072
    v_mfma_f32_16x16x32_bf16 a[164:167], v[112:115], v[52:55], a[164:167]
    ds_read_b64_tr_b16 v[108:109], v5 offset:3072
    buffer_load_dwordx4 v6, s[12:15], s46 offen offset:384 lds
    v_mfma_f32_16x16x32_bf16 a[180:183], v[116:119], v[52:55], a[180:183]
    ds_read_b64_tr_b16 v[110:111], v5 offset:11264
    s_add_u32 s46, s46, 32768
    v_mfma_f32_16x16x32_bf16 a[184:187], v[116:119], v[56:59], a[184:187]
    v_exp_f32 v122, v42
    v_mfma_f32_16x16x32_bf16 a[168:171], v[112:115], v[56:59], a[168:171]
    v_add_f32 v14, v14, v122
    v_exp_f32 v123, v43
    v_mfma_f32_16x16x32_bf16 a[172:175], v[112:115], v[60:63], a[172:175]
    v_add_f32_e64 v14, v14, v123
    v_cvt_pk_bf16_f32 v75, v122, v123
    v_mfma_f32_16x16x32_bf16 a[188:191], v[116:119], v[60:63], a[188:191]
    v_exp_f32 v124, v44
    s_waitcnt lgkmcnt(4)
    v_mfma_f32_16x16x32_bf16 a[208:211], v[100:103], v[48:51], a[208:211]
    s_waitcnt vmcnt(9)
    s_barrier
    ds_read_b128 v[112:115], v0 offset:0
    v_mfma_f32_16x16x32_bf16 a[192:195], v[96:99], v[48:51], a[192:195]
    v_add_f32 v15, v15, v124
    v_exp_f32 v125, v45
    v_mfma_f32_16x16x32_bf16 a[196:199], v[96:99], v[52:55], a[196:199]
    ds_read_b128 v[116:119], v1 offset:0
    v_add_f32_e64 v15, v15, v125
    v_mfma_f32_16x16x32_bf16 a[212:215], v[100:103], v[52:55], a[212:215]
    v_cvt_pk_bf16_f32 v78, v124, v125
    v_exp_f32_e64 v120, v46
    v_mfma_f32_16x16x32_bf16 a[216:219], v[100:103], v[56:59], a[216:219]
    v_add_f32 v15, v15, v120
    v_add_u32 v2, s50, v2
    v_mfma_f32_16x16x32_bf16 a[200:203], v[96:99], v[56:59], a[200:203]
    v_exp_f32 v121, v47
    v_add_u32 v3, s50, v3
    v_mfma_f32_16x16x32_bf16 a[204:207], v[96:99], v[60:63], a[204:207]
    v_add_f32_e64 v15, v15, v121
    v_cvt_pk_bf16_f32 v79, v120, v121
    v_mfma_f32_16x16x32_bf16 a[220:223], v[100:103], v[60:63], a[220:223]
    v_add_u32 v4, s50, v4
    v_add_u32 v5, s50, v5
    s_waitcnt lgkmcnt(2)
    v_mfma_f32_16x16x32_bf16 a[240:243], v[108:111], v[48:51], a[240:243]
    ds_read_b128 v[96:99], v0 offset:1024
    v_max3_f32 v120, v12, v13, v14
    v_mfma_f32_16x16x32_bf16 a[224:227], v[104:107], v[48:51], a[224:227]
    v_mfma_f32_16x16x32_bf16 a[228:231], v[104:107], v[52:55], a[228:231]
    ds_read_b128 v[100:103], v1 offset:1024
    v_max_f32 v120, v120, v15
    v_cmp_nge_f32 vcc, s52, v120
    v_mfma_f32_16x16x32_bf16 a[244:247], v[108:111], v[52:55], a[244:247]
    v_mfma_f32_16x16x32_bf16 a[248:251], v[108:111], v[56:59], a[248:251]
    v_mfma_f32_16x16x32_bf16 a[232:235], v[104:107], v[56:59], a[232:235]
    v_mfma_f32_16x16x32_bf16 a[236:239], v[104:107], v[60:63], a[236:239]
    v_mfma_f32_16x16x32_bf16 a[252:255], v[108:111], v[60:63], a[252:255]
    s_cbranch_vccnz L_rare_a
L_back_a:
    s_waitcnt lgkmcnt(3)
    v_mfma_f32_16x16x32_bf16 v[16:19], v[112:115], v[128:131], v[80:83]
    ds_read_b128 v[108:111], v0 offset:2048
    s_sub_u32 s49, s44, s42
    v_mfma_f32_16x16x32_bf16 v[20:23], v[112:115], v[160:163], v[84:87]
    s_add_u32 m0, s40, 0
    s_sub_u32 s50, s40, s43
    v_mfma_f32_16x16x32_bf16 v[24:27], v[112:115], v[192:195], v[88:91]
    buffer_load_dwordx4 v7, s[16:19], s47 offen offset:0 lds
    v_mfma_f32_16x16x32_bf16 v[28:31], v[112:115], v[224:227], v[92:95]
    s_waitcnt lgkmcnt(3)
    v_mfma_f32_16x16x32_bf16 v[16:19], v[116:119], v[132:135], v[16:19]
    ds_read_b128 v[112:115], v1 offset:2048
    v_add_f32 v8, v8, v12
    v_mfma_f32_16x16x32_bf16 v[20:23], v[116:119], v[164:167], v[20:23]
    s_add_u32 m0, s40, 896
    v_add_f32_e64 v9, v9, v13
    v_mfma_f32_16x16x32_bf16 v[24:27], v[116:119], v[196:199], v[24:27]
    buffer_load_dwordx4 v7, s[16:19], s47 offen offset:128 lds
    v_mfma_f32_16x16x32_bf16 v[28:31], v[116:119], v[228:231], v[28:31]
    s_waitcnt lgkmcnt(3)
    v_mfma_f32_16x16x32_bf16 v[16:19], v[96:99], v[136:139], v[16:19]
    ds_read_b128 v[116:119], v0 offset:3072
    v_add_f32 v10, v10, v14
    v_mfma_f32_16x16x32_bf16 v[20:23], v[96:99], v[168:171], v[20:23]
    v_add_f32_e64 v11, v11, v15
    v_mfma_f32_16x16x32_bf16 v[24:27], v[96:99], v[200:203], v[24:27]
    v_mfma_f32_16x16x32_bf16 v[28:31], v[96:99], v[232:235], v[28:31]
    s_waitcnt lgkmcnt(3)
    v_mfma_f32_16x16x32_bf16 v[16:19], v[100:103], v[140:143], v[16:19]
    ds_read_b128 v[96:99], v1 offset:3072
    v_mfma_f32_16x16x32_bf16 v[20:23], v[100:103], v[172:175], v[20:23]
    s_add_u32 m0, s40, 1792
    v_mfma_f32_16x16x32_bf16 v[24:27], v[100:103], v[204:207], v[24:27]
    buffer_load_dwordx4 v7, s[16:19], s47 offen offset:256 lds
    v_mfma_f32_16x16x32_bf16 v[28:31], v[100:103], v[236:239], v[28:31]
    s_waitcnt lgkmcnt(3)
    v_mfma_f32_16x16x32_bf16 v[16:19], v[108:111], v[144:147], v[16:19]
    ds_read_b128 v[104:107], v0 offset:8192
    v_mfma_f32_16x16x32_bf16 v[20:23], v[108:111], v[176:179], v[20:23]
    s_add_u32 m0, s40, 2688
    v_mfma_f32_16x16x32_bf16 v[24:27], v[108:111], v[208:211], v[24:27]
    buffer_load_dwordx4 v7, s[16:19], s47 offen offset:384 lds
    v_mfma_f32_16x16x32_bf16 v[28:31], v[108:111], v[240:243], v[28:31]
    s_add_u32 s47, s47, 32768
    s_waitcnt lgkmcnt(3)
    v_mfma_f32_16x16x32_bf16 v[16:19], v[112:115], v[148:151], v[16:19]
    ds_read_b128 v[108:111], v1 offset:8192
    v_mfma_f32_16x16x32_bf16 v[20:23], v[112:115], v[180:183], v[20:23]
    v_mfma_f32_16x16x32_bf16 v[24:27], v[112:115], v[212:215], v[24:27]
    v_mfma_f32_16x16x32_bf16 v[28:31], v[112:115], v[244:247], v[28:31]
    s_waitcnt lgkmcnt(3)
    v_mfma_f32_16x16x32_bf16 v[16:19], v[116:119], v[152:155], v[16:19]
    ds_read_b128 v[112:115], v0 offset:9216
    v_mfma_f32_16x16x32_bf16 v[20:23], v[116:119], v[184:187], v[20:23]
    s_add_u32 m0, s40, 16128
    v_mfma_f32_16x16x32_bf16 v[24:27], v[116:119], v[216:219], v[24:27]
    buffer_load_dwordx4 v7, s[16:19], s48 offen offset:256 lds
    v_mfma_f32_16x16x32_bf16 v[28:31], v[116:119], v[248:251], v[28:31]
    s_waitcnt lgkmcnt(3)
    v_mfma_f32_16x16x32_bf16 v[16:19], v[96:99], v[156:159], v[16:19]
    ds_read_b128 v[116:119], v1 offset:9216
    v_mfma_f32_16x16x32_bf16 v[20:23], v[96:99], v[188:191], v[20:23]
    s_add_u32 m0, s40, 17024
    v_mfma_f32_16x16x32_bf16 v[24:27], v[96:99], v[220:223], v[24:27]
    buffer_load_dwordx4 v7, s[16:19], s48 offen offset:384 lds
    v_mfma_f32_16x16x32_bf16 v[28:31], v[96:99], v[252:255], v[28:31]
    s_waitcnt lgkmcnt(3)
    v_mfma_f32_16x16x32_bf16 v[32:35], v[104:107], v[128:131], v[80:83]
    ds_read_b128 v[100:103], v0 offset:10240
    v_mfma_f32_16x16x32_bf16 v[36:39], v[104:107], v[160:163], v[84:87]
    v_exp_f32_e64 v120, v16
    v_mfma_f32_16x16x32_bf16 v[40:43], v[104:107], v[192:195], v[88:91]
    v_exp_f32_e64 v121, v17
    v_mfma_f32_16x16x32_bf16 v[44:47], v[104:107], v[224:227], v[92:95]
    v_add_f32_e64 v12, v120, v121
    v_cvt_pk_bf16_f32 v48, v120, v121
    s_waitcnt lgkmcnt(3)
    v_mfma_f32_16x16x32_bf16 v[32:35], v[108:111], v[132:135], v[32:35]
    ds_read_b128 v[104:107], v1 offset:10240
    v_mfma_f32_16x16x32_bf16 v[36:39], v[108:111], v[164:167], v[36:39]
    s_add_u32 m0, s40, 18432
    v_exp_f32 v122, v18
    v_mfma_f32_16x16x32_bf16 v[40:43], v[108:111], v[196:199], v[40:43]
    buffer_load_dwordx4 v7, s[16:19], s48 offen offset:0 lds
    v_mfma_f32_16x16x32_bf16 v[44:47], v[108:111], v[228:231], v[44:47]
    v_add_f32 v12, v12, v122
    s_waitcnt lgkmcnt(3)
    v_mfma_f32_16x16x32_bf16 v[32:35], v[112:115], v[136:139], v[32:35]
    ds_read_b128 v[108:111], v0 offset:11264
    v_exp_f32_e64 v123, v19
    v_mfma_f32_16x16x32_bf16 v[36:39], v[112:115], v[168:171], v[36:39]
    v_add_f32_e64 v12, v12, v123
    v_cvt_pk_bf16_f32 v49, v122, v123
    v_mfma_f32_16x16x32_bf16 v[40:43], v[112:115], v[200:203], v[40:43]
    v_exp_f32_e64 v124, v20
    v_mfma_f32_16x16x32_bf16 v[44:47], v[112:115], v[232:235], v[44:47]
    v_exp_f32 v125, v21
    s_waitcnt lgkmcnt(3)
    v_mfma_f32_16x16x32_bf16 v[32:35], v[116:119], v[140:143], v[32:35]
    ds_read_b128 v[112:115], v1 offset:11264
    v_add_f32_e64 v13, v124, v125
    v_mfma_f32_16x16x32_bf16 v[36:39], v[116:119], v[172:175], v[36:39]
    s_add_u32 m0, s40, 19328
    v_add_u32 v0, s49, v0
    v_add_u32 v1, s49, v1
    v_mfma_f32_16x16x32_bf16 v[40:43], v[116:119], v[204:207], v[40:43]
    buffer_load_dwordx4 v7, s[16:19], s48 offen offset:128 lds
    v_mfma_f32_16x16x32_bf16 v[44:47], v[116:119], v[236:239], v[44:47]
    s_add_u32 s48, s48, 32768
    v_cvt_pk_bf16_f32 v52, v124, v125
    s_waitcnt lgkmcnt(3)
    v_mfma_f32_16x16x32_bf16 v[32:35], v[100:103], v[144:147], v[32:35]
    ds_read_b64_tr_b16 v[96:97], v2 offset:0
    v_mfma_f32_16x16x32_bf16 v[36:39], v[100:103], v[176:179], v[36:39]
    ds_read_b64_tr_b16 v[98:99], v2 offset:8192
    v_exp_f32 v120, v22
    v_mfma_f32_16x16x32_bf16 v[40:43], v[100:103], v[208:211], v[40:43]
    v_add_f32_e64 v13, v13, v120
    v_mfma_f32_16x16x32_bf16 v[44:47], v[100:103], v[240:243], v[44:47]
    v_exp_f32 v121, v23
    s_waitcnt lgkmcnt(4)
    v_mfma_f32_16x16x32_bf16 v[32:35], v[104:107], v[148:151], v[32:35]
    ds_read_b64_tr_b16 v[100:101], v3 offset:0
    v_add_f32_e64 v13, v13, v121
    v_mfma_f32_16x16x32_bf16 v[36:39], v[104:107], v[180:183], v[36:39]
    ds_read_b64_tr_b16 v[102:103], v3 offset:8192
    s_add_u32 m0, s41, 0
    v_cvt_pk_bf16_f32 v53, v120, v121
    v_mfma_f32_16x16x32_bf16 v[40:43], v[104:107], v[212:215], v[40:43]
    buffer_load_dwordx4 v6, s[12:15], s45 offen offset:0 lds
    v_mfma_f32_16x16x32_bf16 v[44:47], v[104:107], v[244:247], v[44:47]
    v_exp_f32 v122, v24
    s_waitcnt lgkmcnt(5)
    v_mfma_f32_16x16x32_bf16 v[32:35], v[108:111], v[152:155], v[32:35]
    ds_read_b64_tr_b16 v[104:105], v4 offset:0
    v_mfma_f32_16x16x32_bf16 v[36:39], v[108:111], v[184:187], v[36:39]
    ds_read_b64_tr_b16 v[106:107], v4 offset:8192
    v_exp_f32 v123, v25
    v_mfma_f32_16x16x32_bf16 v[40:43], v[108:111], v[216:219], v[40:43]
    v_add_f32_e64 v14, v122, v123
    v_cvt_pk_bf16_f32 v56, v122, v123
    v_mfma_f32_16x16x32_bf16 v[44:47], v[108:111], v[248:251], v[44:47]
    v_exp_f32 v124, v26
    s_waitcnt lgkmcnt(6)
    v_mfma_f32_16x16x32_bf16 v[32:35], v[112:115], v[156:159], v[32:35]
    ds_read_b64_tr_b16 v[108:109], v5 offset:0
    v_add_f32_e64 v14, v14, v124
    v_mfma_f32_16x16x32_bf16 v[36:39], v[112:115], v[188:191], v[36:39]
    ds_read_b64_tr_b16 v[110:111], v5 offset:8192
    s_add_u32 m0, s41, 896
    v_mfma_f32_16x16x32_bf16 v[40:43], v[112:115], v[220:223], v[40:43]
    buffer_load_dwordx4 v6, s[12:15], s45 offen offset:128 lds
    v_mfma_f32_16x16x32_bf16 v[44:47], v[112:115], v[252:255], v[44:47]
    v_exp_f32 v125, v27
    s_waitcnt lgkmcnt(4)
    v_mfma_f32_16x16x32_bf16 a[16:19], v[100:103], v[64:67], a[16:19]
    ds_read_b64_tr_b16 v[112:113], v2 offset:1024
    v_add_f32_e64 v14, v14, v125
    v_mfma_f32_16x16x32_bf16 a[0:3], v[96:99], v[64:67], a[0:3]
    ds_read_b64_tr_b16 v[114:115], v2 offset:9216
    v_cvt_pk_bf16_f32 v57, v124, v125
    v_mfma_f32_16x16x32_bf16 a[4:7], v[96:99], v[68:71], a[4:7]
    ds_read_b64_tr_b16 v[116:117], v3 offset:1024
    v_exp_f32_e64 v120, v28
    v_mfma_f32_16x16x32_bf16 a[20:23], v[100:103], v[68:71], a[20:23]
    ds_read_b64_tr_b16 v[118:119], v3 offset:9216
    v_mfma_f32_16x16x32_bf16 a[24:27], v[100:103], v[72:75], a[24:27]
    v_exp_f32_e64 v121, v29
    v_mfma_f32_16x16x32_bf16 a[8:11], v[96:99], v[72:75], a[8:11]
    s_add_u32 m0, s41, 1792
    v_add_f32_e64 v15, v120, v121
    v_cvt_pk_bf16_f32 v60, v120, v121
    v_mfma_f32_16x16x32_bf16 a[12:15], v[96:99], v[76:79], a[12:15]
    buffer_load_dwordx4 v6, s[12:15], s45 offen offset:256 lds
    v_mfma_f32_16x16x32_bf16 a[28:31], v[100:103], v[76:79], a[28:31]
    v_exp_f32 v122, v30
    s_waitcnt lgkmcnt(4)
    v_mfma_f32_16x16x32_bf16 a[48:51], v[108:111], v[64:67], a[48:51]
    ds_read_b64_tr_b16 v[96:97], v4 offset:1024
    v_add_f32_e64 v15, v15, v122
    v_mfma_f32_16x16x32_bf16 a[32:35], v[104:107], v[64:67], a[32:35]
    ds_read_b64_tr_b16 v[98:99], v4 offset:9216
    v_exp_f32_e64 v123, v31
    v_mfma_f32_16x16x32_bf16 a[36:39], v[104:107], v[68:71], a[36:39]
    ds_read_b64_tr_b16 v[100:101], v5 offset:1024
    v_add_f32_e64 v15, v15, v123
    v_mfma_f32_16x16x32_bf16 a[52:55], v[108:111], v[68:71], a[52:55]
    ds_read_b64_tr_b16 v[102:103], v5 offset:9216
    v_cvt_pk_bf16_f32 v61, v122, v123
    v_mfma_f32_16x16x32_bf16 a[56:59], v[108:111], v[72:75], a[56:59]
    v_exp_f32_e64 v124, v32
    v_mfma_f32_16x16x32_bf16 a[40:43], v[104:107], v[72:75], a[40:43]
    s_add_u32 m0, s41, 2688
    v_add_f32_e64 v12, v12, v124
    v_mfma_f32_16x16x32_bf16 a[44:47], v[104:107], v[76:79], a[44:47]
    buffer_load_dwordx4 v6, s[12:15], s45 offen offset:384 lds
    v_mfma_f32_16x16x32_bf16 a[60:63], v[108:111], v[76:79], a[60:63]
    s_add_u32 s45, s45, 32768
    s_waitcnt lgkmcnt(4)
    v_mfma_f32_16x16x32_bf16 a[80:83], v[116:119], v[64:67], a[80:83]
    ds_read_b64_tr_b16 v[104:105], v2 offset:2048
    v_exp_f32 v125, v33
    v_mfma_f32_16x16x32_bf16 a[64:67], v[112:115], v[64:67], a[64:67]
    ds_read_b64_tr_b16 v[106:107], v2 offset:10240
    v_add_f32_e64 v12, v12, v125
    v_mfma_f32_16x16x32_bf16 a[68:71], v[112:115], v[68:71], a[68:71]
    ds_read_b64_tr_b16 v[108:109], v3 offset:2048
    v_cvt_pk_bf16_f32 v50, v124, v125
    v_mfma_f32_16x16x32_bf16 a[84:87], v[116:119], v[68:71], a[84:87]
    ds_read_b64_tr_b16 v[110:111], v3 offset:10240
    v_exp_f32_e64 v120, v34
    v_mfma_f32_16x16x32_bf16 a[88:91], v[116:119], v[72:75], a[88:91]
    v_add_f32_e64 v12, v12, v120
    v_mfma_f32_16x16x32_bf16 a[72:75], v[112:115], v[72:75], a[72:75]
    s_add_u32 m0, s41, 16384
    v_exp_f32_e64 v121, v35
    v_mfma_f32_16x16x32_bf16 a[76:79], v[112:115], v[76:79], a[76:79]
    buffer_load_dwordx4 v6, s[12:15], s46 offen offset:0 lds
    v_mfma_f32_16x16x32_bf16 a[92:95], v[116:119], v[76:79], a[92:95]
    v_add_f32_e64 v12, v12, v121
    v_cvt_pk_bf16_f32 v51, v120, v121
    s_waitcnt lgkmcnt(4)
    v_mfma_f32_16x16x32_bf16 a[112:115], v[100:103], v[64:67], a[112:115]
    ds_read_b64_tr_b16 v[112:113], v4 offset:2048
    v_mfma_f32_16x16x32_bf16 a[96:99], v[96:99], v[64:67], a[96:99]
    ds_read_b64_tr_b16 v[114:115], v4 offset:10240
    v_exp_f32 v122, v36
    v_mfma_f32_16x16x32_bf16 a[100:103], v[96:99], v[68:71], a[100:103]
    ds_read_b64_tr_b16 v[116:117], v5 offset:2048
    v_add_f32_e64 v13, v13, v122
    v_mfma_f32_16x16x32_bf16 a[116:119], v[100:103], v[68:71], a[116:119]
    ds_read_b64_tr_b16 v[118:119], v5 offset:10240
    v_exp_f32_e64 v123, v37
    v_mfma_f32_16x16x32_bf16 a[120:123], v[100:103], v[72:75], a[120:123]
    v_add_f32_e64 v13, v13, v123
    v_cvt_pk_bf16_f32 v54, v122, v123
    v_mfma_f32_16x16x32_bf16 a[104:107], v[96:99], v[72:75], a[104:107]
    s_add_u32 m0, s41, 17280
    v_exp_f32_e64 v124, v38
    v_mfma_f32_16x16x32_bf16 a[108:111], v[96:99], v[76:79], a[108:111]
    buffer_load_dwordx4 v6, s[12:15], s46 offen offset:128 lds
    v_mfma_f32_16x16x32_bf16 a[124:127], v[100:103], v[76:79], a[124:127]
    v_add_f32 v13, v13, v124
    s_waitcnt lgkmcnt(4)
    v_mfma_f32_16x16x32_bf16 a[144:147], v[108:111], v[64:67], a[144:147]
    ds_read_b64_tr_b16 v[96:97], v2 offset:3072
    v_exp_f32_e64 v125, v39
    v_mfma_f32_16x16x32_bf16 a[128:131], v[104:107], v[64:67], a[128:131]
    ds_read_b64_tr_b16 v[98:99], v2 offset:11264
    v_add_f32_e64 v13, v13, v125
    v_mfma_f32_16x16x32_bf16 a[132:135], v[104:107], v[68:71], a[132:135]
    ds_read_b64_tr_b16 v[100:101], v3 offset:3072
    v_cvt_pk_bf16_f32 v55, v124, v125
    v_mfma_f32_16x16x32_bf16 a[148:151], v[108:111], v[68:71], a[148:151]
    ds_read_b64_tr_b16 v[102:103], v3 offset:11264
    v_exp_f32_e64 v120, v40
    v_mfma_f32_16x16x32_bf16 a[152:155], v[108:111], v[72:75], a[152:155]
    v_add_f32_e64 v14, v14, v120
    v_mfma_f32_16x16x32_bf16 a[136:139], v[104:107], v[72:75], a[136:139]
    s_add_u32 m0, s41, 18176
    v_exp_f32_e64 v121, v41
    v_mfma_f32_16x16x32_bf16 a[140:143], v[104:107], v[76:79], a[140:143]
    buffer_load_dwordx4 v6, s[12:15], s46 offen offset:256 lds
    v_mfma_f32_16x16x32_bf16 a[156:159], v[108:111], v[76:79], a[156:159]
    v_add_f32_e64 v14, v14, v121
    v_cvt_pk_bf16_f32 v58, v120, v121
    s_waitcnt lgkmcnt(4)
    v_mfma_f32_16x16x32_bf16 a[176:179], v[116:119], v[64:67], a[176:179]
    ds_read_b64_tr_b16 v[104:105], v4 offset:3072
    v_mfma_f32_16x16x32_bf16 a[160:163], v[112:115], v[64:67], a[160:163]
    ds_read_b64_tr_b16 v[106:107], v4 offset:11264
    s_add_u32 m0, s41, 19072
    v_mfma_f32_16x16x32_bf16 a[164:167], v[112:115], v[68:71], a[164:167]
    ds_read_b64_tr_b16 v[108:109], v5 offset:3072
    buffer_load_dwordx4 v6, s[12:15], s46 offen offset:384 lds
    v_mfma_f32_16x16x32_bf16 a[180:183], v[116:119], v[68:71], a[180:183]
    ds_read_b64_tr_b16 v[110:111], v5 offset:11264
    s_add_u32 s46, s46, 32768
    v_mfma_f32_16x16x32_bf16 a[184:187], v[116:119], v[72:75], a[184:187]
    v_exp_f32 v122, v42
    v_mfma_f32_16x16x32_bf16 a[168:171], v[112:115], v[72:75], a[168:171]
    v_add_f32 v14, v14, v122
    v_exp_f32 v123, v43
    v_mfma_f32_16x16x32_bf16 a[172:175], v[112:115], v[76:79], a[172:175]
    v_add_f32_e64 v14, v14, v123
    v_cvt_pk_bf16_f32 v59, v122, v123
    v_mfma_f32_16x16x32_bf16 a[188:191], v[116:119], v[76:79], a[188:191]
    v_exp_f32 v124, v44
    s_waitcnt lgkmcnt(4)
    v_mfma_f32_16x16x32_bf16 a[208:211], v[100:103], v[64:67], a[208:211]
    s_waitcnt vmcnt(8)
    s_barrier
    ds_read_b128 v[112:115], v0 offset:0
    v_mfma_f32_16x16x32_bf16 a[192:195], v[96:99], v[64:67], a[192:195]
    v_add_f32 v15, v15, v124
    v_exp_f32 v125, v45
    v_mfma_f32_16x16x32_bf16 a[196:199], v[96:99], v[68:71], a[196:199]
    ds_read_b128 v[116:119], v1 offset:0
    v_add_f32_e64 v15, v15, v125
    v_mfma_f32_16x16x32_bf16 a[212:215], v[100:103], v[68:71], a[212:215]
    v_cvt_pk_bf16_f32 v62, v124, v125
    v_exp_f32_e64 v120, v46
    v_mfma_f32_16x16x32_bf16 a[216:219], v[100:103], v[72:75], a[216:219]
    v_add_f32 v15, v15, v120
    v_add_u32 v2, s50, v2
    v_mfma_f32_16x16x32_bf16 a[200:203], v[96:99], v[72:75], a[200:203]
    v_exp_f32 v121, v47
    v_add_u32 v3, s50, v3
    v_mfma_f32_16x16x32_bf16 a[204:207], v[96:99], v[76:79], a[204:207]
    v_add_f32_e64 v15, v15, v121
    v_cvt_pk_bf16_f32 v63, v120, v121
    v_mfma_f32_16x16x32_bf16 a[220:223], v[100:103], v[76:79], a[220:223]
    v_add_u32 v4, s50, v4
    v_add_u32 v5, s50, v5
    s_waitcnt lgkmcnt(2)
    v_mfma_f32_16x16x32_bf16 a[240:243], v[108:111], v[64:67], a[240:243]
    ds_read_b128 v[96:99], v0 offset:1024
    v_max3_f32 v120, v12, v13, v14
    v_mfma_f32_16x16x32_bf16 a[224:227], v[104:107], v[64:67], a[224:227]
    s_mov_b32 s36, s40
    s_mov_b32 s40, s44
    s_mov_b32 s44, s43
    v_mfma_f32_16x16x32_bf16 a[228:231], v[104:107], v[68:71], a[228:231]
    ds_read_b128 v[100:103], v1 offset:1024
    v_max_f32_e64 v120, v120, v15
    v_mfma_f32_16x16x32_bf16 a[244:247], v[108:111], v[68:71], a[244:247]
    v_cmp_nge_f32 vcc, s52, v120
    s_mov_b32 s43, s42
    s_mov_b32 s42, s41
    v_mfma_f32_16x16x32_bf16 a[248:251], v[108:111], v[72:75], a[248:251]
    s_mov_b32 s41, s36
    s_add_u32 s51, s51, 1
    v_mfma_f32_16x16x32_bf16 a[232:235], v[104:107], v[72:75], a[232:235]
    v_mfma_f32_16x16x32_bf16 a[236:239], v[104:107], v[76:79], a[236:239]
    v_mfma_f32_16x16x32_bf16 a[252:255], v[108:111], v[76:79], a[252:255]
    s_cmp_lt_u32 s51, 13
    s_cbranch_vccnz L_rare_b
L_back_b:
    s_cbranch_scc1 L_k2_loop
    s_waitcnt lgkmcnt(3)
    v_mfma_f32_16x16x32_bf16 v[16:19], v[112:115], v[128:131], v[80:83]
    ds_read_b128 v[108:111], v0 offset:2048
    s_sub_u32 s49, s42, s40
    v_mfma_f32_16x16x32_bf16 v[20:23], v[112:115], v[160:163], v[84:87]
    s_add_u32 m0, s43, 0
    s_sub_u32 s50, s43, s41
    v_mfma_f32_16x16x32_bf16 v[24:27], v[112:115], v[192:195], v[88:91]
    buffer_load_dwordx4 v7, s[16:19], s47 offen offset:0 lds
    v_mfma_f32_16x16x32_bf16 v[28:31], v[112:115], v[224:227], v[92:95]
    s_waitcnt lgkmcnt(3)
    v_mfma_f32_16x16x32_bf16 v[16:19], v[116:119], v[132:135], v[16:19]
    ds_read_b128 v[112:115], v1 offset:2048
    v_add_f32 v8, v8, v12
    v_mfma_f32_16x16x32_bf16 v[20:23], v[116:119], v[164:167], v[20:23]
    s_add_u32 m0, s43, 896
    v_add_f32_e64 v9, v9, v13
    v_mfma_f32_16x16x32_bf16 v[24:27], v[116:119], v[196:199], v[24:27]
    buffer_load_dwordx4 v7, s[16:19], s47 offen offset:128 lds
    v_mfma_f32_16x16x32_bf16 v[28:31], v[116:119], v[228:231], v[28:31]
    s_waitcnt lgkmcnt(3)
    v_mfma_f32_16x16x32_bf16 v[16:19], v[96:99], v[136:139], v[16:19]
    ds_read_b128 v[116:119], v0 offset:3072
    v_add_f32 v10, v10, v14
    v_mfma_f32_16x16x32_bf16 v[20:23], v[96:99], v[168:171], v[20:23]
    v_add_f32_e64 v11, v11, v15
    v_mfma_f32_16x16x32_bf16 v[24:27], v[96:99], v[200:203], v[24:27]
    v_mfma_f32_16x16x32_bf16 v[28:31], v[96:99], v[232:235], v[28:31]
    s_waitcnt lgkmcnt(3)
    v_mfma_f32_16x16x32_bf16 v[16:19], v[100:103], v[140:143], v[16:19]
    ds_read_b128 v[96:99], v1 offset:3072
    v_mfma_f32_16x16x32_bf16 v[20:23], v[100:103], v[172:175], v[20:23]
    s_add_u32 m0, s43, 1792
    v_mfma_f32_16x16x32_bf16 v[24:27], v[100:103], v[204:207], v[24:27]
    buffer_load_dwordx4 v7, s[16:19], s47 offen offset:256 lds
    v_mfma_f32_16x16x32_bf16 v[28:31], v[100:103], v[236:239], v[28:31]
    s_waitcnt lgkmcnt(3)
    v_mfma_f32_16x16x32_bf16 v[16:19], v[108:111], v[144:147], v[16:19]
    ds_read_b128 v[104:107], v0 offset:8192
    v_mfma_f32_16x16x32_bf16 v[20:23], v[108:111], v[176:179], v[20:23]
    s_add_u32 m0, s43, 2688
    v_mfma_f32_16x16x32_bf16 v[24:27], v[108:111], v[208:211], v[24:27]
    buffer_load_dwordx4 v7, s[16:19], s47 offen offset:384 lds
    v_mfma_f32_16x16x32_bf16 v[28:31], v[108:111], v[240:243], v[28:31]
    s_add_u32 s47, s47, 32768
    s_waitcnt lgkmcnt(3)
    v_mfma_f32_16x16x32_bf16 v[16:19], v[112:115], v[148:151], v[16:19]
    ds_read_b128 v[108:111], v1 offset:8192
    v_mfma_f32_16x16x32_bf16 v[20:23], v[112:115], v[180:183], v[20:23]
    v_mfma_f32_16x16x32_bf16 v[24:27], v[112:115], v[212:215], v[24:27]
    v_mfma_f32_16x16x32_bf16 v[28:31], v[112:115], v[244:247], v[28:31]
    s_waitcnt lgkmcnt(3)
    v_mfma_f32_16x16x32_bf16 v[16:19], v[116:119], v[152:155], v[16:19]
    ds_read_b128 v[112:115], v0 offset:9216
    v_mfma_f32_16x16x32_bf16 v[20:23], v[116:119], v[184:187], v[20:23]
    s_add_u32 m0, s43, 16128
    v_mfma_f32_16x16x32_bf16 v[24:27], v[116:119], v[216:219], v[24:27]
    buffer_load_dwordx4 v7, s[16:19], s48 offen offset:256 lds
    v_mfma_f32_16x16x32_bf16 v[28:31], v[116:119], v[248:251], v[28:31]
    s_waitcnt lgkmcnt(3)
    v_mfma_f32_16x16x32_bf16 v[16:19], v[96:99], v[156:159], v[16:19]
    ds_read_b128 v[116:119], v1 offset:9216
    v_mfma_f32_16x16x32_bf16 v[20:23], v[96:99], v[188:191], v[20:23]
    s_add_u32 m0, s43, 17024
    v_mfma_f32_16x16x32_bf16 v[24:27], v[96:99], v[220:223], v[24:27]
    buffer_load_dwordx4 v7, s[16:19], s48 offen offset:384 lds
    v_mfma_f32_16x16x32_bf16 v[28:31], v[96:99], v[252:255], v[28:31]
    s_waitcnt lgkmcnt(3)
    v_mfma_f32_16x16x32_bf16 v[32:35], v[104:107], v[128:131], v[80:83]
    ds_read_b128 v[100:103], v0 offset:10240
    v_mfma_f32_16x16x32_bf16 v[36:39], v[104:107], v[160:163], v[84:87]
    v_exp_f32_e64 v120, v16
    v_mfma_f32_16x16x32_bf16 v[40:43], v[104:107], v[192:195], v[88:91]
    v_exp_f32_e64 v121, v17
    v_mfma_f32_16x16x32_bf16 v[44:47], v[104:107], v[224:227], v[92:95]
    v_add_f32_e64 v12, v120, v121
    v_cvt_pk_bf16_f32 v64, v120, v121
    s_waitcnt lgkmcnt(3)
    v_mfma_f32_16x16x32_bf16 v[32:35], v[108:111], v[132:135], v[32:35]
    ds_read_b128 v[104:107], v1 offset:10240
    v_mfma_f32_16x16x32_bf16 v[36:39], v[108:111], v[164:167], v[36:39]
    s_add_u32 m0, s43, 18432
    v_exp_f32 v122, v18
    v_mfma_f32_16x16x32_bf16 v[40:43], v[108:111], v[196:199], v[40:43]
    buffer_load_dwordx4 v7, s[16:19], s48 offen offset:0 lds
    v_mfma_f32_16x16x32_bf16 v[44:47], v[108:111], v[228:231], v[44:47]
    v_add_f32 v12, v12, v122
    s_waitcnt lgkmcnt(3)
    v_mfma_f32_16x16x32_bf16 v[32:35], v[112:115], v[136:139], v[32:35]
    ds_read_b128 v[108:111], v0 offset:11264
    v_exp_f32_e64 v123, v19
    v_mfma_f32_16x16x32_bf16 v[36:39], v[112:115], v[168:171], v[36:39]
    v_add_f32_e64 v12, v12, v123
    v_cvt_pk_bf16_f32 v65, v122, v123
    v_mfma_f32_16x16x32_bf16 v[40:43], v[112:115], v[200:203], v[40:43]
    v_exp_f32_e64 v124, v20
    v_mfma_f32_16x16x32_bf16 v[44:47], v[112:115], v[232:235], v[44:47]
    v_exp_f32 v125, v21
    s_waitcnt lgkmcnt(3)
    v_mfma_f32_16x16x32_bf16 v[32:35], v[116:119], v[140:143], v[32:35]
    ds_read_b128 v[112:115], v1 offset:11264
    v_add_f32_e64 v13, v124, v125
    v_mfma_f32_16x16x32_bf16 v[36:39], v[116:119], v[172:175], v[36:39]
    s_add_u32 m0, s43, 19328
    v_add_u32 v0, s49, v0
    v_add_u32 v1, s49, v1
    v_mfma_f32_16x16x32_bf16 v[40:43], v[116:119], v[204:207], v[40:43]
    buffer_load_dwordx4 v7, s[16:19], s48 offen offset:128 lds
    v_mfma_f32_16x16x32_bf16 v[44:47], v[116:119], v[236:239], v[44:47]
    s_add_u32 s48, s48, 32768
    v_cvt_pk_bf16_f32 v68, v124, v125
    s_waitcnt lgkmcnt(3)
    v_mfma_f32_16x16x32_bf16 v[32:35], v[100:103], v[144:147], v[32:35]
    ds_read_b64_tr_b16 v[96:97], v2 offset:0
    v_mfma_f32_16x16x32_bf16 v[36:39], v[100:103], v[176:179], v[36:39]
    ds_read_b64_tr_b16 v[98:99], v2 offset:8192
    v_exp_f32 v120, v22
    v_mfma_f32_16x16x32_bf16 v[40:43], v[100:103], v[208:211], v[40:43]
    v_add_f32_e64 v13, v13, v120
    v_mfma_f32_16x16x32_bf16 v[44:47], v[100:103], v[240:243], v[44:47]
    v_exp_f32 v121, v23
    s_waitcnt lgkmcnt(4)
    v_mfma_f32_16x16x32_bf16 v[32:35], v[104:107], v[148:151], v[32:35]
    ds_read_b64_tr_b16 v[100:101], v3 offset:0
    v_add_f32_e64 v13, v13, v121
    v_mfma_f32_16x16x32_bf16 v[36:39], v[104:107], v[180:183], v[36:39]
    ds_read_b64_tr_b16 v[102:103], v3 offset:8192
    s_add_u32 m0, s44, 0
    v_cvt_pk_bf16_f32 v69, v120, v121
    v_mfma_f32_16x16x32_bf16 v[40:43], v[104:107], v[212:215], v[40:43]
    buffer_load_dwordx4 v6, s[12:15], s45 offen offset:0 lds
    v_mfma_f32_16x16x32_bf16 v[44:47], v[104:107], v[244:247], v[44:47]
    v_exp_f32 v122, v24
    s_waitcnt lgkmcnt(5)
    v_mfma_f32_16x16x32_bf16 v[32:35], v[108:111], v[152:155], v[32:35]
    ds_read_b64_tr_b16 v[104:105], v4 offset:0
    v_mfma_f32_16x16x32_bf16 v[36:39], v[108:111], v[184:187], v[36:39]
    ds_read_b64_tr_b16 v[106:107], v4 offset:8192
    v_exp_f32 v123, v25
    v_mfma_f32_16x16x32_bf16 v[40:43], v[108:111], v[216:219], v[40:43]
    v_add_f32_e64 v14, v122, v123
    v_cvt_pk_bf16_f32 v72, v122, v123
    v_mfma_f32_16x16x32_bf16 v[44:47], v[108:111], v[248:251], v[44:47]
    v_exp_f32 v124, v26
    s_waitcnt lgkmcnt(6)
    v_mfma_f32_16x16x32_bf16 v[32:35], v[112:115], v[156:159], v[32:35]
    ds_read_b64_tr_b16 v[108:109], v5 offset:0
    v_add_f32_e64 v14, v14, v124
    v_mfma_f32_16x16x32_bf16 v[36:39], v[112:115], v[188:191], v[36:39]
    ds_read_b64_tr_b16 v[110:111], v5 offset:8192
    s_add_u32 m0, s44, 896
    v_mfma_f32_16x16x32_bf16 v[40:43], v[112:115], v[220:223], v[40:43]
    buffer_load_dwordx4 v6, s[12:15], s45 offen offset:128 lds
    v_mfma_f32_16x16x32_bf16 v[44:47], v[112:115], v[252:255], v[44:47]
    v_exp_f32 v125, v27
    s_waitcnt lgkmcnt(4)
    v_mfma_f32_16x16x32_bf16 a[16:19], v[100:103], v[48:51], a[16:19]
    ds_read_b64_tr_b16 v[112:113], v2 offset:1024
    v_add_f32_e64 v14, v14, v125
    v_mfma_f32_16x16x32_bf16 a[0:3], v[96:99], v[48:51], a[0:3]
    ds_read_b64_tr_b16 v[114:115], v2 offset:9216
    v_cvt_pk_bf16_f32 v73, v124, v125
    v_mfma_f32_16x16x32_bf16 a[4:7], v[96:99], v[52:55], a[4:7]
    ds_read_b64_tr_b16 v[116:117], v3 offset:1024
    v_exp_f32_e64 v120, v28
    v_mfma_f32_16x16x32_bf16 a[20:23], v[100:103], v[52:55], a[20:23]
    ds_read_b64_tr_b16 v[118:119], v3 offset:9216
    v_mfma_f32_16x16x32_bf16 a[24:27], v[100:103], v[56:59], a[24:27]
    v_exp_f32_e64 v121, v29
    v_mfma_f32_16x16x32_bf16 a[8:11], v[96:99], v[56:59], a[8:11]
    s_add_u32 m0, s44, 1792
    v_add_f32_e64 v15, v120, v121
    v_cvt_pk_bf16_f32 v76, v120, v121
    v_mfma_f32_16x16x32_bf16 a[12:15], v[96:99], v[60:63], a[12:15]
    buffer_load_dwordx4 v6, s[12:15], s45 offen offset:256 lds
    v_mfma_f32_16x16x32_bf16 a[28:31], v[100:103], v[60:63], a[28:31]
    v_exp_f32 v122, v30
    s_waitcnt lgkmcnt(4)
    v_mfma_f32_16x16x32_bf16 a[48:51], v[108:111], v[48:51], a[48:51]
    ds_read_b64_tr_b16 v[96:97], v4 offset:1024
    v_add_f32_e64 v15, v15, v122
    v_mfma_f32_16x16x32_bf16 a[32:35], v[104:107], v[48:51], a[32:35]
    ds_read_b64_tr_b16 v[98:99], v4 offset:9216
    v_exp_f32_e64 v123, v31
    v_mfma_f32_16x16x32_bf16 a[36:39], v[104:107], v[52:55], a[36:39]
    ds_read_b64_tr_b16 v[100:101], v5 offset:1024
    v_add_f32_e64 v15, v15, v123
    v_mfma_f32_16x16x32_bf16 a[52:55], v[108:111], v[52:55], a[52:55]
    ds_read_b64_tr_b16 v[102:103], v5 offset:9216
    v_cvt_pk_bf16_f32 v77, v122, v123
    v_mfma_f32_16x16x32_bf16 a[56:59], v[108:111], v[56:59], a[56:59]
    v_exp_f32_e64 v124, v32
    v_mfma_f32_16x16x32_bf16 a[40:43], v[104:107], v[56:59], a[40:43]
    s_add_u32 m0, s44, 2688
    v_add_f32_e64 v12, v12, v124
    v_mfma_f32_16x16x32_bf16 a[44:47], v[104:107], v[60:63], a[44:47]
    buffer_load_dwordx4 v6, s[12:15], s45 offen offset:384 lds
    v_mfma_f32_16x16x32_bf16 a[60:63], v[108:111], v[60:63], a[60:63]
    s_add_u32 s45, s45, 32768
    s_waitcnt lgkmcnt(4)
    v_mfma_f32_16x16x32_bf16 a[80:83], v[116:119], v[48:51], a[80:83]
    ds_read_b64_tr_b16 v[104:105], v2 offset:2048
    v_exp_f32 v125, v33
    v_mfma_f32_16x16x32_bf16 a[64:67], v[112:115], v[48:51], a[64:67]
    ds_read_b64_tr_b16 v[106:107], v2 offset:10240
    v_add_f32_e64 v12, v12, v125
    v_mfma_f32_16x16x32_bf16 a[68:71], v[112:115], v[52:55], a[68:71]
    ds_read_b64_tr_b16 v[108:109], v3 offset:2048
    v_cvt_pk_bf16_f32 v66, v124, v125
    v_mfma_f32_16x16x32_bf16 a[84:87], v[116:119], v[52:55], a[84:87]
    ds_read_b64_tr_b16 v[110:111], v3 offset:10240
    v_exp_f32_e64 v120, v34
    v_mfma_f32_16x16x32_bf16 a[88:91], v[116:119], v[56:59], a[88:91]
    v_add_f32_e64 v12, v12, v120
    v_mfma_f32_16x16x32_bf16 a[72:75], v[112:115], v[56:59], a[72:75]
    s_add_u32 m0, s44, 16384
    v_exp_f32_e64 v121, v35
    v_mfma_f32_16x16x32_bf16 a[76:79], v[112:115], v[60:63], a[76:79]
    buffer_load_dwordx4 v6, s[12:15], s46 offen offset:0 lds
    v_mfma_f32_16x16x32_bf16 a[92:95], v[116:119], v[60:63], a[92:95]
    v_add_f32_e64 v12, v12, v121
    v_cvt_pk_bf16_f32 v67, v120, v121
    s_waitcnt lgkmcnt(4)
    v_mfma_f32_16x16x32_bf16 a[112:115], v[100:103], v[48:51], a[112:115]
    ds_read_b64_tr_b16 v[112:113], v4 offset:2048
    v_mfma_f32_16x16x32_bf16 a[96:99], v[96:99], v[48:51], a[96:99]
    ds_read_b64_tr_b16 v[114:115], v4 offset:10240
    v_exp_f32 v122, v36
    v_mfma_f32_16x16x32_bf16 a[100:103], v[96:99], v[52:55], a[100:103]
    ds_read_b64_tr_b16 v[116:117], v5 offset:2048
    v_add_f32_e64 v13, v13, v122
    v_mfma_f32_16x16x32_bf16 a[116:119], v[100:103], v[52:55], a[116:119]
    ds_read_b64_tr_b16 v[118:119], v5 offset:10240
    v_exp_f32_e64 v123, v37
    v_mfma_f32_16x16x32_bf16 a[120:123], v[100:103], v[56:59], a[120:123]
    v_add_f32_e64 v13, v13, v123
    v_cvt_pk_bf16_f32 v70, v122, v123
    v_mfma_f32_16x16x32_bf16 a[104:107], v[96:99], v[56:59], a[104:107]
    s_add_u32 m0, s44, 17280
    v_exp_f32_e64 v124, v38
    v_mfma_f32_16x16x32_bf16 a[108:111], v[96:99], v[60:63], a[108:111]
    buffer_load_dwordx4 v6, s[12:15], s46 offen offset:128 lds
    v_mfma_f32_16x16x32_bf16 a[124:127], v[100:103], v[60:63], a[124:127]
    v_add_f32 v13, v13, v124
    s_waitcnt lgkmcnt(4)
    v_mfma_f32_16x16x32_bf16 a[144:147], v[108:111], v[48:51], a[144:147]
    ds_read_b64_tr_b16 v[96:97], v2 offset:3072
    v_exp_f32_e64 v125, v39
    v_mfma_f32_16x16x32_bf16 a[128:131], v[104:107], v[48:51], a[128:131]
    ds_read_b64_tr_b16 v[98:99], v2 offset:11264
    v_add_f32_e64 v13, v13, v125
    v_mfma_f32_16x16x32_bf16 a[132:135], v[104:107], v[52:55], a[132:135]
    ds_read_b64_tr_b16 v[100:101], v3 offset:3072
    v_cvt_pk_bf16_f32 v71, v124, v125
    v_mfma_f32_16x16x32_bf16 a[148:151], v[108:111], v[52:55], a[148:151]
    ds_read_b64_tr_b16 v[102:103], v3 offset:11264
    v_exp_f32_e64 v120, v40
    v_mfma_f32_16x16x32_bf16 a[152:155], v[108:111], v[56:59], a[152:155]
    v_add_f32_e64 v14, v14, v120
    v_mfma_f32_16x16x32_bf16 a[136:139], v[104:107], v[56:59], a[136:139]
    s_add_u32 m0, s44, 18176
    v_exp_f32_e64 v121, v41
    v_mfma_f32_16x16x32_bf16 a[140:143], v[104:107], v[60:63], a[140:143]
    buffer_load_dwordx4 v6, s[12:15], s46 offen offset:256 lds
    v_mfma_f32_16x16x32_bf16 a[156:159], v[108:111], v[60:63], a[156:159]
    v_add_f32_e64 v14, v14, v121
    v_cvt_pk_bf16_f32 v74, v120, v121
    s_waitcnt lgkmcnt(4)
    v_mfma_f32_16x16x32_bf16 a[176:179], v[116:119], v[48:51], a[176:179]
    ds_read_b64_tr_b16 v[104:105], v4 offset:3072
    v_mfma_f32_16x16x32_bf16 a[160:163], v[112:115], v[48:51], a[160:163]
    ds_read_b64_tr_b16 v[106:107], v4 offset:11264
    s_add_u32 m0, s44, 19072
    v_mfma_f32_16x16x32_bf16 a[164:167], v[112:115], v[52:55], a[164:167]
    ds_read_b64_tr_b16 v[108:109], v5 offset:3072
    buffer_load_dwordx4 v6, s[12:15], s46 offen offset:384 lds
    v_mfma_f32_16x16x32_bf16 a[180:183], v[116:119], v[52:55], a[180:183]
    ds_read_b64_tr_b16 v[110:111], v5 offset:11264
    s_add_u32 s46, s46, 32768
    v_mfma_f32_16x16x32_bf16 a[184:187], v[116:119], v[56:59], a[184:187]
    v_exp_f32 v122, v42
    v_mfma_f32_16x16x32_bf16 a[168:171], v[112:115], v[56:59], a[168:171]
    v_add_f32 v14, v14, v122
    v_exp_f32 v123, v43
    v_mfma_f32_16x16x32_bf16 a[172:175], v[112:115], v[60:63], a[172:175]
    v_add_f32_e64 v14, v14, v123
    v_cvt_pk_bf16_f32 v75, v122, v123
    v_mfma_f32_16x16x32_bf16 a[188:191], v[116:119], v[60:63], a[188:191]
    v_exp_f32 v124, v44
    s_waitcnt lgkmcnt(4)
    v_mfma_f32_16x16x32_bf16 a[208:211], v[100:103], v[48:51], a[208:211]
    s_waitcnt vmcnt(8)
    s_barrier
    ds_read_b128 v[112:115], v0 offset:0
    v_mfma_f32_16x16x32_bf16 a[192:195], v[96:99], v[48:51], a[192:195]
    v_add_f32 v15, v15, v124
    v_exp_f32 v125, v45
    v_mfma_f32_16x16x32_bf16 a[196:199], v[96:99], v[52:55], a[196:199]
    ds_read_b128 v[116:119], v1 offset:0
    v_add_f32_e64 v15, v15, v125
    v_mfma_f32_16x16x32_bf16 a[212:215], v[100:103], v[52:55], a[212:215]
    v_cvt_pk_bf16_f32 v78, v124, v125
    v_exp_f32_e64 v120, v46
    v_mfma_f32_16x16x32_bf16 a[216:219], v[100:103], v[56:59], a[216:219]
    v_add_f32 v15, v15, v120
    v_add_u32 v2, s50, v2
    v_mfma_f32_16x16x32_bf16 a[200:203], v[96:99], v[56:59], a[200:203]
    v_exp_f32 v121, v47
    v_add_u32 v3, s50, v3
    v_mfma_f32_16x16x32_bf16 a[204:207], v[96:99], v[60:63], a[204:207]
    v_add_f32_e64 v15, v15, v121
    v_cvt_pk_bf16_f32 v79, v120, v121
    v_mfma_f32_16x16x32_bf16 a[220:223], v[100:103], v[60:63], a[220:223]
    v_add_u32 v4, s50, v4
    v_add_u32 v5, s50, v5
    s_waitcnt lgkmcnt(2)
    v_mfma_f32_16x16x32_bf16 a[240:243], v[108:111], v[48:51], a[240:243]
    ds_read_b128 v[96:99], v0 offset:1024
    v_max3_f32 v120, v12, v13, v14
    v_mfma_f32_16x16x32_bf16 a[224:227], v[104:107], v[48:51], a[224:227]
    v_mfma_f32_16x16x32_bf16 a[228:231], v[104:107], v[52:55], a[228:231]
    ds_read_b128 v[100:103], v1 offset:1024
    v_max_f32 v120, v120, v15
    v_cmp_nge_f32 vcc, s52, v120
    v_mfma_f32_16x16x32_bf16 a[244:247], v[108:111], v[52:55], a[244:247]
    v_mfma_f32_16x16x32_bf16 a[248:251], v[108:111], v[56:59], a[248:251]
    v_mfma_f32_16x16x32_bf16 a[232:235], v[104:107], v[56:59], a[232:235]
    v_mfma_f32_16x16x32_bf16 a[236:239], v[104:107], v[60:63], a[236:239]
    v_mfma_f32_16x16x32_bf16 a[252:255], v[108:111], v[60:63], a[252:255]
    s_cbranch_vccnz L_rare_c
L_back_c:
    s_waitcnt lgkmcnt(3)
    v_mfma_f32_16x16x32_bf16 v[16:19], v[112:115], v[128:131], v[80:83]
    ds_read_b128 v[108:111], v0 offset:2048
    s_sub_u32 s49, s44, s42
    v_mfma_f32_16x16x32_bf16 v[20:23], v[112:115], v[160:163], v[84:87]
    s_add_u32 m0, s40, 0
    s_sub_u32 s50, s40, s43
    v_mfma_f32_16x16x32_bf16 v[24:27], v[112:115], v[192:195], v[88:91]
    buffer_load_dwordx4 v7, s[16:19], s47 offen offset:0 lds
    v_mfma_f32_16x16x32_bf16 v[28:31], v[112:115], v[224:227], v[92:95]
    s_waitcnt lgkmcnt(3)
    v_mfma_f32_16x16x32_bf16 v[16:19], v[116:119], v[132:135], v[16:19]
    ds_read_b128 v[112:115], v1 offset:2048
    v_add_f32 v8, v8, v12
    v_mfma_f32_16x16x32_bf16 v[20:23], v[116:119], v[164:167], v[20:23]
    s_add_u32 m0, s40, 896
    v_add_f32_e64 v9, v9, v13
    v_mfma_f32_16x16x32_bf16 v[24:27], v[116:119], v[196:199], v[24:27]
    buffer_load_dwordx4 v7, s[16:19], s47 offen offset:128 lds
    v_mfma_f32_16x16x32_bf16 v[28:31], v[116:119], v[228:231], v[28:31]
    s_waitcnt lgkmcnt(3)
    v_mfma_f32_16x16x32_bf16 v[16:19], v[96:99], v[136:139], v[16:19]
    ds_read_b128 v[116:119], v0 offset:3072
    v_add_f32 v10, v10, v14
    v_mfma_f32_16x16x32_bf16 v[20:23], v[96:99], v[168:171], v[20:23]
    v_add_f32_e64 v11, v11, v15
    v_mfma_f32_16x16x32_bf16 v[24:27], v[96:99], v[200:203], v[24:27]
    v_mfma_f32_16x16x32_bf16 v[28:31], v[96:99], v[232:235], v[28:31]
    s_waitcnt lgkmcnt(3)
    v_mfma_f32_16x16x32_bf16 v[16:19], v[100:103], v[140:143], v[16:19]
    ds_read_b128 v[96:99], v1 offset:3072
    v_mfma_f32_16x16x32_bf16 v[20:23], v[100:103], v[172:175], v[20:23]
    s_add_u32 m0, s40, 1792
    v_mfma_f32_16x16x32_bf16 v[24:27], v[100:103], v[204:207], v[24:27]
    buffer_load_dwordx4 v7, s[16:19], s47 offen offset:256 lds
    v_mfma_f32_16x16x32_bf16 v[28:31], v[100:103], v[236:239], v[28:31]
    s_waitcnt lgkmcnt(3)
    v_mfma_f32_16x16x32_bf16 v[16:19], v[108:111], v[144:147], v[16:19]
    ds_read_b128 v[104:107], v0 offset:8192
    v_mfma_f32_16x16x32_bf16 v[20:23], v[108:111], v[176:179], v[20:23]
    s_add_u32 m0, s40, 2688
    v_mfma_f32_16x16x32_bf16 v[24:27], v[108:111], v[208:211], v[24:27]
    buffer_load_dwordx4 v7, s[16:19], s47 offen offset:384 lds
    v_mfma_f32_16x16x32_bf16 v[28:31], v[108:111], v[240:243], v[28:31]
    s_add_u32 s47, s47, 32768
    s_waitcnt lgkmcnt(3)
    v_mfma_f32_16x16x32_bf16 v[16:19], v[112:115], v[148:151], v[16:19]
    ds_read_b128 v[108:111], v1 offset:8192
    v_mfma_f32_16x16x32_bf16 v[20:23], v[112:115], v[180:183], v[20:23]
    v_mfma_f32_16x16x32_bf16 v[24:27], v[112:115], v[212:215], v[24:27]
    v_mfma_f32_16x16x32_bf16 v[28:31], v[112:115], v[244:247], v[28:31]
    s_waitcnt lgkmcnt(3)
    v_mfma_f32_16x16x32_bf16 v[16:19], v[116:119], v[152:155], v[16:19]
    ds_read_b128 v[112:115], v0 offset:9216
    v_mfma_f32_16x16x32_bf16 v[20:23], v[116:119], v[184:187], v[20:23]
    s_add_u32 m0, s40, 16128
    v_mfma_f32_16x16x32_bf16 v[24:27], v[116:119], v[216:219], v[24:27]
    buffer_load_dwordx4 v7, s[16:19], s48 offen offset:256 lds
    v_mfma_f32_16x16x32_bf16 v[28:31], v[116:119], v[248:251], v[28:31]
    s_waitcnt lgkmcnt(3)
    v_mfma_f32_16x16x32_bf16 v[16:19], v[96:99], v[156:159], v[16:19]
    ds_read_b128 v[116:119], v1 offset:9216
    v_mfma_f32_16x16x32_bf16 v[20:23], v[96:99], v[188:191], v[20:23]
    s_add_u32 m0, s40, 17024
    v_mfma_f32_16x16x32_bf16 v[24:27], v[96:99], v[220:223], v[24:27]
    buffer_load_dwordx4 v7, s[16:19], s48 offen offset:384 lds
    v_mfma_f32_16x16x32_bf16 v[28:31], v[96:99], v[252:255], v[28:31]
    s_waitcnt lgkmcnt(3)
    v_mfma_f32_16x16x32_bf16 v[32:35], v[104:107], v[128:131], v[80:83]
    ds_read_b128 v[100:103], v0 offset:10240
    v_mfma_f32_16x16x32_bf16 v[36:39], v[104:107], v[160:163], v[84:87]
    v_exp_f32_e64 v120, v16
    v_mfma_f32_16x16x32_bf16 v[40:43], v[104:107], v[192:195], v[88:91]
    v_exp_f32_e64 v121, v17
    v_mfma_f32_16x16x32_bf16 v[44:47], v[104:107], v[224:227], v[92:95]
    v_add_f32_e64 v12, v120, v121
    v_cvt_pk_bf16_f32 v48, v120, v121
    s_waitcnt lgkmcnt(3)
    v_mfma_f32_16x16x32_bf16 v[32:35], v[108:111], v[132:135], v[32:35]
    ds_read_b128 v[104:107], v1 offset:10240
    v_mfma_f32_16x16x32_bf16 v[36:39], v[108:111], v[164:167], v[36:39]
    s_add_u32 m0, s40, 18432
    v_mfma_f32_16x16x32_bf16 v[40:43], v[108:111], v[196:199], v[40:43]
    buffer_load_dwordx4 v7, s[16:19], s48 offen offset:0 lds
    v_mfma_f32_16x16x32_bf16 v[44:47], v[108:111], v[228:231], v[44:47]
    s_waitcnt lgkmcnt(3)
    v_mfma_f32_16x16x32_bf16 v[32:35], v[112:115], v[136:139], v[32:35]
    ds_read_b128 v[108:111], v0 offset:11264
    v_exp_f32_e64 v122, v18
    v_mfma_f32_16x16x32_bf16 v[36:39], v[112:115], v[168:171], v[36:39]
    v_add_f32_e64 v12, v12, v122
    v_mfma_f32_16x16x32_bf16 v[40:43], v[112:115], v[200:203], v[40:43]
    v_exp_f32_e64 v123, v19
    v_mfma_f32_16x16x32_bf16 v[44:47], v[112:115], v[232:235], v[44:47]
    v_add_f32 v12, v12, v123
    s_waitcnt lgkmcnt(3)
    v_mfma_f32_16x16x32_bf16 v[32:35], v[116:119], v[140:143], v[32:35]
    ds_read_b128 v[112:115], v1 offset:11264
    v_cvt_pk_bf16_f32 v49, v122, v123
    v_mfma_f32_16x16x32_bf16 v[36:39], v[116:119], v[172:175], v[36:39]
    s_add_u32 m0, s40, 19328
    v_add_u32 v0, s49, v0
    v_add_u32 v1, s49, v1
    v_mfma_f32_16x16x32_bf16 v[40:43], v[116:119], v[204:207], v[40:43]
    buffer_load_dwordx4 v7, s[16:19], s48 offen offset:128 lds
    v_mfma_f32_16x16x32_bf16 v[44:47], v[116:119], v[236:239], v[44:47]
    s_add_u32 s48, s48, 32768
    s_waitcnt lgkmcnt(3)
    v_mfma_f32_16x16x32_bf16 v[32:35], v[100:103], v[144:147], v[32:35]
    ds_read_b64_tr_b16 v[96:97], v2 offset:0
    v_mfma_f32_16x16x32_bf16 v[36:39], v[100:103], v[176:179], v[36:39]
    ds_read_b64_tr_b16 v[98:99], v2 offset:8192
    v_mfma_f32_16x16x32_bf16 v[40:43], v[100:103], v[208:211], v[40:43]
    v_exp_f32 v124, v20
    v_mfma_f32_16x16x32_bf16 v[44:47], v[100:103], v[240:243], v[44:47]
    v_exp_f32 v125, v21
    s_waitcnt lgkmcnt(4)
    v_mfma_f32_16x16x32_bf16 v[32:35], v[104:107], v[148:151], v[32:35]
    ds_read_b64_tr_b16 v[100:101], v3 offset:0
    v_add_f32_e64 v13, v124, v125
    v_mfma_f32_16x16x32_bf16 v[36:39], v[104:107], v[180:183], v[36:39]
    ds_read_b64_tr_b16 v[102:103], v3 offset:8192
    v_cvt_pk_bf16_f32 v52, v124, v125
    v_mfma_f32_16x16x32_bf16 v[40:43], v[104:107], v[212:215], v[40:43]
    v_exp_f32_e64 v120, v22
    v_mfma_f32_16x16x32_bf16 v[44:47], v[104:107], v[244:247], v[44:47]
    v_add_f32 v13, v13, v120
    s_waitcnt lgkmcnt(5)
    v_mfma_f32_16x16x32_bf16 v[32:35], v[108:111], v[152:155], v[32:35]
    ds_read_b64_tr_b16 v[104:105], v4 offset:0
    v_exp_f32_e64 v121, v23
    v_mfma_f32_16x16x32_bf16 v[36:39], v[108:111], v[184:187], v[36:39]
    ds_read_b64_tr_b16 v[106:107], v4 offset:8192
    v_add_f32_e64 v13, v13, v121
    v_mfma_f32_16x16x32_bf16 v[40:43], v[108:111], v[216:219], v[40:43]
    v_cvt_pk_bf16_f32 v53, v120, v121
    v_mfma_f32_16x16x32_bf16 v[44:47], v[108:111], v[248:251], v[44:47]
    s_waitcnt lgkmcnt(6)
    v_mfma_f32_16x16x32_bf16 v[32:35], v[112:115], v[156:159], v[32:35]
    ds_read_b64_tr_b16 v[108:109], v5 offset:0
    v_mfma_f32_16x16x32_bf16 v[36:39], v[112:115], v[188:191], v[36:39]
    ds_read_b64_tr_b16 v[110:111], v5 offset:8192
    v_exp_f32 v122, v24
    v_mfma_f32_16x16x32_bf16 v[40:43], v[112:115], v[220:223], v[40:43]
    v_exp_f32_e64 v123, v25
    v_mfma_f32_16x16x32_bf16 v[44:47], v[112:115], v[252:255], v[44:47]
    v_add_f32 v14, v122, v123
    s_waitcnt lgkmcnt(4)
    v_mfma_f32_16x16x32_bf16 a[16:19], v[100:103], v[64:67], a[16:19]
    ds_read_b64_tr_b16 v[112:113], v2 offset:1024
    v_cvt_pk_bf16_f32 v56, v122, v123
    v_mfma_f32_16x16x32_bf16 a[0:3], v[96:99], v[64:67], a[0:3]
    ds_read_b64_tr_b16 v[114:115], v2 offset:9216
    v_mfma_f32_16x16x32_bf16 a[4:7], v[96:99], v[68:71], a[4:7]
    ds_read_b64_tr_b16 v[116:117], v3 offset:1024
    v_exp_f32_e64 v124, v26
    v_mfma_f32_16x16x32_bf16 a[20:23], v[100:103], v[68:71], a[20:23]
    ds_read_b64_tr_b16 v[118:119], v3 offset:9216
    v_add_f32_e64 v14, v14, v124
    v_mfma_f32_16x16x32_bf16 a[24:27], v[100:103], v[72:75], a[24:27]
    v_exp_f32_e64 v125, v27
    v_mfma_f32_16x16x32_bf16 a[8:11], v[96:99], v[72:75], a[8:11]
    v_add_f32_e64 v14, v14, v125
    v_cvt_pk_bf16_f32 v57, v124, v125
    v_mfma_f32_16x16x32_bf16 a[12:15], v[96:99], v[76:79], a[12:15]
    v_exp_f32_e64 v120, v28
    v_mfma_f32_16x16x32_bf16 a[28:31], v[100:103], v[76:79], a[28:31]
    v_exp_f32 v121, v29
    s_waitcnt lgkmcnt(4)
    v_mfma_f32_16x16x32_bf16 a[48:51], v[108:111], v[64:67], a[48:51]
    ds_read_b64_tr_b16 v[96:97], v4 offset:1024
    v_add_f32_e64 v15, v120, v121
    v_mfma_f32_16x16x32_bf16 a[32:35], v[104:107], v[64:67], a[32:35]
    ds_read_b64_tr_b16 v[98:99], v4 offset:9216
    v_cvt_pk_bf16_f32 v60, v120, v121
    v_mfma_f32_16x16x32_bf16 a[36:39], v[104:107], v[68:71], a[36:39]
    ds_read_b64_tr_b16 v[100:101], v5 offset:1024
    v_mfma_f32_16x16x32_bf16 a[52:55], v[108:111], v[68:71], a[52:55]
    ds_read_b64_tr_b16 v[102:103], v5 offset:9216
    v_mfma_f32_16x16x32_bf16 a[56:59], v[108:111], v[72:75], a[56:59]
    v_exp_f32_e64 v122, v30
    v_mfma_f32_16x16x32_bf16 a[40:43], v[104:107], v[72:75], a[40:43]
    v_add_f32 v15, v15, v122
    v_exp_f32 v123, v31
    v_mfma_f32_16x16x32_bf16 a[44:47], v[104:107], v[76:79], a[44:47]
    v_add_f32_e64 v15, v15, v123
    v_cvt_pk_bf16_f32 v61, v122, v123
    v_mfma_f32_16x16x32_bf16 a[60:63], v[108:111], v[76:79], a[60:63]
    s_waitcnt lgkmcnt(4)
    v_mfma_f32_16x16x32_bf16 a[80:83], v[116:119], v[64:67], a[80:83]
    ds_read_b64_tr_b16 v[104:105], v2 offset:2048
    v_mfma_f32_16x16x32_bf16 a[64:67], v[112:115], v[64:67], a[64:67]
    ds_read_b64_tr_b16 v[106:107], v2 offset:10240
    v_mfma_f32_16x16x32_bf16 a[68:71], v[112:115], v[68:71], a[68:71]
    ds_read_b64_tr_b16 v[108:109], v3 offset:2048
    v_exp_f32 v124, v32
    v_mfma_f32_16x16x32_bf16 a[84:87], v[116:119], v[68:71], a[84:87]
    ds_read_b64_tr_b16 v[110:111], v3 offset:10240
    v_add_f32_e64 v12, v12, v124
    v_mfma_f32_16x16x32_bf16 a[88:91], v[116:119], v[72:75], a[88:91]
    v_exp_f32_e64 v125, v33
    v_mfma_f32_16x16x32_bf16 a[72:75], v[112:115], v[72:75], a[72:75]
    v_add_f32_e64 v12, v12, v125
    v_cvt_pk_bf16_f32 v50, v124, v125
    v_mfma_f32_16x16x32_bf16 a[76:79], v[112:115], v[76:79], a[76:79]
    v_exp_f32_e64 v120, v34
    v_mfma_f32_16x16x32_bf16 a[92:95], v[116:119], v[76:79], a[92:95]
    v_add_f32 v12, v12, v120
    s_waitcnt lgkmcnt(4)
    v_mfma_f32_16x16x32_bf16 a[112:115], v[100:103], v[64:67], a[112:115]
    ds_read_b64_tr_b16 v[112:113], v4 offset:2048
    v_exp_f32_e64 v121, v35
    v_mfma_f32_16x16x32_bf16 a[96:99], v[96:99], v[64:67], a[96:99]
    ds_read_b64_tr_b16 v[114:115], v4 offset:10240
    v_add_f32_e64 v12, v12, v121
    v_mfma_f32_16x16x32_bf16 a[100:103], v[96:99], v[68:71], a[100:103]
    ds_read_b64_tr_b16 v[116:117], v5 offset:2048
    v_cvt_pk_bf16_f32 v51, v120, v121
    v_mfma_f32_16x16x32_bf16 a[116:119], v[100:103], v[68:71], a[116:119]
    ds_read_b64_tr_b16 v[118:119], v5 offset:10240
    v_mfma_f32_16x16x32_bf16 a[120:123], v[100:103], v[72:75], a[120:123]
    v_exp_f32_e64 v122, v36
    v_mfma_f32_16x16x32_bf16 a[104:107], v[96:99], v[72:75], a[104:107]
    v_add_f32 v13, v13, v122
    v_exp_f32 v123, v37
    v_mfma_f32_16x16x32_bf16 a[108:111], v[96:99], v[76:79], a[108:111]
    v_add_f32_e64 v13, v13, v123
    v_cvt_pk_bf16_f32 v54, v122, v123
    v_mfma_f32_16x16x32_bf16 a[124:127], v[100:103], v[76:79], a[124:127]
    s_waitcnt lgkmcnt(4)
    v_mfma_f32_16x16x32_bf16 a[144:147], v[108:111], v[64:67], a[144:147]
    ds_read_b64_tr_b16 v[96:97], v2 offset:3072
    v_mfma_f32_16x16x32_bf16 a[128:131], v[104:107], v[64:67], a[128:131]
    ds_read_b64_tr_b16 v[98:99], v2 offset:11264
    v_mfma_f32_16x16x32_bf16 a[132:135], v[104:107], v[68:71], a[132:135]
    ds_read_b64_tr_b16 v[100:101], v3 offset:3072
    v_exp_f32 v124, v38
    v_mfma_f32_16x16x32_bf16 a[148:151], v[108:111], v[68:71], a[148:151]
    ds_read_b64_tr_b16 v[102:103], v3 offset:11264
    v_add_f32_e64 v13, v13, v124
    v_mfma_f32_16x16x32_bf16 a[152:155], v[108:111], v[72:75], a[152:155]
    v_exp_f32_e64 v125, v39
    v_mfma_f32_16x16x32_bf16 a[136:139], v[104:107], v[72:75], a[136:139]
    v_add_f32_e64 v13, v13, v125
    v_cvt_pk_bf16_f32 v55, v124, v125
    v_mfma_f32_16x16x32_bf16 a[140:143], v[104:107], v[76:79], a[140:143]
    v_exp_f32_e64 v120, v40
    v_mfma_f32_16x16x32_bf16 a[156:159], v[108:111], v[76:79], a[156:159]
    v_add_f32 v14, v14, v120
    s_waitcnt lgkmcnt(4)
    v_mfma_f32_16x16x32_bf16 a[176:179], v[116:119], v[64:67], a[176:179]
    ds_read_b64_tr_b16 v[104:105], v4 offset:3072
    v_exp_f32_e64 v121, v41
    v_mfma_f32_16x16x32_bf16 a[160:163], v[112:115], v[64:67], a[160:163]
    ds_read_b64_tr_b16 v[106:107], v4 offset:11264
    v_add_f32_e64 v14, v14, v121
    v_mfma_f32_16x16x32_bf16 a[164:167], v[112:115], v[68:71], a[164:167]
    ds_read_b64_tr_b16 v[108:109], v5 offset:3072
    v_cvt_pk_bf16_f32 v58, v120, v121
    v_mfma_f32_16x16x32_bf16 a[180:183], v[116:119], v[68:71], a[180:183]
    ds_read_b64_tr_b16 v[110:111], v5 offset:11264
    v_mfma_f32_16x16x32_bf16 a[184:187], v[116:119], v[72:75], a[184:187]
    v_exp_f32_e64 v122, v42
    v_mfma_f32_16x16x32_bf16 a[168:171], v[112:115], v[72:75], a[168:171]
    v_add_f32 v14, v14, v122
    v_exp_f32 v123, v43
    v_mfma_f32_16x16x32_bf16 a[172:175], v[112:115], v[76:79], a[172:175]
    v_add_f32_e64 v14, v14, v123
    v_cvt_pk_bf16_f32 v59, v122, v123
    v_mfma_f32_16x16x32_bf16 a[188:191], v[116:119], v[76:79], a[188:191]
    v_add_u32 v2, s50, v2
    s_waitcnt lgkmcnt(4)
    v_mfma_f32_16x16x32_bf16 a[208:211], v[100:103], v[64:67], a[208:211]
    s_waitcnt vmcnt(0)
    s_barrier
    ds_read_b128 v[112:115], v0 offset:0
    v_mfma_f32_16x16x32_bf16 a[192:195], v[96:99], v[64:67], a[192:195]
    v_exp_f32_e64 v124, v44
    v_mfma_f32_16x16x32_bf16 a[196:199], v[96:99], v[68:71], a[196:199]
    ds_read_b128 v[116:119], v1 offset:0
    v_add_f32 v15, v15, v124
    v_add_u32 v3, s50, v3
    v_mfma_f32_16x16x32_bf16 a[212:215], v[100:103], v[68:71], a[212:215]
    v_exp_f32_e64 v125, v45
    v_mfma_f32_16x16x32_bf16 a[216:219], v[100:103], v[72:75], a[216:219]
    v_add_f32_e64 v15, v15, v125
    v_cvt_pk_bf16_f32 v62, v124, v125
    v_mfma_f32_16x16x32_bf16 a[200:203], v[96:99], v[72:75], a[200:203]
    v_exp_f32_e64 v120, v46
    v_mfma_f32_16x16x32_bf16 a[204:207], v[96:99], v[76:79], a[204:207]
    v_add_f32 v15, v15, v120
    v_add_u32 v4, s50, v4
    v_mfma_f32_16x16x32_bf16 a[220:223], v[100:103], v[76:79], a[220:223]
    v_exp_f32 v121, v47
    s_waitcnt lgkmcnt(2)
    v_mfma_f32_16x16x32_bf16 a[240:243], v[108:111], v[64:67], a[240:243]
    ds_read_b128 v[96:99], v0 offset:1024
    v_add_f32_e64 v15, v15, v121
    v_mfma_f32_16x16x32_bf16 a[224:227], v[104:107], v[64:67], a[224:227]
    v_cvt_pk_bf16_f32 v63, v120, v121
    v_add_u32_e64 v5, s50, v5
    v_mfma_f32_16x16x32_bf16 a[228:231], v[104:107], v[68:71], a[228:231]
    ds_read_b128 v[100:103], v1 offset:1024
    v_mfma_f32_16x16x32_bf16 a[244:247], v[108:111], v[68:71], a[244:247]
    v_max3_f32 v120, v12, v13, v14
    v_mfma_f32_16x16x32_bf16 a[248:251], v[108:111], v[72:75], a[248:251]
    v_mfma_f32_16x16x32_bf16 a[232:235], v[104:107], v[72:75], a[232:235]
    v_max_f32 v120, v120, v15
    v_cmp_nge_f32 vcc, s52, v120
    v_mfma_f32_16x16x32_bf16 a[236:239], v[104:107], v[76:79], a[236:239]
    v_mfma_f32_16x16x32_bf16 a[252:255], v[108:111], v[76:79], a[252:255]
    s_cbranch_vccnz L_rare_d
L_back_d:
    s_waitcnt lgkmcnt(3)
    v_mfma_f32_16x16x32_bf16 v[16:19], v[112:115], v[128:131], v[80:83]
    ds_read_b128 v[108:111], v0 offset:2048
    s_sub_u32 s49, s41, s44
    v_mfma_f32_16x16x32_bf16 v[20:23], v[112:115], v[160:163], v[84:87]
    s_add_u32 m0, s42, 0
    s_sub_u32 s50, s42, s40
    v_mfma_f32_16x16x32_bf16 v[24:27], v[112:115], v[192:195], v[88:91]
    buffer_load_dwordx4 v7, s[16:19], s47 offen offset:0 lds
    v_mfma_f32_16x16x32_bf16 v[28:31], v[112:115], v[224:227], v[92:95]
    s_waitcnt lgkmcnt(3)
    v_mfma_f32_16x16x32_bf16 v[16:19], v[116:119], v[132:135], v[16:19]
    ds_read_b128 v[112:115], v1 offset:2048
    v_add_f32_e64 v8, v8, v12
    v_mfma_f32_16x16x32_bf16 v[20:23], v[116:119], v[164:167], v[20:23]
    s_add_u32 m0, s42, 896
    v_add_f32_e64 v9, v9, v13
    v_mfma_f32_16x16x32_bf16 v[24:27], v[116:119], v[196:199], v[24:27]
    buffer_load_dwordx4 v7, s[16:19], s47 offen offset:128 lds
    v_mfma_f32_16x16x32_bf16 v[28:31], v[116:119], v[228:231], v[28:31]
    s_waitcnt lgkmcnt(3)
    v_mfma_f32_16x16x32_bf16 v[16:19], v[96:99], v[136:139], v[16:19]
    ds_read_b128 v[116:119], v0 offset:3072
    v_add_f32 v10, v10, v14
    v_mfma_f32_16x16x32_bf16 v[20:23], v[96:99], v[168:171], v[20:23]
    v_add_f32_e64 v11, v11, v15
    v_mfma_f32_16x16x32_bf16 v[24:27], v[96:99], v[200:203], v[24:27]
    v_mfma_f32_16x16x32_bf16 v[28:31], v[96:99], v[232:235], v[28:31]
    s_waitcnt lgkmcnt(3)
    v_mfma_f32_16x16x32_bf16 v[16:19], v[100:103], v[140:143], v[16:19]
    ds_read_b128 v[96:99], v1 offset:3072
    v_mfma_f32_16x16x32_bf16 v[20:23], v[100:103], v[172:175], v[20:23]
    s_add_u32 m0, s42, 1792
    v_mfma_f32_16x16x32_bf16 v[24:27], v[100:103], v[204:207], v[24:27]
    buffer_load_dwordx4 v7, s[16:19], s47 offen offset:256 lds
    v_mfma_f32_16x16x32_bf16 v[28:31], v[100:103], v[236:239], v[28:31]
    s_waitcnt lgkmcnt(3)
    v_mfma_f32_16x16x32_bf16 v[16:19], v[108:111], v[144:147], v[16:19]
    ds_read_b128 v[104:107], v0 offset:8192
    v_mfma_f32_16x16x32_bf16 v[20:23], v[108:111], v[176:179], v[20:23]
    s_add_u32 m0, s42, 2688
    v_mfma_f32_16x16x32_bf16 v[24:27], v[108:111], v[208:211], v[24:27]
    buffer_load_dwordx4 v7, s[16:19], s47 offen offset:384 lds
    v_mfma_f32_16x16x32_bf16 v[28:31], v[108:111], v[240:243], v[28:31]
    s_add_u32 s47, s47, 32768
    s_waitcnt lgkmcnt(3)
    v_mfma_f32_16x16x32_bf16 v[16:19], v[112:115], v[148:151], v[16:19]
    ds_read_b128 v[108:111], v1 offset:8192
    v_mfma_f32_16x16x32_bf16 v[20:23], v[112:115], v[180:183], v[20:23]
    v_mfma_f32_16x16x32_bf16 v[24:27], v[112:115], v[212:215], v[24:27]
    v_mfma_f32_16x16x32_bf16 v[28:31], v[112:115], v[244:247], v[28:31]
    s_waitcnt lgkmcnt(3)
    v_mfma_f32_16x16x32_bf16 v[16:19], v[116:119], v[152:155], v[16:19]
    ds_read_b128 v[112:115], v0 offset:9216
    v_mfma_f32_16x16x32_bf16 v[20:23], v[116:119], v[184:187], v[20:23]
    s_add_u32 m0, s42, 16128
    v_mfma_f32_16x16x32_bf16 v[24:27], v[116:119], v[216:219], v[24:27]
    buffer_load_dwordx4 v7, s[16:19], s48 offen offset:256 lds
    v_mfma_f32_16x16x32_bf16 v[28:31], v[116:119], v[248:251], v[28:31]
    s_waitcnt lgkmcnt(3)
    v_mfma_f32_16x16x32_bf16 v[16:19], v[96:99], v[156:159], v[16:19]
    ds_read_b128 v[116:119], v1 offset:9216
    v_mfma_f32_16x16x32_bf16 v[20:23], v[96:99], v[188:191], v[20:23]
    s_add_u32 m0, s42, 17024
    v_mfma_f32_16x16x32_bf16 v[24:27], v[96:99], v[220:223], v[24:27]
    buffer_load_dwordx4 v7, s[16:19], s48 offen offset:384 lds
    v_mfma_f32_16x16x32_bf16 v[28:31], v[96:99], v[252:255], v[28:31]
    s_waitcnt lgkmcnt(3)
    v_mfma_f32_16x16x32_bf16 v[32:35], v[104:107], v[128:131], v[80:83]
    ds_read_b128 v[100:103], v0 offset:10240
    v_mfma_f32_16x16x32_bf16 v[36:39], v[104:107], v[160:163], v[84:87]
    v_exp_f32_e64 v120, v16
    v_mfma_f32_16x16x32_bf16 v[40:43], v[104:107], v[192:195], v[88:91]
    v_exp_f32_e64 v121, v17
    v_mfma_f32_16x16x32_bf16 v[44:47], v[104:107], v[224:227], v[92:95]
    v_add_f32_e64 v12, v120, v121
    v_cvt_pk_bf16_f32 v64, v120, v121
    s_waitcnt lgkmcnt(3)
    v_mfma_f32_16x16x32_bf16 v[32:35], v[108:111], v[132:135], v[32:35]
    ds_read_b128 v[104:107], v1 offset:10240
    v_mfma_f32_16x16x32_bf16 v[36:39], v[108:111], v[164:167], v[36:39]
    s_add_u32 m0, s42, 18432
    v_mfma_f32_16x16x32_bf16 v[40:43], v[108:111], v[196:199], v[40:43]
    buffer_load_dwordx4 v7, s[16:19], s48 offen offset:0 lds
    v_mfma_f32_16x16x32_bf16 v[44:47], v[108:111], v[228:231], v[44:47]
    s_waitcnt lgkmcnt(3)
    v_mfma_f32_16x16x32_bf16 v[32:35], v[112:115], v[136:139], v[32:35]
    ds_read_b128 v[108:111], v0 offset:11264
    v_exp_f32_e64 v122, v18
    v_mfma_f32_16x16x32_bf16 v[36:39], v[112:115], v[168:171], v[36:39]
    v_add_f32_e64 v12, v12, v122
    v_mfma_f32_16x16x32_bf16 v[40:43], v[112:115], v[200:203], v[40:43]
    v_exp_f32_e64 v123, v19
    v_mfma_f32_16x16x32_bf16 v[44:47], v[112:115], v[232:235], v[44:47]
    v_add_f32 v12, v12, v123
    s_waitcnt lgkmcnt(3)
    v_mfma_f32_16x16x32_bf16 v[32:35], v[116:119], v[140:143], v[32:35]
    ds_read_b128 v[112:115], v1 offset:11264
    v_cvt_pk_bf16_f32 v65, v122, v123
    v_mfma_f32_16x16x32_bf16 v[36:39], v[116:119], v[172:175], v[36:39]
    s_add_u32 m0, s42, 19328
    v_add_u32 v0, s49, v0
    v_add_u32 v1, s49, v1
    v_mfma_f32_16x16x32_bf16 v[40:43], v[116:119], v[204:207], v[40:43]
    buffer_load_dwordx4 v7, s[16:19], s48 offen offset:128 lds
    v_mfma_f32_16x16x32_bf16 v[44:47], v[116:119], v[236:239], v[44:47]
    s_add_u32 s48, s48, 32768
    s_waitcnt lgkmcnt(3)
    v_mfma_f32_16x16x32_bf16 v[32:35], v[100:103], v[144:147], v[32:35]
    ds_read_b64_tr_b16 v[96:97], v2 offset:0
    v_mfma_f32_16x16x32_bf16 v[36:39], v[100:103], v[176:179], v[36:39]
    ds_read_b64_tr_b16 v[98:99], v2 offset:8192
    v_mfma_f32_16x16x32_bf16 v[40:43], v[100:103], v[208:211], v[40:43]
    v_exp_f32 v124, v20
    v_mfma_f32_16x16x32_bf16 v[44:47], v[100:103], v[240:243], v[44:47]
    v_exp_f32 v125, v21
    s_waitcnt lgkmcnt(4)
    v_mfma_f32_16x16x32_bf16 v[32:35], v[104:107], v[148:151], v[32:35]
    ds_read_b64_tr_b16 v[100:101], v3 offset:0
    v_add_f32_e64 v13, v124, v125
    v_mfma_f32_16x16x32_bf16 v[36:39], v[104:107], v[180:183], v[36:39]
    ds_read_b64_tr_b16 v[102:103], v3 offset:8192
    v_cvt_pk_bf16_f32 v68, v124, v125
    v_mfma_f32_16x16x32_bf16 v[40:43], v[104:107], v[212:215], v[40:43]
    v_exp_f32_e64 v120, v22
    v_mfma_f32_16x16x32_bf16 v[44:47], v[104:107], v[244:247], v[44:47]
    v_add_f32 v13, v13, v120
    s_waitcnt lgkmcnt(5)
    v_mfma_f32_16x16x32_bf16 v[32:35], v[108:111], v[152:155], v[32:35]
    ds_read_b64_tr_b16 v[104:105], v4 offset:0
    v_exp_f32_e64 v121, v23
    v_mfma_f32_16x16x32_bf16 v[36:39], v[108:111], v[184:187], v[36:39]
    ds_read_b64_tr_b16 v[106:107], v4 offset:8192
    v_add_f32_e64 v13, v13, v121
    v_mfma_f32_16x16x32_bf16 v[40:43], v[108:111], v[216:219], v[40:43]
    v_cvt_pk_bf16_f32 v69, v120, v121
    v_mfma_f32_16x16x32_bf16 v[44:47], v[108:111], v[248:251], v[44:47]
    s_waitcnt lgkmcnt(6)
    v_mfma_f32_16x16x32_bf16 v[32:35], v[112:115], v[156:159], v[32:35]
    ds_read_b64_tr_b16 v[108:109], v5 offset:0
    v_mfma_f32_16x16x32_bf16 v[36:39], v[112:115], v[188:191], v[36:39]
    ds_read_b64_tr_b16 v[110:111], v5 offset:8192
    v_exp_f32 v122, v24
    v_mfma_f32_16x16x32_bf16 v[40:43], v[112:115], v[220:223], v[40:43]
    v_exp_f32_e64 v123, v25
    v_mfma_f32_16x16x32_bf16 v[44:47], v[112:115], v[252:255], v[44:47]
    v_add_f32 v14, v122, v123
    s_waitcnt lgkmcnt(4)
    v_mfma_f32_16x16x32_bf16 a[16:19], v[100:103], v[48:51], a[16:19]
    ds_read_b64_tr_b16 v[112:113], v2 offset:1024
    v_cvt_pk_bf16_f32 v72, v122, v123
    v_mfma_f32_16x16x32_bf16 a[0:3], v[96:99], v[48:51], a[0:3]
    ds_read_b64_tr_b16 v[114:115], v2 offset:9216
    v_mfma_f32_16x16x32_bf16 a[4:7], v[96:99], v[52:55], a[4:7]
    ds_read_b64_tr_b16 v[116:117], v3 offset:1024
    v_exp_f32_e64 v124, v26
    v_mfma_f32_16x16x32_bf16 a[20:23], v[100:103], v[52:55], a[20:23]
    ds_read_b64_tr_b16 v[118:119], v3 offset:9216
    v_add_f32_e64 v14, v14, v124
    v_mfma_f32_16x16x32_bf16 a[24:27], v[100:103], v[56:59], a[24:27]
    v_exp_f32_e64 v125, v27
    v_mfma_f32_16x16x32_bf16 a[8:11], v[96:99], v[56:59], a[8:11]
    v_add_f32_e64 v14, v14, v125
    v_cvt_pk_bf16_f32 v73, v124, v125
    v_mfma_f32_16x16x32_bf16 a[12:15], v[96:99], v[60:63], a[12:15]
    v_exp_f32_e64 v120, v28
    v_mfma_f32_16x16x32_bf16 a[28:31], v[100:103], v[60:63], a[28:31]
    v_exp_f32 v121, v29
    s_waitcnt lgkmcnt(4)
    v_mfma_f32_16x16x32_bf16 a[48:51], v[108:111], v[48:51], a[48:51]
    ds_read_b64_tr_b16 v[96:97], v4 offset:1024
    v_add_f32_e64 v15, v120, v121
    v_mfma_f32_16x16x32_bf16 a[32:35], v[104:107], v[48:51], a[32:35]
    ds_read_b64_tr_b16 v[98:99], v4 offset:9216
    v_cvt_pk_bf16_f32 v76, v120, v121
    v_mfma_f32_16x16x32_bf16 a[36:39], v[104:107], v[52:55], a[36:39]
    ds_read_b64_tr_b16 v[100:101], v5 offset:1024
    v_mfma_f32_16x16x32_bf16 a[52:55], v[108:111], v[52:55], a[52:55]
    ds_read_b64_tr_b16 v[102:103], v5 offset:9216
    v_mfma_f32_16x16x32_bf16 a[56:59], v[108:111], v[56:59], a[56:59]
    v_exp_f32_e64 v122, v30
    v_mfma_f32_16x16x32_bf16 a[40:43], v[104:107], v[56:59], a[40:43]
    v_add_f32 v15, v15, v122
    v_exp_f32 v123, v31
    v_mfma_f32_16x16x32_bf16 a[44:47], v[104:107], v[60:63], a[44:47]
    v_add_f32_e64 v15, v15, v123
    v_cvt_pk_bf16_f32 v77, v122, v123
    v_mfma_f32_16x16x32_bf16 a[60:63], v[108:111], v[60:63], a[60:63]
    s_waitcnt lgkmcnt(4)
    v_mfma_f32_16x16x32_bf16 a[80:83], v[116:119], v[48:51], a[80:83]
    ds_read_b64_tr_b16 v[104:105], v2 offset:2048
    v_mfma_f32_16x16x32_bf16 a[64:67], v[112:115], v[48:51], a[64:67]
    ds_read_b64_tr_b16 v[106:107], v2 offset:10240
    v_mfma_f32_16x16x32_bf16 a[68:71], v[112:115], v[52:55], a[68:71]
    ds_read_b64_tr_b16 v[108:109], v3 offset:2048
    v_exp_f32 v124, v32
    v_mfma_f32_16x16x32_bf16 a[84:87], v[116:119], v[52:55], a[84:87]
    ds_read_b64_tr_b16 v[110:111], v3 offset:10240
    v_add_f32_e64 v12, v12, v124
    v_mfma_f32_16x16x32_bf16 a[88:91], v[116:119], v[56:59], a[88:91]
    v_exp_f32_e64 v125, v33
    v_mfma_f32_16x16x32_bf16 a[72:75], v[112:115], v[56:59], a[72:75]
    v_add_f32_e64 v12, v12, v125
    v_cvt_pk_bf16_f32 v66, v124, v125
    v_mfma_f32_16x16x32_bf16 a[76:79], v[112:115], v[60:63], a[76:79]
    v_exp_f32_e64 v120, v34
    v_mfma_f32_16x16x32_bf16 a[92:95], v[116:119], v[60:63], a[92:95]
    v_add_f32 v12, v12, v120
    s_waitcnt lgkmcnt(4)
    v_mfma_f32_16x16x32_bf16 a[112:115], v[100:103], v[48:51], a[112:115]
    ds_read_b64_tr_b16 v[112:113], v4 offset:2048
    v_exp_f32_e64 v121, v35
    v_mfma_f32_16x16x32_bf16 a[96:99], v[96:99], v[48:51], a[96:99]
    ds_read_b64_tr_b16 v[114:115], v4 offset:10240
    v_add_f32_e64 v12, v12, v121
    v_mfma_f32_16x16x32_bf16 a[100:103], v[96:99], v[52:55], a[100:103]
    ds_read_b64_tr_b16 v[116:117], v5 offset:2048
    v_cvt_pk_bf16_f32 v67, v120, v121
    v_mfma_f32_16x16x32_bf16 a[116:119], v[100:103], v[52:55], a[116:119]
    ds_read_b64_tr_b16 v[118:119], v5 offset:10240
    v_mfma_f32_16x16x32_bf16 a[120:123], v[100:103], v[56:59], a[120:123]
    v_exp_f32_e64 v122, v36
    v_mfma_f32_16x16x32_bf16 a[104:107], v[96:99], v[56:59], a[104:107]
    v_add_f32 v13, v13, v122
    v_exp_f32 v123, v37
    v_mfma_f32_16x16x32_bf16 a[108:111], v[96:99], v[60:63], a[108:111]
    v_add_f32_e64 v13, v13, v123
    v_cvt_pk_bf16_f32 v70, v122, v123
    v_mfma_f32_16x16x32_bf16 a[124:127], v[100:103], v[60:63], a[124:127]
    s_waitcnt lgkmcnt(4)
    v_mfma_f32_16x16x32_bf16 a[144:147], v[108:111], v[48:51], a[144:147]
    ds_read_b64_tr_b16 v[96:97], v2 offset:3072
    v_mfma_f32_16x16x32_bf16 a[128:131], v[104:107], v[48:51], a[128:131]
    ds_read_b64_tr_b16 v[98:99], v2 offset:11264
    v_mfma_f32_16x16x32_bf16 a[132:135], v[104:107], v[52:55], a[132:135]
    ds_read_b64_tr_b16 v[100:101], v3 offset:3072
    v_exp_f32 v124, v38
    v_mfma_f32_16x16x32_bf16 a[148:151], v[108:111], v[52:55], a[148:151]
    ds_read_b64_tr_b16 v[102:103], v3 offset:11264
    v_add_f32_e64 v13, v13, v124
    v_mfma_f32_16x16x32_bf16 a[152:155], v[108:111], v[56:59], a[152:155]
    v_exp_f32_e64 v125, v39
    v_mfma_f32_16x16x32_bf16 a[136:139], v[104:107], v[56:59], a[136:139]
    v_add_f32_e64 v13, v13, v125
    v_cvt_pk_bf16_f32 v71, v124, v125
    v_mfma_f32_16x16x32_bf16 a[140:143], v[104:107], v[60:63], a[140:143]
    v_exp_f32_e64 v120, v40
    v_mfma_f32_16x16x32_bf16 a[156:159], v[108:111], v[60:63], a[156:159]
    v_add_f32 v14, v14, v120
    s_waitcnt lgkmcnt(4)
    v_mfma_f32_16x16x32_bf16 a[176:179], v[116:119], v[48:51], a[176:179]
    ds_read_b64_tr_b16 v[104:105], v4 offset:3072
    v_exp_f32_e64 v121, v41
    v_mfma_f32_16x16x32_bf16 a[160:163], v[112:115], v[48:51], a[160:163]
    ds_read_b64_tr_b16 v[106:107], v4 offset:11264
    v_add_f32_e64 v14, v14, v121
    v_mfma_f32_16x16x32_bf16 a[164:167], v[112:115], v[52:55], a[164:167]
    ds_read_b64_tr_b16 v[108:109], v5 offset:3072
    v_cvt_pk_bf16_f32 v74, v120, v121
    v_mfma_f32_16x16x32_bf16 a[180:183], v[116:119], v[52:55], a[180:183]
    ds_read_b64_tr_b16 v[110:111], v5 offset:11264
    v_mfma_f32_16x16x32_bf16 a[184:187], v[116:119], v[56:59], a[184:187]
    v_exp_f32_e64 v122, v42
    v_mfma_f32_16x16x32_bf16 a[168:171], v[112:115], v[56:59], a[168:171]
    v_add_f32 v14, v14, v122
    v_exp_f32 v123, v43
    v_mfma_f32_16x16x32_bf16 a[172:175], v[112:115], v[60:63], a[172:175]
    v_add_f32_e64 v14, v14, v123
    v_cvt_pk_bf16_f32 v75, v122, v123
    v_mfma_f32_16x16x32_bf16 a[188:191], v[116:119], v[60:63], a[188:191]
    v_add_u32 v2, s50, v2
    s_waitcnt lgkmcnt(4)
    v_mfma_f32_16x16x32_bf16 a[208:211], v[100:103], v[48:51], a[208:211]
    v_exp_f32_e64 v124, v44
    v_mfma_f32_16x16x32_bf16 a[192:195], v[96:99], v[48:51], a[192:195]
    v_add_f32 v15, v15, v124
    v_add_u32 v3, s50, v3
    v_mfma_f32_16x16x32_bf16 a[196:199], v[96:99], v[52:55], a[196:199]
    v_exp_f32 v125, v45
    v_add_u32 v4, s50, v4
    v_mfma_f32_16x16x32_bf16 a[212:215], v[100:103], v[52:55], a[212:215]
    v_add_f32_e64 v15, v15, v125
    v_cvt_pk_bf16_f32 v78, v124, v125
    v_mfma_f32_16x16x32_bf16 a[216:219], v[100:103], v[56:59], a[216:219]
    v_exp_f32_e64 v120, v46
    v_mfma_f32_16x16x32_bf16 a[200:203], v[96:99], v[56:59], a[200:203]
    v_add_f32 v15, v15, v120
    v_add_u32 v5, s50, v5
    v_mfma_f32_16x16x32_bf16 a[204:207], v[96:99], v[60:63], a[204:207]
    v_exp_f32_e64 v121, v47
    v_mfma_f32_16x16x32_bf16 a[220:223], v[100:103], v[60:63], a[220:223]
    v_add_f32_e64 v15, v15, v121
    v_cvt_pk_bf16_f32 v79, v120, v121
    s_waitcnt lgkmcnt(0)
    v_mfma_f32_16x16x32_bf16 a[240:243], v[108:111], v[48:51], a[240:243]
    v_mfma_f32_16x16x32_bf16 a[224:227], v[104:107], v[48:51], a[224:227]
    v_max3_f32 v120, v12, v13, v14
    v_mfma_f32_16x16x32_bf16 a[228:231], v[104:107], v[52:55], a[228:231]
    v_mfma_f32_16x16x32_bf16 a[244:247], v[108:111], v[52:55], a[244:247]
    v_max_f32 v120, v120, v15
    v_cmp_nge_f32 vcc, s52, v120
    v_mfma_f32_16x16x32_bf16 a[248:251], v[108:111], v[56:59], a[248:251]
    v_mfma_f32_16x16x32_bf16 a[232:235], v[104:107], v[56:59], a[232:235]
    v_mfma_f32_16x16x32_bf16 a[236:239], v[104:107], v[60:63], a[236:239]
    v_mfma_f32_16x16x32_bf16 a[252:255], v[108:111], v[60:63], a[252:255]
    s_cbranch_vccnz L_rare_e
L_back_e:
    s_load_dwordx2 s[58:59], s[0:1], 56
    s_load_dwordx2 s[64:65], s[0:1], 72
    s_load_dwordx2 s[62:63], s[0:1], 96
    v_add_f32 v81, v8, v12
    v_add_f32 v85, v9, v13
    v_add_f32 v89, v10, v14
    v_add_f32 v93, v11, v15
    v_mbcnt_lo_u32_b32 v16, -1, 0
    v_mbcnt_hi_u32_b32 v16, -1, v16
    s_lshl_b32 s37, s5, 11
    s_add_u32 s37, s37, 98304
    v_lshlrev_b32 v0, 3, v16
    v_add_u32_e64 v0, s37, v0
    ds_write_b64 v0, v[80:81] offset:0
    ds_write_b64 v0, v[84:85] offset:512
    ds_write_b64 v0, v[88:89] offset:1024
    ds_write_b64 v0, v[92:93] offset:1536
    v_xor_b32 v1, 2048, v0
    s_waitcnt vmcnt(0)
    s_waitcnt lgkmcnt(0)
    s_barrier
    ds_read_b64 v[82:83], v1 offset:0
    ds_read_b64 v[86:87], v1 offset:512
    ds_read_b64 v[90:91], v1 offset:1024
    ds_read_b64 v[94:95], v1 offset:1536
    ds_read_b64_tr_b16 v[96:97], v2 offset:2048
    ds_read_b64_tr_b16 v[98:99], v2 offset:10240
    ds_read_b64_tr_b16 v[100:101], v3 offset:2048
    ds_read_b64_tr_b16 v[102:103], v3 offset:10240
    ds_read_b64_tr_b16 v[104:105], v4 offset:2048
    ds_read_b64_tr_b16 v[106:107], v4 offset:10240
    ds_read_b64_tr_b16 v[108:109], v5 offset:2048
    ds_read_b64_tr_b16 v[110:111], v5 offset:10240
    s_waitcnt lgkmcnt(4)
    v_mfma_f32_16x16x32_bf16 a[144:147], v[100:103], v[64:67], a[144:147]
    ds_read_b64_tr_b16 v[112:113], v2 offset:3072
    v_lshlrev_b32 v30, 4, v16
    s_lshl_b32 s43, s5, 15
    v_mfma_f32_16x16x32_bf16 a[128:131], v[96:99], v[64:67], a[128:131]
    ds_read_b64_tr_b16 v[114:115], v2 offset:11264
    v_add_u32 v36, s43, v30
    v_min_u32 v60, 55, v16
    v_mfma_f32_16x16x32_bf16 a[132:135], v[96:99], v[68:71], a[132:135]
    v_lshlrev_b32_e64 v60, 2, v60
    s_mov_b32 s38, 45056
    buffer_load_dword v61, v60, s[28:31], s38 offen sc0 sc1
    v_mfma_f32_16x16x32_bf16 a[148:151], v[100:103], v[68:71], a[148:151]
    v_min_f32 v38, v80, v82
    v_sub_f32 v80, v38, v80
    v_mfma_f32_16x16x32_bf16 a[152:155], v[100:103], v[72:75], a[152:155]
    ds_read_b64_tr_b16 v[116:117], v3 offset:3072
    v_sub_f32_e64 v82, v38, v82
    v_mfma_f32_16x16x32_bf16 a[136:139], v[96:99], v[72:75], a[136:139]
    ds_read_b64_tr_b16 v[118:119], v3 offset:11264
    v_exp_f32_e64 v80, v80
    v_mfma_f32_16x16x32_bf16 a[140:143], v[96:99], v[76:79], a[140:143]
    v_mov_b32 v39, v95
    s_barrier
    v_mfma_f32_16x16x32_bf16 a[156:159], v[100:103], v[76:79], a[156:159]
    ds_write_b128 v36, a[144:147] offset:4096
    s_waitcnt lgkmcnt(5)
    v_mfma_f32_16x16x32_bf16 a[176:179], v[108:111], v[64:67], a[176:179]
    ds_read_b64_tr_b16 v[96:97], v4 offset:3072
    ds_write_b128 v36, a[128:131] offset:0
    v_mfma_f32_16x16x32_bf16 a[160:163], v[104:107], v[64:67], a[160:163]
    ds_read_b64_tr_b16 v[98:99], v4 offset:11264
    ds_write_b128 v36, a[132:135] offset:1024
    v_mfma_f32_16x16x32_bf16 a[164:167], v[104:107], v[68:71], a[164:167]
    ds_write_b128 v36, a[148:151] offset:5120
    v_exp_f32 v82, v82
    v_mfma_f32_16x16x32_bf16 a[180:183], v[108:111], v[68:71], a[180:183]
    ds_write_b128 v36, a[152:155] offset:6144
    v_mul_f32_e64 v81, v81, v80
    v_mfma_f32_16x16x32_bf16 a[184:187], v[108:111], v[72:75], a[184:187]
    ds_read_b64_tr_b16 v[100:101], v5 offset:3072
    ds_write_b128 v36, a[136:139] offset:2048
    v_fmac_f32 v81, v83, v82
    v_mfma_f32_16x16x32_bf16 a[168:171], v[104:107], v[72:75], a[168:171]
    ds_read_b64_tr_b16 v[102:103], v5 offset:11264
    ds_write_b128 v36, a[140:143] offset:3072
    v_mov_b32 v83, v81
    v_mfma_f32_16x16x32_bf16 a[172:175], v[104:107], v[76:79], a[172:175]
    ds_write_b128 v36, a[156:159] offset:7168
    v_permlane16_swap_b32 v81, v83
    v_add_f32 v81, v81, v83
    v_mfma_f32_16x16x32_bf16 a[188:191], v[108:111], v[76:79], a[188:191]
    ds_write_b128 v36, a[176:179] offset:12288
    v_mov_b32 v83, v81
    s_waitcnt lgkmcnt(13)
    v_mfma_f32_16x16x32_bf16 a[208:211], v[116:119], v[64:67], a[208:211]
    ds_read_b64_tr_b16 v[104:105], v2 offset:0
    ds_write_b128 v36, a[160:163] offset:8192
    v_permlane32_swap_b32 v81, v83
    v_mfma_f32_16x16x32_bf16 a[192:195], v[112:115], v[64:67], a[192:195]
    ds_read_b64_tr_b16 v[106:107], v2 offset:8192
    ds_write_b128 v36, a[164:167] offset:9216
    v_add_f32 v81, v81, v83
    v_mfma_f32_16x16x32_bf16 a[196:199], v[112:115], v[68:71], a[196:199]
    ds_write_b128 v36, a[180:183] offset:13312
    v_rcp_f32_e64 v81, v81
    v_mfma_f32_16x16x32_bf16 a[212:215], v[116:119], v[68:71], a[212:215]
    ds_write_b128 v36, a[184:187] offset:14336
    v_mul_f32_e64 v40, v80, v81
    v_mfma_f32_16x16x32_bf16 a[216:219], v[116:119], v[72:75], a[216:219]
    ds_read_b64_tr_b16 v[108:109], v3 offset:0
    ds_write_b128 v36, a[168:171] offset:10240
    v_mul_f32_e64 v41, v80, v81
    v_mfma_f32_16x16x32_bf16 a[200:203], v[112:115], v[72:75], a[200:203]
    ds_read_b64_tr_b16 v[110:111], v3 offset:8192
    ds_write_b128 v36, a[172:175] offset:11264
    v_mul_f32_e64 v42, v82, v81
    v_mfma_f32_16x16x32_bf16 a[204:207], v[112:115], v[76:79], a[204:207]
    ds_write_b128 v36, a[188:191] offset:15360
    v_mul_f32 v43, v82, v81
    v_min_f32 v38, v84, v86
    v_mfma_f32_16x16x32_bf16 a[220:223], v[116:119], v[76:79], a[220:223]
    ds_write_b128 v36, a[208:211] offset:20480
    v_sub_f32 v84, v38, v84
    s_waitcnt lgkmcnt(15)
    v_mfma_f32_16x16x32_bf16 a[240:243], v[100:103], v[64:67], a[240:243]
    ds_read_b64_tr_b16 v[112:113], v4 offset:0
    ds_write_b128 v36, a[192:195] offset:16384
    v_sub_f32_e64 v86, v38, v86
    v_mfma_f32_16x16x32_bf16 a[224:227], v[96:99], v[64:67], a[224:227]
    ds_read_b64_tr_b16 v[114:115], v4 offset:8192
    ds_write_b128 v36, a[196:199] offset:17408
    v_mfma_f32_16x16x32_bf16 a[228:231], v[96:99], v[68:71], a[228:231]
    ds_write_b128 v36, a[212:215] offset:21504
    v_exp_f32_e64 v84, v84
    v_mfma_f32_16x16x32_bf16 a[244:247], v[100:103], v[68:71], a[244:247]
    ds_write_b128 v36, a[216:219] offset:22528
    v_mfma_f32_16x16x32_bf16 a[248:251], v[100:103], v[72:75], a[248:251]
    ds_read_b64_tr_b16 v[116:117], v5 offset:0
    ds_write_b128 v36, a[200:203] offset:18432
    v_mfma_f32_16x16x32_bf16 a[232:235], v[96:99], v[72:75], a[232:235]
    ds_read_b64_tr_b16 v[118:119], v5 offset:8192
    ds_write_b128 v36, a[204:207] offset:19456
    v_mfma_f32_16x16x32_bf16 a[236:239], v[96:99], v[76:79], a[236:239]
    ds_write_b128 v36, a[220:223] offset:23552
    v_exp_f32_e64 v86, v86
    v_mfma_f32_16x16x32_bf16 a[252:255], v[100:103], v[76:79], a[252:255]
    ds_write_b128 v36, a[240:243] offset:28672
    v_mul_f32 v85, v85, v84
    s_waitcnt lgkmcnt(15)
    v_mfma_f32_16x16x32_bf16 a[16:19], v[108:111], v[64:67], a[16:19]
    ds_read_b64_tr_b16 v[96:97], v2 offset:1024
    ds_write_b128 v36, a[224:227] offset:24576
    v_fmac_f32 v85, v87, v86
    v_mfma_f32_16x16x32_bf16 a[0:3], v[104:107], v[64:67], a[0:3]
    ds_read_b64_tr_b16 v[98:99], v2 offset:9216
    ds_write_b128 v36, a[228:231] offset:25600
    v_mov_b32 v87, v85
    v_mfma_f32_16x16x32_bf16 a[4:7], v[104:107], v[68:71], a[4:7]
    ds_write_b128 v36, a[244:247] offset:29696
    v_permlane16_swap_b32 v85, v87
    v_add_f32 v85, v85, v87
    v_mfma_f32_16x16x32_bf16 a[20:23], v[108:111], v[68:71], a[20:23]
    ds_write_b128 v36, a[248:251] offset:30720
    v_mov_b32_e64 v87, v85
    v_mfma_f32_16x16x32_bf16 a[24:27], v[108:111], v[72:75], a[24:27]
    ds_read_b64_tr_b16 v[100:101], v3 offset:1024
    ds_write_b128 v36, a[232:235] offset:26624
    v_permlane32_swap_b32 v85, v87
    v_mfma_f32_16x16x32_bf16 a[8:11], v[104:107], v[72:75], a[8:11]
    ds_read_b64_tr_b16 v[102:103], v3 offset:9216
    ds_write_b128 v36, a[236:239] offset:27648
    v_add_f32 v85, v85, v87
    v_mfma_f32_16x16x32_bf16 a[12:15], v[104:107], v[76:79], a[12:15]
    ds_write_b128 v36, a[252:255] offset:31744
    v_rcp_f32_e64 v85, v85
    v_mfma_f32_16x16x32_bf16 a[28:31], v[108:111], v[76:79], a[28:31]
    v_mul_f32 v44, v84, v85
    v_mul_f32 v45, v84, v85
    s_waitcnt lgkmcnt(14)
    v_mfma_f32_16x16x32_bf16 a[48:51], v[116:119], v[64:67], a[48:51]
    ds_read_b64_tr_b16 v[104:105], v4 offset:1024
    v_mul_f32 v46, v86, v85
    v_mul_f32_e64 v47, v86, v85
    v_mfma_f32_16x16x32_bf16 a[32:35], v[112:115], v[64:67], a[32:35]
    ds_read_b64_tr_b16 v[106:107], v4 offset:9216
    v_min_f32 v38, v88, v90
    v_sub_f32 v88, v38, v88
    v_mfma_f32_16x16x32_bf16 a[36:39], v[112:115], v[68:71], a[36:39]
    v_sub_f32 v90, v38, v90
    v_exp_f32 v88, v88
    v_mfma_f32_16x16x32_bf16 a[52:55], v[116:119], v[68:71], a[52:55]
    v_exp_f32_e64 v90, v90
    v_mfma_f32_16x16x32_bf16 a[56:59], v[116:119], v[72:75], a[56:59]
    ds_read_b64_tr_b16 v[108:109], v5 offset:1024
    v_mul_f32 v89, v89, v88
    v_fmac_f32 v89, v91, v90
    v_mfma_f32_16x16x32_bf16 a[40:43], v[112:115], v[72:75], a[40:43]
    ds_read_b64_tr_b16 v[110:111], v5 offset:9216
    v_mov_b32 v91, v89
    s_nop 1
    v_permlane16_swap_b32 v89, v91
    v_mfma_f32_16x16x32_bf16 a[44:47], v[112:115], v[76:79], a[44:47]
    v_add_f32 v89, v89, v91
    v_mov_b32 v91, v89
    s_nop 1
    v_permlane32_swap_b32 v89, v91
    v_mfma_f32_16x16x32_bf16 a[60:63], v[116:119], v[76:79], a[60:63]
    v_add_f32 v89, v89, v91
    s_waitcnt lgkmcnt(6)
    v_mfma_f32_16x16x32_bf16 a[80:83], v[100:103], v[64:67], a[80:83]
    v_rcp_f32 v89, v89
    s_nop 0
    v_mul_f32 v48, v88, v89
    v_mfma_f32_16x16x32_bf16 a[64:67], v[96:99], v[64:67], a[64:67]
    v_mul_f32 v49, v88, v89
    v_mul_f32 v50, v90, v89
    v_mul_f32_e64 v51, v90, v89
    v_mfma_f32_16x16x32_bf16 a[68:71], v[96:99], v[68:71], a[68:71]
    v_min_f32 v38, v92, v94
    v_sub_f32 v92, v38, v92
    v_sub_f32_e64 v94, v38, v94
    v_mfma_f32_16x16x32_bf16 a[84:87], v[100:103], v[68:71], a[84:87]
    v_exp_f32_e64 v92, v92
    v_mfma_f32_16x16x32_bf16 a[88:91], v[100:103], v[72:75], a[88:91]
    v_exp_f32 v94, v94
    v_mul_f32 v93, v93, v92
    v_mfma_f32_16x16x32_bf16 a[72:75], v[96:99], v[72:75], a[72:75]
    v_fmac_f32 v93, v95, v94
    v_mov_b32 v95, v93
    s_nop 1
    v_permlane16_swap_b32 v93, v95
    v_mfma_f32_16x16x32_bf16 a[76:79], v[96:99], v[76:79], a[76:79]
    v_add_f32 v93, v93, v95
    v_mov_b32 v95, v93
    s_nop 1
    v_permlane32_swap_b32 v93, v95
    v_mfma_f32_16x16x32_bf16 a[92:95], v[100:103], v[76:79], a[92:95]
    v_add_f32 v93, v93, v95
    s_waitcnt lgkmcnt(0)
    v_mfma_f32_16x16x32_bf16 a[112:115], v[108:111], v[64:67], a[112:115]
    v_rcp_f32 v93, v93
    s_nop 0
    v_mul_f32_e64 v52, v92, v93
    v_mfma_f32_16x16x32_bf16 a[96:99], v[104:107], v[64:67], a[96:99]
    v_mul_f32 v53, v92, v93
    v_mul_f32 v54, v94, v93
    v_mul_f32_e64 v55, v94, v93
    v_mfma_f32_16x16x32_bf16 a[100:103], v[104:107], v[68:71], a[100:103]
    s_xor_b32 s44, s43, 32768
    v_add_u32 v37, s44, v30
    s_lshl_b32 s40, s5, 13
    v_mfma_f32_16x16x32_bf16 a[116:119], v[108:111], v[68:71], a[116:119]
    s_add_u32 s40, s40, 131072
    s_mul_i32 s45, s3, 458752
    v_mfma_f32_16x16x32_bf16 a[120:123], v[108:111], v[72:75], a[120:123]
    s_mul_i32 s37, s5, 224
    v_add_u32_e64 v38, 0, v16
    v_mul_u32_u24 v39, 4682, v38
    v_mfma_f32_16x16x32_bf16 a[104:107], v[104:107], v[72:75], a[104:107]
    v_lshrrev_b32_e64 v39, 16, v39
    v_mul_u32_u24 v20, 672, v39
    v_lshl_add_u32 v20, v38, 4, v20
    v_mfma_f32_16x16x32_bf16 a[108:111], v[104:107], v[76:79], a[108:111]
    v_add_u32 v20, s37, v20
    v_add_u32 v38, 64, v16
    v_mul_u32_u24 v39, 4682, v38
    v_mfma_f32_16x16x32_bf16 a[124:127], v[108:111], v[76:79], a[124:127]
    v_lshrrev_b32_e64 v39, 16, v39
    v_mul_u32_u24 v21, 672, v39
    v_lshl_add_u32 v21, v38, 4, v21
    v_add_u32_e64 v21, s37, v21
    v_add_u32 v38, 128, v16
    v_mul_u32_u24 v39, 4682, v38
    v_lshrrev_b32_e64 v39, 16, v39
    v_mul_u32_u24 v22, 672, v39
    v_lshl_add_u32 v22, v38, 4, v22
    v_add_u32_e64 v22, s37, v22
    v_add_u32 v38, 192, v16
    v_mul_u32_u24 v39, 4682, v38
    v_lshrrev_b32_e64 v39, 16, v39
    v_mul_u32_u24 v23, 672, v39
    v_lshl_add_u32 v23, v38, 4, v23
    v_add_u32_e64 v23, s37, v23
    v_add_u32 v38, 256, v16
    v_mul_u32_u24 v39, 4682, v38
    v_lshrrev_b32_e64 v39, 16, v39
    v_mul_u32_u24 v24, 672, v39
    v_lshl_add_u32 v24, v38, 4, v24
    v_add_u32_e64 v24, s37, v24
    v_add_u32 v38, 320, v16
    v_mul_u32_u24 v39, 4682, v38
    v_lshrrev_b32_e64 v39, 16, v39
    v_mul_u32_u24 v25, 672, v39
    v_lshl_add_u32 v25, v38, 4, v25
    v_add_u32_e64 v25, s37, v25
    v_add_u32 v38, 384, v16
    v_mul_u32_u24 v39, 4682, v38
    v_lshrrev_b32_e64 v39, 16, v39
    v_mul_u32_u24 v26, 672, v39
    v_lshl_add_u32 v26, v38, 4, v26
    v_add_u32 v26, s37, v26
    s_waitcnt lgkmcnt(0)
    s_barrier
    ds_read_b128 v[128:131], v37 offset:0
    ds_read_b128 v[144:147], v37 offset:4096
    ds_read_b128 v[132:135], v37 offset:1024
    ds_read_b128 v[148:151], v37 offset:5120
    ds_read_b128 v[136:139], v37 offset:2048
    ds_read_b128 v[152:155], v37 offset:6144
    ds_read_b128 v[140:143], v37 offset:3072
    ds_read_b128 v[156:159], v37 offset:7168
    ds_read_b128 v[160:163], v37 offset:8192
    ds_read_b128 v[176:179], v37 offset:12288
    ds_read_b128 v[164:167], v37 offset:9216
    ds_read_b128 v[180:183], v37 offset:13312
    ds_read_b128 v[168:171], v37 offset:10240
    ds_read_b128 v[184:187], v37 offset:14336
    ds_read_b128 v[172:175], v37 offset:11264
    ds_read_b128 v[188:191], v37 offset:15360
    ds_read_b128 v[192:195], v37 offset:16384
    ds_read_b128 v[208:211], v37 offset:20480
    ds_read_b128 v[196:199], v37 offset:17408
    ds_read_b128 v[212:215], v37 offset:21504
    ds_read_b128 v[200:203], v37 offset:18432
    ds_read_b128 v[216:219], v37 offset:22528
    ds_read_b128 v[204:207], v37 offset:19456
    ds_read_b128 v[220:223], v37 offset:23552
    ds_read_b128 v[224:227], v37 offset:24576
    ds_read_b128 v[240:243], v37 offset:28672
    ds_read_b128 v[228:231], v37 offset:25600
    ds_read_b128 v[244:247], v37 offset:29696
    ds_read_b128 v[232:235], v37 offset:26624
    ds_read_b128 v[248:251], v37 offset:30720
    ds_read_b128 v[236:239], v37 offset:27648
    ds_read_b128 v[252:255], v37 offset:31744
    s_add_u32 m0, s40, 0
    s_add_u32 s37, s45, 0
    buffer_load_dwordx4 v20, s[24:27], s37 offen lds
    s_add_u32 m0, s40, 1024
    s_nop 0
    buffer_load_dwordx4 v21, s[24:27], s37 offen lds
    s_add_u32 m0, s40, 2048
    s_nop 0
    buffer_load_dwordx4 v22, s[24:27], s37 offen lds
    s_add_u32 m0, s40, 3072
    s_nop 0
    buffer_load_dwordx4 v23, s[24:27], s37 offen lds
    s_add_u32 m0, s40, 4096
    s_nop 0
    buffer_load_dwordx4 v24, s[24:27], s37 offen lds
    s_add_u32 m0, s40, 5120
    s_nop 0
    buffer_load_dwordx4 v25, s[24:27], s37 offen lds
    s_add_u32 m0, s40, 6144
    s_nop 0
    buffer_load_dwordx4 v26, s[24:27], s37 offen lds
    v_and_b32 v17, 15, v16
    v_lshrrev_b32 v18, 4, v16
    v_lshrrev_b32 v38, 2, v17
    v_lshl_add_u32 v38, v18, 2, v38
    v_mul_u32_u24 v38, 224, v38
    v_and_b32_e64 v39, 3, v17
    v_lshl_add_u32 v27, v39, 3, v38
    v_lshrrev_b32_e64 v38, 3, v17
    v_mul_u32_u24 v38, 57344, v38
    v_and_b32_e64 v39, 7, v17
    v_lshl_add_u32 v39, v18, 3, v39
    v_lshl_add_u32 v28, v39, 4, v38
    v_lshl_add_u32 v29, v39, 3, v38
    v_add_u32 v29, 1536, v29
    s_add_u32 s41, s44, 16384
    s_add_u32 s42, s44, 23552
    s_mul_i32 s46, s4, 458752
    s_mul_i32 s37, s3, 7168
    s_add_u32 s46, s46, s37
    s_mul_i32 s37, s5, 1792
    s_add_u32 s46, s46, s37
    v_add_u32 v33, s40, v27
    v_add_u32 v34, s41, v27
    v_add_u32_e64 v35, s42, v27
    v_add_u32 v31, 65536, v30
    s_mov_b32 s8, s68
    s_mov_b32 s9, s69
    s_mov_b32 s10, 1605632
    s_mov_b32 s11, 0x00020000
    s_mov_b32 s20, s70
    s_mov_b32 s21, s71
    s_mov_b32 s22, 1605632
    s_mov_b32 s23, 0x00020000
    s_lshl_b32 s38, s5, 6
    v_add_u32 v38, s38, v16
    s_mov_b32 s49, s3
    v_lshrrev_b32 v39, 3, v38
    v_mul_u32_u24 v39, 3584, v39
    v_and_b32_e64 v56, 7, v38
    v_lshl_add_u32 v39, v56, 6, v39
    v_cmp_gt_u32 vcc, 112, v38
    v_mov_b32 v57, 0x7fffffff
    s_nop 0
    v_cndmask_b32 v39, v57, v39, vcc
    s_mul_i32 s38, s4, 50176
    s_mul_i32 s39, s49, 448
    s_add_u32 s38, s38, s39
    buffer_load_dword v58, v39, s[8:11], s38 offen
    v_lshlrev_b32 v38, 6, v38
    v_cndmask_b32 v38, v57, v38, vcc
    s_lshl_b32 s38, s49, 5
    s_add_u32 s38, s38, s4
    s_mul_i32 s38, s38, 6272
    buffer_load_dword v59, v38, s[20:23], s38 offen
    v_accvgpr_read_b32 v64, a0
    v_accvgpr_read_b32 v65, a1
    v_accvgpr_read_b32 v66, a2
    v_accvgpr_read_b32 v67, a3
    v_accvgpr_read_b32 v68, a16
    v_accvgpr_read_b32 v69, a17
    v_accvgpr_read_b32 v70, a18
    v_accvgpr_read_b32 v71, a19
    v_accvgpr_read_b32 v72, a4
    v_accvgpr_read_b32 v73, a5
    v_accvgpr_read_b32 v74, a6
    v_accvgpr_read_b32 v75, a7
    v_accvgpr_read_b32 v76, a20
    v_accvgpr_read_b32 v77, a21
    v_accvgpr_read_b32 v78, a22
    v_accvgpr_read_b32 v79, a23
    v_accvgpr_read_b32 v80, a8
    v_accvgpr_read_b32 v81, a9
    v_accvgpr_read_b32 v82, a10
    v_accvgpr_read_b32 v83, a11
    v_accvgpr_read_b32 v84, a24
    v_accvgpr_read_b32 v85, a25
    v_accvgpr_read_b32 v86, a26
    v_accvgpr_read_b32 v87, a27
    v_accvgpr_read_b32 v88, a12
    v_accvgpr_read_b32 v89, a13
    v_accvgpr_read_b32 v90, a14
    v_accvgpr_read_b32 v91, a15
    v_accvgpr_read_b32 v92, a28
    v_accvgpr_read_b32 v93, a29
    v_accvgpr_read_b32 v94, a30
    v_accvgpr_read_b32 v95, a31
    v_pk_mul_f32 v[64:65], v[64:65], v[40:41]
    v_pk_mul_f32 v[66:67], v[66:67], v[40:41]
    v_pk_mul_f32 v[68:69], v[68:69], v[40:41]
    v_pk_mul_f32 v[70:71], v[70:71], v[40:41]
    v_pk_mul_f32 v[72:73], v[72:73], v[44:45]
    v_pk_mul_f32 v[74:75], v[74:75], v[44:45]
    v_pk_mul_f32 v[76:77], v[76:77], v[44:45]
    v_pk_mul_f32 v[78:79], v[78:79], v[44:45]
    v_pk_mul_f32 v[80:81], v[80:81], v[48:49]
    v_pk_mul_f32 v[82:83], v[82:83], v[48:49]
    v_pk_mul_f32 v[84:85], v[84:85], v[48:49]
    v_pk_mul_f32 v[86:87], v[86:87], v[48:49]
    v_pk_mul_f32 v[88:89], v[88:89], v[52:53]
    v_pk_mul_f32 v[90:91], v[90:91], v[52:53]
    v_pk_mul_f32 v[92:93], v[92:93], v[52:53]
    v_pk_mul_f32 v[94:95], v[94:95], v[52:53]
    s_waitcnt lgkmcnt(15)
    v_pk_fma_f32 v[64:65], v[128:129], v[42:43], v[64:65]
    v_pk_fma_f32 v[66:67], v[130:131], v[42:43], v[66:67]
    v_pk_fma_f32 v[68:69], v[144:145], v[42:43], v[68:69]
    v_pk_fma_f32 v[70:71], v[146:147], v[42:43], v[70:71]
    v_pk_fma_f32 v[72:73], v[132:133], v[46:47], v[72:73]
    v_pk_fma_f32 v[74:75], v[134:135], v[46:47], v[74:75]
    v_pk_fma_f32 v[76:77], v[148:149], v[46:47], v[76:77]
    v_pk_fma_f32 v[78:79], v[150:151], v[46:47], v[78:79]
    v_pk_fma_f32 v[80:81], v[136:137], v[50:51], v[80:81]
    v_pk_fma_f32 v[82:83], v[138:139], v[50:51], v[82:83]
    v_pk_fma_f32 v[84:85], v[152:153], v[50:51], v[84:85]
    v_pk_fma_f32 v[86:87], v[154:155], v[50:51], v[86:87]
    v_pk_fma_f32 v[88:89], v[140:141], v[54:55], v[88:89]
    v_pk_fma_f32 v[90:91], v[142:143], v[54:55], v[90:91]
    v_pk_fma_f32 v[92:93], v[156:157], v[54:55], v[92:93]
    v_pk_fma_f32 v[94:95], v[158:159], v[54:55], v[94:95]
    v_cvt_pk_bf16_f32 v96, v64, v65
    v_cvt_pk_bf16_f32 v97, v66, v67
    v_cvt_pk_bf16_f32 v98, v68, v69
    v_cvt_pk_bf16_f32 v99, v70, v71
    v_cvt_pk_bf16_f32 v100, v72, v73
    v_cvt_pk_bf16_f32 v101, v74, v75
    v_cvt_pk_bf16_f32 v102, v76, v77
    v_cvt_pk_bf16_f32 v103, v78, v79
    v_cvt_pk_bf16_f32 v104, v80, v81
    v_cvt_pk_bf16_f32 v105, v82, v83
    v_cvt_pk_bf16_f32 v106, v84, v85
    v_cvt_pk_bf16_f32 v107, v86, v87
    v_cvt_pk_bf16_f32 v108, v88, v89
    v_cvt_pk_bf16_f32 v109, v90, v91
    v_cvt_pk_bf16_f32 v110, v92, v93
    v_cvt_pk_bf16_f32 v111, v94, v95
    ds_write_b128 v37, v[96:99] offset:0
    ds_write_b128 v37, v[100:103] offset:1024
    ds_write_b128 v37, v[104:107] offset:2048
    ds_write_b128 v37, v[108:111] offset:3072
    s_waitcnt lgkmcnt(4)
    v_mov_b32 v38, v255
    s_add_u32 m0, s41, 0
    s_add_u32 s37, s45, 28672
    buffer_load_dwordx4 v20, s[24:27], s37 offen lds
    s_add_u32 m0, s41, 1024
    s_nop 0
    buffer_load_dwordx4 v21, s[24:27], s37 offen lds
    s_add_u32 m0, s41, 2048
    s_nop 0
    buffer_load_dwordx4 v22, s[24:27], s37 offen lds
    s_add_u32 m0, s41, 3072
    s_nop 0
    buffer_load_dwordx4 v23, s[24:27], s37 offen lds
    s_add_u32 m0, s41, 4096
    s_nop 0
    buffer_load_dwordx4 v24, s[24:27], s37 offen lds
    s_add_u32 m0, s41, 5120
    s_nop 0
    buffer_load_dwordx4 v25, s[24:27], s37 offen lds
    s_add_u32 m0, s41, 6144
    s_nop 0
    buffer_load_dwordx4 v26, s[24:27], s37 offen lds
    v_accvgpr_read_b32 v64, a32
    v_accvgpr_read_b32 v65, a33
    v_accvgpr_read_b32 v66, a34
    v_accvgpr_read_b32 v67, a35
    v_accvgpr_read_b32 v68, a48
    v_accvgpr_read_b32 v69, a49
    v_accvgpr_read_b32 v70, a50
    v_accvgpr_read_b32 v71, a51
    v_accvgpr_read_b32 v72, a36
    v_accvgpr_read_b32 v73, a37
    v_accvgpr_read_b32 v74, a38
    v_accvgpr_read_b32 v75, a39
    v_accvgpr_read_b32 v76, a52
    v_accvgpr_read_b32 v77, a53
    v_accvgpr_read_b32 v78, a54
    v_accvgpr_read_b32 v79, a55
    v_accvgpr_read_b32 v80, a40
    v_accvgpr_read_b32 v81, a41
    v_accvgpr_read_b32 v82, a42
    v_accvgpr_read_b32 v83, a43
    v_accvgpr_read_b32 v84, a56
    v_accvgpr_read_b32 v85, a57
    v_accvgpr_read_b32 v86, a58
    v_accvgpr_read_b32 v87, a59
    v_accvgpr_read_b32 v88, a44
    v_accvgpr_read_b32 v89, a45
    v_accvgpr_read_b32 v90, a46
    v_accvgpr_read_b32 v91, a47
    v_accvgpr_read_b32 v92, a60
    v_accvgpr_read_b32 v93, a61
    v_accvgpr_read_b32 v94, a62
    v_accvgpr_read_b32 v95, a63
    v_pk_mul_f32 v[64:65], v[64:65], v[40:41]
    v_pk_mul_f32 v[66:67], v[66:67], v[40:41]
    v_pk_mul_f32 v[68:69], v[68:69], v[40:41]
    v_pk_mul_f32 v[70:71], v[70:71], v[40:41]
    v_pk_mul_f32 v[72:73], v[72:73], v[44:45]
    v_pk_mul_f32 v[74:75], v[74:75], v[44:45]
    v_pk_mul_f32 v[76:77], v[76:77], v[44:45]
    v_pk_mul_f32 v[78:79], v[78:79], v[44:45]
    v_pk_mul_f32 v[80:81], v[80:81], v[48:49]
    v_pk_mul_f32 v[82:83], v[82:83], v[48:49]
    v_pk_mul_f32 v[84:85], v[84:85], v[48:49]
    v_pk_mul_f32 v[86:87], v[86:87], v[48:49]
    v_pk_mul_f32 v[88:89], v[88:89], v[52:53]
    v_pk_mul_f32 v[90:91], v[90:91], v[52:53]
    v_pk_mul_f32 v[92:93], v[92:93], v[52:53]
    v_pk_mul_f32 v[94:95], v[94:95], v[52:53]
    v_pk_fma_f32 v[64:65], v[160:161], v[42:43], v[64:65]
    v_pk_fma_f32 v[66:67], v[162:163], v[42:43], v[66:67]
    v_pk_fma_f32 v[68:69], v[176:177], v[42:43], v[68:69]
    v_pk_fma_f32 v[70:71], v[178:179], v[42:43], v[70:71]
    v_pk_fma_f32 v[72:73], v[164:165], v[46:47], v[72:73]
    v_pk_fma_f32 v[74:75], v[166:167], v[46:47], v[74:75]
    v_pk_fma_f32 v[76:77], v[180:181], v[46:47], v[76:77]
    v_pk_fma_f32 v[78:79], v[182:183], v[46:47], v[78:79]
    v_pk_fma_f32 v[80:81], v[168:169], v[50:51], v[80:81]
    v_pk_fma_f32 v[82:83], v[170:171], v[50:51], v[82:83]
    v_pk_fma_f32 v[84:85], v[184:185], v[50:51], v[84:85]
    v_pk_fma_f32 v[86:87], v[186:187], v[50:51], v[86:87]
    v_pk_fma_f32 v[88:89], v[172:173], v[54:55], v[88:89]
    v_pk_fma_f32 v[90:91], v[174:175], v[54:55], v[90:91]
    v_pk_fma_f32 v[92:93], v[188:189], v[54:55], v[92:93]
    v_pk_fma_f32 v[94:95], v[190:191], v[54:55], v[94:95]
    v_cvt_pk_bf16_f32 v112, v64, v65
    v_cvt_pk_bf16_f32 v113, v66, v67
    v_cvt_pk_bf16_f32 v114, v68, v69
    v_cvt_pk_bf16_f32 v115, v70, v71
    v_cvt_pk_bf16_f32 v116, v72, v73
    v_cvt_pk_bf16_f32 v117, v74, v75
    v_cvt_pk_bf16_f32 v118, v76, v77
    v_cvt_pk_bf16_f32 v119, v78, v79
    v_cvt_pk_bf16_f32 v120, v80, v81
    v_cvt_pk_bf16_f32 v121, v82, v83
    v_cvt_pk_bf16_f32 v122, v84, v85
    v_cvt_pk_bf16_f32 v123, v86, v87
    v_cvt_pk_bf16_f32 v124, v88, v89
    v_cvt_pk_bf16_f32 v125, v90, v91
    v_cvt_pk_bf16_f32 v126, v92, v93
    v_cvt_pk_bf16_f32 v127, v94, v95
    ds_write_b128 v37, v[112:115] offset:4096
    ds_write_b128 v37, v[116:119] offset:5120
    ds_write_b128 v37, v[120:123] offset:6144
    ds_write_b128 v37, v[124:127] offset:7168
    s_add_u32 m0, s42, 0
    s_add_u32 s37, s45, 57344
    buffer_load_dwordx4 v20, s[24:27], s37 offen lds
    s_add_u32 m0, s42, 1024
    s_nop 0
    buffer_load_dwordx4 v21, s[24:27], s37 offen lds
    s_add_u32 m0, s42, 2048
    s_nop 0
    buffer_load_dwordx4 v22, s[24:27], s37 offen lds
    s_add_u32 m0, s42, 3072
    s_nop 0
    buffer_load_dwordx4 v23, s[24:27], s37 offen lds
    s_add_u32 m0, s42, 4096
    s_nop 0
    buffer_load_dwordx4 v24, s[24:27], s37 offen lds
    s_add_u32 m0, s42, 5120
    s_nop 0
    buffer_load_dwordx4 v25, s[24:27], s37 offen lds
    s_add_u32 m0, s42, 6144
    s_nop 0
    buffer_load_dwordx4 v26, s[24:27], s37 offen lds
    v_accvgpr_read_b32 v64, a64
    v_accvgpr_read_b32 v65, a65
    v_accvgpr_read_b32 v66, a66
    v_accvgpr_read_b32 v67, a67
    v_accvgpr_read_b32 v68, a80
    v_accvgpr_read_b32 v69, a81
    v_accvgpr_read_b32 v70, a82
    v_accvgpr_read_b32 v71, a83
    v_accvgpr_read_b32 v72, a68
    v_accvgpr_read_b32 v73, a69
    v_accvgpr_read_b32 v74, a70
    v_accvgpr_read_b32 v75, a71
    v_accvgpr_read_b32 v76, a84
    v_accvgpr_read_b32 v77, a85
    v_accvgpr_read_b32 v78, a86
    v_accvgpr_read_b32 v79, a87
    v_accvgpr_read_b32 v80, a72
    v_accvgpr_read_b32 v81, a73
    v_accvgpr_read_b32 v82, a74
    v_accvgpr_read_b32 v83, a75
    v_accvgpr_read_b32 v84, a88
    v_accvgpr_read_b32 v85, a89
    v_accvgpr_read_b32 v86, a90
    v_accvgpr_read_b32 v87, a91
    v_accvgpr_read_b32 v88, a76
    v_accvgpr_read_b32 v89, a77
    v_accvgpr_read_b32 v90, a78
    v_accvgpr_read_b32 v91, a79
    v_accvgpr_read_b32 v92, a92
    v_accvgpr_read_b32 v93, a93
    v_accvgpr_read_b32 v94, a94
    v_accvgpr_read_b32 v95, a95
    v_pk_mul_f32 v[64:65], v[64:65], v[40:41]
    v_pk_mul_f32 v[66:67], v[66:67], v[40:41]
    v_pk_mul_f32 v[68:69], v[68:69], v[40:41]
    v_pk_mul_f32 v[70:71], v[70:71], v[40:41]
    v_pk_mul_f32 v[72:73], v[72:73], v[44:45]
    v_pk_mul_f32 v[74:75], v[74:75], v[44:45]
    v_pk_mul_f32 v[76:77], v[76:77], v[44:45]
    v_pk_mul_f32 v[78:79], v[78:79], v[44:45]
    v_pk_mul_f32 v[80:81], v[80:81], v[48:49]
    v_pk_mul_f32 v[82:83], v[82:83], v[48:49]
    v_pk_mul_f32 v[84:85], v[84:85], v[48:49]
    v_pk_mul_f32 v[86:87], v[86:87], v[48:49]
    v_pk_mul_f32 v[88:89], v[88:89], v[52:53]
    v_pk_mul_f32 v[90:91], v[90:91], v[52:53]
    v_pk_mul_f32 v[92:93], v[92:93], v[52:53]
    v_pk_mul_f32 v[94:95], v[94:95], v[52:53]
    v_pk_fma_f32 v[64:65], v[192:193], v[42:43], v[64:65]
    v_pk_fma_f32 v[66:67], v[194:195], v[42:43], v[66:67]
    v_pk_fma_f32 v[68:69], v[208:209], v[42:43], v[68:69]
    v_pk_fma_f32 v[70:71], v[210:211], v[42:43], v[70:71]
    v_pk_fma_f32 v[72:73], v[196:197], v[46:47], v[72:73]
    v_pk_fma_f32 v[74:75], v[198:199], v[46:47], v[74:75]
    v_pk_fma_f32 v[76:77], v[212:213], v[46:47], v[76:77]
    v_pk_fma_f32 v[78:79], v[214:215], v[46:47], v[78:79]
    v_pk_fma_f32 v[80:81], v[200:201], v[50:51], v[80:81]
    v_pk_fma_f32 v[82:83], v[202:203], v[50:51], v[82:83]
    v_pk_fma_f32 v[84:85], v[216:217], v[50:51], v[84:85]
    v_pk_fma_f32 v[86:87], v[218:219], v[50:51], v[86:87]
    v_pk_fma_f32 v[88:89], v[204:205], v[54:55], v[88:89]
    v_pk_fma_f32 v[90:91], v[206:207], v[54:55], v[90:91]
    v_pk_fma_f32 v[92:93], v[220:221], v[54:55], v[92:93]
    v_pk_fma_f32 v[94:95], v[222:223], v[54:55], v[94:95]
    v_cvt_pk_bf16_f32 v96, v64, v65
    v_cvt_pk_bf16_f32 v97, v66, v67
    v_cvt_pk_bf16_f32 v98, v68, v69
    v_cvt_pk_bf16_f32 v99, v70, v71
    v_cvt_pk_bf16_f32 v100, v72, v73
    v_cvt_pk_bf16_f32 v101, v74, v75
    v_cvt_pk_bf16_f32 v102, v76, v77
    v_cvt_pk_bf16_f32 v103, v78, v79
    v_cvt_pk_bf16_f32 v104, v80, v81
    v_cvt_pk_bf16_f32 v105, v82, v83
    v_cvt_pk_bf16_f32 v106, v84, v85
    v_cvt_pk_bf16_f32 v107, v86, v87
    v_cvt_pk_bf16_f32 v108, v88, v89
    v_cvt_pk_bf16_f32 v109, v90, v91
    v_cvt_pk_bf16_f32 v110, v92, v93
    v_cvt_pk_bf16_f32 v111, v94, v95
    ds_write_b128 v37, v[96:99] offset:8192
    ds_write_b128 v37, v[100:103] offset:9216
    ds_write_b128 v37, v[104:107] offset:10240
    ds_write_b128 v37, v[108:111] offset:11264
    v_accvgpr_read_b32 v64, a96
    v_accvgpr_read_b32 v65, a97
    v_accvgpr_read_b32 v66, a98
    v_accvgpr_read_b32 v67, a99
    v_accvgpr_read_b32 v68, a112
    v_accvgpr_read_b32 v69, a113
    v_accvgpr_read_b32 v70, a114
    v_accvgpr_read_b32 v71, a115
    v_accvgpr_read_b32 v72, a100
    v_accvgpr_read_b32 v73, a101
    v_accvgpr_read_b32 v74, a102
    v_accvgpr_read_b32 v75, a103
    v_accvgpr_read_b32 v76, a116
    v_accvgpr_read_b32 v77, a117
    v_accvgpr_read_b32 v78, a118
    v_accvgpr_read_b32 v79, a119
    v_accvgpr_read_b32 v80, a104
    v_accvgpr_read_b32 v81, a105
    v_accvgpr_read_b32 v82, a106
    v_accvgpr_read_b32 v83, a107
    v_accvgpr_read_b32 v84, a120
    v_accvgpr_read_b32 v85, a121
    v_accvgpr_read_b32 v86, a122
    v_accvgpr_read_b32 v87, a123
    v_accvgpr_read_b32 v88, a108
    v_accvgpr_read_b32 v89, a109
    v_accvgpr_read_b32 v90, a110
    v_accvgpr_read_b32 v91, a111
    v_accvgpr_read_b32 v92, a124
    v_accvgpr_read_b32 v93, a125
    v_accvgpr_read_b32 v94, a126
    v_accvgpr_read_b32 v95, a127
    v_pk_mul_f32 v[64:65], v[64:65], v[40:41]
    v_pk_mul_f32 v[66:67], v[66:67], v[40:41]
    v_pk_mul_f32 v[68:69], v[68:69], v[40:41]
    v_pk_mul_f32 v[70:71], v[70:71], v[40:41]
    v_pk_mul_f32 v[72:73], v[72:73], v[44:45]
    v_pk_mul_f32 v[74:75], v[74:75], v[44:45]
    v_pk_mul_f32 v[76:77], v[76:77], v[44:45]
    v_pk_mul_f32 v[78:79], v[78:79], v[44:45]
    v_pk_mul_f32 v[80:81], v[80:81], v[48:49]
    v_pk_mul_f32 v[82:83], v[82:83], v[48:49]
    v_pk_mul_f32 v[84:85], v[84:85], v[48:49]
    v_pk_mul_f32 v[86:87], v[86:87], v[48:49]
    v_pk_mul_f32 v[88:89], v[88:89], v[52:53]
    v_pk_mul_f32 v[90:91], v[90:91], v[52:53]
    v_pk_mul_f32 v[92:93], v[92:93], v[52:53]
    v_pk_mul_f32 v[94:95], v[94:95], v[52:53]
    v_pk_fma_f32 v[64:65], v[224:225], v[42:43], v[64:65]
    v_pk_fma_f32 v[66:67], v[226:227], v[42:43], v[66:67]
    v_pk_fma_f32 v[68:69], v[240:241], v[42:43], v[68:69]
    v_pk_fma_f32 v[70:71], v[242:243], v[42:43], v[70:71]
    v_pk_fma_f32 v[72:73], v[228:229], v[46:47], v[72:73]
    v_pk_fma_f32 v[74:75], v[230:231], v[46:47], v[74:75]
    v_pk_fma_f32 v[76:77], v[244:245], v[46:47], v[76:77]
    v_pk_fma_f32 v[78:79], v[246:247], v[46:47], v[78:79]
    v_pk_fma_f32 v[80:81], v[232:233], v[50:51], v[80:81]
    v_pk_fma_f32 v[82:83], v[234:235], v[50:51], v[82:83]
    v_pk_fma_f32 v[84:85], v[248:249], v[50:51], v[84:85]
    v_pk_fma_f32 v[86:87], v[250:251], v[50:51], v[86:87]
    v_pk_fma_f32 v[88:89], v[236:237], v[54:55], v[88:89]
    v_pk_fma_f32 v[90:91], v[238:239], v[54:55], v[90:91]
    v_pk_fma_f32 v[92:93], v[252:253], v[54:55], v[92:93]
    v_pk_fma_f32 v[94:95], v[254:255], v[54:55], v[94:95]
    v_cvt_pk_bf16_f32 v112, v64, v65
    v_cvt_pk_bf16_f32 v113, v66, v67
    v_cvt_pk_bf16_f32 v114, v68, v69
    v_cvt_pk_bf16_f32 v115, v70, v71
    v_cvt_pk_bf16_f32 v116, v72, v73
    v_cvt_pk_bf16_f32 v117, v74, v75
    v_cvt_pk_bf16_f32 v118, v76, v77
    v_cvt_pk_bf16_f32 v119, v78, v79
    v_cvt_pk_bf16_f32 v120, v80, v81
    v_cvt_pk_bf16_f32 v121, v82, v83
    v_cvt_pk_bf16_f32 v122, v84, v85
    v_cvt_pk_bf16_f32 v123, v86, v87
    v_cvt_pk_bf16_f32 v124, v88, v89
    v_cvt_pk_bf16_f32 v125, v90, v91
    v_cvt_pk_bf16_f32 v126, v92, v93
    v_cvt_pk_bf16_f32 v127, v94, v95
    ds_write_b128 v37, v[112:115] offset:12288
    ds_write_b128 v37, v[116:119] offset:13312
    ds_write_b128 v37, v[120:123] offset:14336
    ds_write_b128 v37, v[124:127] offset:15360
    s_waitcnt vmcnt(23)
    v_cmp_ne_u32 vcc, s60, v61
    s_cbranch_vccz L_init_ok
    s_mov_b32 s38, 45056
    s_mov_b32 s37, 65536
L_init_l:
    buffer_load_dword v61, v60, s[28:31], s38 offen sc0 sc1
    s_waitcnt vmcnt(0)
    v_cmp_ne_u32 vcc, s60, v61
    s_cbranch_vccz L_init_ok
    s_sleep 2
    s_sub_u32 s37, s37, 1
    s_cmp_lg_u32 s37, 0
    s_cbranch_scc1 L_init_l
L_init_ok:
    s_waitcnt lgkmcnt(0)
    s_barrier
    ds_read_b128 v[64:67], v30 offset:32768
    ds_read_b128 v[68:71], v30 offset:33792
    ds_read_b128 v[72:75], v30 offset:34816
    ds_read_b128 v[76:79], v30 offset:35840
    s_waitcnt vmcnt(16)
    ds_read_b64_tr_b16 v[96:97], v33 offset:0
    ds_read_b64_tr_b16 v[98:99], v33 offset:3584
    ds_read_b64_tr_b16 v[100:101], v33 offset:32
    ds_read_b64_tr_b16 v[102:103], v33 offset:3616
    ds_read_b64_tr_b16 v[104:105], v33 offset:64
    ds_read_b64_tr_b16 v[106:107], v33 offset:3648
    ds_read_b64_tr_b16 v[108:109], v33 offset:96
    ds_read_b64_tr_b16 v[110:111], v33 offset:3680
    ds_read_b64_tr_b16 v[112:113], v33 offset:128
    ds_read_b64_tr_b16 v[114:115], v33 offset:3712
    s_waitcnt lgkmcnt(8)
    v_mfma_f32_16x16x32_bf16 v[128:131], v[96:99], v[64:67], 0
    ds_read_b64_tr_b16 v[116:117], v33 offset:160
    ds_read_b64_tr_b16 v[118:119], v33 offset:3744
    v_mfma_f32_16x16x32_bf16 v[132:135], v[96:99], v[68:71], 0
    v_mfma_f32_16x16x32_bf16 v[136:139], v[96:99], v[72:75], 0
    ds_read_b128 v[80:83], v30 offset:36864
    v_mfma_f32_16x16x32_bf16 v[140:143], v[96:99], v[76:79], 0
    ds_read_b128 v[84:87], v30 offset:37888
    s_waitcnt lgkmcnt(10)
    v_mfma_f32_16x16x32_bf16 v[144:147], v[100:103], v[64:67], 0
    ds_read_b64_tr_b16 v[120:121], v33 offset:192
    ds_read_b64_tr_b16 v[122:123], v33 offset:3776
    v_mfma_f32_16x16x32_bf16 v[148:151], v[100:103], v[68:71], 0
    v_mfma_f32_16x16x32_bf16 v[152:155], v[100:103], v[72:75], 0
    ds_read_b128 v[88:91], v30 offset:38912
    v_mfma_f32_16x16x32_bf16 v[156:159], v[100:103], v[76:79], 0
    ds_read_b128 v[92:95], v30 offset:39936
    s_waitcnt lgkmcnt(12)
    v_mfma_f32_16x16x32_bf16 v[160:163], v[104:107], v[64:67], 0
    s_waitcnt vmcnt(7)
    ds_read_b64_tr_b16 v[124:125], v34 offset:0
    ds_read_b64_tr_b16 v[126:127], v34 offset:3584
    v_mfma_f32_16x16x32_bf16 v[164:167], v[104:107], v[68:71], 0
    s_add_u32 s72, s66, 65536
    s_addc_u32 s73, s67, 0
    v_mfma_f32_16x16x32_bf16 v[168:171], v[104:107], v[72:75], 0
    s_mov_b32 s74, 49152
    v_mfma_f32_16x16x32_bf16 v[172:175], v[104:107], v[76:79], 0
    s_waitcnt lgkmcnt(12)
    v_mfma_f32_16x16x32_bf16 v[176:179], v[108:111], v[64:67], 0
    ds_read_b64_tr_b16 v[96:97], v34 offset:32
    ds_read_b64_tr_b16 v[98:99], v34 offset:3616
    s_mov_b32 s75, 0x00020000
    v_mfma_f32_16x16x32_bf16 v[180:183], v[108:111], v[68:71], 0
    v_mfma_f32_16x16x32_bf16 v[184:187], v[108:111], v[72:75], 0
    s_mov_b32 s12, s56
    v_mfma_f32_16x16x32_bf16 v[188:191], v[108:111], v[76:79], 0
    s_waitcnt lgkmcnt(12)
    v_mfma_f32_16x16x32_bf16 v[192:195], v[112:115], v[64:67], 0
    ds_read_b64_tr_b16 v[100:101], v34 offset:64
    ds_read_b64_tr_b16 v[102:103], v34 offset:3648
    s_mov_b32 s13, s57
    v_mfma_f32_16x16x32_bf16 v[196:199], v[112:115], v[68:71], 0
    v_mfma_f32_16x16x32_bf16 v[200:203], v[112:115], v[72:75], 0
    s_mov_b32 s14, 1835008
    v_mfma_f32_16x16x32_bf16 v[204:207], v[112:115], v[76:79], 0
    s_waitcnt lgkmcnt(12)
    v_mfma_f32_16x16x32_bf16 v[208:211], v[116:119], v[64:67], 0
    ds_read_b64_tr_b16 v[104:105], v34 offset:96
    ds_read_b64_tr_b16 v[106:107], v34 offset:3680
    s_mov_b32 s15, 0x00020000
    v_mfma_f32_16x16x32_bf16 v[212:215], v[116:119], v[68:71], 0
    v_mfma_f32_16x16x32_bf16 v[216:219], v[116:119], v[72:75], 0
    s_mov_b32 s16, s66
    v_mfma_f32_16x16x32_bf16 v[220:223], v[116:119], v[76:79], 0
    s_waitcnt lgkmcnt(10)
    v_mfma_f32_16x16x32_bf16 v[224:227], v[120:123], v[64:67], 0
    ds_read_b64_tr_b16 v[108:109], v34 offset:128
    ds_read_b64_tr_b16 v[110:111], v34 offset:3712
    s_mov_b32 s17, s67
    v_mfma_f32_16x16x32_bf16 v[228:231], v[120:123], v[68:71], 0
    v_mfma_f32_16x16x32_bf16 v[232:235], v[120:123], v[72:75], 0
    s_mov_b32 s18, 10752
    v_mfma_f32_16x16x32_bf16 v[236:239], v[120:123], v[76:79], 0
    s_waitcnt lgkmcnt(8)
    v_mfma_f32_16x16x32_bf16 v[128:131], v[124:127], v[80:83], v[128:131]
    ds_read_b64_tr_b16 v[112:113], v34 offset:160
    ds_read_b64_tr_b16 v[114:115], v34 offset:3744
    s_mov_b32 s19, 0x00020000
    v_mfma_f32_16x16x32_bf16 v[132:135], v[124:127], v[84:87], v[132:135]
    s_add_u32 m0, s40, 0
    s_add_u32 s36, s45, 86016
    v_mfma_f32_16x16x32_bf16 v[136:139], v[124:127], v[88:91], v[136:139]
    ds_read_b128 v[64:67], v30 offset:40960
    buffer_load_dwordx4 v20, s[24:27], s36 offen lds
    v_mfma_f32_16x16x32_bf16 v[140:143], v[124:127], v[92:95], v[140:143]
    s_add_u32 s28, s66, 131072
    s_addc_u32 s29, s67, 0
    ds_read_b128 v[68:71], v30 offset:41984
    s_waitcnt lgkmcnt(10)
    v_mfma_f32_16x16x32_bf16 v[144:147], v[96:99], v[80:83], v[144:147]
    ds_read_b64_tr_b16 v[116:117], v34 offset:192
    ds_read_b64_tr_b16 v[118:119], v34 offset:3776
    s_mov_b32 s30, 1835008
    v_mfma_f32_16x16x32_bf16 v[148:151], v[96:99], v[84:87], v[148:151]
    s_add_u32 m0, s40, 1024
    v_mfma_f32_16x16x32_bf16 v[152:155], v[96:99], v[88:91], v[152:155]
    ds_read_b128 v[72:75], v30 offset:43008
    buffer_load_dwordx4 v21, s[24:27], s36 offen lds
    v_mfma_f32_16x16x32_bf16 v[156:159], v[96:99], v[92:95], v[156:159]
    s_mov_b32 s31, 0x00020000
    ds_read_b128 v[76:79], v30 offset:44032
    s_waitcnt lgkmcnt(12)
    v_mfma_f32_16x16x32_bf16 v[160:163], v[100:103], v[80:83], v[160:163]
    s_waitcnt vmcnt(2)
    ds_read_b64_tr_b16 v[120:121], v35 offset:0
    ds_read_b64_tr_b16 v[122:123], v35 offset:3584
    v_mfma_f32_16x16x32_bf16 v[164:167], v[100:103], v[84:87], v[164:167]
    s_add_u32 s76, s66, 23199744
    s_addc_u32 s77, s67, 0
    s_add_u32 m0, s40, 2048
    v_mfma_f32_16x16x32_bf16 v[168:171], v[100:103], v[88:91], v[168:171]
    buffer_load_dwordx4 v22, s[24:27], s36 offen lds
    s_mov_b32 s78, 14680064
    v_mfma_f32_16x16x32_bf16 v[172:175], v[100:103], v[92:95], v[172:175]
    s_waitcnt lgkmcnt(12)
    v_mfma_f32_16x16x32_bf16 v[176:179], v[104:107], v[80:83], v[176:179]
    ds_read_b64_tr_b16 v[124:125], v35 offset:32
    ds_read_b64_tr_b16 v[126:127], v35 offset:3616
    s_mov_b32 s79, 0x00020000
    v_mfma_f32_16x16x32_bf16 v[180:183], v[104:107], v[84:87], v[180:183]
    s_add_u32 m0, s40, 3072
    v_mfma_f32_16x16x32_bf16 v[184:187], v[104:107], v[88:91], v[184:187]
    buffer_load_dwordx4 v23, s[24:27], s36 offen lds
    v_and_b32_e64 v2, 7, v16
    v_mfma_f32_16x16x32_bf16 v[188:191], v[104:107], v[92:95], v[188:191]
    s_waitcnt lgkmcnt(12)
    v_mfma_f32_16x16x32_bf16 v[192:195], v[108:111], v[80:83], v[192:195]
    ds_read_b64_tr_b16 v[96:97], v35 offset:64
    ds_read_b64_tr_b16 v[98:99], v35 offset:3648
    v_bfe_u32 v3, v16, 3, 2
    v_mfma_f32_16x16x32_bf16 v[196:199], v[108:111], v[84:87], v[196:199]
    s_add_u32 m0, s40, 4096
    v_mfma_f32_16x16x32_bf16 v[200:203], v[108:111], v[88:91], v[200:203]
    buffer_load_dwordx4 v24, s[24:27], s36 offen lds
    v_lshrrev_b32 v4, 5, v16
    v_mfma_f32_16x16x32_bf16 v[204:207], v[108:111], v[92:95], v[204:207]
    s_waitcnt lgkmcnt(12)
    v_mfma_f32_16x16x32_bf16 v[208:211], v[112:115], v[80:83], v[208:211]
    ds_read_b64_tr_b16 v[100:101], v35 offset:96
    ds_read_b64_tr_b16 v[102:103], v35 offset:3680
    v_and_b32 v56, 31, v16
    v_mfma_f32_16x16x32_bf16 v[212:215], v[112:115], v[84:87], v[212:215]
    s_add_u32 m0, s40, 5120
    v_mfma_f32_16x16x32_bf16 v[216:219], v[112:115], v[88:91], v[216:219]
    buffer_load_dwordx4 v25, s[24:27], s36 offen lds
    v_lshlrev_b32_e64 v57, 4, v56
    v_mfma_f32_16x16x32_bf16 v[220:223], v[112:115], v[92:95], v[220:223]
    s_waitcnt lgkmcnt(10)
    v_mfma_f32_16x16x32_bf16 v[224:227], v[116:119], v[80:83], v[224:227]
    ds_read_b64_tr_b16 v[104:105], v35 offset:128
    ds_read_b64_tr_b16 v[106:107], v35 offset:3712
    v_lshl_add_u32 v5, v4, 10, v57
    v_mfma_f32_16x16x32_bf16 v[228:231], v[116:119], v[84:87], v[228:231]
    s_add_u32 m0, s40, 6144
    v_mfma_f32_16x16x32_bf16 v[232:235], v[116:119], v[88:91], v[232:235]
    buffer_load_dwordx4 v26, s[24:27], s36 offen lds
    v_add_u32 v57, 512, v57
    v_mfma_f32_16x16x32_bf16 v[236:239], v[116:119], v[92:95], v[236:239]
    s_waitcnt lgkmcnt(8)
    v_mfma_f32_16x16x32_bf16 v[128:131], v[120:123], v[64:67], v[128:131]
    ds_read_b64_tr_b16 v[108:109], v35 offset:160
    ds_read_b64_tr_b16 v[110:111], v35 offset:3744
    v_lshlrev_b32_e64 v58, 3, v56
    v_mfma_f32_16x16x32_bf16 v[132:135], v[120:123], v[68:71], v[132:135]
    s_add_u32 m0, s41, 0
    s_add_u32 s36, s45, 114688
    v_mfma_f32_16x16x32_bf16 v[136:139], v[120:123], v[72:75], v[136:139]
    ds_read_b128 v[80:83], v30 offset:45056
    buffer_load_dwordx4 v20, s[24:27], s36 offen lds
    v_mfma_f32_16x16x32_bf16 v[140:143], v[120:123], v[76:79], v[140:143]
    v_add_u32 v58, 1536, v58
    ds_read_b128 v[84:87], v30 offset:46080
    s_waitcnt lgkmcnt(10)
    v_mfma_f32_16x16x32_bf16 v[144:147], v[124:127], v[64:67], v[144:147]
    ds_read_b64_tr_b16 v[112:113], v35 offset:192
    ds_read_b64_tr_b16 v[114:115], v35 offset:3776
    v_cmp_eq_u32 vcc, 0, v4
    v_mfma_f32_16x16x32_bf16 v[148:151], v[124:127], v[68:71], v[148:151]
    s_add_u32 m0, s41, 1024
    v_mfma_f32_16x16x32_bf16 v[152:155], v[124:127], v[72:75], v[152:155]
    ds_read_b128 v[88:91], v30 offset:47104
    buffer_load_dwordx4 v21, s[24:27], s36 offen lds
    v_mfma_f32_16x16x32_bf16 v[156:159], v[124:127], v[76:79], v[156:159]
    v_cndmask_b32 v6, v58, v57, vcc
    ds_read_b128 v[92:95], v30 offset:48128
    s_waitcnt lgkmcnt(12)
    v_mfma_f32_16x16x32_bf16 v[160:163], v[96:99], v[64:67], v[160:163]
    s_waitcnt vmcnt(2)
    ds_read_b64_tr_b16 v[116:117], v33 offset:0
    ds_read_b64_tr_b16 v[118:119], v33 offset:3584
    v_mfma_f32_16x16x32_bf16 v[164:167], v[96:99], v[68:71], v[164:167]
    v_cndmask_b32 v12, 0, 1.0, vcc
    s_add_u32 m0, s41, 2048
    v_mfma_f32_16x16x32_bf16 v[168:171], v[96:99], v[72:75], v[168:171]
    buffer_load_dwordx4 v22, s[24:27], s36 offen lds
    v_mov_b32_e64 v13, v12
    v_mfma_f32_16x16x32_bf16 v[172:175], v[96:99], v[76:79], v[172:175]
    s_waitcnt lgkmcnt(12)
    v_mfma_f32_16x16x32_bf16 v[176:179], v[100:103], v[64:67], v[176:179]
    ds_read_b64_tr_b16 v[120:121], v33 offset:32
    ds_read_b64_tr_b16 v[122:123], v33 offset:3616
    v_mul_u32_u24 v7, 896, v2
    v_mfma_f32_16x16x32_bf16 v[180:183], v[100:103], v[68:71], v[180:183]
    s_add_u32 m0, s41, 3072
    v_mfma_f32_16x16x32_bf16 v[184:187], v[100:103], v[72:75], v[184:187]
    buffer_load_dwordx4 v23, s[24:27], s36 offen lds
    v_lshl_add_u32 v7, v3, 3, v7
    v_mfma_f32_16x16x32_bf16 v[188:191], v[100:103], v[76:79], v[188:191]
    s_waitcnt lgkmcnt(12)
    v_mfma_f32_16x16x32_bf16 v[192:195], v[104:107], v[64:67], v[192:195]
    ds_read_b64_tr_b16 v[124:125], v33 offset:64
    ds_read_b64_tr_b16 v[126:127], v33 offset:3648
    v_lshl_add_u32 v7, v4, 7, v7
    v_mfma_f32_16x16x32_bf16 v[196:199], v[104:107], v[68:71], v[196:199]
    s_add_u32 m0, s41, 4096
    v_mfma_f32_16x16x32_bf16 v[200:203], v[104:107], v[72:75], v[200:203]
    buffer_load_dwordx4 v24, s[24:27], s36 offen lds
    v_lshlrev_b32_e64 v8, 4, v3
    v_mfma_f32_16x16x32_bf16 v[204:207], v[104:107], v[76:79], v[204:207]
    s_waitcnt lgkmcnt(12)
    v_mfma_f32_16x16x32_bf16 v[208:211], v[108:111], v[64:67], v[208:211]
    ds_read_b64_tr_b16 v[96:97], v33 offset:96
    ds_read_b64_tr_b16 v[98:99], v33 offset:3680
    v_lshl_add_u32 v8, v4, 8, v8
    v_mfma_f32_16x16x32_bf16 v[212:215], v[108:111], v[68:71], v[212:215]
    s_add_u32 m0, s41, 5120
    v_mfma_f32_16x16x32_bf16 v[216:219], v[108:111], v[72:75], v[216:219]
    buffer_load_dwordx4 v25, s[24:27], s36 offen lds
    v_lshlrev_b32 v9, 2, v2
    v_mfma_f32_16x16x32_bf16 v[220:223], v[108:111], v[76:79], v[220:223]
    s_waitcnt lgkmcnt(10)
    v_mfma_f32_16x16x32_bf16 v[224:227], v[112:115], v[64:67], v[224:227]
    ds_read_b64_tr_b16 v[100:101], v33 offset:128
    ds_read_b64_tr_b16 v[102:103], v33 offset:3712
    v_lshlrev_b32 v11, 5, v2
    v_mfma_f32_16x16x32_bf16 v[228:231], v[112:115], v[68:71], v[228:231]
    s_add_u32 m0, s41, 6144
    v_mfma_f32_16x16x32_bf16 v[232:235], v[112:115], v[72:75], v[232:235]
    buffer_load_dwordx4 v26, s[24:27], s36 offen lds
    v_add_u32 v11, 57344, v11
    v_mfma_f32_16x16x32_bf16 v[236:239], v[112:115], v[76:79], v[236:239]
    s_waitcnt lgkmcnt(8)
    v_mfma_f32_16x16x32_bf16 v[128:131], v[116:119], v[80:83], v[128:131]
    ds_read_b64_tr_b16 v[104:105], v33 offset:160
    ds_read_b64_tr_b16 v[106:107], v33 offset:3744
    s_lshl_b32 s39, s5, 3
    v_mfma_f32_16x16x32_bf16 v[132:135], v[116:119], v[84:87], v[132:135]
    s_add_u32 m0, s42, 0
    s_add_u32 s36, s45, 143360
    v_mfma_f32_16x16x32_bf16 v[136:139], v[116:119], v[88:91], v[136:139]
    ds_read_b128 v[64:67], v30 offset:0
    buffer_load_dwordx4 v20, s[24:27], s36 offen lds
    v_mfma_f32_16x16x32_bf16 v[140:143], v[116:119], v[92:95], v[140:143]
    v_add_u32 v10, s39, v11
    ds_read_b128 v[68:71], v30 offset:1024
    s_waitcnt lgkmcnt(10)
    v_mfma_f32_16x16x32_bf16 v[144:147], v[120:123], v[80:83], v[144:147]
    ds_read_b64_tr_b16 v[108:109], v33 offset:192
    ds_read_b64_tr_b16 v[110:111], v33 offset:3776
    s_lshl_b32 s52, s4, 3
    v_mfma_f32_16x16x32_bf16 v[148:151], v[120:123], v[84:87], v[148:151]
    s_add_u32 m0, s42, 1024
    v_mfma_f32_16x16x32_bf16 v[152:155], v[120:123], v[88:91], v[152:155]
    ds_read_b128 v[72:75], v30 offset:2048
    buffer_load_dwordx4 v21, s[24:27], s36 offen lds
    v_mfma_f32_16x16x32_bf16 v[156:159], v[120:123], v[92:95], v[156:159]
    s_add_u32 s52, s52, s3
    ds_read_b128 v[76:79], v30 offset:3072
    s_waitcnt lgkmcnt(12)
    v_mfma_f32_16x16x32_bf16 v[160:163], v[124:127], v[80:83], v[160:163]
    s_waitcnt vmcnt(2)
    ds_read_b64_tr_b16 v[112:113], v34 offset:0
    ds_read_b64_tr_b16 v[114:115], v34 offset:3584
    v_mfma_f32_16x16x32_bf16 v[164:167], v[124:127], v[84:87], v[164:167]
    s_mul_i32 s53, s52, 57344
    s_add_u32 m0, s42, 2048
    v_mfma_f32_16x16x32_bf16 v[168:171], v[124:127], v[88:91], v[168:171]
    buffer_load_dwordx4 v22, s[24:27], s36 offen lds
    s_mul_i32 s39, s5, 1792
    v_mfma_f32_16x16x32_bf16 v[172:175], v[124:127], v[92:95], v[172:175]
    s_waitcnt lgkmcnt(12)
    v_mfma_f32_16x16x32_bf16 v[176:179], v[96:99], v[80:83], v[176:179]
    ds_read_b64_tr_b16 v[116:117], v34 offset:32
    ds_read_b64_tr_b16 v[118:119], v34 offset:3616
    s_add_u32 s53, s53, s39
    v_mfma_f32_16x16x32_bf16 v[180:183], v[96:99], v[84:87], v[180:183]
    s_add_u32 m0, s42, 3072
    v_mfma_f32_16x16x32_bf16 v[184:187], v[96:99], v[88:91], v[184:187]
    buffer_load_dwordx4 v23, s[24:27], s36 offen lds
    s_lshl_b32 s55, s5, 15
    v_mfma_f32_16x16x32_bf16 v[188:191], v[96:99], v[92:95], v[188:191]
    s_waitcnt lgkmcnt(12)
    v_mfma_f32_16x16x32_bf16 v[192:195], v[100:103], v[80:83], v[192:195]
    ds_read_b64_tr_b16 v[120:121], v34 offset:64
    ds_read_b64_tr_b16 v[122:123], v34 offset:3648
    s_add_u32 s55, s55, 32768
    v_mfma_f32_16x16x32_bf16 v[196:199], v[100:103], v[84:87], v[196:199]
    s_add_u32 m0, s42, 4096
    v_mfma_f32_16x16x32_bf16 v[200:203], v[100:103], v[88:91], v[200:203]
    buffer_load_dwordx4 v24, s[24:27], s36 offen lds
    s_mul_i32 s43, s3, 448
    v_mfma_f32_16x16x32_bf16 v[204:207], v[100:103], v[92:95], v[204:207]
    s_waitcnt lgkmcnt(12)
    v_mfma_f32_16x16x32_bf16 v[208:211], v[104:107], v[80:83], v[208:211]
    ds_read_b64_tr_b16 v[124:125], v34 offset:96
    ds_read_b64_tr_b16 v[126:127], v34 offset:3680
    s_andn2_b32 s43, s43, 127
    v_mfma_f32_16x16x32_bf16 v[212:215], v[104:107], v[84:87], v[212:215]
    s_add_u32 m0, s42, 5120
    v_mfma_f32_16x16x32_bf16 v[216:219], v[104:107], v[88:91], v[216:219]
    buffer_load_dwordx4 v25, s[24:27], s36 offen lds
    s_lshl_b32 s61, s5, 10
    v_mfma_f32_16x16x32_bf16 v[220:223], v[104:107], v[92:95], v[220:223]
    s_waitcnt lgkmcnt(10)
    v_mfma_f32_16x16x32_bf16 v[224:227], v[108:111], v[80:83], v[224:227]
    ds_read_b64_tr_b16 v[96:97], v34 offset:128
    ds_read_b64_tr_b16 v[98:99], v34 offset:3712
    s_mul_i32 s44, s4, 57344
    v_mfma_f32_16x16x32_bf16 v[228:231], v[108:111], v[84:87], v[228:231]
    s_add_u32 m0, s42, 6144
    v_mfma_f32_16x16x32_bf16 v[232:235], v[108:111], v[88:91], v[232:235]
    buffer_load_dwordx4 v26, s[24:27], s36 offen lds
    s_add_u32 s44, s44, s61
    v_mfma_f32_16x16x32_bf16 v[236:239], v[108:111], v[92:95], v[236:239]
    s_waitcnt lgkmcnt(8)
    v_mfma_f32_16x16x32_bf16 v[128:131], v[112:115], v[64:67], v[128:131]
    ds_read_b64_tr_b16 v[100:101], v34 offset:160
    ds_read_b64_tr_b16 v[102:103], v34 offset:3744
    v_lshrrev_b32_e64 v56, 3, v16
    v_mfma_f32_16x16x32_bf16 v[132:135], v[112:115], v[68:71], v[132:135]
    s_add_u32 m0, s40, 0
    s_add_u32 s36, s45, 172032
    v_mfma_f32_16x16x32_bf16 v[136:139], v[112:115], v[72:75], v[136:139]
    ds_read_b128 v[80:83], v30 offset:4096
    buffer_load_dwordx4 v20, s[24:27], s36 offen lds
    v_mfma_f32_16x16x32_bf16 v[140:143], v[112:115], v[76:79], v[140:143]
    v_and_b32 v58, 6, v56
    ds_read_b128 v[84:87], v30 offset:5120
    s_waitcnt lgkmcnt(10)
    v_mfma_f32_16x16x32_bf16 v[144:147], v[116:119], v[64:67], v[144:147]
    ds_read_b64_tr_b16 v[104:105], v34 offset:192
    ds_read_b64_tr_b16 v[106:107], v34 offset:3776
    v_xor_b32 v58, v58, v2
    v_mfma_f32_16x16x32_bf16 v[148:151], v[116:119], v[68:71], v[148:151]
    s_add_u32 m0, s40, 1024
    v_mfma_f32_16x16x32_bf16 v[152:155], v[116:119], v[72:75], v[152:155]
    ds_read_b128 v[88:91], v30 offset:6144
    buffer_load_dwordx4 v21, s[24:27], s36 offen lds
    v_mfma_f32_16x16x32_bf16 v[156:159], v[116:119], v[76:79], v[156:159]
    v_mul_u32_u24 v60, 3584, v56
    ds_read_b128 v[92:95], v30 offset:7168
    s_waitcnt lgkmcnt(12)
    v_mfma_f32_16x16x32_bf16 v[160:163], v[120:123], v[64:67], v[160:163]
    s_waitcnt vmcnt(2)
    ds_read_b64_tr_b16 v[108:109], v35 offset:0
    ds_read_b64_tr_b16 v[110:111], v35 offset:3584
    v_mfma_f32_16x16x32_bf16 v[164:167], v[120:123], v[68:71], v[164:167]
    v_lshl_add_u32 v60, v58, 4, v60
    s_add_u32 m0, s40, 2048
    v_mfma_f32_16x16x32_bf16 v[168:171], v[120:123], v[72:75], v[168:171]
    buffer_load_dwordx4 v22, s[24:27], s36 offen lds
    s_lshl_b32 s39, s5, 7
    v_mfma_f32_16x16x32_bf16 v[172:175], v[120:123], v[76:79], v[172:175]
    s_waitcnt lgkmcnt(12)
    v_mfma_f32_16x16x32_bf16 v[176:179], v[124:127], v[64:67], v[176:179]
    ds_read_b64_tr_b16 v[112:113], v35 offset:32
    ds_read_b64_tr_b16 v[114:115], v35 offset:3616
    v_add_u32_e64 v60, s39, v60
    v_mfma_f32_16x16x32_bf16 v[180:183], v[124:127], v[68:71], v[180:183]
    s_add_u32 m0, s40, 3072
    v_mfma_f32_16x16x32_bf16 v[184:187], v[124:127], v[72:75], v[184:187]
    buffer_load_dwordx4 v23, s[24:27], s36 offen lds
    v_and_b32_e64 v56, 1, v18
    v_mfma_f32_16x16x32_bf16 v[188:191], v[124:127], v[76:79], v[188:191]
    s_waitcnt lgkmcnt(12)
    v_mfma_f32_16x16x32_bf16 v[192:195], v[96:99], v[64:67], v[192:195]
    ds_read_b64_tr_b16 v[116:117], v35 offset:64
    ds_read_b64_tr_b16 v[118:119], v35 offset:3648
    v_lshlrev_b32 v56, 2, v56
    v_mfma_f32_16x16x32_bf16 v[196:199], v[96:99], v[68:71], v[196:199]
    s_add_u32 m0, s40, 4096
    v_mfma_f32_16x16x32_bf16 v[200:203], v[96:99], v[72:75], v[200:203]
    buffer_load_dwordx4 v24, s[24:27], s36 offen lds
    v_lshrrev_b32_e64 v57, 2, v17
    v_mfma_f32_16x16x32_bf16 v[204:207], v[96:99], v[76:79], v[204:207]
    s_waitcnt lgkmcnt(12)
    v_mfma_f32_16x16x32_bf16 v[208:211], v[100:103], v[64:67], v[208:211]
    ds_read_b64_tr_b16 v[120:121], v35 offset:96
    ds_read_b64_tr_b16 v[122:123], v35 offset:3680
    v_add_u32 v56, v56, v57
    v_mfma_f32_16x16x32_bf16 v[212:215], v[100:103], v[68:71], v[212:215]
    s_add_u32 m0, s40, 5120
    v_mfma_f32_16x16x32_bf16 v[216:219], v[100:103], v[72:75], v[216:219]
    buffer_load_dwordx4 v25, s[24:27], s36 offen lds
    v_lshrrev_b32_e64 v57, 1, v56
    v_mfma_f32_16x16x32_bf16 v[220:223], v[100:103], v[76:79], v[220:223]
    s_waitcnt lgkmcnt(10)
    v_mfma_f32_16x16x32_bf16 v[224:227], v[104:107], v[64:67], v[224:227]
    ds_read_b64_tr_b16 v[124:125], v35 offset:128
    ds_read_b64_tr_b16 v[126:127], v35 offset:3712
    v_and_b32 v58, 3, v17
    v_mfma_f32_16x16x32_bf16 v[228:231], v[104:107], v[68:71], v[228:231]
    s_add_u32 m0, s40, 6144
    v_mfma_f32_16x16x32_bf16 v[232:235], v[104:107], v[72:75], v[232:235]
    buffer_load_dwordx4 v26, s[24:27], s36 offen lds
    v_lshlrev_b32_e64 v58, 3, v58
    v_mfma_f32_16x16x32_bf16 v[236:239], v[104:107], v[76:79], v[236:239]
    s_waitcnt lgkmcnt(8)
    v_mfma_f32_16x16x32_bf16 v[128:131], v[108:111], v[80:83], v[128:131]
    ds_read_b64_tr_b16 v[96:97], v35 offset:160
    ds_read_b64_tr_b16 v[98:99], v35 offset:3744
    v_lshl_add_u32 v58, v56, 7, v58
    v_mfma_f32_16x16x32_bf16 v[132:135], v[108:111], v[84:87], v[132:135]
    s_add_u32 m0, s41, 0
    s_add_u32 s36, s45, 200704
    v_mfma_f32_16x16x32_bf16 v[136:139], v[108:111], v[88:91], v[136:139]
    ds_read_b128 v[64:67], v30 offset:8192
    buffer_load_dwordx4 v20, s[24:27], s36 offen lds
    v_mfma_f32_16x16x32_bf16 v[140:143], v[108:111], v[92:95], v[140:143]
    v_lshrrev_b32_e64 v59, 1, v18
    ds_read_b128 v[68:71], v30 offset:9216
    s_waitcnt lgkmcnt(10)
    v_mfma_f32_16x16x32_bf16 v[144:147], v[112:115], v[80:83], v[144:147]
    ds_read_b64_tr_b16 v[100:101], v35 offset:192
    ds_read_b64_tr_b16 v[102:103], v35 offset:3776
    v_lshl_add_u32 v58, v59, 10, v58
    v_mfma_f32_16x16x32_bf16 v[148:151], v[112:115], v[84:87], v[148:151]
    s_add_u32 m0, s41, 1024
    v_mfma_f32_16x16x32_bf16 v[152:155], v[112:115], v[88:91], v[152:155]
    ds_read_b128 v[72:75], v30 offset:10240
    buffer_load_dwordx4 v21, s[24:27], s36 offen lds
    v_mfma_f32_16x16x32_bf16 v[156:159], v[112:115], v[92:95], v[156:159]
    v_add_u32 v58, s55, v58
    ds_read_b128 v[76:79], v30 offset:11264
    s_waitcnt lgkmcnt(12)
    v_mfma_f32_16x16x32_bf16 v[160:163], v[116:119], v[80:83], v[160:163]
    s_waitcnt vmcnt(2)
    ds_read_b64_tr_b16 v[104:105], v33 offset:0
    ds_read_b64_tr_b16 v[106:107], v33 offset:3584
    v_mfma_f32_16x16x32_bf16 v[164:167], v[116:119], v[84:87], v[164:167]
    v_xor_b32_e64 v59, 0, v57
    s_add_u32 m0, s41, 2048
    v_mfma_f32_16x16x32_bf16 v[168:171], v[116:119], v[88:91], v[168:171]
    buffer_load_dwordx4 v22, s[24:27], s36 offen lds
    v_lshl_add_u32 v61, v59, 5, v58
    v_mfma_f32_16x16x32_bf16 v[172:175], v[116:119], v[92:95], v[172:175]
    s_waitcnt lgkmcnt(12)
    v_mfma_f32_16x16x32_bf16 v[176:179], v[120:123], v[80:83], v[176:179]
    ds_read_b64_tr_b16 v[108:109], v33 offset:32
    ds_read_b64_tr_b16 v[110:111], v33 offset:3616
    v_xor_b32 v59, 1, v57
    v_mfma_f32_16x16x32_bf16 v[180:183], v[120:123], v[84:87], v[180:183]
    s_add_u32 m0, s41, 3072
    v_mfma_f32_16x16x32_bf16 v[184:187], v[120:123], v[88:91], v[184:187]
    buffer_load_dwordx4 v23, s[24:27], s36 offen lds
    v_lshl_add_u32 v62, v59, 5, v58
    v_mfma_f32_16x16x32_bf16 v[188:191], v[120:123], v[92:95], v[188:191]
    s_waitcnt lgkmcnt(12)
    v_mfma_f32_16x16x32_bf16 v[192:195], v[124:127], v[80:83], v[192:195]
    ds_read_b64_tr_b16 v[112:113], v33 offset:64
    ds_read_b64_tr_b16 v[114:115], v33 offset:3648
    v_xor_b32 v59, 2, v57
    v_mfma_f32_16x16x32_bf16 v[196:199], v[124:127], v[84:87], v[196:199]
    s_add_u32 m0, s41, 4096
    v_mfma_f32_16x16x32_bf16 v[200:203], v[124:127], v[88:91], v[200:203]
    buffer_load_dwordx4 v24, s[24:27], s36 offen lds
    v_lshl_add_u32 v63, v59, 5, v58
    v_mfma_f32_16x16x32_bf16 v[204:207], v[124:127], v[92:95], v[204:207]
    s_waitcnt lgkmcnt(12)
    v_mfma_f32_16x16x32_bf16 v[208:211], v[96:99], v[80:83], v[208:211]
    ds_read_b64_tr_b16 v[116:117], v33 offset:96
    ds_read_b64_tr_b16 v[118:119], v33 offset:3680
    v_xor_b32 v59, 3, v57
    v_mfma_f32_16x16x32_bf16 v[212:215], v[96:99], v[84:87], v[212:215]
    s_add_u32 m0, s41, 5120
    v_mfma_f32_16x16x32_bf16 v[216:219], v[96:99], v[88:91], v[216:219]
    buffer_load_dwordx4 v25, s[24:27], s36 offen lds
    v_lshl_add_u32 v1, v59, 5, v58
    v_mfma_f32_16x16x32_bf16 v[220:223], v[96:99], v[92:95], v[220:223]
    s_waitcnt lgkmcnt(10)
    v_mfma_f32_16x16x32_bf16 v[224:227], v[100:103], v[80:83], v[224:227]
    ds_read_b64_tr_b16 v[120:121], v33 offset:128
    ds_read_b64_tr_b16 v[122:123], v33 offset:3712
    v_add_u32 v32, 131072, v30
    v_mfma_f32_16x16x32_bf16 v[228:231], v[100:103], v[84:87], v[228:231]
    s_add_u32 m0, s41, 6144
    v_mfma_f32_16x16x32_bf16 v[232:235], v[100:103], v[88:91], v[232:235]
    buffer_load_dwordx4 v26, s[24:27], s36 offen lds
    s_add_u32 s47, s55, 0
    v_mfma_f32_16x16x32_bf16 v[236:239], v[100:103], v[92:95], v[236:239]
    s_waitcnt lgkmcnt(8)
    v_mfma_f32_16x16x32_bf16 v[128:131], v[104:107], v[64:67], v[128:131]
    ds_read_b64_tr_b16 v[124:125], v33 offset:160
    ds_read_b64_tr_b16 v[126:127], v33 offset:3744
    s_add_u32 s48, s55, 7168
    v_mfma_f32_16x16x32_bf16 v[132:135], v[104:107], v[68:71], v[132:135]
    s_add_u32 m0, s42, 0
    s_add_u32 s36, s45, 229376
    v_mfma_f32_16x16x32_bf16 v[136:139], v[104:107], v[72:75], v[136:139]
    ds_read_b128 v[80:83], v30 offset:12288
    buffer_load_dwordx4 v20, s[24:27], s36 offen lds
    v_mfma_f32_16x16x32_bf16 v[140:143], v[104:107], v[76:79], v[140:143]
    s_add_u32 s49, s55, 14336
    ds_read_b128 v[84:87], v30 offset:13312
    s_waitcnt lgkmcnt(10)
    v_mfma_f32_16x16x32_bf16 v[144:147], v[108:111], v[64:67], v[144:147]
    ds_read_b64_tr_b16 v[96:97], v33 offset:192
    ds_read_b64_tr_b16 v[98:99], v33 offset:3776
    s_add_u32 s50, s55, 21504
    v_mfma_f32_16x16x32_bf16 v[148:151], v[108:111], v[68:71], v[148:151]
    s_add_u32 m0, s42, 1024
    v_mfma_f32_16x16x32_bf16 v[152:155], v[108:111], v[72:75], v[152:155]
    ds_read_b128 v[88:91], v30 offset:14336
    buffer_load_dwordx4 v21, s[24:27], s36 offen lds
    v_mfma_f32_16x16x32_bf16 v[156:159], v[108:111], v[76:79], v[156:159]
    v_add_u32 v36, s47, v27
    ds_read_b128 v[92:95], v30 offset:15360
    s_waitcnt lgkmcnt(12)
    v_mfma_f32_16x16x32_bf16 v[160:163], v[112:115], v[64:67], v[160:163]
    s_waitcnt vmcnt(2)
    ds_read_b64_tr_b16 v[100:101], v34 offset:0
    ds_read_b64_tr_b16 v[102:103], v34 offset:3584
    v_mfma_f32_16x16x32_bf16 v[164:167], v[112:115], v[68:71], v[164:167]
    v_add_u32_e64 v37, s48, v27
    s_add_u32 m0, s42, 2048
    v_mfma_f32_16x16x32_bf16 v[168:171], v[112:115], v[72:75], v[168:171]
    buffer_load_dwordx4 v22, s[24:27], s36 offen lds
    v_add_u32_e64 v38, s49, v27
    v_mfma_f32_16x16x32_bf16 v[172:175], v[112:115], v[76:79], v[172:175]
    s_waitcnt lgkmcnt(12)
    v_mfma_f32_16x16x32_bf16 v[176:179], v[116:119], v[64:67], v[176:179]
    ds_read_b64_tr_b16 v[104:105], v34 offset:32
    ds_read_b64_tr_b16 v[106:107], v34 offset:3616
    v_add_u32 v39, s50, v27
    v_mfma_f32_16x16x32_bf16 v[180:183], v[116:119], v[68:71], v[180:183]
    s_add_u32 m0, s42, 3072
    v_mfma_f32_16x16x32_bf16 v[184:187], v[116:119], v[72:75], v[184:187]
    buffer_load_dwordx4 v23, s[24:27], s36 offen lds
    s_mul_i32 s51, s3, 200704
    v_mfma_f32_16x16x32_bf16 v[188:191], v[116:119], v[76:79], v[188:191]
    s_waitcnt lgkmcnt(12)
    v_mfma_f32_16x16x32_bf16 v[192:195], v[120:123], v[64:67], v[192:195]
    ds_read_b64_tr_b16 v[108:109], v34 offset:64
    ds_read_b64_tr_b16 v[110:111], v34 offset:3648
    s_and_b32 s39, s3, 1
    v_mfma_f32_16x16x32_bf16 v[196:199], v[120:123], v[68:71], v[196:199]
    s_add_u32 m0, s42, 4096
    v_mfma_f32_16x16x32_bf16 v[200:203], v[120:123], v[72:75], v[200:203]
    buffer_load_dwordx4 v24, s[24:27], s36 offen lds
    s_lshl_b32 s39, s39, 12
    v_mfma_f32_16x16x32_bf16 v[204:207], v[120:123], v[76:79], v[204:207]
    s_waitcnt lgkmcnt(12)
    v_mfma_f32_16x16x32_bf16 v[208:211], v[124:127], v[64:67], v[208:211]
    ds_read_b64_tr_b16 v[112:113], v34 offset:96
    ds_read_b64_tr_b16 v[114:115], v34 offset:3680
    v_add_u32_e64 v19, s39, v30
    v_mfma_f32_16x16x32_bf16 v[212:215], v[124:127], v[68:71], v[212:215]
    s_add_u32 m0, s42, 5120
    v_mfma_f32_16x16x32_bf16 v[216:219], v[124:127], v[72:75], v[216:219]
    buffer_load_dwordx4 v25, s[24:27], s36 offen lds
    v_mfma_f32_16x16x32_bf16 v[220:223], v[124:127], v[76:79], v[220:223]
    s_waitcnt lgkmcnt(10)
    v_mfma_f32_16x16x32_bf16 v[224:227], v[96:99], v[64:67], v[224:227]
    ds_read_b64_tr_b16 v[116:117], v34 offset:128
    ds_read_b64_tr_b16 v[118:119], v34 offset:3712
    v_mfma_f32_16x16x32_bf16 v[228:231], v[96:99], v[68:71], v[228:231]
    s_add_u32 m0, s42, 6144
    v_mfma_f32_16x16x32_bf16 v[232:235], v[96:99], v[72:75], v[232:235]
    buffer_load_dwordx4 v26, s[24:27], s36 offen lds
    v_mfma_f32_16x16x32_bf16 v[236:239], v[96:99], v[76:79], v[236:239]
    s_waitcnt lgkmcnt(8)
    v_mfma_f32_16x16x32_bf16 v[128:131], v[100:103], v[80:83], v[128:131]
    ds_read_b64_tr_b16 v[120:121], v34 offset:160
    ds_read_b64_tr_b16 v[122:123], v34 offset:3744
    v_mfma_f32_16x16x32_bf16 v[132:135], v[100:103], v[84:87], v[132:135]
    s_add_u32 m0, s40, 0
    s_add_u32 s36, s45, 258048
    v_mfma_f32_16x16x32_bf16 v[136:139], v[100:103], v[88:91], v[136:139]
    ds_read_b128 v[64:67], v31 offset:32768
    buffer_load_dwordx4 v20, s[24:27], s36 offen lds
    v_mfma_f32_16x16x32_bf16 v[140:143], v[100:103], v[92:95], v[140:143]
    ds_read_b128 v[68:71], v31 offset:33792
    s_waitcnt lgkmcnt(10)
    v_mfma_f32_16x16x32_bf16 v[144:147], v[104:107], v[80:83], v[144:147]
    ds_read_b64_tr_b16 v[124:125], v34 offset:192
    ds_read_b64_tr_b16 v[126:127], v34 offset:3776
    v_mfma_f32_16x16x32_bf16 v[148:151], v[104:107], v[84:87], v[148:151]
    s_add_u32 m0, s40, 1024
    v_mfma_f32_16x16x32_bf16 v[152:155], v[104:107], v[88:91], v[152:155]
    ds_read_b128 v[72:75], v31 offset:34816
    buffer_load_dwordx4 v21, s[24:27], s36 offen lds
    v_mfma_f32_16x16x32_bf16 v[156:159], v[104:107], v[92:95], v[156:159]
    ds_read_b128 v[76:79], v31 offset:35840
    s_waitcnt lgkmcnt(12)
    v_mfma_f32_16x16x32_bf16 v[160:163], v[108:111], v[80:83], v[160:163]
    s_waitcnt vmcnt(2)
    ds_read_b64_tr_b16 v[96:97], v35 offset:0
    ds_read_b64_tr_b16 v[98:99], v35 offset:3584
    v_mfma_f32_16x16x32_bf16 v[164:167], v[108:111], v[84:87], v[164:167]
    s_add_u32 m0, s40, 2048
    v_mfma_f32_16x16x32_bf16 v[168:171], v[108:111], v[88:91], v[168:171]
    buffer_load_dwordx4 v22, s[24:27], s36 offen lds
    v_mfma_f32_16x16x32_bf16 v[172:175], v[108:111], v[92:95], v[172:175]
    s_waitcnt lgkmcnt(12)
    v_mfma_f32_16x16x32_bf16 v[176:179], v[112:115], v[80:83], v[176:179]
    ds_read_b64_tr_b16 v[100:101], v35 offset:32
    ds_read_b64_tr_b16 v[102:103], v35 offset:3616
    v_mfma_f32_16x16x32_bf16 v[180:183], v[112:115], v[84:87], v[180:183]
    s_add_u32 m0, s40, 3072
    v_mfma_f32_16x16x32_bf16 v[184:187], v[112:115], v[88:91], v[184:187]
    buffer_load_dwordx4 v23, s[24:27], s36 offen lds
    v_mfma_f32_16x16x32_bf16 v[188:191], v[112:115], v[92:95], v[188:191]
    s_waitcnt lgkmcnt(12)
    v_mfma_f32_16x16x32_bf16 v[192:195], v[116:119], v[80:83], v[192:195]
    ds_read_b64_tr_b16 v[104:105], v35 offset:64
    ds_read_b64_tr_b16 v[106:107], v35 offset:3648
    v_mfma_f32_16x16x32_bf16 v[196:199], v[116:119], v[84:87], v[196:199]
    s_add_u32 m0, s40, 4096
    v_mfma_f32_16x16x32_bf16 v[200:203], v[116:119], v[88:91], v[200:203]
    buffer_load_dwordx4 v24, s[24:27], s36 offen lds
    v_mfma_f32_16x16x32_bf16 v[204:207], v[116:119], v[92:95], v[204:207]
    s_waitcnt lgkmcnt(12)
    v_mfma_f32_16x16x32_bf16 v[208:211], v[120:123], v[80:83], v[208:211]
    ds_read_b64_tr_b16 v[108:109], v35 offset:96
    ds_read_b64_tr_b16 v[110:111], v35 offset:3680
    v_mfma_f32_16x16x32_bf16 v[212:215], v[120:123], v[84:87], v[212:215]
    s_add_u32 m0, s40, 5120
    v_mfma_f32_16x16x32_bf16 v[216:219], v[120:123], v[88:91], v[216:219]
    buffer_load_dwordx4 v25, s[24:27], s36 offen lds
    v_mfma_f32_16x16x32_bf16 v[220:223], v[120:123], v[92:95], v[220:223]
    s_waitcnt lgkmcnt(10)
    v_mfma_f32_16x16x32_bf16 v[224:227], v[124:127], v[80:83], v[224:227]
    ds_read_b64_tr_b16 v[112:113], v35 offset:128
    ds_read_b64_tr_b16 v[114:115], v35 offset:3712
    v_mfma_f32_16x16x32_bf16 v[228:231], v[124:127], v[84:87], v[228:231]
    s_add_u32 m0, s40, 6144
    v_mfma_f32_16x16x32_bf16 v[232:235], v[124:127], v[88:91], v[232:235]
    buffer_load_dwordx4 v26, s[24:27], s36 offen lds
    v_mfma_f32_16x16x32_bf16 v[236:239], v[124:127], v[92:95], v[236:239]
    s_waitcnt lgkmcnt(8)
    v_mfma_f32_16x16x32_bf16 v[128:131], v[96:99], v[64:67], v[128:131]
    ds_read_b64_tr_b16 v[116:117], v35 offset:160
    ds_read_b64_tr_b16 v[118:119], v35 offset:3744
    v_mfma_f32_16x16x32_bf16 v[132:135], v[96:99], v[68:71], v[132:135]
    s_add_u32 m0, s41, 0
    s_add_u32 s36, s45, 286720
    v_mfma_f32_16x16x32_bf16 v[136:139], v[96:99], v[72:75], v[136:139]
    ds_read_b128 v[80:83], v31 offset:36864
    buffer_load_dwordx4 v20, s[24:27], s36 offen lds
    v_mfma_f32_16x16x32_bf16 v[140:143], v[96:99], v[76:79], v[140:143]
    ds_read_b128 v[84:87], v31 offset:37888
    s_waitcnt lgkmcnt(10)
    v_mfma_f32_16x16x32_bf16 v[144:147], v[100:103], v[64:67], v[144:147]
    ds_read_b64_tr_b16 v[120:121], v35 offset:192
    ds_read_b64_tr_b16 v[122:123], v35 offset:3776
    v_mfma_f32_16x16x32_bf16 v[148:151], v[100:103], v[68:71], v[148:151]
    s_add_u32 m0, s41, 1024
    v_mfma_f32_16x16x32_bf16 v[152:155], v[100:103], v[72:75], v[152:155]
    ds_read_b128 v[88:91], v31 offset:38912
    buffer_load_dwordx4 v21, s[24:27], s36 offen lds
    v_mfma_f32_16x16x32_bf16 v[156:159], v[100:103], v[76:79], v[156:159]
    ds_read_b128 v[92:95], v31 offset:39936
    s_waitcnt lgkmcnt(12)
    v_mfma_f32_16x16x32_bf16 v[160:163], v[104:107], v[64:67], v[160:163]
    s_waitcnt vmcnt(2)
    ds_read_b64_tr_b16 v[124:125], v33 offset:0
    ds_read_b64_tr_b16 v[126:127], v33 offset:3584
    v_mfma_f32_16x16x32_bf16 v[164:167], v[104:107], v[68:71], v[164:167]
    s_add_u32 m0, s41, 2048
    v_mfma_f32_16x16x32_bf16 v[168:171], v[104:107], v[72:75], v[168:171]
    buffer_load_dwordx4 v22, s[24:27], s36 offen lds
    v_mfma_f32_16x16x32_bf16 v[172:175], v[104:107], v[76:79], v[172:175]
    s_waitcnt lgkmcnt(12)
    v_mfma_f32_16x16x32_bf16 v[176:179], v[108:111], v[64:67], v[176:179]
    ds_read_b64_tr_b16 v[96:97], v33 offset:32
    ds_read_b64_tr_b16 v[98:99], v33 offset:3616
    v_mfma_f32_16x16x32_bf16 v[180:183], v[108:111], v[68:71], v[180:183]
    s_add_u32 m0, s41, 3072
    v_mfma_f32_16x16x32_bf16 v[184:187], v[108:111], v[72:75], v[184:187]
    buffer_load_dwordx4 v23, s[24:27], s36 offen lds
    v_mfma_f32_16x16x32_bf16 v[188:191], v[108:111], v[76:79], v[188:191]
    s_waitcnt lgkmcnt(12)
    v_mfma_f32_16x16x32_bf16 v[192:195], v[112:115], v[64:67], v[192:195]
    ds_read_b64_tr_b16 v[100:101], v33 offset:64
    ds_read_b64_tr_b16 v[102:103], v33 offset:3648
    v_mfma_f32_16x16x32_bf16 v[196:199], v[112:115], v[68:71], v[196:199]
    s_add_u32 m0, s41, 4096
    v_mfma_f32_16x16x32_bf16 v[200:203], v[112:115], v[72:75], v[200:203]
    buffer_load_dwordx4 v24, s[24:27], s36 offen lds
    v_mfma_f32_16x16x32_bf16 v[204:207], v[112:115], v[76:79], v[204:207]
    s_waitcnt lgkmcnt(12)
    v_mfma_f32_16x16x32_bf16 v[208:211], v[116:119], v[64:67], v[208:211]
    ds_read_b64_tr_b16 v[104:105], v33 offset:96
    ds_read_b64_tr_b16 v[106:107], v33 offset:3680
    v_mfma_f32_16x16x32_bf16 v[212:215], v[116:119], v[68:71], v[212:215]
    s_add_u32 m0, s41, 5120
    v_mfma_f32_16x16x32_bf16 v[216:219], v[116:119], v[72:75], v[216:219]
    buffer_load_dwordx4 v25, s[24:27], s36 offen lds
    v_mfma_f32_16x16x32_bf16 v[220:223], v[116:119], v[76:79], v[220:223]
    s_waitcnt lgkmcnt(10)
    v_mfma_f32_16x16x32_bf16 v[224:227], v[120:123], v[64:67], v[224:227]
    ds_read_b64_tr_b16 v[108:109], v33 offset:128
    ds_read_b64_tr_b16 v[110:111], v33 offset:3712
    v_mfma_f32_16x16x32_bf16 v[228:231], v[120:123], v[68:71], v[228:231]
    s_add_u32 m0, s41, 6144
    v_mfma_f32_16x16x32_bf16 v[232:235], v[120:123], v[72:75], v[232:235]
    buffer_load_dwordx4 v26, s[24:27], s36 offen lds
    v_mfma_f32_16x16x32_bf16 v[236:239], v[120:123], v[76:79], v[236:239]
    s_waitcnt lgkmcnt(8)
    v_mfma_f32_16x16x32_bf16 v[128:131], v[124:127], v[80:83], v[128:131]
    ds_read_b64_tr_b16 v[112:113], v33 offset:160
    ds_read_b64_tr_b16 v[114:115], v33 offset:3744
    v_mfma_f32_16x16x32_bf16 v[132:135], v[124:127], v[84:87], v[132:135]
    s_add_u32 m0, s42, 0
    s_add_u32 s36, s45, 315392
    v_mfma_f32_16x16x32_bf16 v[136:139], v[124:127], v[88:91], v[136:139]
    ds_read_b128 v[64:67], v31 offset:40960
    buffer_load_dwordx4 v20, s[24:27], s36 offen lds
    v_mfma_f32_16x16x32_bf16 v[140:143], v[124:127], v[92:95], v[140:143]
    ds_read_b128 v[68:71], v31 offset:41984
    s_waitcnt lgkmcnt(10)
    v_mfma_f32_16x16x32_bf16 v[144:147], v[96:99], v[80:83], v[144:147]
    ds_read_b64_tr_b16 v[116:117], v33 offset:192
    ds_read_b64_tr_b16 v[118:119], v33 offset:3776
    v_mfma_f32_16x16x32_bf16 v[148:151], v[96:99], v[84:87], v[148:151]
    s_add_u32 m0, s42, 1024
    v_mfma_f32_16x16x32_bf16 v[152:155], v[96:99], v[88:91], v[152:155]
    ds_read_b128 v[72:75], v31 offset:43008
    buffer_load_dwordx4 v21, s[24:27], s36 offen lds
    v_mfma_f32_16x16x32_bf16 v[156:159], v[96:99], v[92:95], v[156:159]
    ds_read_b128 v[76:79], v31 offset:44032
    s_waitcnt lgkmcnt(12)
    v_mfma_f32_16x16x32_bf16 v[160:163], v[100:103], v[80:83], v[160:163]
    s_waitcnt vmcnt(2)
    ds_read_b64_tr_b16 v[120:121], v34 offset:0
    ds_read_b64_tr_b16 v[122:123], v34 offset:3584
    v_mfma_f32_16x16x32_bf16 v[164:167], v[100:103], v[84:87], v[164:167]
    s_add_u32 m0, s42, 2048
    v_mfma_f32_16x16x32_bf16 v[168:171], v[100:103], v[88:91], v[168:171]
    buffer_load_dwordx4 v22, s[24:27], s36 offen lds
    v_mfma_f32_16x16x32_bf16 v[172:175], v[100:103], v[92:95], v[172:175]
    s_waitcnt lgkmcnt(12)
    v_mfma_f32_16x16x32_bf16 v[176:179], v[104:107], v[80:83], v[176:179]
    ds_read_b64_tr_b16 v[124:125], v34 offset:32
    ds_read_b64_tr_b16 v[126:127], v34 offset:3616
    v_mfma_f32_16x16x32_bf16 v[180:183], v[104:107], v[84:87], v[180:183]
    s_add_u32 m0, s42, 3072
    v_mfma_f32_16x16x32_bf16 v[184:187], v[104:107], v[88:91], v[184:187]
    buffer_load_dwordx4 v23, s[24:27], s36 offen lds
    v_mfma_f32_16x16x32_bf16 v[188:191], v[104:107], v[92:95], v[188:191]
    s_waitcnt lgkmcnt(12)
    v_mfma_f32_16x16x32_bf16 v[192:195], v[108:111], v[80:83], v[192:195]
    ds_read_b64_tr_b16 v[96:97], v34 offset:64
    ds_read_b64_tr_b16 v[98:99], v34 offset:3648
    v_mfma_f32_16x16x32_bf16 v[196:199], v[108:111], v[84:87], v[196:199]
    s_add_u32 m0, s42, 4096
    v_mfma_f32_16x16x32_bf16 v[200:203], v[108:111], v[88:91], v[200:203]
    buffer_load_dwordx4 v24, s[24:27], s36 offen lds
    v_mfma_f32_16x16x32_bf16 v[204:207], v[108:111], v[92:95], v[204:207]
    s_waitcnt lgkmcnt(12)
    v_mfma_f32_16x16x32_bf16 v[208:211], v[112:115], v[80:83], v[208:211]
    ds_read_b64_tr_b16 v[100:101], v34 offset:96
    ds_read_b64_tr_b16 v[102:103], v34 offset:3680
    v_mfma_f32_16x16x32_bf16 v[212:215], v[112:115], v[84:87], v[212:215]
    s_add_u32 m0, s42, 5120
    v_mfma_f32_16x16x32_bf16 v[216:219], v[112:115], v[88:91], v[216:219]
    buffer_load_dwordx4 v25, s[24:27], s36 offen lds
    v_mfma_f32_16x16x32_bf16 v[220:223], v[112:115], v[92:95], v[220:223]
    s_waitcnt lgkmcnt(10)
    v_mfma_f32_16x16x32_bf16 v[224:227], v[116:119], v[80:83], v[224:227]
    ds_read_b64_tr_b16 v[104:105], v34 offset:128
    ds_read_b64_tr_b16 v[106:107], v34 offset:3712
    v_mfma_f32_16x16x32_bf16 v[228:231], v[116:119], v[84:87], v[228:231]
    s_add_u32 m0, s42, 6144
    v_mfma_f32_16x16x32_bf16 v[232:235], v[116:119], v[88:91], v[232:235]
    buffer_load_dwordx4 v26, s[24:27], s36 offen lds
    v_mfma_f32_16x16x32_bf16 v[236:239], v[116:119], v[92:95], v[236:239]
    s_waitcnt lgkmcnt(8)
    v_mfma_f32_16x16x32_bf16 v[128:131], v[120:123], v[64:67], v[128:131]
    ds_read_b64_tr_b16 v[108:109], v34 offset:160
    ds_read_b64_tr_b16 v[110:111], v34 offset:3744
    v_mfma_f32_16x16x32_bf16 v[132:135], v[120:123], v[68:71], v[132:135]
    s_add_u32 m0, s40, 0
    s_add_u32 s36, s45, 344064
    v_mfma_f32_16x16x32_bf16 v[136:139], v[120:123], v[72:75], v[136:139]
    ds_read_b128 v[80:83], v31 offset:45056
    buffer_load_dwordx4 v20, s[24:27], s36 offen lds
    v_mfma_f32_16x16x32_bf16 v[140:143], v[120:123], v[76:79], v[140:143]
    ds_read_b128 v[84:87], v31 offset:46080
    s_waitcnt lgkmcnt(10)
    v_mfma_f32_16x16x32_bf16 v[144:147], v[124:127], v[64:67], v[144:147]
    ds_read_b64_tr_b16 v[112:113], v34 offset:192
    ds_read_b64_tr_b16 v[114:115], v34 offset:3776
    v_mfma_f32_16x16x32_bf16 v[148:151], v[124:127], v[68:71], v[148:151]
    s_add_u32 m0, s40, 1024
    v_mfma_f32_16x16x32_bf16 v[152:155], v[124:127], v[72:75], v[152:155]
    ds_read_b128 v[88:91], v31 offset:47104
    buffer_load_dwordx4 v21, s[24:27], s36 offen lds
    v_mfma_f32_16x16x32_bf16 v[156:159], v[124:127], v[76:79], v[156:159]
    ds_read_b128 v[92:95], v31 offset:48128
    s_waitcnt lgkmcnt(12)
    v_mfma_f32_16x16x32_bf16 v[160:163], v[96:99], v[64:67], v[160:163]
    s_waitcnt vmcnt(2)
    ds_read_b64_tr_b16 v[116:117], v35 offset:0
    ds_read_b64_tr_b16 v[118:119], v35 offset:3584
    v_mfma_f32_16x16x32_bf16 v[164:167], v[96:99], v[68:71], v[164:167]
    s_add_u32 m0, s40, 2048
    v_mfma_f32_16x16x32_bf16 v[168:171], v[96:99], v[72:75], v[168:171]
    buffer_load_dwordx4 v22, s[24:27], s36 offen lds
    v_mfma_f32_16x16x32_bf16 v[172:175], v[96:99], v[76:79], v[172:175]
    s_waitcnt lgkmcnt(12)
    v_mfma_f32_16x16x32_bf16 v[176:179], v[100:103], v[64:67], v[176:179]
    ds_read_b64_tr_b16 v[120:121], v35 offset:32
    ds_read_b64_tr_b16 v[122:123], v35 offset:3616
    v_mfma_f32_16x16x32_bf16 v[180:183], v[100:103], v[68:71], v[180:183]
    s_add_u32 m0, s40, 3072
    v_mfma_f32_16x16x32_bf16 v[184:187], v[100:103], v[72:75], v[184:187]
    buffer_load_dwordx4 v23, s[24:27], s36 offen lds
    v_mfma_f32_16x16x32_bf16 v[188:191], v[100:103], v[76:79], v[188:191]
    s_waitcnt lgkmcnt(12)
    v_mfma_f32_16x16x32_bf16 v[192:195], v[104:107], v[64:67], v[192:195]
    ds_read_b64_tr_b16 v[124:125], v35 offset:64
    ds_read_b64_tr_b16 v[126:127], v35 offset:3648
    v_mfma_f32_16x16x32_bf16 v[196:199], v[104:107], v[68:71], v[196:199]
    s_add_u32 m0, s40, 4096
    v_mfma_f32_16x16x32_bf16 v[200:203], v[104:107], v[72:75], v[200:203]
    buffer_load_dwordx4 v24, s[24:27], s36 offen lds
    v_mfma_f32_16x16x32_bf16 v[204:207], v[104:107], v[76:79], v[204:207]
    s_waitcnt lgkmcnt(12)
    v_mfma_f32_16x16x32_bf16 v[208:211], v[108:111], v[64:67], v[208:211]
    ds_read_b64_tr_b16 v[96:97], v35 offset:96
    ds_read_b64_tr_b16 v[98:99], v35 offset:3680
    v_mfma_f32_16x16x32_bf16 v[212:215], v[108:111], v[68:71], v[212:215]
    s_add_u32 m0, s40, 5120
    v_mfma_f32_16x16x32_bf16 v[216:219], v[108:111], v[72:75], v[216:219]
    buffer_load_dwordx4 v25, s[24:27], s36 offen lds
    v_mfma_f32_16x16x32_bf16 v[220:223], v[108:111], v[76:79], v[220:223]
    s_waitcnt lgkmcnt(10)
    v_mfma_f32_16x16x32_bf16 v[224:227], v[112:115], v[64:67], v[224:227]
    ds_read_b64_tr_b16 v[100:101], v35 offset:128
    ds_read_b64_tr_b16 v[102:103], v35 offset:3712
    v_mfma_f32_16x16x32_bf16 v[228:231], v[112:115], v[68:71], v[228:231]
    s_add_u32 m0, s40, 6144
    v_mfma_f32_16x16x32_bf16 v[232:235], v[112:115], v[72:75], v[232:235]
    buffer_load_dwordx4 v26, s[24:27], s36 offen lds
    v_mfma_f32_16x16x32_bf16 v[236:239], v[112:115], v[76:79], v[236:239]
    s_waitcnt lgkmcnt(8)
    v_mfma_f32_16x16x32_bf16 v[128:131], v[116:119], v[80:83], v[128:131]
    ds_read_b64_tr_b16 v[104:105], v35 offset:160
    ds_read_b64_tr_b16 v[106:107], v35 offset:3744
    v_mfma_f32_16x16x32_bf16 v[132:135], v[116:119], v[84:87], v[132:135]
    s_add_u32 m0, s41, 0
    s_add_u32 s36, s45, 372736
    v_mfma_f32_16x16x32_bf16 v[136:139], v[116:119], v[88:91], v[136:139]
    ds_read_b128 v[64:67], v31 offset:0
    buffer_load_dwordx4 v20, s[24:27], s36 offen lds
    v_mfma_f32_16x16x32_bf16 v[140:143], v[116:119], v[92:95], v[140:143]
    ds_read_b128 v[68:71], v31 offset:1024
    s_waitcnt lgkmcnt(10)
    v_mfma_f32_16x16x32_bf16 v[144:147], v[120:123], v[80:83], v[144:147]
    ds_read_b64_tr_b16 v[108:109], v35 offset:192
    ds_read_b64_tr_b16 v[110:111], v35 offset:3776
    v_mfma_f32_16x16x32_bf16 v[148:151], v[120:123], v[84:87], v[148:151]
    s_add_u32 m0, s41, 1024
    v_mfma_f32_16x16x32_bf16 v[152:155], v[120:123], v[88:91], v[152:155]
    ds_read_b128 v[72:75], v31 offset:2048
    buffer_load_dwordx4 v21, s[24:27], s36 offen lds
    v_mfma_f32_16x16x32_bf16 v[156:159], v[120:123], v[92:95], v[156:159]
    ds_read_b128 v[76:79], v31 offset:3072
    s_waitcnt lgkmcnt(12)
    v_mfma_f32_16x16x32_bf16 v[160:163], v[124:127], v[80:83], v[160:163]
    s_waitcnt vmcnt(2)
    ds_read_b64_tr_b16 v[112:113], v33 offset:0
    ds_read_b64_tr_b16 v[114:115], v33 offset:3584
    v_mfma_f32_16x16x32_bf16 v[164:167], v[124:127], v[84:87], v[164:167]
    s_add_u32 m0, s41, 2048
    v_mfma_f32_16x16x32_bf16 v[168:171], v[124:127], v[88:91], v[168:171]
    buffer_load_dwordx4 v22, s[24:27], s36 offen lds
    v_mfma_f32_16x16x32_bf16 v[172:175], v[124:127], v[92:95], v[172:175]
    s_waitcnt lgkmcnt(12)
    v_mfma_f32_16x16x32_bf16 v[176:179], v[96:99], v[80:83], v[176:179]
    ds_read_b64_tr_b16 v[116:117], v33 offset:32
    ds_read_b64_tr_b16 v[118:119], v33 offset:3616
    v_mfma_f32_16x16x32_bf16 v[180:183], v[96:99], v[84:87], v[180:183]
    s_add_u32 m0, s41, 3072
    v_mfma_f32_16x16x32_bf16 v[184:187], v[96:99], v[88:91], v[184:187]
    buffer_load_dwordx4 v23, s[24:27], s36 offen lds
    v_mfma_f32_16x16x32_bf16 v[188:191], v[96:99], v[92:95], v[188:191]
    s_waitcnt lgkmcnt(12)
    v_mfma_f32_16x16x32_bf16 v[192:195], v[100:103], v[80:83], v[192:195]
    ds_read_b64_tr_b16 v[120:121], v33 offset:64
    ds_read_b64_tr_b16 v[122:123], v33 offset:3648
    v_mfma_f32_16x16x32_bf16 v[196:199], v[100:103], v[84:87], v[196:199]
    s_add_u32 m0, s41, 4096
    v_mfma_f32_16x16x32_bf16 v[200:203], v[100:103], v[88:91], v[200:203]
    buffer_load_dwordx4 v24, s[24:27], s36 offen lds
    v_mfma_f32_16x16x32_bf16 v[204:207], v[100:103], v[92:95], v[204:207]
    s_waitcnt lgkmcnt(12)
    v_mfma_f32_16x16x32_bf16 v[208:211], v[104:107], v[80:83], v[208:211]
    ds_read_b64_tr_b16 v[124:125], v33 offset:96
    ds_read_b64_tr_b16 v[126:127], v33 offset:3680
    v_mfma_f32_16x16x32_bf16 v[212:215], v[104:107], v[84:87], v[212:215]
    s_add_u32 m0, s41, 5120
    v_mfma_f32_16x16x32_bf16 v[216:219], v[104:107], v[88:91], v[216:219]
    buffer_load_dwordx4 v25, s[24:27], s36 offen lds
    v_mfma_f32_16x16x32_bf16 v[220:223], v[104:107], v[92:95], v[220:223]
    s_waitcnt lgkmcnt(10)
    v_mfma_f32_16x16x32_bf16 v[224:227], v[108:111], v[80:83], v[224:227]
    ds_read_b64_tr_b16 v[96:97], v33 offset:128
    ds_read_b64_tr_b16 v[98:99], v33 offset:3712
    v_mfma_f32_16x16x32_bf16 v[228:231], v[108:111], v[84:87], v[228:231]
    s_add_u32 m0, s41, 6144
    v_mfma_f32_16x16x32_bf16 v[232:235], v[108:111], v[88:91], v[232:235]
    buffer_load_dwordx4 v26, s[24:27], s36 offen lds
    v_mfma_f32_16x16x32_bf16 v[236:239], v[108:111], v[92:95], v[236:239]
    s_waitcnt lgkmcnt(8)
    v_mfma_f32_16x16x32_bf16 v[128:131], v[112:115], v[64:67], v[128:131]
    ds_read_b64_tr_b16 v[100:101], v33 offset:160
    ds_read_b64_tr_b16 v[102:103], v33 offset:3744
    v_mfma_f32_16x16x32_bf16 v[132:135], v[112:115], v[68:71], v[132:135]
    s_add_u32 m0, s42, 0
    s_add_u32 s36, s45, 401408
    v_mfma_f32_16x16x32_bf16 v[136:139], v[112:115], v[72:75], v[136:139]
    ds_read_b128 v[80:83], v31 offset:4096
    buffer_load_dwordx4 v20, s[24:27], s36 offen lds
    v_mfma_f32_16x16x32_bf16 v[140:143], v[112:115], v[76:79], v[140:143]
    ds_read_b128 v[84:87], v31 offset:5120
    s_waitcnt lgkmcnt(10)
    v_mfma_f32_16x16x32_bf16 v[144:147], v[116:119], v[64:67], v[144:147]
    ds_read_b64_tr_b16 v[104:105], v33 offset:192
    ds_read_b64_tr_b16 v[106:107], v33 offset:3776
    v_mfma_f32_16x16x32_bf16 v[148:151], v[116:119], v[68:71], v[148:151]
    s_add_u32 m0, s42, 1024
    v_mfma_f32_16x16x32_bf16 v[152:155], v[116:119], v[72:75], v[152:155]
    ds_read_b128 v[88:91], v31 offset:6144
    buffer_load_dwordx4 v21, s[24:27], s36 offen lds
    v_mfma_f32_16x16x32_bf16 v[156:159], v[116:119], v[76:79], v[156:159]
    ds_read_b128 v[92:95], v31 offset:7168
    s_waitcnt lgkmcnt(12)
    v_mfma_f32_16x16x32_bf16 v[160:163], v[120:123], v[64:67], v[160:163]
    s_waitcnt vmcnt(2)
    ds_read_b64_tr_b16 v[108:109], v34 offset:0
    ds_read_b64_tr_b16 v[110:111], v34 offset:3584
    v_mfma_f32_16x16x32_bf16 v[164:167], v[120:123], v[68:71], v[164:167]
    s_add_u32 m0, s42, 2048
    v_mfma_f32_16x16x32_bf16 v[168:171], v[120:123], v[72:75], v[168:171]
    buffer_load_dwordx4 v22, s[24:27], s36 offen lds
    v_mfma_f32_16x16x32_bf16 v[172:175], v[120:123], v[76:79], v[172:175]
    s_waitcnt lgkmcnt(12)
    v_mfma_f32_16x16x32_bf16 v[176:179], v[124:127], v[64:67], v[176:179]
    ds_read_b64_tr_b16 v[112:113], v34 offset:32
    ds_read_b64_tr_b16 v[114:115], v34 offset:3616
    v_mfma_f32_16x16x32_bf16 v[180:183], v[124:127], v[68:71], v[180:183]
    s_add_u32 m0, s42, 3072
    v_mfma_f32_16x16x32_bf16 v[184:187], v[124:127], v[72:75], v[184:187]
    buffer_load_dwordx4 v23, s[24:27], s36 offen lds
    v_mfma_f32_16x16x32_bf16 v[188:191], v[124:127], v[76:79], v[188:191]
    s_waitcnt lgkmcnt(12)
    v_mfma_f32_16x16x32_bf16 v[192:195], v[96:99], v[64:67], v[192:195]
    ds_read_b64_tr_b16 v[116:117], v34 offset:64
    ds_read_b64_tr_b16 v[118:119], v34 offset:3648
    v_mfma_f32_16x16x32_bf16 v[196:199], v[96:99], v[68:71], v[196:199]
    s_add_u32 m0, s42, 4096
    v_mfma_f32_16x16x32_bf16 v[200:203], v[96:99], v[72:75], v[200:203]
    buffer_load_dwordx4 v24, s[24:27], s36 offen lds
    v_mfma_f32_16x16x32_bf16 v[204:207], v[96:99], v[76:79], v[204:207]
    s_waitcnt lgkmcnt(12)
    v_mfma_f32_16x16x32_bf16 v[208:211], v[100:103], v[64:67], v[208:211]
    ds_read_b64_tr_b16 v[120:121], v34 offset:96
    ds_read_b64_tr_b16 v[122:123], v34 offset:3680
    v_mfma_f32_16x16x32_bf16 v[212:215], v[100:103], v[68:71], v[212:215]
    s_add_u32 m0, s42, 5120
    v_mfma_f32_16x16x32_bf16 v[216:219], v[100:103], v[72:75], v[216:219]
    buffer_load_dwordx4 v25, s[24:27], s36 offen lds
    v_mfma_f32_16x16x32_bf16 v[220:223], v[100:103], v[76:79], v[220:223]
    s_waitcnt lgkmcnt(10)
    v_mfma_f32_16x16x32_bf16 v[224:227], v[104:107], v[64:67], v[224:227]
    ds_read_b64_tr_b16 v[124:125], v34 offset:128
    ds_read_b64_tr_b16 v[126:127], v34 offset:3712
    v_mfma_f32_16x16x32_bf16 v[228:231], v[104:107], v[68:71], v[228:231]
    s_add_u32 m0, s42, 6144
    v_mfma_f32_16x16x32_bf16 v[232:235], v[104:107], v[72:75], v[232:235]
    buffer_load_dwordx4 v26, s[24:27], s36 offen lds
    v_mfma_f32_16x16x32_bf16 v[236:239], v[104:107], v[76:79], v[236:239]
    s_waitcnt lgkmcnt(8)
    v_mfma_f32_16x16x32_bf16 v[128:131], v[108:111], v[80:83], v[128:131]
    ds_read_b64_tr_b16 v[96:97], v34 offset:160
    ds_read_b64_tr_b16 v[98:99], v34 offset:3744
    v_mfma_f32_16x16x32_bf16 v[132:135], v[108:111], v[84:87], v[132:135]
    s_add_u32 m0, s40, 0
    s_add_u32 s36, s45, 430080
    v_mfma_f32_16x16x32_bf16 v[136:139], v[108:111], v[88:91], v[136:139]
    ds_read_b128 v[64:67], v31 offset:8192
    buffer_load_dwordx4 v20, s[24:27], s36 offen lds
    v_mfma_f32_16x16x32_bf16 v[140:143], v[108:111], v[92:95], v[140:143]
    ds_read_b128 v[68:71], v31 offset:9216
    s_waitcnt lgkmcnt(10)
    v_mfma_f32_16x16x32_bf16 v[144:147], v[112:115], v[80:83], v[144:147]
    ds_read_b64_tr_b16 v[100:101], v34 offset:192
    ds_read_b64_tr_b16 v[102:103], v34 offset:3776
    v_mfma_f32_16x16x32_bf16 v[148:151], v[112:115], v[84:87], v[148:151]
    s_add_u32 m0, s40, 1024
    v_mfma_f32_16x16x32_bf16 v[152:155], v[112:115], v[88:91], v[152:155]
    ds_read_b128 v[72:75], v31 offset:10240
    buffer_load_dwordx4 v21, s[24:27], s36 offen lds
    v_mfma_f32_16x16x32_bf16 v[156:159], v[112:115], v[92:95], v[156:159]
    ds_read_b128 v[76:79], v31 offset:11264
    s_waitcnt lgkmcnt(12)
    v_mfma_f32_16x16x32_bf16 v[160:163], v[116:119], v[80:83], v[160:163]
    s_waitcnt vmcnt(2)
    ds_read_b64_tr_b16 v[104:105], v35 offset:0
    ds_read_b64_tr_b16 v[106:107], v35 offset:3584
    v_mfma_f32_16x16x32_bf16 v[164:167], v[116:119], v[84:87], v[164:167]
    s_add_u32 m0, s40, 2048
    v_mfma_f32_16x16x32_bf16 v[168:171], v[116:119], v[88:91], v[168:171]
    buffer_load_dwordx4 v22, s[24:27], s36 offen lds
    v_mfma_f32_16x16x32_bf16 v[172:175], v[116:119], v[92:95], v[172:175]
    s_waitcnt lgkmcnt(12)
    v_mfma_f32_16x16x32_bf16 v[176:179], v[120:123], v[80:83], v[176:179]
    ds_read_b64_tr_b16 v[108:109], v35 offset:32
    ds_read_b64_tr_b16 v[110:111], v35 offset:3616
    v_mfma_f32_16x16x32_bf16 v[180:183], v[120:123], v[84:87], v[180:183]
    s_add_u32 m0, s40, 3072
    v_mfma_f32_16x16x32_bf16 v[184:187], v[120:123], v[88:91], v[184:187]
    buffer_load_dwordx4 v23, s[24:27], s36 offen lds
    v_mfma_f32_16x16x32_bf16 v[188:191], v[120:123], v[92:95], v[188:191]
    s_waitcnt lgkmcnt(12)
    v_mfma_f32_16x16x32_bf16 v[192:195], v[124:127], v[80:83], v[192:195]
    ds_read_b64_tr_b16 v[112:113], v35 offset:64
    ds_read_b64_tr_b16 v[114:115], v35 offset:3648
    v_mfma_f32_16x16x32_bf16 v[196:199], v[124:127], v[84:87], v[196:199]
    s_add_u32 m0, s40, 4096
    v_mfma_f32_16x16x32_bf16 v[200:203], v[124:127], v[88:91], v[200:203]
    buffer_load_dwordx4 v24, s[24:27], s36 offen lds
    v_mfma_f32_16x16x32_bf16 v[204:207], v[124:127], v[92:95], v[204:207]
    s_waitcnt lgkmcnt(12)
    v_mfma_f32_16x16x32_bf16 v[208:211], v[96:99], v[80:83], v[208:211]
    ds_read_b64_tr_b16 v[116:117], v35 offset:96
    ds_read_b64_tr_b16 v[118:119], v35 offset:3680
    v_mfma_f32_16x16x32_bf16 v[212:215], v[96:99], v[84:87], v[212:215]
    s_add_u32 m0, s40, 5120
    v_mfma_f32_16x16x32_bf16 v[216:219], v[96:99], v[88:91], v[216:219]
    buffer_load_dwordx4 v25, s[24:27], s36 offen lds
    v_mfma_f32_16x16x32_bf16 v[220:223], v[96:99], v[92:95], v[220:223]
    s_waitcnt lgkmcnt(10)
    v_mfma_f32_16x16x32_bf16 v[224:227], v[100:103], v[80:83], v[224:227]
    ds_read_b64_tr_b16 v[120:121], v35 offset:128
    ds_read_b64_tr_b16 v[122:123], v35 offset:3712
    v_mfma_f32_16x16x32_bf16 v[228:231], v[100:103], v[84:87], v[228:231]
    s_add_u32 m0, s40, 6144
    v_mfma_f32_16x16x32_bf16 v[232:235], v[100:103], v[88:91], v[232:235]
    buffer_load_dwordx4 v26, s[24:27], s36 offen lds
    v_mfma_f32_16x16x32_bf16 v[236:239], v[100:103], v[92:95], v[236:239]
    s_waitcnt lgkmcnt(8)
    v_mfma_f32_16x16x32_bf16 v[128:131], v[104:107], v[64:67], v[128:131]
    ds_read_b64_tr_b16 v[124:125], v35 offset:160
    ds_read_b64_tr_b16 v[126:127], v35 offset:3744
    v_mfma_f32_16x16x32_bf16 v[132:135], v[104:107], v[68:71], v[132:135]
    v_mfma_f32_16x16x32_bf16 v[136:139], v[104:107], v[72:75], v[136:139]
    ds_read_b128 v[80:83], v31 offset:12288
    v_mfma_f32_16x16x32_bf16 v[140:143], v[104:107], v[76:79], v[140:143]
    ds_read_b128 v[84:87], v31 offset:13312
    s_waitcnt lgkmcnt(10)
    v_mfma_f32_16x16x32_bf16 v[144:147], v[108:111], v[64:67], v[144:147]
    ds_read_b64_tr_b16 v[96:97], v35 offset:192
    ds_read_b64_tr_b16 v[98:99], v35 offset:3776
    v_mfma_f32_16x16x32_bf16 v[148:151], v[108:111], v[68:71], v[148:151]
    v_mfma_f32_16x16x32_bf16 v[152:155], v[108:111], v[72:75], v[152:155]
    ds_read_b128 v[88:91], v31 offset:14336
    v_mfma_f32_16x16x32_bf16 v[156:159], v[108:111], v[76:79], v[156:159]
    ds_read_b128 v[92:95], v31 offset:15360
    s_waitcnt lgkmcnt(12)
    v_mfma_f32_16x16x32_bf16 v[160:163], v[112:115], v[64:67], v[160:163]
    s_waitcnt vmcnt(0)
    ds_read_b64_tr_b16 v[100:101], v33 offset:0
    ds_read_b64_tr_b16 v[102:103], v33 offset:3584
    v_mfma_f32_16x16x32_bf16 v[164:167], v[112:115], v[68:71], v[164:167]
    v_mfma_f32_16x16x32_bf16 v[168:171], v[112:115], v[72:75], v[168:171]
    v_mfma_f32_16x16x32_bf16 v[172:175], v[112:115], v[76:79], v[172:175]
    s_waitcnt lgkmcnt(12)
    v_mfma_f32_16x16x32_bf16 v[176:179], v[116:119], v[64:67], v[176:179]
    ds_read_b64_tr_b16 v[104:105], v33 offset:32
    ds_read_b64_tr_b16 v[106:107], v33 offset:3616
    v_mfma_f32_16x16x32_bf16 v[180:183], v[116:119], v[68:71], v[180:183]
    v_mfma_f32_16x16x32_bf16 v[184:187], v[116:119], v[72:75], v[184:187]
    v_mfma_f32_16x16x32_bf16 v[188:191], v[116:119], v[76:79], v[188:191]
    s_waitcnt lgkmcnt(12)
    v_mfma_f32_16x16x32_bf16 v[192:195], v[120:123], v[64:67], v[192:195]
    ds_read_b64_tr_b16 v[108:109], v33 offset:64
    ds_read_b64_tr_b16 v[110:111], v33 offset:3648
    v_mfma_f32_16x16x32_bf16 v[196:199], v[120:123], v[68:71], v[196:199]
    v_mfma_f32_16x16x32_bf16 v[200:203], v[120:123], v[72:75], v[200:203]
    v_mfma_f32_16x16x32_bf16 v[204:207], v[120:123], v[76:79], v[204:207]
    s_waitcnt lgkmcnt(12)
    v_mfma_f32_16x16x32_bf16 v[208:211], v[124:127], v[64:67], v[208:211]
    ds_read_b64_tr_b16 v[112:113], v33 offset:96
    ds_read_b64_tr_b16 v[114:115], v33 offset:3680
    v_mfma_f32_16x16x32_bf16 v[212:215], v[124:127], v[68:71], v[212:215]
    v_mfma_f32_16x16x32_bf16 v[216:219], v[124:127], v[72:75], v[216:219]
    v_mfma_f32_16x16x32_bf16 v[220:223], v[124:127], v[76:79], v[220:223]
    s_waitcnt lgkmcnt(10)
    v_mfma_f32_16x16x32_bf16 v[224:227], v[96:99], v[64:67], v[224:227]
    ds_read_b64_tr_b16 v[116:117], v33 offset:128
    ds_read_b64_tr_b16 v[118:119], v33 offset:3712
    s_add_u32 s37, s46, 0
    v_mfma_f32_16x16x32_bf16 v[228:231], v[96:99], v[68:71], v[228:231]
    s_add_u32 s38, s46, 114688
    s_add_u32 s39, s46, 229376
    s_add_u32 s54, s46, 344064
    v_mfma_f32_16x16x32_bf16 v[232:235], v[96:99], v[72:75], v[232:235]
    v_mfma_f32_16x16x32_bf16 v[236:239], v[96:99], v[76:79], v[236:239]
    s_waitcnt lgkmcnt(8)
    v_mfma_f32_16x16x32_bf16 v[128:131], v[100:103], v[80:83], v[128:131]
    ds_read_b64_tr_b16 v[120:121], v33 offset:160
    ds_read_b64_tr_b16 v[122:123], v33 offset:3744
    v_mfma_f32_16x16x32_bf16 v[132:135], v[100:103], v[84:87], v[132:135]
    v_mfma_f32_16x16x32_bf16 v[136:139], v[100:103], v[88:91], v[136:139]
    v_mfma_f32_16x16x32_bf16 v[140:143], v[100:103], v[92:95], v[140:143]
    s_waitcnt lgkmcnt(8)
    v_mfma_f32_16x16x32_bf16 v[144:147], v[104:107], v[80:83], v[144:147]
    ds_read_b64_tr_b16 v[124:125], v33 offset:192
    ds_read_b64_tr_b16 v[126:127], v33 offset:3776
    v_mfma_f32_16x16x32_bf16 v[148:151], v[104:107], v[84:87], v[148:151]
    v_mfma_f32_16x16x32_bf16 v[152:155], v[104:107], v[88:91], v[152:155]
    v_mfma_f32_16x16x32_bf16 v[156:159], v[104:107], v[92:95], v[156:159]
    s_waitcnt lgkmcnt(8)
    v_mfma_f32_16x16x32_bf16 v[160:163], v[108:111], v[80:83], v[160:163]
    v_mfma_f32_16x16x32_bf16 v[164:167], v[108:111], v[84:87], v[164:167]
    v_cvt_pk_bf16_f32 v128, v128, v129
    v_cvt_pk_bf16_f32 v129, v130, v131
    v_cvt_pk_bf16_f32 v130, v144, v145
    v_mfma_f32_16x16x32_bf16 v[168:171], v[108:111], v[88:91], v[168:171]
    v_cvt_pk_bf16_f32 v131, v146, v147
    buffer_store_dwordx4 v[128:131], v28, s[32:35], s37 offen offset:0 sc0 sc1
    v_cvt_pk_bf16_f32 v132, v132, v133
    v_mfma_f32_16x16x32_bf16 v[172:175], v[108:111], v[92:95], v[172:175]
    v_cvt_pk_bf16_f32 v133, v134, v135
    v_cvt_pk_bf16_f32 v134, v148, v149
    v_cvt_pk_bf16_f32 v135, v150, v151
    s_waitcnt lgkmcnt(6)
    v_mfma_f32_16x16x32_bf16 v[176:179], v[112:115], v[80:83], v[176:179]
    buffer_store_dwordx4 v[132:135], v28, s[32:35], s38 offen offset:0 sc0 sc1
    v_cvt_pk_bf16_f32 v136, v136, v137
    v_cvt_pk_bf16_f32 v137, v138, v139
    v_mfma_f32_16x16x32_bf16 v[180:183], v[112:115], v[84:87], v[180:183]
    v_cvt_pk_bf16_f32 v138, v152, v153
    v_cvt_pk_bf16_f32 v139, v154, v155
    buffer_store_dwordx4 v[136:139], v28, s[32:35], s39 offen offset:0 sc0 sc1
    v_mfma_f32_16x16x32_bf16 v[184:187], v[112:115], v[88:91], v[184:187]
    v_cvt_pk_bf16_f32 v140, v140, v141
    v_cvt_pk_bf16_f32 v141, v142, v143
    v_cvt_pk_bf16_f32 v142, v156, v157
    v_mfma_f32_16x16x32_bf16 v[188:191], v[112:115], v[92:95], v[188:191]
    v_cvt_pk_bf16_f32 v143, v158, v159
    buffer_store_dwordx4 v[140:143], v28, s[32:35], s54 offen offset:0 sc0 sc1
    s_waitcnt lgkmcnt(4)
    v_mfma_f32_16x16x32_bf16 v[192:195], v[116:119], v[80:83], v[192:195]
    v_mfma_f32_16x16x32_bf16 v[196:199], v[116:119], v[84:87], v[196:199]
    v_cvt_pk_bf16_f32 v160, v160, v161
    v_cvt_pk_bf16_f32 v161, v162, v163
    v_cvt_pk_bf16_f32 v162, v176, v177
    v_mfma_f32_16x16x32_bf16 v[200:203], v[116:119], v[88:91], v[200:203]
    v_cvt_pk_bf16_f32 v163, v178, v179
    buffer_store_dwordx4 v[160:163], v28, s[32:35], s37 offen offset:512 sc0 sc1
    v_cvt_pk_bf16_f32 v164, v164, v165
    v_mfma_f32_16x16x32_bf16 v[204:207], v[116:119], v[92:95], v[204:207]
    v_cvt_pk_bf16_f32 v165, v166, v167
    v_cvt_pk_bf16_f32 v166, v180, v181
    v_cvt_pk_bf16_f32 v167, v182, v183
    s_waitcnt lgkmcnt(2)
    v_mfma_f32_16x16x32_bf16 v[208:211], v[120:123], v[80:83], v[208:211]
    buffer_store_dwordx4 v[164:167], v28, s[32:35], s38 offen offset:512 sc0 sc1
    v_cvt_pk_bf16_f32 v168, v168, v169
    v_cvt_pk_bf16_f32 v169, v170, v171
    v_mfma_f32_16x16x32_bf16 v[212:215], v[120:123], v[84:87], v[212:215]
    v_cvt_pk_bf16_f32 v170, v184, v185
    v_cvt_pk_bf16_f32 v171, v186, v187
    buffer_store_dwordx4 v[168:171], v28, s[32:35], s39 offen offset:512 sc0 sc1
    v_mfma_f32_16x16x32_bf16 v[216:219], v[120:123], v[88:91], v[216:219]
    v_cvt_pk_bf16_f32 v172, v172, v173
    v_cvt_pk_bf16_f32 v173, v174, v175
    v_cvt_pk_bf16_f32 v174, v188, v189
    v_mfma_f32_16x16x32_bf16 v[220:223], v[120:123], v[92:95], v[220:223]
    v_cvt_pk_bf16_f32 v175, v190, v191
    buffer_store_dwordx4 v[172:175], v28, s[32:35], s54 offen offset:512 sc0 sc1
    s_waitcnt lgkmcnt(0)
    v_mfma_f32_16x16x32_bf16 v[224:227], v[124:127], v[80:83], v[224:227]
    v_mfma_f32_16x16x32_bf16 v[228:231], v[124:127], v[84:87], v[228:231]
    v_mfma_f32_16x16x32_bf16 v[232:235], v[124:127], v[88:91], v[232:235]
    v_mfma_f32_16x16x32_bf16 v[236:239], v[124:127], v[92:95], v[236:239]
    v_cvt_pk_bf16_f32 v192, v192, v193
    v_cvt_pk_bf16_f32 v193, v194, v195
    v_cvt_pk_bf16_f32 v194, v208, v209
    v_cvt_pk_bf16_f32 v195, v210, v211
    buffer_store_dwordx4 v[192:195], v28, s[32:35], s37 offen offset:1024 sc0 sc1
    v_cvt_pk_bf16_f32 v196, v196, v197
    v_cvt_pk_bf16_f32 v197, v198, v199
    v_cvt_pk_bf16_f32 v198, v212, v213
    v_cvt_pk_bf16_f32 v199, v214, v215
    buffer_store_dwordx4 v[196:199], v28, s[32:35], s38 offen offset:1024 sc0 sc1
    v_cvt_pk_bf16_f32 v200, v200, v201
    v_cvt_pk_bf16_f32 v201, v202, v203
    v_cvt_pk_bf16_f32 v202, v216, v217
    v_cvt_pk_bf16_f32 v203, v218, v219
    buffer_store_dwordx4 v[200:203], v28, s[32:35], s39 offen offset:1024 sc0 sc1
    v_cvt_pk_bf16_f32 v204, v204, v205
    v_cvt_pk_bf16_f32 v205, v206, v207
    v_cvt_pk_bf16_f32 v206, v220, v221
    v_cvt_pk_bf16_f32 v207, v222, v223
    buffer_store_dwordx4 v[204:207], v28, s[32:35], s54 offen offset:1024 sc0 sc1
    v_cvt_pk_bf16_f32 v224, v224, v225
    v_cvt_pk_bf16_f32 v225, v226, v227
    buffer_store_dwordx2 v[224:225], v29, s[32:35], s37 offen sc0 sc1
    v_cvt_pk_bf16_f32 v228, v228, v229
    v_cvt_pk_bf16_f32 v229, v230, v231
    buffer_store_dwordx2 v[228:229], v29, s[32:35], s38 offen sc0 sc1
    v_cvt_pk_bf16_f32 v232, v232, v233
    v_cvt_pk_bf16_f32 v233, v234, v235
    buffer_store_dwordx2 v[232:233], v29, s[32:35], s39 offen sc0 sc1
    v_cvt_pk_bf16_f32 v236, v236, v237
    v_cvt_pk_bf16_f32 v237, v238, v239
    buffer_store_dwordx2 v[236:237], v29, s[32:35], s54 offen sc0 sc1
    s_lshl_b32 s36, s4, 9
    s_lshl_b32 s37, s5, 7
    s_add_u32 s36, s36, s37
    s_add_u32 s36, s36, 0
    buffer_load_dword v56, v9, s[72:75], s36 offen sc0 sc1
    s_mov_b32 s24, s58
    s_mov_b32 s25, s59
    s_mov_b32 s26, 3584
    s_mov_b32 s27, 0x00020000
    s_mul_i32 s38, s52, 7168
    s_mul_i32 s39, s5, 224
    s_add_u32 s38, s38, s39
    buffer_load_dwordx2 v[128:129], v7, s[12:15], s38 offen offset:0
    buffer_load_dwordx2 v[130:131], v7, s[12:15], s38 offen offset:32
    buffer_load_dwordx2 v[132:133], v7, s[12:15], s38 offen offset:64
    buffer_load_dwordx2 v[134:135], v7, s[12:15], s38 offen offset:96
    s_mul_i32 s39, s5, 448
    s_add_u32 s38, s39, 3584
    buffer_load_dwordx4 v[136:139], v8, s[16:19], s38 offen offset:0 sc0 sc1
    buffer_load_dwordx4 v[140:143], v8, s[16:19], s38 offen offset:64 sc0 sc1
    buffer_load_dwordx4 v[144:147], v8, s[16:19], s38 offen offset:128 sc0 sc1
    buffer_load_dwordx4 v[148:151], v8, s[16:19], s38 offen offset:192 sc0 sc1
    s_add_u32 s38, s39, 7168
    buffer_load_dwordx4 v[152:155], v8, s[16:19], s38 offen offset:0 sc0 sc1
    buffer_load_dwordx4 v[156:159], v8, s[16:19], s38 offen offset:64 sc0 sc1
    buffer_load_dwordx4 v[160:163], v8, s[16:19], s38 offen offset:128 sc0 sc1
    buffer_load_dwordx4 v[164:167], v8, s[16:19], s38 offen offset:192 sc0 sc1
    s_add_u32 s38, s39, 5376
    buffer_load_dwordx4 v[168:171], v8, s[16:19], s38 offen offset:0 sc0 sc1
    buffer_load_dwordx4 v[172:175], v8, s[16:19], s38 offen offset:64 sc0 sc1
    buffer_load_dwordx4 v[176:179], v8, s[16:19], s38 offen offset:128 sc0 sc1
    buffer_load_dwordx4 v[180:183], v8, s[16:19], s38 offen offset:192 sc0 sc1
    s_lshl_b32 s38, s5, 7
    s_add_u32 s38, s38, s43
    v_lshlrev_b32 v57, 3, v18
    buffer_load_dwordx2 v[184:185], v57, s[24:27], s38 offen offset:0
    buffer_load_dwordx2 v[186:187], v57, s[24:27], s38 offen offset:32
    buffer_load_dwordx2 v[188:189], v57, s[24:27], s38 offen offset:64
    buffer_load_dwordx2 v[190:191], v57, s[24:27], s38 offen offset:96
    s_barrier
    s_lshl_b32 s38, s3, 2
    s_add_u32 s38, s38, s36
    s_lshl_b32 s40, 1, s3
    s_mov_b32 s54, 0
    s_mov_b32 s37, 65536
    v_mov_b32 v14, 0
    v_mov_b32_e64 v15, s60
    v_mov_b32 v58, 0x00003f80
    v_mov_b32 v59, 0x3f800000
    s_waitcnt vmcnt(21)
    s_mov_b64 exec, 1
    buffer_store_dword v15, v14, s[72:75], s38 offen sc0 sc1
    s_mov_b64 exec, -1
    s_waitcnt vmcnt(21)
    s_branch L_poll0_in
L_poll0_l:
    s_sleep 1
    buffer_load_dword v56, v9, s[72:75], s36 offen sc0 sc1
    s_waitcnt vmcnt(0)
L_poll0_in:
    v_cmp_eq_u32 vcc, s60, v56
    s_sub_u32 s37, s37, 1
    s_cmp_eq_u32 s37, 0
    s_cselect_b32 s45, -1, vcc_lo
    s_or_b32 s45, s45, s40
    s_andn2_b32 s45, s45, s54
    s_bitcmp0_b32 s45, 0
    s_cbranch_scc1 L_pr0_0
    s_add_u32 s38, s53, 0
    buffer_load_dwordx4 v[64:67], v5, s[32:35], s38 offen sc0 sc1
    buffer_load_dwordx4 v[68:71], v6, s[32:35], s38 offen sc0 sc1
L_pr0_0:
    s_bitcmp0_b32 s45, 1
    s_cbranch_scc1 L_pr0_1
    s_add_u32 s38, s53, 7168
    buffer_load_dwordx4 v[72:75], v5, s[32:35], s38 offen sc0 sc1
    buffer_load_dwordx4 v[76:79], v6, s[32:35], s38 offen sc0 sc1
L_pr0_1:
    s_bitcmp0_b32 s45, 2
    s_cbranch_scc1 L_pr0_2
    s_add_u32 s38, s53, 14336
    buffer_load_dwordx4 v[80:83], v5, s[32:35], s38 offen sc0 sc1
    buffer_load_dwordx4 v[84:87], v6, s[32:35], s38 offen sc0 sc1
L_pr0_2:
    s_bitcmp0_b32 s45, 3
    s_cbranch_scc1 L_pr0_3
    s_add_u32 s38, s53, 21504
    buffer_load_dwordx4 v[88:91], v5, s[32:35], s38 offen sc0 sc1
    buffer_load_dwordx4 v[92:95], v6, s[32:35], s38 offen sc0 sc1
L_pr0_3:
    s_bitcmp0_b32 s45, 4
    s_cbranch_scc1 L_pr0_4
    s_add_u32 s38, s53, 28672
    buffer_load_dwordx4 v[96:99], v5, s[32:35], s38 offen sc0 sc1
    buffer_load_dwordx4 v[100:103], v6, s[32:35], s38 offen sc0 sc1
L_pr0_4:
    s_bitcmp0_b32 s45, 5
    s_cbranch_scc1 L_pr0_5
    s_add_u32 s38, s53, 35840
    buffer_load_dwordx4 v[104:107], v5, s[32:35], s38 offen sc0 sc1
    buffer_load_dwordx4 v[108:111], v6, s[32:35], s38 offen sc0 sc1
L_pr0_5:
    s_bitcmp0_b32 s45, 6
    s_cbranch_scc1 L_pr0_6
    s_add_u32 s38, s53, 43008
    buffer_load_dwordx4 v[112:115], v5, s[32:35], s38 offen sc0 sc1
    buffer_load_dwordx4 v[116:119], v6, s[32:35], s38 offen sc0 sc1
L_pr0_6:
    s_bitcmp0_b32 s45, 7
    s_cbranch_scc1 L_pr0_7
    s_add_u32 s38, s53, 50176
    buffer_load_dwordx4 v[120:123], v5, s[32:35], s38 offen sc0 sc1
    buffer_load_dwordx4 v[124:127], v6, s[32:35], s38 offen sc0 sc1
L_pr0_7:
    s_or_b32 s54, s54, s45
    s_and_b32 s54, s54, 0xff
    s_cmp_lg_u32 s54, 0xff
    s_cbranch_scc1 L_poll0_l
    s_add_u32 m0, s55, 16384
    s_add_u32 s38, s43, 0
    buffer_load_dwordx4 v60, s[8:11], s38 offen lds
    s_add_u32 m0, s55, 17408
    s_add_u32 s38, s43, 28672
    buffer_load_dwordx4 v60, s[8:11], s38 offen lds
    s_add_u32 m0, s55, 18432
    s_add_u32 s38, s43, 57344
    buffer_load_dwordx4 v60, s[8:11], s38 offen lds
    s_add_u32 m0, s55, 19456
    s_add_u32 s38, s43, 86016
    buffer_load_dwordx4 v60, s[8:11], s38 offen lds
    s_add_u32 m0, s55, 20480
    s_add_u32 s38, s43, 114688
    buffer_load_dwordx4 v60, s[8:11], s38 offen lds
    s_add_u32 m0, s55, 21504
    s_add_u32 s38, s43, 143360
    buffer_load_dwordx4 v60, s[8:11], s38 offen lds
    s_add_u32 m0, s55, 22528
    s_add_u32 s38, s43, 172032
    buffer_load_dwordx4 v60, s[8:11], s38 offen lds
    s_add_u32 m0, s55, 23552
    s_add_u32 s38, s43, 200704
    buffer_load_dwordx4 v60, s[8:11], s38 offen lds
    s_add_u32 m0, s55, 0
    s_add_u32 s38, s43, 229376
    buffer_load_dwordx4 v60, s[8:11], s38 offen lds
    s_add_u32 m0, s55, 1024
    s_add_u32 s38, s43, 258048
    buffer_load_dwordx4 v60, s[8:11], s38 offen lds
    s_add_u32 m0, s55, 2048
    s_add_u32 s38, s43, 286720
    buffer_load_dwordx4 v60, s[8:11], s38 offen lds
    s_add_u32 m0, s55, 3072
    s_add_u32 s38, s43, 315392
    buffer_load_dwordx4 v60, s[8:11], s38 offen lds
    s_waitcnt vmcnt(12)
    v_lshlrev_b32 v40, 16, v64
    v_and_b32 v41, 0xffff0000, v64
    v_lshlrev_b32_e64 v42, 16, v65
    v_and_b32 v43, 0xffff0000, v65
    v_lshlrev_b32_e64 v44, 16, v66
    v_and_b32 v45, 0xffff0000, v66
    v_lshlrev_b32_e64 v46, 16, v67
    v_and_b32 v47, 0xffff0000, v67
    v_lshlrev_b32_e64 v48, 16, v68
    v_and_b32 v49, 0xffff0000, v68
    v_lshlrev_b32_e64 v50, 16, v69
    v_and_b32 v51, 0xffff0000, v69
    v_lshlrev_b32_e64 v52, 16, v70
    v_and_b32 v53, 0xffff0000, v70
    v_lshlrev_b32_e64 v54, 16, v71
    v_and_b32 v55, 0xffff0000, v71
    v_dot2c_f32_bf16 v40, v72, v58
    v_dot2c_f32_bf16 v41, v72, v59
    v_dot2c_f32_bf16 v42, v73, v58
    v_dot2c_f32_bf16 v43, v73, v59
    v_dot2c_f32_bf16 v44, v74, v58
    v_dot2c_f32_bf16 v45, v74, v59
    v_dot2c_f32_bf16 v46, v75, v58
    v_dot2c_f32_bf16 v47, v75, v59
    v_dot2c_f32_bf16 v48, v76, v58
    v_dot2c_f32_bf16 v49, v76, v59
    v_dot2c_f32_bf16 v50, v77, v58
    v_dot2c_f32_bf16 v51, v77, v59
    v_dot2c_f32_bf16 v52, v78, v58
    v_dot2c_f32_bf16 v53, v78, v59
    v_dot2c_f32_bf16 v54, v79, v58
    v_dot2c_f32_bf16 v55, v79, v59
    v_dot2c_f32_bf16 v40, v80, v58
    v_dot2c_f32_bf16 v41, v80, v59
    v_dot2c_f32_bf16 v42, v81, v58
    v_dot2c_f32_bf16 v43, v81, v59
    v_dot2c_f32_bf16 v44, v82, v58
    v_dot2c_f32_bf16 v45, v82, v59
    v_dot2c_f32_bf16 v46, v83, v58
    v_dot2c_f32_bf16 v47, v83, v59
    v_dot2c_f32_bf16 v48, v84, v58
    v_dot2c_f32_bf16 v49, v84, v59
    v_dot2c_f32_bf16 v50, v85, v58
    v_dot2c_f32_bf16 v51, v85, v59
    v_dot2c_f32_bf16 v52, v86, v58
    v_dot2c_f32_bf16 v53, v86, v59
    v_dot2c_f32_bf16 v54, v87, v58
    v_dot2c_f32_bf16 v55, v87, v59
    v_dot2c_f32_bf16 v40, v88, v58
    v_dot2c_f32_bf16 v41, v88, v59
    v_dot2c_f32_bf16 v42, v89, v58
    v_dot2c_f32_bf16 v43, v89, v59
    v_dot2c_f32_bf16 v44, v90, v58
    v_dot2c_f32_bf16 v45, v90, v59
    v_dot2c_f32_bf16 v46, v91, v58
    v_dot2c_f32_bf16 v47, v91, v59
    v_dot2c_f32_bf16 v48, v92, v58
    v_dot2c_f32_bf16 v49, v92, v59
    v_dot2c_f32_bf16 v50, v93, v58
    v_dot2c_f32_bf16 v51, v93, v59
    v_dot2c_f32_bf16 v52, v94, v58
    v_dot2c_f32_bf16 v53, v94, v59
    v_dot2c_f32_bf16 v54, v95, v58
    v_dot2c_f32_bf16 v55, v95, v59
    v_dot2c_f32_bf16 v40, v96, v58
    v_dot2c_f32_bf16 v41, v96, v59
    v_dot2c_f32_bf16 v42, v97, v58
    v_dot2c_f32_bf16 v43, v97, v59
    v_dot2c_f32_bf16 v44, v98, v58
    v_dot2c_f32_bf16 v45, v98, v59
    v_dot2c_f32_bf16 v46, v99, v58
    v_dot2c_f32_bf16 v47, v99, v59
    v_dot2c_f32_bf16 v48, v100, v58
    v_dot2c_f32_bf16 v49, v100, v59
    v_dot2c_f32_bf16 v50, v101, v58
    v_dot2c_f32_bf16 v51, v101, v59
    v_dot2c_f32_bf16 v52, v102, v58
    v_dot2c_f32_bf16 v53, v102, v59
    v_dot2c_f32_bf16 v54, v103, v58
    v_dot2c_f32_bf16 v55, v103, v59
    v_dot2c_f32_bf16 v40, v104, v58
    v_dot2c_f32_bf16 v41, v104, v59
    v_dot2c_f32_bf16 v42, v105, v58
    v_dot2c_f32_bf16 v43, v105, v59
    v_dot2c_f32_bf16 v44, v106, v58
    v_dot2c_f32_bf16 v45, v106, v59
    v_dot2c_f32_bf16 v46, v107, v58
    v_dot2c_f32_bf16 v47, v107, v59
    v_dot2c_f32_bf16 v48, v108, v58
    v_dot2c_f32_bf16 v49, v108, v59
    v_dot2c_f32_bf16 v50, v109, v58
    v_dot2c_f32_bf16 v51, v109, v59
    v_dot2c_f32_bf16 v52, v110, v58
    v_dot2c_f32_bf16 v53, v110, v59
    v_dot2c_f32_bf16 v54, v111, v58
    v_dot2c_f32_bf16 v55, v111, v59
    v_dot2c_f32_bf16 v40, v112, v58
    v_dot2c_f32_bf16 v41, v112, v59
    v_dot2c_f32_bf16 v42, v113, v58
    v_dot2c_f32_bf16 v43, v113, v59
    v_dot2c_f32_bf16 v44, v114, v58
    v_dot2c_f32_bf16 v45, v114, v59
    v_dot2c_f32_bf16 v46, v115, v58
    v_dot2c_f32_bf16 v47, v115, v59
    v_dot2c_f32_bf16 v48, v116, v58
    v_dot2c_f32_bf16 v49, v116, v59
    v_dot2c_f32_bf16 v50, v117, v58
    v_dot2c_f32_bf16 v51, v117, v59
    v_dot2c_f32_bf16 v52, v118, v58
    v_dot2c_f32_bf16 v53, v118, v59
    v_dot2c_f32_bf16 v54, v119, v58
    v_dot2c_f32_bf16 v55, v119, v59
    v_dot2c_f32_bf16 v40, v120, v58
    v_dot2c_f32_bf16 v41, v120, v59
    v_dot2c_f32_bf16 v42, v121, v58
    v_dot2c_f32_bf16 v43, v121, v59
    v_dot2c_f32_bf16 v44, v122, v58
    v_dot2c_f32_bf16 v45, v122, v59
    v_dot2c_f32_bf16 v46, v123, v58
    v_dot2c_f32_bf16 v47, v123, v59
    v_dot2c_f32_bf16 v48, v124, v58
    v_dot2c_f32_bf16 v49, v124, v59
    v_dot2c_f32_bf16 v50, v125, v58
    v_dot2c_f32_bf16 v51, v125, v59
    v_dot2c_f32_bf16 v52, v126, v58
    v_dot2c_f32_bf16 v53, v126, v59
    v_dot2c_f32_bf16 v54, v127, v58
    v_dot2c_f32_bf16 v55, v127, v59
    s_nop 2
    v_cmp_eq_u32 vcc, 0, v4
    s_nop 1
    v_cndmask_b32 v52, 0, v52, vcc
    v_cndmask_b32 v53, 0, v53, vcc
    v_cndmask_b32 v54, 0, v54, vcc
    v_cndmask_b32 v55, 0, v55, vcc
    v_lshlrev_b32 v14, 16, v128
    v_and_b32 v15, 0xffff0000, v128
    v_pk_fma_f32 v[40:41], v[40:41], v[136:137], v[14:15]
    v_pk_mul_f32 v[240:241], v[40:41], 1.0 op_sel_hi:[1,0]
    v_lshlrev_b32_e64 v14, 16, v129
    v_and_b32 v15, 0xffff0000, v129
    v_pk_fma_f32 v[42:43], v[42:43], v[138:139], v[14:15]
    v_pk_mul_f32 v[242:243], v[42:43], 1.0 op_sel_hi:[1,0]
    v_lshlrev_b32_e64 v14, 16, v130
    v_and_b32 v15, 0xffff0000, v130
    v_pk_fma_f32 v[44:45], v[44:45], v[140:141], v[14:15]
    v_pk_mul_f32 v[244:245], v[44:45], 1.0 op_sel_hi:[1,0]
    v_lshlrev_b32_e64 v14, 16, v131
    v_and_b32 v15, 0xffff0000, v131
    v_pk_fma_f32 v[46:47], v[46:47], v[142:143], v[14:15]
    v_pk_mul_f32 v[246:247], v[46:47], 1.0 op_sel_hi:[1,0]
    v_lshlrev_b32_e64 v14, 16, v132
    v_and_b32 v15, 0xffff0000, v132
    v_pk_fma_f32 v[48:49], v[48:49], v[144:145], v[14:15]
    v_pk_mul_f32 v[248:249], v[48:49], 1.0 op_sel_hi:[1,0]
    v_lshlrev_b32_e64 v14, 16, v133
    v_and_b32 v15, 0xffff0000, v133
    v_pk_fma_f32 v[50:51], v[50:51], v[146:147], v[14:15]
    v_pk_mul_f32 v[250:251], v[50:51], 1.0 op_sel_hi:[1,0]
    v_lshlrev_b32_e64 v14, 16, v134
    v_and_b32 v15, 0xffff0000, v134
    v_pk_fma_f32 v[52:53], v[52:53], v[148:149], v[14:15]
    v_pk_mul_f32 v[252:253], v[52:53], 1.0 op_sel_hi:[1,0]
    v_lshlrev_b32_e64 v14, 16, v135
    v_and_b32 v15, 0xffff0000, v135
    v_pk_fma_f32 v[54:55], v[54:55], v[150:151], v[14:15]
    v_pk_mul_f32 v[254:255], v[54:55], 1.0 op_sel_hi:[1,0]
    s_add_u32 m0, s55, 4096
    s_add_u32 s38, s43, 401408
    buffer_load_dwordx4 v60, s[8:11], s38 offen lds
    s_add_u32 m0, s55, 5120
    s_add_u32 s38, s43, 430080
    buffer_load_dwordx4 v60, s[8:11], s38 offen lds
    s_add_u32 m0, s55, 6144
    s_add_u32 s38, s43, 458752
    buffer_load_dwordx4 v60, s[8:11], s38 offen lds
    s_add_u32 m0, s55, 7168
    s_add_u32 s38, s43, 487424
    buffer_load_dwordx4 v60, s[8:11], s38 offen lds
    s_add_u32 m0, s55, 8192
    s_add_u32 s38, s43, 516096
    buffer_load_dwordx4 v60, s[8:11], s38 offen lds
    s_add_u32 m0, s55, 9216
    s_add_u32 s38, s43, 544768
    buffer_load_dwordx4 v60, s[8:11], s38 offen lds
    s_add_u32 m0, s55, 10240
    s_add_u32 s38, s43, 573440
    buffer_load_dwordx4 v60, s[8:11], s38 offen lds
    s_add_u32 m0, s55, 11264
    s_add_u32 s38, s43, 602112
    buffer_load_dwordx4 v60, s[8:11], s38 offen lds
    s_add_u32 m0, s55, 12288
    s_add_u32 s38, s43, 630784
    buffer_load_dwordx4 v60, s[8:11], s38 offen lds
    s_add_u32 m0, s55, 13312
    s_add_u32 s38, s43, 659456
    buffer_load_dwordx4 v60, s[8:11], s38 offen lds
    s_add_u32 m0, s55, 14336
    s_add_u32 s38, s43, 688128
    buffer_load_dwordx4 v60, s[8:11], s38 offen lds
    s_add_u32 m0, s55, 15360
    s_add_u32 s38, s43, 716800
    buffer_load_dwordx4 v60, s[8:11], s38 offen lds
    v_pk_mul_f32 v[52:53], v[52:53], v[12:13]
    v_pk_mul_f32 v[54:55], v[54:55], v[12:13]
    v_pk_add_f32 v[14:15], v[40:41], v[42:43]
    v_pk_add_f32 v[14:15], v[14:15], v[44:45]
    v_pk_add_f32 v[14:15], v[14:15], v[46:47]
    v_pk_add_f32 v[14:15], v[14:15], v[48:49]
    v_pk_add_f32 v[14:15], v[14:15], v[50:51]
    v_pk_add_f32 v[14:15], v[14:15], v[52:53]
    v_pk_add_f32 v[14:15], v[14:15], v[54:55]
    v_add_f32 v14, v14, v15
    s_nop 1
    v_add_f32_dpp v14, v14, v14 row_ror:8 row_mask:0xf bank_mask:0xf
    v_mov_b32 v15, v14
    s_nop 1
    v_permlane16_swap_b32 v14, v15
    v_add_f32 v14, v14, v15
    v_mov_b32 v15, v14
    s_nop 1
    v_permlane32_swap_b32 v14, v15
    v_add_f32 v14, v14, v15
    v_mul_f32 v72, 0x3c124925, v14
    v_sub_f32 v14, 0, v72
    v_sub_f32 v15, 0, v72
    v_pk_add_f32 v[40:41], v[40:41], v[14:15]
    v_pk_add_f32 v[42:43], v[42:43], v[14:15]
    v_pk_add_f32 v[44:45], v[44:45], v[14:15]
    v_pk_add_f32 v[46:47], v[46:47], v[14:15]
    v_pk_add_f32 v[48:49], v[48:49], v[14:15]
    v_pk_add_f32 v[50:51], v[50:51], v[14:15]
    v_pk_add_f32 v[52:53], v[52:53], v[14:15]
    v_pk_add_f32 v[54:55], v[54:55], v[14:15]
    v_pk_mul_f32 v[52:53], v[52:53], v[12:13]
    v_pk_mul_f32 v[54:55], v[54:55], v[12:13]
    v_pk_mul_f32 v[14:15], v[40:41], v[40:41]
    v_pk_fma_f32 v[14:15], v[42:43], v[42:43], v[14:15]
    v_pk_fma_f32 v[14:15], v[44:45], v[44:45], v[14:15]
    v_pk_fma_f32 v[14:15], v[46:47], v[46:47], v[14:15]
    v_pk_fma_f32 v[14:15], v[48:49], v[48:49], v[14:15]
    v_pk_fma_f32 v[14:15], v[50:51], v[50:51], v[14:15]
    v_pk_fma_f32 v[14:15], v[52:53], v[52:53], v[14:15]
    v_pk_fma_f32 v[14:15], v[54:55], v[54:55], v[14:15]
    v_add_f32 v73, v14, v15
    s_nop 1
    v_add_f32_dpp v73, v73, v73 row_ror:8 row_mask:0xf bank_mask:0xf
    v_mov_b32 v15, v73
    s_nop 1
    v_permlane16_swap_b32 v73, v15
    v_add_f32 v73, v73, v15
    v_mov_b32 v15, v73
    s_nop 1
    v_permlane32_swap_b32 v73, v15
    v_add_f32 v73, v73, v15
    ds_write_b64 v10, v[72:73] offset:0
    s_waitcnt lgkmcnt(0)
    s_barrier
    ds_read_b128 v[64:67], v11 offset:0
    ds_read_b128 v[68:71], v11 offset:16
    s_waitcnt lgkmcnt(1)
    v_add_f32 v14, v64, v66
    s_waitcnt lgkmcnt(0)
    v_add_f32 v15, v68, v70
    v_add_f32_e64 v14, v14, v15
    v_mul_f32 v14, 0x3e800000, v14
    v_add_f32 v15, v65, v67
    v_add_f32 v15, v15, v69
    v_add_f32_e64 v15, v15, v71
    v_mov_b32 v75, 0x3727c5ac
    v_fmac_f32 v75, 0x3b124925, v15
    v_sub_f32 v64, v64, v14
    v_mul_f32 v64, v64, v64
    v_fmac_f32 v75, 0x3e800000, v64
    v_sub_f32 v66, v66, v14
    v_mul_f32 v66, v66, v66
    v_fmac_f32 v75, 0x3e800000, v66
    v_sub_f32 v68, v68, v14
    v_mul_f32 v68, v68, v68
    v_fmac_f32 v75, 0x3e800000, v68
    v_sub_f32 v70, v70, v14
    v_mul_f32 v70, v70, v70
    v_fmac_f32 v75, 0x3e800000, v70
    v_rsq_f32 v75, v75
    v_sub_f32 v14, v72, v14
    v_mul_f32 v14, v14, v75
    v_mov_b32 v15, v14
    v_mov_b32_e64 v74, v75
    v_pk_fma_f32 v[40:41], v[40:41], v[74:75], v[14:15]
    v_pk_fma_f32 v[42:43], v[42:43], v[74:75], v[14:15]
    v_pk_fma_f32 v[44:45], v[44:45], v[74:75], v[14:15]
    v_pk_fma_f32 v[46:47], v[46:47], v[74:75], v[14:15]
    v_pk_fma_f32 v[48:49], v[48:49], v[74:75], v[14:15]
    v_pk_fma_f32 v[50:51], v[50:51], v[74:75], v[14:15]
    v_pk_fma_f32 v[52:53], v[52:53], v[74:75], v[14:15]
    v_pk_fma_f32 v[54:55], v[54:55], v[74:75], v[14:15]
    v_pk_fma_f32 v[40:41], v[40:41], v[152:153], v[168:169]
    v_pk_fma_f32 v[42:43], v[42:43], v[154:155], v[170:171]
    v_pk_fma_f32 v[44:45], v[44:45], v[156:157], v[172:173]
    v_pk_fma_f32 v[46:47], v[46:47], v[158:159], v[174:175]
    v_pk_fma_f32 v[48:49], v[48:49], v[160:161], v[176:177]
    v_pk_fma_f32 v[50:51], v[50:51], v[162:163], v[178:179]
    v_pk_fma_f32 v[52:53], v[52:53], v[164:165], v[180:181]
    v_pk_fma_f32 v[54:55], v[54:55], v[166:167], v[182:183]
    s_mul_i32 s38, s4, 57344
    s_lshr_b32 s39, s3, 1
    s_lshl_b32 s39, s39, 10
    s_add_u32 s38, s38, s39
    s_and_b32 s39, s3, 1
    s_lshl_b32 s39, s39, 7
    s_add_u32 s38, s38, s39
    v_lshlrev_b32_e64 v129, 4, v2
    v_lshl_add_u32 v129, v3, 8, v129
    v_lshl_add_u32 v128, v4, 13, v129
    s_mul_i32 s36, s5, 12288
    s_add_u32 s36, s36, s38
    s_add_u32 s37, s36, 4096
    s_lshr_b32 s39, s5, 1
    s_lshl_b32 s39, s39, 12
    s_add_u32 s38, s38, s39
    s_lshl_b32 s39, s7, 3
    s_add_u32 s38, s38, s39
    s_add_u32 s38, s38, 49152
    v_pk_mul_f32 v[52:53], v[52:53], v[12:13]
    v_pk_mul_f32 v[54:55], v[54:55], v[12:13]
    v_pk_add_f32 v[14:15], v[40:41], v[42:43]
    v_pk_add_f32 v[14:15], v[14:15], v[44:45]
    v_pk_add_f32 v[14:15], v[14:15], v[46:47]
    v_pk_add_f32 v[14:15], v[14:15], v[48:49]
    v_pk_add_f32 v[14:15], v[14:15], v[50:51]
    v_pk_add_f32 v[14:15], v[14:15], v[52:53]
    v_pk_add_f32 v[14:15], v[14:15], v[54:55]
    v_add_f32 v14, v14, v15
    s_nop 1
    v_add_f32_dpp v14, v14, v14 row_ror:8 row_mask:0xf bank_mask:0xf
    v_mov_b32 v15, v14
    s_nop 1
    v_permlane16_swap_b32 v14, v15
    v_add_f32 v14, v14, v15
    v_mov_b32 v15, v14
    s_nop 1
    v_permlane32_swap_b32 v14, v15
    v_add_f32 v14, v14, v15
    v_mul_f32 v72, 0x3c124925, v14
    v_sub_f32 v14, 0, v72
    v_sub_f32 v15, 0, v72
    v_pk_add_f32 v[40:41], v[40:41], v[14:15]
    v_pk_add_f32 v[42:43], v[42:43], v[14:15]
    v_pk_add_f32 v[44:45], v[44:45], v[14:15]
    v_pk_add_f32 v[46:47], v[46:47], v[14:15]
    v_pk_add_f32 v[48:49], v[48:49], v[14:15]
    v_pk_add_f32 v[50:51], v[50:51], v[14:15]
    v_pk_add_f32 v[52:53], v[52:53], v[14:15]
    v_pk_add_f32 v[54:55], v[54:55], v[14:15]
    v_pk_mul_f32 v[52:53], v[52:53], v[12:13]
    v_pk_mul_f32 v[54:55], v[54:55], v[12:13]
    v_pk_mul_f32 v[14:15], v[40:41], v[40:41]
    v_pk_fma_f32 v[14:15], v[42:43], v[42:43], v[14:15]
    v_pk_fma_f32 v[14:15], v[44:45], v[44:45], v[14:15]
    v_pk_fma_f32 v[14:15], v[46:47], v[46:47], v[14:15]
    v_pk_fma_f32 v[14:15], v[48:49], v[48:49], v[14:15]
    v_pk_fma_f32 v[14:15], v[50:51], v[50:51], v[14:15]
    v_pk_fma_f32 v[14:15], v[52:53], v[52:53], v[14:15]
    v_pk_fma_f32 v[14:15], v[54:55], v[54:55], v[14:15]
    v_add_f32 v73, v14, v15
    s_nop 1
    v_add_f32_dpp v73, v73, v73 row_ror:8 row_mask:0xf bank_mask:0xf
    v_mov_b32 v15, v73
    s_nop 1
    v_permlane16_swap_b32 v73, v15
    v_add_f32 v73, v73, v15
    v_mov_b32 v15, v73
    s_nop 1
    v_permlane32_swap_b32 v73, v15
    v_add_f32 v73, v73, v15
    ds_write_b64 v10, v[72:73] offset:256
    s_waitcnt lgkmcnt(0)
    s_barrier
    ds_read_b128 v[64:67], v11 offset:256
    ds_read_b128 v[68:71], v11 offset:272
    s_waitcnt lgkmcnt(1)
    v_add_f32 v14, v64, v66
    s_waitcnt lgkmcnt(0)
    v_add_f32 v15, v68, v70
    v_add_f32_e64 v14, v14, v15
    v_mul_f32 v14, 0x3e800000, v14
    v_add_f32 v15, v65, v67
    v_add_f32 v15, v15, v69
    v_add_f32_e64 v15, v15, v71
    v_mov_b32 v75, 0x3727c5ac
    v_fmac_f32 v75, 0x3b124925, v15
    v_sub_f32 v64, v64, v14
    v_mul_f32 v64, v64, v64
    v_fmac_f32 v75, 0x3e800000, v64
    v_sub_f32 v66, v66, v14
    v_mul_f32 v66, v66, v66
    v_fmac_f32 v75, 0x3e800000, v66
    v_sub_f32 v68, v68, v14
    v_mul_f32 v68, v68, v68
    v_fmac_f32 v75, 0x3e800000, v68
    v_sub_f32 v70, v70, v14
    v_mul_f32 v70, v70, v70
    v_fmac_f32 v75, 0x3e800000, v70
    v_rsq_f32 v75, v75
    v_sub_f32 v14, v72, v14
    v_mul_f32 v14, v14, v75
    v_mov_b32 v15, v14
    v_mov_b32_e64 v74, v75
    v_pk_fma_f32 v[40:41], v[40:41], v[74:75], v[14:15]
    v_pk_fma_f32 v[42:43], v[42:43], v[74:75], v[14:15]
    v_pk_fma_f32 v[44:45], v[44:45], v[74:75], v[14:15]
    v_pk_fma_f32 v[46:47], v[46:47], v[74:75], v[14:15]
    v_pk_fma_f32 v[48:49], v[48:49], v[74:75], v[14:15]
    v_pk_fma_f32 v[50:51], v[50:51], v[74:75], v[14:15]
    v_pk_fma_f32 v[52:53], v[52:53], v[74:75], v[14:15]
    v_pk_fma_f32 v[54:55], v[54:55], v[74:75], v[14:15]
    v_cvt_pk_bf16_f32 v136, v40, v41
    v_cvt_pk_bf16_f32 v137, v42, v43
    v_cvt_pk_bf16_f32 v138, v44, v45
    v_cvt_pk_bf16_f32 v139, v46, v47
    v_cvt_pk_bf16_f32 v140, v48, v49
    v_cvt_pk_bf16_f32 v141, v50, v51
    v_cvt_pk_bf16_f32 v142, v52, v53
    v_cvt_pk_bf16_f32 v143, v54, v55
    buffer_store_dwordx4 v[136:139], v128, s[28:31], s36 offen sc0 sc1
    s_mov_b32 exec_hi, 0
    buffer_store_dwordx4 v[140:143], v129, s[28:31], s37 offen sc0 sc1
    s_mov_b32 exec_hi, -1
    s_mov_b32 exec_lo, 0
    buffer_store_dwordx2 v[140:141], v129, s[28:31], s38 offen sc0 sc1
    s_mov_b64 exec, -1
    v_lshlrev_b32_e64 v40, 16, v184
    v_and_b32 v41, 0xffff0000, v184
    v_lshlrev_b32_e64 v42, 16, v185
    v_and_b32 v43, 0xffff0000, v185
    v_lshlrev_b32_e64 v44, 16, v186
    v_and_b32 v45, 0xffff0000, v186
    v_lshlrev_b32_e64 v46, 16, v187
    v_and_b32 v47, 0xffff0000, v187
    v_lshlrev_b32_e64 v48, 16, v188
    v_and_b32 v49, 0xffff0000, v188
    v_lshlrev_b32_e64 v50, 16, v189
    v_and_b32 v51, 0xffff0000, v189
    v_lshlrev_b32_e64 v52, 16, v190
    v_and_b32 v53, 0xffff0000, v190
    v_lshlrev_b32_e64 v54, 16, v191
    v_and_b32 v55, 0xffff0000, v191
    s_lshr_b32 s36, s3, 1
    s_and_b32 s37, s3, 1
    s_lshl_b32 s37, s37, 2
    s_add_u32 s37, s37, s5
    s_lshl_b32 s36, s36, 7
    s_lshl_b32 s37, s37, 2
    s_add_u32 s36, s36, s37
    s_lshl_b32 s37, s4, 9
    s_add_u32 s36, s36, s37
    s_add_u32 s36, s36, 16384
    v_mov_b32 v56, 0
    v_mov_b32 v57, s60
    s_waitcnt vmcnt(0)
    s_mov_b64 exec, 1
    buffer_store_dword v57, v56, s[72:75], s36 offen sc0 sc1
    s_mov_b64 exec, -1
    s_lshl_b32 s36, s4, 9
    s_lshl_b32 s37, s5, 7
    s_add_u32 s36, s36, s37
    s_add_u32 s36, s36, 16384
    s_mov_b32 s37, 65536
L_poll1_l:
    buffer_load_dword v56, v9, s[72:75], s36 offen sc0 sc1
    s_waitcnt vmcnt(0)
    v_cmp_ne_u32 vcc, s60, v56
    s_cbranch_vccz L_polled1
    s_sleep 1
    s_sub_u32 s37, s37, 1
    s_cmp_lg_u32 s37, 0
    s_cbranch_scc1 L_poll1_l
L_polled1:
    s_add_u32 s38, s44, 0
    buffer_load_dwordx4 a[16:19], v30, s[28:31], s38 offen sc0 sc1
    s_add_u32 s38, s44, 4096
    buffer_load_dwordx4 a[20:23], v30, s[28:31], s38 offen sc0 sc1
    s_add_u32 s38, s44, 8192
    buffer_load_dwordx4 a[24:27], v30, s[28:31], s38 offen sc0 sc1
    s_add_u32 s38, s44, 12288
    buffer_load_dwordx4 a[28:31], v30, s[28:31], s38 offen sc0 sc1
    s_add_u32 s38, s44, 16384
    buffer_load_dwordx4 a[32:35], v30, s[28:31], s38 offen sc0 sc1
    s_add_u32 s38, s44, 20480
    buffer_load_dwordx4 a[36:39], v30, s[28:31], s38 offen sc0 sc1
    s_add_u32 s38, s44, 24576
    buffer_load_dwordx4 a[40:43], v30, s[28:31], s38 offen sc0 sc1
    s_add_u32 s38, s44, 28672
    buffer_load_dwordx4 a[44:47], v30, s[28:31], s38 offen sc0 sc1
    s_add_u32 s38, s44, 32768
    buffer_load_dwordx4 a[48:51], v30, s[28:31], s38 offen sc0 sc1
    s_add_u32 s38, s44, 36864
    buffer_load_dwordx4 a[52:55], v30, s[28:31], s38 offen sc0 sc1
    s_add_u32 s38, s44, 40960
    buffer_load_dwordx4 a[56:59], v30, s[28:31], s38 offen sc0 sc1
    s_add_u32 s38, s44, 45056
    buffer_load_dwordx4 a[60:63], v30, s[28:31], s38 offen sc0 sc1
    s_add_u32 s38, s44, 49152
    buffer_load_dwordx4 a[64:67], v30, s[28:31], s38 offen sc0 sc1
    s_add_u32 s38, s44, 53248
    buffer_load_dwordx4 a[68:71], v30, s[28:31], s38 offen sc0 sc1
    v_add_u32 v56, s61, v30
    v_add_u32 v57, s55, v30
    s_waitcnt vmcnt(13)
    ds_write_b128 v56, a[16:19] offset:0
    s_waitcnt vmcnt(12)
    ds_write_b128 v56, a[20:23] offset:4096
    s_waitcnt vmcnt(11)
    ds_write_b128 v56, a[24:27] offset:8192
    s_waitcnt lgkmcnt(0)
    s_barrier
    ds_read_b128 v[192:195], v30 offset:0
    ds_read_b128 v[196:199], v30 offset:1024
    ds_read_b128 v[200:203], v30 offset:2048
    ds_read_b128 v[204:207], v30 offset:3072
    ds_read_b64_tr_b16 v[96:97], v61 offset:16384
    ds_read_b64_tr_b16 v[98:99], v61 offset:18432
    ds_read_b64_tr_b16 v[100:101], v62 offset:16384
    ds_read_b64_tr_b16 v[102:103], v62 offset:18432
    ds_read_b64_tr_b16 v[104:105], v63 offset:16384
    ds_read_b64_tr_b16 v[106:107], v63 offset:18432
    ds_read_b64_tr_b16 v[108:109], v1 offset:16384
    ds_read_b64_tr_b16 v[110:111], v1 offset:18432
    ds_read_b64_tr_b16 v[112:113], v61 offset:20480
    ds_read_b64_tr_b16 v[114:115], v61 offset:22528
    ds_read_b64_tr_b16 v[116:117], v62 offset:20480
    ds_read_b64_tr_b16 v[118:119], v62 offset:22528
    ds_read_b128 v[208:211], v30 offset:4096
    ds_read_b128 v[212:215], v30 offset:5120
    ds_read_b128 v[216:219], v30 offset:6144
    ds_read_b128 v[220:223], v30 offset:7168
    s_waitcnt lgkmcnt(14)
    v_mfma_f32_16x16x32_bf16 v[128:131], v[96:99], v[192:195], v[40:43]
    ds_read_b64_tr_b16 v[120:121], v63 offset:20480
    ds_read_b64_tr_b16 v[122:123], v63 offset:22528
    v_mfma_f32_16x16x32_bf16 v[132:135], v[96:99], v[196:199], v[40:43]
    v_mfma_f32_16x16x32_bf16 v[136:139], v[96:99], v[200:203], v[40:43]
    ds_read_b128 v[224:227], v30 offset:8192
    s_waitcnt vmcnt(10)
    ds_write_b128 v56, a[28:31] offset:12288
    v_mfma_f32_16x16x32_bf16 v[140:143], v[96:99], v[204:207], v[40:43]
    s_waitcnt lgkmcnt(15)
    v_mfma_f32_16x16x32_bf16 v[144:147], v[100:103], v[192:195], v[44:47]
    ds_read_b64_tr_b16 v[124:125], v1 offset:20480
    ds_read_b64_tr_b16 v[126:127], v1 offset:22528
    v_mfma_f32_16x16x32_bf16 v[148:151], v[100:103], v[196:199], v[44:47]
    s_waitcnt vmcnt(9)
    ds_write_b128 v56, a[32:35] offset:16384
    v_mfma_f32_16x16x32_bf16 v[152:155], v[100:103], v[200:203], v[44:47]
    ds_read_b128 v[228:231], v30 offset:9216
    s_waitcnt vmcnt(8)
    ds_write_b128 v56, a[36:39] offset:20480
    v_mfma_f32_16x16x32_bf16 v[156:159], v[100:103], v[204:207], v[44:47]
    s_waitcnt lgkmcnt(15)
    v_mfma_f32_16x16x32_bf16 v[160:163], v[104:107], v[192:195], v[48:51]
    ds_read_b64_tr_b16 v[96:97], v61 offset:0
    ds_read_b64_tr_b16 v[98:99], v61 offset:2048
    v_mfma_f32_16x16x32_bf16 v[164:167], v[104:107], v[196:199], v[48:51]
    s_waitcnt vmcnt(7)
    ds_write_b128 v56, a[40:43] offset:24576
    v_mfma_f32_16x16x32_bf16 v[168:171], v[104:107], v[200:203], v[48:51]
    ds_read_b128 v[232:235], v30 offset:10240
    s_waitcnt vmcnt(6)
    ds_write_b128 v56, a[44:47] offset:28672
    v_mfma_f32_16x16x32_bf16 v[172:175], v[104:107], v[204:207], v[48:51]
    v_mfma_f32_16x16x32_bf16 v[176:179], v[108:111], v[192:195], v[52:55]
    ds_read_b64_tr_b16 v[100:101], v62 offset:0
    ds_read_b64_tr_b16 v[102:103], v62 offset:2048
    v_mfma_f32_16x16x32_bf16 v[180:183], v[108:111], v[196:199], v[52:55]
    v_mfma_f32_16x16x32_bf16 v[184:187], v[108:111], v[200:203], v[52:55]
    ds_read_b128 v[236:239], v30 offset:11264
    v_mfma_f32_16x16x32_bf16 v[188:191], v[108:111], v[204:207], v[52:55]
    s_waitcnt lgkmcnt(15)
    v_mfma_f32_16x16x32_bf16 v[128:131], v[112:115], v[208:211], v[128:131]
    ds_read_b64_tr_b16 v[104:105], v63 offset:0
    ds_read_b64_tr_b16 v[106:107], v63 offset:2048
    v_mfma_f32_16x16x32_bf16 v[132:135], v[112:115], v[212:215], v[132:135]
    s_waitcnt lgkmcnt(0)
    s_barrier
    s_add_u32 m0, s55, 16384
    s_add_u32 s38, s43, 802816
    v_mfma_f32_16x16x32_bf16 v[136:139], v[112:115], v[216:219], v[136:139]
    ds_read_b128 v[192:195], v30 offset:12288
    buffer_load_dwordx4 v60, s[8:11], s38 offen lds
    v_mfma_f32_16x16x32_bf16 v[140:143], v[112:115], v[220:223], v[140:143]
    v_mfma_f32_16x16x32_bf16 v[144:147], v[116:119], v[208:211], v[144:147]
    ds_read_b64_tr_b16 v[108:109], v1 offset:0
    ds_read_b64_tr_b16 v[110:111], v1 offset:2048
    v_mfma_f32_16x16x32_bf16 v[148:151], v[116:119], v[212:215], v[148:151]
    s_add_u32 m0, s55, 17408
    s_add_u32 s38, s43, 831488
    v_mfma_f32_16x16x32_bf16 v[152:155], v[116:119], v[216:219], v[152:155]
    ds_read_b128 v[196:199], v30 offset:13312
    buffer_load_dwordx4 v60, s[8:11], s38 offen lds
    v_mfma_f32_16x16x32_bf16 v[156:159], v[116:119], v[220:223], v[156:159]
    v_mfma_f32_16x16x32_bf16 v[160:163], v[120:123], v[208:211], v[160:163]
    ds_read_b64_tr_b16 v[112:113], v61 offset:4096
    ds_read_b64_tr_b16 v[114:115], v61 offset:6144
    v_mfma_f32_16x16x32_bf16 v[164:167], v[120:123], v[212:215], v[164:167]
    s_add_u32 m0, s55, 18432
    s_add_u32 s38, s43, 860160
    v_mfma_f32_16x16x32_bf16 v[168:171], v[120:123], v[216:219], v[168:171]
    ds_read_b128 v[200:203], v30 offset:14336
    buffer_load_dwordx4 v60, s[8:11], s38 offen lds
    v_mfma_f32_16x16x32_bf16 v[172:175], v[120:123], v[220:223], v[172:175]
    v_mfma_f32_16x16x32_bf16 v[176:179], v[124:127], v[208:211], v[176:179]
    ds_read_b64_tr_b16 v[116:117], v62 offset:4096
    ds_read_b64_tr_b16 v[118:119], v62 offset:6144
    v_mfma_f32_16x16x32_bf16 v[180:183], v[124:127], v[212:215], v[180:183]
    s_add_u32 m0, s55, 19456
    s_add_u32 s38, s43, 888832
    v_mfma_f32_16x16x32_bf16 v[184:187], v[124:127], v[216:219], v[184:187]
    ds_read_b128 v[204:207], v30 offset:15360
    buffer_load_dwordx4 v60, s[8:11], s38 offen lds
    v_mfma_f32_16x16x32_bf16 v[188:191], v[124:127], v[220:223], v[188:191]
    v_mfma_f32_16x16x32_bf16 v[128:131], v[96:99], v[224:227], v[128:131]
    ds_read_b64_tr_b16 v[120:121], v63 offset:4096
    ds_read_b64_tr_b16 v[122:123], v63 offset:6144
    v_mfma_f32_16x16x32_bf16 v[132:135], v[96:99], v[228:231], v[132:135]
    s_add_u32 m0, s55, 20480
    s_add_u32 s38, s43, 917504
    v_mfma_f32_16x16x32_bf16 v[136:139], v[96:99], v[232:235], v[136:139]
    ds_read_b128 v[208:211], v30 offset:16384
    buffer_load_dwordx4 v60, s[8:11], s38 offen lds
    v_mfma_f32_16x16x32_bf16 v[140:143], v[96:99], v[236:239], v[140:143]
    v_mfma_f32_16x16x32_bf16 v[144:147], v[100:103], v[224:227], v[144:147]
    ds_read_b64_tr_b16 v[124:125], v1 offset:4096
    ds_read_b64_tr_b16 v[126:127], v1 offset:6144
    v_mfma_f32_16x16x32_bf16 v[148:151], v[100:103], v[228:231], v[148:151]
    s_add_u32 m0, s55, 21504
    s_add_u32 s38, s43, 946176
    v_mfma_f32_16x16x32_bf16 v[152:155], v[100:103], v[232:235], v[152:155]
    ds_read_b128 v[212:215], v30 offset:17408
    buffer_load_dwordx4 v60, s[8:11], s38 offen lds
    v_mfma_f32_16x16x32_bf16 v[156:159], v[100:103], v[236:239], v[156:159]
    v_mfma_f32_16x16x32_bf16 v[160:163], v[104:107], v[224:227], v[160:163]
    ds_read_b64_tr_b16 v[96:97], v61 offset:8192
    ds_read_b64_tr_b16 v[98:99], v61 offset:10240
    v_mfma_f32_16x16x32_bf16 v[164:167], v[104:107], v[228:231], v[164:167]
    s_add_u32 m0, s55, 22528
    s_add_u32 s38, s43, 974848
    v_mfma_f32_16x16x32_bf16 v[168:171], v[104:107], v[232:235], v[168:171]
    ds_read_b128 v[216:219], v30 offset:18432
    buffer_load_dwordx4 v60, s[8:11], s38 offen lds
    v_mfma_f32_16x16x32_bf16 v[172:175], v[104:107], v[236:239], v[172:175]
    s_waitcnt lgkmcnt(15)
    v_mfma_f32_16x16x32_bf16 v[176:179], v[108:111], v[224:227], v[176:179]
    ds_read_b64_tr_b16 v[100:101], v62 offset:8192
    ds_read_b64_tr_b16 v[102:103], v62 offset:10240
    v_mfma_f32_16x16x32_bf16 v[180:183], v[108:111], v[228:231], v[180:183]
    s_add_u32 m0, s55, 23552
    s_add_u32 s38, s43, 1003520
    v_mfma_f32_16x16x32_bf16 v[184:187], v[108:111], v[232:235], v[184:187]
    ds_read_b128 v[220:223], v30 offset:19456
    buffer_load_dwordx4 v60, s[8:11], s38 offen lds
    v_mfma_f32_16x16x32_bf16 v[188:191], v[108:111], v[236:239], v[188:191]
    s_waitcnt lgkmcnt(15)
    v_mfma_f32_16x16x32_bf16 v[128:131], v[112:115], v[192:195], v[128:131]
    ds_read_b64_tr_b16 v[104:105], v63 offset:8192
    ds_read_b64_tr_b16 v[106:107], v63 offset:10240
    v_mfma_f32_16x16x32_bf16 v[132:135], v[112:115], v[196:199], v[132:135]
    s_add_u32 m0, s55, 0
    s_add_u32 s38, s43, 1032192
    v_mfma_f32_16x16x32_bf16 v[136:139], v[112:115], v[200:203], v[136:139]
    ds_read_b128 v[224:227], v30 offset:20480
    buffer_load_dwordx4 v60, s[8:11], s38 offen lds
    s_waitcnt lgkmcnt(15)
    v_mfma_f32_16x16x32_bf16 v[140:143], v[112:115], v[204:207], v[140:143]
    v_mfma_f32_16x16x32_bf16 v[144:147], v[116:119], v[192:195], v[144:147]
    ds_read_b64_tr_b16 v[108:109], v1 offset:8192
    ds_read_b64_tr_b16 v[110:111], v1 offset:10240
    v_mfma_f32_16x16x32_bf16 v[148:151], v[116:119], v[196:199], v[148:151]
    s_add_u32 m0, s55, 1024
    s_add_u32 s38, s43, 1060864
    v_mfma_f32_16x16x32_bf16 v[152:155], v[116:119], v[200:203], v[152:155]
    ds_read_b128 v[228:231], v30 offset:21504
    buffer_load_dwordx4 v60, s[8:11], s38 offen lds
    v_mfma_f32_16x16x32_bf16 v[156:159], v[116:119], v[204:207], v[156:159]
    s_waitcnt lgkmcnt(15)
    v_mfma_f32_16x16x32_bf16 v[160:163], v[120:123], v[192:195], v[160:163]
    ds_read_b64_tr_b16 v[112:113], v61 offset:12288
    ds_read_b64_tr_b16 v[114:115], v61 offset:14336
    v_mfma_f32_16x16x32_bf16 v[164:167], v[120:123], v[196:199], v[164:167]
    s_add_u32 m0, s55, 2048
    s_add_u32 s38, s43, 1089536
    v_mfma_f32_16x16x32_bf16 v[168:171], v[120:123], v[200:203], v[168:171]
    ds_read_b128 v[232:235], v30 offset:22528
    buffer_load_dwordx4 v60, s[8:11], s38 offen lds
    v_mfma_f32_16x16x32_bf16 v[172:175], v[120:123], v[204:207], v[172:175]
    s_waitcnt lgkmcnt(15)
    v_mfma_f32_16x16x32_bf16 v[176:179], v[124:127], v[192:195], v[176:179]
    ds_read_b64_tr_b16 v[116:117], v62 offset:12288
    ds_read_b64_tr_b16 v[118:119], v62 offset:14336
    v_mfma_f32_16x16x32_bf16 v[180:183], v[124:127], v[196:199], v[180:183]
    s_add_u32 m0, s55, 3072
    s_add_u32 s38, s43, 1118208
    v_mfma_f32_16x16x32_bf16 v[184:187], v[124:127], v[200:203], v[184:187]
    ds_read_b128 v[236:239], v30 offset:23552
    buffer_load_dwordx4 v60, s[8:11], s38 offen lds
    v_mfma_f32_16x16x32_bf16 v[188:191], v[124:127], v[204:207], v[188:191]
    s_waitcnt lgkmcnt(15)
    v_mfma_f32_16x16x32_bf16 v[128:131], v[96:99], v[208:211], v[128:131]
    ds_read_b64_tr_b16 v[120:121], v63 offset:12288
    ds_read_b64_tr_b16 v[122:123], v63 offset:14336
    v_mfma_f32_16x16x32_bf16 v[132:135], v[96:99], v[212:215], v[132:135]
    s_add_u32 m0, s55, 4096
    s_add_u32 s38, s43, 1204224
    v_mfma_f32_16x16x32_bf16 v[136:139], v[96:99], v[216:219], v[136:139]
    ds_read_b128 v[192:195], v30 offset:24576
    buffer_load_dwordx4 v60, s[8:11], s38 offen lds
    s_waitcnt lgkmcnt(15)
    v_mfma_f32_16x16x32_bf16 v[140:143], v[96:99], v[220:223], v[140:143]
    v_mfma_f32_16x16x32_bf16 v[144:147], v[100:103], v[208:211], v[144:147]
    ds_read_b64_tr_b16 v[124:125], v1 offset:12288
    ds_read_b64_tr_b16 v[126:127], v1 offset:14336
    v_mfma_f32_16x16x32_bf16 v[148:151], v[100:103], v[212:215], v[148:151]
    s_add_u32 m0, s55, 5120
    s_add_u32 s38, s43, 1232896
    v_mfma_f32_16x16x32_bf16 v[152:155], v[100:103], v[216:219], v[152:155]
    ds_read_b128 v[196:199], v30 offset:25600
    buffer_load_dwordx4 v60, s[8:11], s38 offen lds
    v_mfma_f32_16x16x32_bf16 v[156:159], v[100:103], v[220:223], v[156:159]
    s_waitcnt lgkmcnt(15)
    v_mfma_f32_16x16x32_bf16 v[160:163], v[104:107], v[208:211], v[160:163]
    s_waitcnt vmcnt(10)
    ds_read_b64_tr_b16 v[96:97], v61 offset:16384
    ds_read_b64_tr_b16 v[98:99], v61 offset:18432
    v_mfma_f32_16x16x32_bf16 v[164:167], v[104:107], v[212:215], v[164:167]
    s_add_u32 m0, s55, 6144
    s_add_u32 s38, s43, 1261568
    v_mfma_f32_16x16x32_bf16 v[168:171], v[104:107], v[216:219], v[168:171]
    ds_read_b128 v[200:203], v30 offset:26624
    buffer_load_dwordx4 v60, s[8:11], s38 offen lds
    v_mfma_f32_16x16x32_bf16 v[172:175], v[104:107], v[220:223], v[172:175]
    s_waitcnt lgkmcnt(15)
    v_mfma_f32_16x16x32_bf16 v[176:179], v[108:111], v[208:211], v[176:179]
    ds_read_b64_tr_b16 v[100:101], v62 offset:16384
    ds_read_b64_tr_b16 v[102:103], v62 offset:18432
    v_mfma_f32_16x16x32_bf16 v[180:183], v[108:111], v[212:215], v[180:183]
    s_add_u32 m0, s55, 7168
    s_add_u32 s38, s43, 1290240
    v_mfma_f32_16x16x32_bf16 v[184:187], v[108:111], v[216:219], v[184:187]
    ds_read_b128 v[204:207], v30 offset:27648
    buffer_load_dwordx4 v60, s[8:11], s38 offen lds
    v_mfma_f32_16x16x32_bf16 v[188:191], v[108:111], v[220:223], v[188:191]
    s_waitcnt lgkmcnt(15)
    v_mfma_f32_16x16x32_bf16 v[128:131], v[112:115], v[224:227], v[128:131]
    ds_read_b64_tr_b16 v[104:105], v63 offset:16384
    ds_read_b64_tr_b16 v[106:107], v63 offset:18432
    v_mfma_f32_16x16x32_bf16 v[132:135], v[112:115], v[228:231], v[132:135]
    s_add_u32 m0, s55, 8192
    s_add_u32 s38, s43, 1318912
    v_mfma_f32_16x16x32_bf16 v[136:139], v[112:115], v[232:235], v[136:139]
    ds_read_b128 v[208:211], v30 offset:28672
    ds_write_b128 v57, a[48:51] offset:26624
    s_waitcnt lgkmcnt(15)
    v_mfma_f32_16x16x32_bf16 v[140:143], v[112:115], v[236:239], v[140:143]
    buffer_load_dwordx4 v60, s[8:11], s38 offen lds
    v_mfma_f32_16x16x32_bf16 v[144:147], v[116:119], v[224:227], v[144:147]
    ds_read_b64_tr_b16 v[108:109], v1 offset:16384
    ds_read_b64_tr_b16 v[110:111], v1 offset:18432
    v_mfma_f32_16x16x32_bf16 v[148:151], v[116:119], v[228:231], v[148:151]
    ds_write_b128 v57, a[52:55] offset:27648
    s_add_u32 m0, s55, 9216
    s_add_u32 s38, s43, 1347584
    v_mfma_f32_16x16x32_bf16 v[152:155], v[116:119], v[232:235], v[152:155]
    ds_read_b128 v[212:215], v30 offset:29696
    ds_write_b128 v57, a[56:59] offset:28672
    v_mfma_f32_16x16x32_bf16 v[156:159], v[116:119], v[236:239], v[156:159]
    buffer_load_dwordx4 v60, s[8:11], s38 offen lds
    s_waitcnt lgkmcnt(15)
    v_mfma_f32_16x16x32_bf16 v[160:163], v[120:123], v[224:227], v[160:163]
    s_waitcnt vmcnt(10)
    ds_read_b64_tr_b16 v[112:113], v61 offset:20480
    ds_read_b64_tr_b16 v[114:115], v61 offset:22528
    v_mfma_f32_16x16x32_bf16 v[164:167], v[120:123], v[228:231], v[164:167]
    ds_write_b128 v57, a[60:63] offset:29696
    s_add_u32 m0, s55, 10240
    s_add_u32 s38, s43, 1376256
    v_mfma_f32_16x16x32_bf16 v[168:171], v[120:123], v[232:235], v[168:171]
    ds_read_b128 v[216:219], v30 offset:30720
    ds_write_b128 v57, a[64:67] offset:30720
    v_mfma_f32_16x16x32_bf16 v[172:175], v[120:123], v[236:239], v[172:175]
    buffer_load_dwordx4 v60, s[8:11], s38 offen lds
    v_mfma_f32_16x16x32_bf16 v[176:179], v[124:127], v[224:227], v[176:179]
    ds_read_b64_tr_b16 v[116:117], v62 offset:20480
    ds_read_b64_tr_b16 v[118:119], v62 offset:22528
    v_mfma_f32_16x16x32_bf16 v[180:183], v[124:127], v[228:231], v[180:183]
    ds_write_b128 v57, a[68:71] offset:31744
    s_add_u32 m0, s55, 11264
    s_add_u32 s38, s43, 1404928
    v_mfma_f32_16x16x32_bf16 v[184:187], v[124:127], v[232:235], v[184:187]
    ds_read_b128 v[220:223], v30 offset:31744
    buffer_load_dwordx4 v60, s[8:11], s38 offen lds
    v_mfma_f32_16x16x32_bf16 v[188:191], v[124:127], v[236:239], v[188:191]
    s_waitcnt lgkmcnt(15)
    v_mfma_f32_16x16x32_bf16 v[128:131], v[96:99], v[192:195], v[128:131]
    ds_read_b64_tr_b16 v[120:121], v63 offset:20480
    ds_read_b64_tr_b16 v[122:123], v63 offset:22528
    v_mfma_f32_16x16x32_bf16 v[132:135], v[96:99], v[196:199], v[132:135]
    s_waitcnt lgkmcnt(0)
    s_barrier
    s_add_u32 m0, s55, 12288
    s_add_u32 s38, s43, 1433600
    v_mfma_f32_16x16x32_bf16 v[136:139], v[96:99], v[200:203], v[136:139]
    ds_read_b128 v[224:227], v30 offset:59392
    buffer_load_dwordx4 v60, s[8:11], s38 offen lds
    v_mfma_f32_16x16x32_bf16 v[140:143], v[96:99], v[204:207], v[140:143]
    v_mfma_f32_16x16x32_bf16 v[144:147], v[100:103], v[192:195], v[144:147]
    ds_read_b64_tr_b16 v[124:125], v1 offset:20480
    ds_read_b64_tr_b16 v[126:127], v1 offset:22528
    v_mfma_f32_16x16x32_bf16 v[148:151], v[100:103], v[196:199], v[148:151]
    s_add_u32 m0, s55, 13312
    s_add_u32 s38, s43, 1462272
    v_mfma_f32_16x16x32_bf16 v[152:155], v[100:103], v[200:203], v[152:155]
    ds_read_b128 v[228:231], v31 offset:26624
    buffer_load_dwordx4 v60, s[8:11], s38 offen lds
    v_mfma_f32_16x16x32_bf16 v[156:159], v[100:103], v[204:207], v[156:159]
    v_mfma_f32_16x16x32_bf16 v[160:163], v[104:107], v[192:195], v[160:163]
    s_waitcnt vmcnt(10)
    ds_read_b64_tr_b16 v[96:97], v61 offset:0
    ds_read_b64_tr_b16 v[98:99], v61 offset:2048
    v_mfma_f32_16x16x32_bf16 v[164:167], v[104:107], v[196:199], v[164:167]
    s_add_u32 m0, s55, 14336
    s_add_u32 s38, s43, 1490944
    v_mfma_f32_16x16x32_bf16 v[168:171], v[104:107], v[200:203], v[168:171]
    ds_read_b128 v[232:235], v31 offset:59392
    buffer_load_dwordx4 v60, s[8:11], s38 offen lds
    v_mfma_f32_16x16x32_bf16 v[172:175], v[104:107], v[204:207], v[172:175]
    v_mfma_f32_16x16x32_bf16 v[176:179], v[108:111], v[192:195], v[176:179]
    ds_read_b64_tr_b16 v[100:101], v62 offset:0
    ds_read_b64_tr_b16 v[102:103], v62 offset:2048
    v_mfma_f32_16x16x32_bf16 v[180:183], v[108:111], v[196:199], v[180:183]
    s_add_u32 m0, s55, 15360
    s_add_u32 s38, s43, 1519616
    v_mfma_f32_16x16x32_bf16 v[184:187], v[108:111], v[200:203], v[184:187]
    ds_read_b128 v[236:239], v32 offset:26624
    buffer_load_dwordx4 v60, s[8:11], s38 offen lds
    v_mfma_f32_16x16x32_bf16 v[188:191], v[108:111], v[204:207], v[188:191]
    v_mfma_f32_16x16x32_bf16 v[128:131], v[112:115], v[208:211], v[128:131]
    ds_read_b64_tr_b16 v[104:105], v63 offset:0
    ds_read_b64_tr_b16 v[106:107], v63 offset:2048
    v_mfma_f32_16x16x32_bf16 v[132:135], v[112:115], v[212:215], v[132:135]
    s_add_u32 m0, s55, 16384
    s_add_u32 s38, s43, 344064
    v_mfma_f32_16x16x32_bf16 v[136:139], v[112:115], v[216:219], v[136:139]
    ds_read_b128 v[192:195], v30 offset:60416
    buffer_load_dwordx4 v60, s[8:11], s38 offen lds
    v_mfma_f32_16x16x32_bf16 v[140:143], v[112:115], v[220:223], v[140:143]
    v_mfma_f32_16x16x32_bf16 v[144:147], v[116:119], v[208:211], v[144:147]
    ds_read_b64_tr_b16 v[108:109], v1 offset:0
    ds_read_b64_tr_b16 v[110:111], v1 offset:2048
    v_mfma_f32_16x16x32_bf16 v[148:151], v[116:119], v[212:215], v[148:151]
    s_add_u32 m0, s55, 17408
    s_add_u32 s38, s43, 372736
    v_mfma_f32_16x16x32_bf16 v[152:155], v[116:119], v[216:219], v[152:155]
    ds_read_b128 v[196:199], v31 offset:27648
    buffer_load_dwordx4 v60, s[8:11], s38 offen lds
    v_mfma_f32_16x16x32_bf16 v[156:159], v[116:119], v[220:223], v[156:159]
    v_mfma_f32_16x16x32_bf16 v[160:163], v[120:123], v[208:211], v[160:163]
    s_waitcnt vmcnt(10)
    ds_read_b64_tr_b16 v[112:113], v61 offset:4096
    ds_read_b64_tr_b16 v[114:115], v61 offset:6144
    v_mfma_f32_16x16x32_bf16 v[164:167], v[120:123], v[212:215], v[164:167]
    s_add_u32 m0, s55, 18432
    s_add_u32 s38, s43, 745472
    v_mfma_f32_16x16x32_bf16 v[168:171], v[120:123], v[216:219], v[168:171]
    ds_read_b128 v[200:203], v31 offset:60416
    buffer_load_dwordx4 v60, s[8:11], s38 offen lds
    v_mfma_f32_16x16x32_bf16 v[172:175], v[120:123], v[220:223], v[172:175]
    s_waitcnt lgkmcnt(15)
    v_mfma_f32_16x16x32_bf16 v[176:179], v[124:127], v[208:211], v[176:179]
    ds_read_b64_tr_b16 v[116:117], v62 offset:4096
    ds_read_b64_tr_b16 v[118:119], v62 offset:6144
    v_mfma_f32_16x16x32_bf16 v[180:183], v[124:127], v[212:215], v[180:183]
    s_add_u32 m0, s55, 19456
    s_add_u32 s38, s43, 774144
    v_mfma_f32_16x16x32_bf16 v[184:187], v[124:127], v[216:219], v[184:187]
    ds_read_b128 v[204:207], v32 offset:27648
    buffer_load_dwordx4 v60, s[8:11], s38 offen lds
    v_mfma_f32_16x16x32_bf16 v[188:191], v[124:127], v[220:223], v[188:191]
    s_waitcnt lgkmcnt(15)
    v_mfma_f32_16x16x32_bf16 v[128:131], v[96:99], v[224:227], v[128:131]
    ds_read_b64_tr_b16 v[120:121], v63 offset:4096
    ds_read_b64_tr_b16 v[122:123], v63 offset:6144
    v_mfma_f32_16x16x32_bf16 v[132:135], v[96:99], v[228:231], v[132:135]
    s_add_u32 m0, s55, 20480
    s_add_u32 s38, s43, 1146880
    v_mfma_f32_16x16x32_bf16 v[136:139], v[96:99], v[232:235], v[136:139]
    ds_read_b128 v[208:211], v30 offset:61440
    buffer_load_dwordx4 v60, s[8:11], s38 offen lds
    s_waitcnt lgkmcnt(15)
    v_mfma_f32_16x16x32_bf16 v[140:143], v[96:99], v[236:239], v[140:143]
    v_mfma_f32_16x16x32_bf16 v[144:147], v[100:103], v[224:227], v[144:147]
    ds_read_b64_tr_b16 v[124:125], v1 offset:4096
    ds_read_b64_tr_b16 v[126:127], v1 offset:6144
    v_mfma_f32_16x16x32_bf16 v[148:151], v[100:103], v[228:231], v[148:151]
    s_add_u32 m0, s55, 21504
    s_add_u32 s38, s43, 1175552
    v_mfma_f32_16x16x32_bf16 v[152:155], v[100:103], v[232:235], v[152:155]
    ds_read_b128 v[212:215], v31 offset:28672
    buffer_load_dwordx4 v60, s[8:11], s38 offen lds
    v_mfma_f32_16x16x32_bf16 v[156:159], v[100:103], v[236:239], v[156:159]
    s_waitcnt lgkmcnt(15)
    v_mfma_f32_16x16x32_bf16 v[160:163], v[104:107], v[224:227], v[160:163]
    s_waitcnt vmcnt(10)
    ds_read_b64_tr_b16 v[96:97], v61 offset:8192
    ds_read_b64_tr_b16 v[98:99], v61 offset:10240
    v_mfma_f32_16x16x32_bf16 v[164:167], v[104:107], v[228:231], v[164:167]
    s_add_u32 m0, s55, 22528
    s_add_u32 s38, s43, 1548288
    v_mfma_f32_16x16x32_bf16 v[168:171], v[104:107], v[232:235], v[168:171]
    ds_read_b128 v[216:219], v31 offset:61440
    buffer_load_dwordx4 v60, s[8:11], s38 offen lds
    v_mfma_f32_16x16x32_bf16 v[172:175], v[104:107], v[236:239], v[172:175]
    s_waitcnt lgkmcnt(15)
    v_mfma_f32_16x16x32_bf16 v[176:179], v[108:111], v[224:227], v[176:179]
    ds_read_b64_tr_b16 v[100:101], v62 offset:8192
    ds_read_b64_tr_b16 v[102:103], v62 offset:10240
    v_mfma_f32_16x16x32_bf16 v[180:183], v[108:111], v[228:231], v[180:183]
    s_add_u32 m0, s55, 23552
    s_add_u32 s38, s43, 1576960
    v_mfma_f32_16x16x32_bf16 v[184:187], v[108:111], v[232:235], v[184:187]
    ds_read_b128 v[220:223], v32 offset:28672
    buffer_load_dwordx4 v60, s[8:11], s38 offen lds
    v_mfma_f32_16x16x32_bf16 v[188:191], v[108:111], v[236:239], v[188:191]
    s_waitcnt lgkmcnt(15)
    v_mfma_f32_16x16x32_bf16 v[128:131], v[112:115], v[192:195], v[128:131]
    ds_read_b64_tr_b16 v[104:105], v63 offset:8192
    ds_read_b64_tr_b16 v[106:107], v63 offset:10240
    v_mfma_f32_16x16x32_bf16 v[132:135], v[112:115], v[196:199], v[132:135]
    v_mfma_f32_16x16x32_bf16 v[136:139], v[112:115], v[200:203], v[136:139]
    ds_read_b128 v[224:227], v30 offset:62464
    s_waitcnt lgkmcnt(15)
    v_mfma_f32_16x16x32_bf16 v[140:143], v[112:115], v[204:207], v[140:143]
    v_mfma_f32_16x16x32_bf16 v[144:147], v[116:119], v[192:195], v[144:147]
    ds_read_b64_tr_b16 v[108:109], v1 offset:8192
    ds_read_b64_tr_b16 v[110:111], v1 offset:10240
    v_mfma_f32_16x16x32_bf16 v[148:151], v[116:119], v[196:199], v[148:151]
    v_mfma_f32_16x16x32_bf16 v[152:155], v[116:119], v[200:203], v[152:155]
    ds_read_b128 v[228:231], v31 offset:29696
    v_mfma_f32_16x16x32_bf16 v[156:159], v[116:119], v[204:207], v[156:159]
    s_waitcnt lgkmcnt(15)
    v_mfma_f32_16x16x32_bf16 v[160:163], v[120:123], v[192:195], v[160:163]
    s_waitcnt vmcnt(8)
    ds_read_b64_tr_b16 v[112:113], v61 offset:12288
    ds_read_b64_tr_b16 v[114:115], v61 offset:14336
    v_mfma_f32_16x16x32_bf16 v[164:167], v[120:123], v[196:199], v[164:167]
    v_mfma_f32_16x16x32_bf16 v[168:171], v[120:123], v[200:203], v[168:171]
    ds_read_b128 v[232:235], v31 offset:62464
    v_mfma_f32_16x16x32_bf16 v[172:175], v[120:123], v[204:207], v[172:175]
    s_waitcnt lgkmcnt(15)
    v_mfma_f32_16x16x32_bf16 v[176:179], v[124:127], v[192:195], v[176:179]
    ds_read_b64_tr_b16 v[116:117], v62 offset:12288
    ds_read_b64_tr_b16 v[118:119], v62 offset:14336
    v_mfma_f32_16x16x32_bf16 v[180:183], v[124:127], v[196:199], v[180:183]
    v_mfma_f32_16x16x32_bf16 v[184:187], v[124:127], v[200:203], v[184:187]
    ds_read_b128 v[236:239], v32 offset:29696
    v_mfma_f32_16x16x32_bf16 v[188:191], v[124:127], v[204:207], v[188:191]
    s_waitcnt lgkmcnt(15)
    v_mfma_f32_16x16x32_bf16 v[128:131], v[96:99], v[208:211], v[128:131]
    ds_read_b64_tr_b16 v[120:121], v63 offset:12288
    ds_read_b64_tr_b16 v[122:123], v63 offset:14336
    v_mfma_f32_16x16x32_bf16 v[132:135], v[96:99], v[212:215], v[132:135]
    s_add_u32 m0, s47, 0
    s_add_u32 s38, s51, 0
    v_mfma_f32_16x16x32_bf16 v[136:139], v[96:99], v[216:219], v[136:139]
    ds_read_b128 v[192:195], v30 offset:63488
    buffer_load_dwordx4 v20, s[20:23], s38 offen lds
    s_waitcnt lgkmcnt(15)
    v_mfma_f32_16x16x32_bf16 v[140:143], v[96:99], v[220:223], v[140:143]
    v_mfma_f32_16x16x32_bf16 v[144:147], v[100:103], v[208:211], v[144:147]
    ds_read_b64_tr_b16 v[124:125], v1 offset:12288
    ds_read_b64_tr_b16 v[126:127], v1 offset:14336
    v_mfma_f32_16x16x32_bf16 v[148:151], v[100:103], v[212:215], v[148:151]
    s_add_u32 m0, s47, 1024
    v_mfma_f32_16x16x32_bf16 v[152:155], v[100:103], v[216:219], v[152:155]
    ds_read_b128 v[196:199], v31 offset:30720
    buffer_load_dwordx4 v21, s[20:23], s38 offen lds
    v_mfma_f32_16x16x32_bf16 v[156:159], v[100:103], v[220:223], v[156:159]
    s_waitcnt lgkmcnt(15)
    v_mfma_f32_16x16x32_bf16 v[160:163], v[104:107], v[208:211], v[160:163]
    s_waitcnt vmcnt(6)
    ds_read_b64_tr_b16 v[96:97], v61 offset:16384
    ds_read_b64_tr_b16 v[98:99], v61 offset:18432
    v_mfma_f32_16x16x32_bf16 v[164:167], v[104:107], v[212:215], v[164:167]
    s_add_u32 m0, s47, 2048
    v_mfma_f32_16x16x32_bf16 v[168:171], v[104:107], v[216:219], v[168:171]
    ds_read_b128 v[200:203], v31 offset:63488
    buffer_load_dwordx4 v22, s[20:23], s38 offen lds
    v_mfma_f32_16x16x32_bf16 v[172:175], v[104:107], v[220:223], v[172:175]
    s_waitcnt lgkmcnt(15)
    v_mfma_f32_16x16x32_bf16 v[176:179], v[108:111], v[208:211], v[176:179]
    ds_read_b64_tr_b16 v[100:101], v62 offset:16384
    ds_read_b64_tr_b16 v[102:103], v62 offset:18432
    v_mfma_f32_16x16x32_bf16 v[180:183], v[108:111], v[212:215], v[180:183]
    s_add_u32 m0, s47, 3072
    v_mfma_f32_16x16x32_bf16 v[184:187], v[108:111], v[216:219], v[184:187]
    ds_read_b128 v[204:207], v32 offset:30720
    buffer_load_dwordx4 v23, s[20:23], s38 offen lds
    v_mfma_f32_16x16x32_bf16 v[188:191], v[108:111], v[220:223], v[188:191]
    s_waitcnt lgkmcnt(15)
    v_mfma_f32_16x16x32_bf16 v[128:131], v[112:115], v[224:227], v[128:131]
    ds_read_b64_tr_b16 v[104:105], v63 offset:16384
    ds_read_b64_tr_b16 v[106:107], v63 offset:18432
    v_mfma_f32_16x16x32_bf16 v[132:135], v[112:115], v[228:231], v[132:135]
    s_add_u32 m0, s47, 4096
    v_mfma_f32_16x16x32_bf16 v[136:139], v[112:115], v[232:235], v[136:139]
    ds_read_b128 v[208:211], v30 offset:64512
    buffer_load_dwordx4 v24, s[20:23], s38 offen lds
    s_waitcnt lgkmcnt(15)
    v_mfma_f32_16x16x32_bf16 v[140:143], v[112:115], v[236:239], v[140:143]
    v_mfma_f32_16x16x32_bf16 v[144:147], v[116:119], v[224:227], v[144:147]
    ds_read_b64_tr_b16 v[108:109], v1 offset:16384
    ds_read_b64_tr_b16 v[110:111], v1 offset:18432
    v_mfma_f32_16x16x32_bf16 v[148:151], v[116:119], v[228:231], v[148:151]
    s_add_u32 m0, s47, 5120
    v_mfma_f32_16x16x32_bf16 v[152:155], v[116:119], v[232:235], v[152:155]
    ds_read_b128 v[212:215], v31 offset:31744
    buffer_load_dwordx4 v25, s[20:23], s38 offen lds
    v_mfma_f32_16x16x32_bf16 v[156:159], v[116:119], v[236:239], v[156:159]
    s_waitcnt lgkmcnt(15)
    v_mfma_f32_16x16x32_bf16 v[160:163], v[120:123], v[224:227], v[160:163]
    s_waitcnt vmcnt(6)
    ds_read_b64_tr_b16 v[112:113], v61 offset:20480
    ds_read_b64_tr_b16 v[114:115], v61 offset:22528
    v_mfma_f32_16x16x32_bf16 v[164:167], v[120:123], v[228:231], v[164:167]
    s_add_u32 m0, s47, 6144
    v_mfma_f32_16x16x32_bf16 v[168:171], v[120:123], v[232:235], v[168:171]
    ds_read_b128 v[216:219], v31 offset:64512
    buffer_load_dwordx4 v26, s[20:23], s38 offen lds
    v_mfma_f32_16x16x32_bf16 v[172:175], v[120:123], v[236:239], v[172:175]
    s_waitcnt lgkmcnt(15)
    v_mfma_f32_16x16x32_bf16 v[176:179], v[124:127], v[224:227], v[176:179]
    ds_read_b64_tr_b16 v[116:117], v62 offset:20480
    ds_read_b64_tr_b16 v[118:119], v62 offset:22528
    v_mfma_f32_16x16x32_bf16 v[180:183], v[124:127], v[228:231], v[180:183]
    v_mfma_f32_16x16x32_bf16 v[184:187], v[124:127], v[232:235], v[184:187]
    ds_read_b128 v[220:223], v32 offset:31744
    v_mfma_f32_16x16x32_bf16 v[188:191], v[124:127], v[236:239], v[188:191]
    s_waitcnt lgkmcnt(15)
    v_mfma_f32_16x16x32_bf16 v[128:131], v[96:99], v[192:195], v[128:131]
    ds_read_b64_tr_b16 v[120:121], v63 offset:20480
    ds_read_b64_tr_b16 v[122:123], v63 offset:22528
    v_mfma_f32_16x16x32_bf16 v[132:135], v[96:99], v[196:199], v[132:135]
    s_add_u32 m0, s48, 0
    s_add_u32 s38, s51, 28672
    v_mfma_f32_16x16x32_bf16 v[136:139], v[96:99], v[200:203], v[136:139]
    buffer_load_dwordx4 v20, s[20:23], s38 offen lds
    s_waitcnt lgkmcnt(14)
    v_mfma_f32_16x16x32_bf16 v[140:143], v[96:99], v[204:207], v[140:143]
    v_mfma_f32_16x16x32_bf16 v[144:147], v[100:103], v[192:195], v[144:147]
    ds_read_b64_tr_b16 v[124:125], v1 offset:20480
    ds_read_b64_tr_b16 v[126:127], v1 offset:22528
    v_mfma_f32_16x16x32_bf16 v[148:151], v[100:103], v[196:199], v[148:151]
    s_add_u32 m0, s48, 1024
    v_mfma_f32_16x16x32_bf16 v[152:155], v[100:103], v[200:203], v[152:155]
    buffer_load_dwordx4 v21, s[20:23], s38 offen lds
    v_mfma_f32_16x16x32_bf16 v[156:159], v[100:103], v[204:207], v[156:159]
    s_waitcnt lgkmcnt(14)
    v_mfma_f32_16x16x32_bf16 v[160:163], v[104:107], v[192:195], v[160:163]
    v_mfma_f32_16x16x32_bf16 v[164:167], v[104:107], v[196:199], v[164:167]
    s_add_u32 m0, s48, 2048
    v_mfma_f32_16x16x32_bf16 v[168:171], v[104:107], v[200:203], v[168:171]
    buffer_load_dwordx4 v22, s[20:23], s38 offen lds
    v_mfma_f32_16x16x32_bf16 v[172:175], v[104:107], v[204:207], v[172:175]
    s_waitcnt lgkmcnt(11)
    v_mfma_f32_16x16x32_bf16 v[176:179], v[108:111], v[192:195], v[176:179]
    v_mfma_f32_16x16x32_bf16 v[180:183], v[108:111], v[196:199], v[180:183]
    s_add_u32 m0, s48, 3072
    v_mfma_f32_16x16x32_bf16 v[184:187], v[108:111], v[200:203], v[184:187]
    buffer_load_dwordx4 v23, s[20:23], s38 offen lds
    v_mfma_f32_16x16x32_bf16 v[188:191], v[108:111], v[204:207], v[188:191]
    s_waitcnt lgkmcnt(8)
    v_mfma_f32_16x16x32_bf16 v[128:131], v[112:115], v[208:211], v[128:131]
    v_mfma_f32_16x16x32_bf16 v[132:135], v[112:115], v[212:215], v[132:135]
    s_add_u32 m0, s48, 4096
    s_waitcnt lgkmcnt(7)
    v_mfma_f32_16x16x32_bf16 v[136:139], v[112:115], v[216:219], v[136:139]
    buffer_load_dwordx4 v24, s[20:23], s38 offen lds
    s_waitcnt lgkmcnt(4)
    v_mfma_f32_16x16x32_bf16 v[140:143], v[112:115], v[220:223], v[140:143]
    v_mfma_f32_16x16x32_bf16 v[144:147], v[116:119], v[208:211], v[144:147]
    v_mfma_f32_16x16x32_bf16 v[148:151], v[116:119], v[212:215], v[148:151]
    s_add_u32 m0, s48, 5120
    v_mfma_f32_16x16x32_bf16 v[152:155], v[116:119], v[216:219], v[152:155]
    buffer_load_dwordx4 v25, s[20:23], s38 offen lds
    v_mfma_f32_16x16x32_bf16 v[156:159], v[116:119], v[220:223], v[156:159]
    s_waitcnt lgkmcnt(2)
    v_mfma_f32_16x16x32_bf16 v[160:163], v[120:123], v[208:211], v[160:163]
    v_mfma_f32_16x16x32_bf16 v[164:167], v[120:123], v[212:215], v[164:167]
    s_add_u32 m0, s48, 6144
    v_mfma_f32_16x16x32_bf16 v[168:171], v[120:123], v[216:219], v[168:171]
    buffer_load_dwordx4 v26, s[20:23], s38 offen lds
    v_mfma_f32_16x16x32_bf16 v[172:175], v[120:123], v[220:223], v[172:175]
    s_waitcnt lgkmcnt(0)
    v_mfma_f32_16x16x32_bf16 v[176:179], v[124:127], v[208:211], v[176:179]
    v_mfma_f32_16x16x32_bf16 v[180:183], v[124:127], v[212:215], v[180:183]
    v_mfma_f32_16x16x32_bf16 v[184:187], v[124:127], v[216:219], v[184:187]
    v_mfma_f32_16x16x32_bf16 v[188:191], v[124:127], v[220:223], v[188:191]
    s_barrier
    v_mov_b32 v40, 0xbdd2d3e8
    v_mov_b32 v41, 0xbdd2d3e8
    v_mov_b32 v42, 0xc0135761
    v_mov_b32 v43, 0xc0135761
    v_mov_b32 v44, 1.0
    v_mov_b32 v45, 1.0
    s_lshl_b32 s37, s5, 13
    v_add_u32_e64 v56, s37, v30
    v_pk_mul_f32 v[64:65], v[128:129], v[128:129]
    v_pk_mul_f32 v[66:67], v[130:131], v[130:131]
    v_pk_mul_f32 v[68:69], v[144:145], v[144:145]
    v_pk_mul_f32 v[70:71], v[146:147], v[146:147]
    v_pk_fma_f32 v[64:65], v[64:65], v[40:41], v[42:43]
    v_pk_fma_f32 v[66:67], v[66:67], v[40:41], v[42:43]
    v_pk_fma_f32 v[68:69], v[68:69], v[40:41], v[42:43]
    v_pk_fma_f32 v[70:71], v[70:71], v[40:41], v[42:43]
    s_add_u32 m0, s49, 0
    s_add_u32 s38, s51, 57344
    buffer_load_dwordx4 v20, s[20:23], s38 offen lds
    v_pk_mul_f32 v[64:65], v[64:65], v[128:129]
    v_pk_mul_f32 v[66:67], v[66:67], v[130:131]
    v_pk_mul_f32 v[68:69], v[68:69], v[144:145]
    v_pk_mul_f32 v[70:71], v[70:71], v[146:147]
    v_exp_f32 v64, v64
    v_exp_f32 v65, v65
    v_exp_f32 v66, v66
    v_exp_f32 v67, v67
    v_exp_f32 v68, v68
    v_exp_f32 v69, v69
    v_exp_f32 v70, v70
    v_exp_f32_e64 v71, v71
    s_add_u32 m0, s49, 1024
    s_nop 0
    buffer_load_dwordx4 v21, s[20:23], s38 offen lds
    v_pk_add_f32 v[64:65], v[64:65], v[44:45]
    v_pk_add_f32 v[66:67], v[66:67], v[44:45]
    v_pk_add_f32 v[68:69], v[68:69], v[44:45]
    v_pk_add_f32 v[70:71], v[70:71], v[44:45]
    v_rcp_f32 v64, v64
    v_rcp_f32 v65, v65
    v_rcp_f32 v66, v66
    v_rcp_f32 v67, v67
    v_rcp_f32 v68, v68
    v_rcp_f32 v69, v69
    v_rcp_f32 v70, v70
    v_rcp_f32_e64 v71, v71
    s_add_u32 m0, s49, 2048
    s_nop 0
    buffer_load_dwordx4 v22, s[20:23], s38 offen lds
    v_pk_mul_f32 v[64:65], v[64:65], v[128:129]
    v_pk_mul_f32 v[66:67], v[66:67], v[130:131]
    v_pk_mul_f32 v[68:69], v[68:69], v[144:145]
    v_pk_mul_f32 v[70:71], v[70:71], v[146:147]
    v_cvt_pk_bf16_f32 v72, v64, v65
    v_cvt_pk_bf16_f32 v73, v66, v67
    v_cvt_pk_bf16_f32 v74, v68, v69
    v_cvt_pk_bf16_f32 v75, v70, v71
    ds_write_b128 v56, v[72:75] offset:0
    v_pk_mul_f32 v[80:81], v[132:133], v[132:133]
    v_pk_mul_f32 v[82:83], v[134:135], v[134:135]
    v_pk_mul_f32 v[84:85], v[148:149], v[148:149]
    s_add_u32 m0, s49, 3072
    s_nop 0
    buffer_load_dwordx4 v23, s[20:23], s38 offen lds
    v_pk_mul_f32 v[86:87], v[150:151], v[150:151]
    v_pk_fma_f32 v[80:81], v[80:81], v[40:41], v[42:43]
    v_pk_fma_f32 v[82:83], v[82:83], v[40:41], v[42:43]
    v_pk_fma_f32 v[84:85], v[84:85], v[40:41], v[42:43]
    v_pk_fma_f32 v[86:87], v[86:87], v[40:41], v[42:43]
    v_pk_mul_f32 v[80:81], v[80:81], v[132:133]
    v_pk_mul_f32 v[82:83], v[82:83], v[134:135]
    v_pk_mul_f32 v[84:85], v[84:85], v[148:149]
    v_pk_mul_f32 v[86:87], v[86:87], v[150:151]
    v_exp_f32 v80, v80
    v_exp_f32 v81, v81
    v_exp_f32_e64 v82, v82
    s_add_u32 m0, s49, 4096
    s_nop 0
    buffer_load_dwordx4 v24, s[20:23], s38 offen lds
    v_exp_f32 v83, v83
    v_exp_f32 v84, v84
    v_exp_f32 v85, v85
    v_exp_f32 v86, v86
    v_exp_f32 v87, v87
    v_pk_add_f32 v[80:81], v[80:81], v[44:45]
    v_pk_add_f32 v[82:83], v[82:83], v[44:45]
    v_pk_add_f32 v[84:85], v[84:85], v[44:45]
    v_pk_add_f32 v[86:87], v[86:87], v[44:45]
    v_rcp_f32 v80, v80
    v_rcp_f32 v81, v81
    v_rcp_f32_e64 v82, v82
    s_add_u32 m0, s49, 5120
    s_nop 0
    buffer_load_dwordx4 v25, s[20:23], s38 offen lds
    v_rcp_f32 v83, v83
    v_rcp_f32 v84, v84
    v_rcp_f32 v85, v85
    v_rcp_f32 v86, v86
    v_rcp_f32 v87, v87
    v_pk_mul_f32 v[80:81], v[80:81], v[132:133]
    v_pk_mul_f32 v[82:83], v[82:83], v[134:135]
    v_pk_mul_f32 v[84:85], v[84:85], v[148:149]
    v_pk_mul_f32 v[86:87], v[86:87], v[150:151]
    v_cvt_pk_bf16_f32 v88, v80, v81
    v_cvt_pk_bf16_f32 v89, v82, v83
    v_cvt_pk_bf16_f32 v90, v84, v85
    s_add_u32 m0, s49, 6144
    s_nop 0
    buffer_load_dwordx4 v26, s[20:23], s38 offen lds
    v_cvt_pk_bf16_f32 v91, v86, v87
    ds_write_b128 v56, v[88:91] offset:1024
    v_pk_mul_f32 v[96:97], v[136:137], v[136:137]
    v_pk_mul_f32 v[98:99], v[138:139], v[138:139]
    v_pk_mul_f32 v[100:101], v[152:153], v[152:153]
    v_pk_mul_f32 v[102:103], v[154:155], v[154:155]
    v_pk_fma_f32 v[96:97], v[96:97], v[40:41], v[42:43]
    v_pk_fma_f32 v[98:99], v[98:99], v[40:41], v[42:43]
    v_pk_fma_f32 v[100:101], v[100:101], v[40:41], v[42:43]
    v_pk_fma_f32 v[102:103], v[102:103], v[40:41], v[42:43]
    v_pk_mul_f32 v[96:97], v[96:97], v[136:137]
    v_pk_mul_f32 v[98:99], v[98:99], v[138:139]
    s_add_u32 m0, s50, 0
    s_add_u32 s38, s51, 86016
    buffer_load_dwordx4 v20, s[20:23], s38 offen lds
    v_pk_mul_f32 v[100:101], v[100:101], v[152:153]
    v_pk_mul_f32 v[102:103], v[102:103], v[154:155]
    v_exp_f32 v96, v96
    v_exp_f32 v97, v97
    v_exp_f32 v98, v98
    v_exp_f32 v99, v99
    v_exp_f32 v100, v100
    v_exp_f32 v101, v101
    v_exp_f32 v102, v102
    v_exp_f32 v103, v103
    v_pk_add_f32 v[96:97], v[96:97], v[44:45]
    v_pk_add_f32 v[98:99], v[98:99], v[44:45]
    s_add_u32 m0, s50, 1024
    s_nop 0
    buffer_load_dwordx4 v21, s[20:23], s38 offen lds
    v_pk_add_f32 v[100:101], v[100:101], v[44:45]
    v_pk_add_f32 v[102:103], v[102:103], v[44:45]
    v_rcp_f32 v96, v96
    v_rcp_f32 v97, v97
    v_rcp_f32 v98, v98
    v_rcp_f32 v99, v99
    v_rcp_f32 v100, v100
    v_rcp_f32 v101, v101
    v_rcp_f32 v102, v102
    v_rcp_f32_e64 v103, v103
    v_pk_mul_f32 v[96:97], v[96:97], v[136:137]
    v_pk_mul_f32 v[98:99], v[98:99], v[138:139]
    s_add_u32 m0, s50, 2048
    s_nop 0
    buffer_load_dwordx4 v22, s[20:23], s38 offen lds
    v_pk_mul_f32 v[100:101], v[100:101], v[152:153]
    v_pk_mul_f32 v[102:103], v[102:103], v[154:155]
    v_cvt_pk_bf16_f32 v104, v96, v97
    v_cvt_pk_bf16_f32 v105, v98, v99
    v_cvt_pk_bf16_f32 v106, v100, v101
    v_cvt_pk_bf16_f32 v107, v102, v103
    ds_write_b128 v56, v[104:107] offset:2048
    v_pk_mul_f32 v[112:113], v[140:141], v[140:141]
    v_pk_mul_f32 v[114:115], v[142:143], v[142:143]
    v_pk_mul_f32 v[116:117], v[156:157], v[156:157]
    v_pk_mul_f32 v[118:119], v[158:159], v[158:159]
    v_pk_fma_f32 v[112:113], v[112:113], v[40:41], v[42:43]
    s_add_u32 m0, s50, 3072
    s_nop 0
    buffer_load_dwordx4 v23, s[20:23], s38 offen lds
    v_pk_fma_f32 v[114:115], v[114:115], v[40:41], v[42:43]
    v_pk_fma_f32 v[116:117], v[116:117], v[40:41], v[42:43]
    v_pk_fma_f32 v[118:119], v[118:119], v[40:41], v[42:43]
    v_pk_mul_f32 v[112:113], v[112:113], v[140:141]
    v_pk_mul_f32 v[114:115], v[114:115], v[142:143]
    v_pk_mul_f32 v[116:117], v[116:117], v[156:157]
    v_pk_mul_f32 v[118:119], v[118:119], v[158:159]
    v_exp_f32 v112, v112
    v_exp_f32 v113, v113
    v_exp_f32 v114, v114
    v_exp_f32 v115, v115
    v_exp_f32_e64 v116, v116
    s_add_u32 m0, s50, 4096
    s_nop 0
    buffer_load_dwordx4 v24, s[20:23], s38 offen lds
    v_exp_f32 v117, v117
    v_exp_f32 v118, v118
    v_exp_f32 v119, v119
    v_pk_add_f32 v[112:113], v[112:113], v[44:45]
    v_pk_add_f32 v[114:115], v[114:115], v[44:45]
    v_pk_add_f32 v[116:117], v[116:117], v[44:45]
    v_pk_add_f32 v[118:119], v[118:119], v[44:45]
    v_rcp_f32 v112, v112
    v_rcp_f32 v113, v113
    v_rcp_f32 v114, v114
    v_rcp_f32 v115, v115
    v_rcp_f32_e64 v116, v116
    s_add_u32 m0, s50, 5120
    s_nop 0
    buffer_load_dwordx4 v25, s[20:23], s38 offen lds
    v_rcp_f32 v117, v117
    v_rcp_f32 v118, v118
    v_rcp_f32 v119, v119
    v_pk_mul_f32 v[112:113], v[112:113], v[140:141]
    v_pk_mul_f32 v[114:115], v[114:115], v[142:143]
    v_pk_mul_f32 v[116:117], v[116:117], v[156:157]
    v_pk_mul_f32 v[118:119], v[118:119], v[158:159]
    v_cvt_pk_bf16_f32 v120, v112, v113
    v_cvt_pk_bf16_f32 v121, v114, v115
    v_cvt_pk_bf16_f32 v122, v116, v117
    v_cvt_pk_bf16_f32 v123, v118, v119
    ds_write_b128 v56, v[120:123] offset:3072
    s_add_u32 m0, s50, 6144
    s_nop 0
    buffer_load_dwordx4 v26, s[20:23], s38 offen lds
    v_pk_mul_f32 v[64:65], v[160:161], v[160:161]
    v_pk_mul_f32 v[66:67], v[162:163], v[162:163]
    v_pk_mul_f32 v[68:69], v[176:177], v[176:177]
    v_pk_mul_f32 v[70:71], v[178:179], v[178:179]
    v_pk_fma_f32 v[64:65], v[64:65], v[40:41], v[42:43]
    v_pk_fma_f32 v[66:67], v[66:67], v[40:41], v[42:43]
    v_pk_fma_f32 v[68:69], v[68:69], v[40:41], v[42:43]
    v_pk_fma_f32 v[70:71], v[70:71], v[40:41], v[42:43]
    v_pk_mul_f32 v[64:65], v[64:65], v[160:161]
    v_pk_mul_f32 v[66:67], v[66:67], v[162:163]
    v_pk_mul_f32 v[68:69], v[68:69], v[176:177]
    v_pk_mul_f32 v[70:71], v[70:71], v[178:179]
    v_exp_f32 v64, v64
    v_exp_f32 v65, v65
    v_exp_f32 v66, v66
    v_exp_f32 v67, v67
    v_exp_f32 v68, v68
    v_exp_f32 v69, v69
    v_exp_f32 v70, v70
    v_exp_f32_e64 v71, v71
    v_pk_add_f32 v[64:65], v[64:65], v[44:45]
    v_pk_add_f32 v[66:67], v[66:67], v[44:45]
    v_pk_add_f32 v[68:69], v[68:69], v[44:45]
    v_pk_add_f32 v[70:71], v[70:71], v[44:45]
    v_rcp_f32 v64, v64
    v_rcp_f32 v65, v65
    v_rcp_f32 v66, v66
    v_rcp_f32 v67, v67
    v_rcp_f32 v68, v68
    v_rcp_f32 v69, v69
    v_rcp_f32 v70, v70
    v_rcp_f32 v71, v71
    v_pk_mul_f32 v[64:65], v[64:65], v[160:161]
    v_pk_mul_f32 v[66:67], v[66:67], v[162:163]
    v_pk_mul_f32 v[68:69], v[68:69], v[176:177]
    v_pk_mul_f32 v[70:71], v[70:71], v[178:179]
    v_cvt_pk_bf16_f32 v72, v64, v65
    v_cvt_pk_bf16_f32 v73, v66, v67
    v_cvt_pk_bf16_f32 v74, v68, v69
    v_cvt_pk_bf16_f32 v75, v70, v71
    ds_write_b128 v56, v[72:75] offset:4096
    v_pk_mul_f32 v[80:81], v[164:165], v[164:165]
    v_pk_mul_f32 v[82:83], v[166:167], v[166:167]
    v_pk_mul_f32 v[84:85], v[180:181], v[180:181]
    v_pk_mul_f32 v[86:87], v[182:183], v[182:183]
    v_pk_fma_f32 v[80:81], v[80:81], v[40:41], v[42:43]
    v_pk_fma_f32 v[82:83], v[82:83], v[40:41], v[42:43]
    v_pk_fma_f32 v[84:85], v[84:85], v[40:41], v[42:43]
    v_pk_fma_f32 v[86:87], v[86:87], v[40:41], v[42:43]
    v_pk_mul_f32 v[80:81], v[80:81], v[164:165]
    v_pk_mul_f32 v[82:83], v[82:83], v[166:167]
    v_pk_mul_f32 v[84:85], v[84:85], v[180:181]
    v_pk_mul_f32 v[86:87], v[86:87], v[182:183]
    v_exp_f32 v80, v80
    v_exp_f32 v81, v81
    v_exp_f32 v82, v82
    v_exp_f32 v83, v83
    v_exp_f32 v84, v84
    v_exp_f32 v85, v85
    v_exp_f32 v86, v86
    v_exp_f32 v87, v87
    v_pk_add_f32 v[80:81], v[80:81], v[44:45]
    v_pk_add_f32 v[82:83], v[82:83], v[44:45]
    v_pk_add_f32 v[84:85], v[84:85], v[44:45]
    v_pk_add_f32 v[86:87], v[86:87], v[44:45]
    v_rcp_f32 v80, v80
    v_rcp_f32 v81, v81
    v_rcp_f32 v82, v82
    v_rcp_f32 v83, v83
    v_rcp_f32 v84, v84
    v_rcp_f32 v85, v85
    v_rcp_f32 v86, v86
    v_rcp_f32 v87, v87
    v_pk_mul_f32 v[80:81], v[80:81], v[164:165]
    v_pk_mul_f32 v[82:83], v[82:83], v[166:167]
    v_pk_mul_f32 v[84:85], v[84:85], v[180:181]
    v_pk_mul_f32 v[86:87], v[86:87], v[182:183]
    v_cvt_pk_bf16_f32 v88, v80, v81
    v_cvt_pk_bf16_f32 v89, v82, v83
    v_cvt_pk_bf16_f32 v90, v84, v85
    v_cvt_pk_bf16_f32 v91, v86, v87
    ds_write_b128 v56, v[88:91] offset:5120
    v_pk_mul_f32 v[96:97], v[168:169], v[168:169]
    v_pk_mul_f32 v[98:99], v[170:171], v[170:171]
    v_pk_mul_f32 v[100:101], v[184:185], v[184:185]
    v_pk_mul_f32 v[102:103], v[186:187], v[186:187]
    v_pk_fma_f32 v[96:97], v[96:97], v[40:41], v[42:43]
    v_pk_fma_f32 v[98:99], v[98:99], v[40:41], v[42:43]
    v_pk_fma_f32 v[100:101], v[100:101], v[40:41], v[42:43]
    v_pk_fma_f32 v[102:103], v[102:103], v[40:41], v[42:43]
    v_pk_mul_f32 v[96:97], v[96:97], v[168:169]
    v_pk_mul_f32 v[98:99], v[98:99], v[170:171]
    v_pk_mul_f32 v[100:101], v[100:101], v[184:185]
    v_pk_mul_f32 v[102:103], v[102:103], v[186:187]
    v_exp_f32 v96, v96
    v_exp_f32 v97, v97
    v_exp_f32 v98, v98
    v_exp_f32 v99, v99
    v_exp_f32 v100, v100
    v_exp_f32 v101, v101
    v_exp_f32 v102, v102
    v_exp_f32 v103, v103
    v_pk_add_f32 v[96:97], v[96:97], v[44:45]
    v_pk_add_f32 v[98:99], v[98:99], v[44:45]
    v_pk_add_f32 v[100:101], v[100:101], v[44:45]
    v_pk_add_f32 v[102:103], v[102:103], v[44:45]
    v_rcp_f32 v96, v96
    v_rcp_f32 v97, v97
    v_rcp_f32 v98, v98
    v_rcp_f32 v99, v99
    v_rcp_f32 v100, v100
    v_rcp_f32 v101, v101
    v_rcp_f32 v102, v102
    v_rcp_f32 v103, v103
    v_pk_mul_f32 v[96:97], v[96:97], v[168:169]
    v_pk_mul_f32 v[98:99], v[98:99], v[170:171]
    v_pk_mul_f32 v[100:101], v[100:101], v[184:185]
    v_pk_mul_f32 v[102:103], v[102:103], v[186:187]
    v_cvt_pk_bf16_f32 v104, v96, v97
    v_cvt_pk_bf16_f32 v105, v98, v99
    v_cvt_pk_bf16_f32 v106, v100, v101
    v_cvt_pk_bf16_f32 v107, v102, v103
    ds_write_b128 v56, v[104:107] offset:6144
    v_pk_mul_f32 v[112:113], v[172:173], v[172:173]
    v_pk_mul_f32 v[114:115], v[174:175], v[174:175]
    v_pk_mul_f32 v[116:117], v[188:189], v[188:189]
    v_pk_mul_f32 v[118:119], v[190:191], v[190:191]
    v_pk_fma_f32 v[112:113], v[112:113], v[40:41], v[42:43]
    v_pk_fma_f32 v[114:115], v[114:115], v[40:41], v[42:43]
    v_pk_fma_f32 v[116:117], v[116:117], v[40:41], v[42:43]
    v_pk_fma_f32 v[118:119], v[118:119], v[40:41], v[42:43]
    v_pk_mul_f32 v[112:113], v[112:113], v[172:173]
    v_pk_mul_f32 v[114:115], v[114:115], v[174:175]
    v_pk_mul_f32 v[116:117], v[116:117], v[188:189]
    v_pk_mul_f32 v[118:119], v[118:119], v[190:191]
    v_exp_f32 v112, v112
    v_exp_f32 v113, v113
    v_exp_f32 v114, v114
    v_exp_f32 v115, v115
    v_exp_f32 v116, v116
    v_exp_f32 v117, v117
    v_exp_f32 v118, v118
    v_exp_f32 v119, v119
    v_pk_add_f32 v[112:113], v[112:113], v[44:45]
    v_pk_add_f32 v[114:115], v[114:115], v[44:45]
    v_pk_add_f32 v[116:117], v[116:117], v[44:45]
    v_pk_add_f32 v[118:119], v[118:119], v[44:45]
    v_rcp_f32 v112, v112
    v_rcp_f32 v113, v113
    v_rcp_f32 v114, v114
    v_rcp_f32 v115, v115
    v_rcp_f32 v116, v116
    v_rcp_f32 v117, v117
    v_rcp_f32 v118, v118
    v_rcp_f32 v119, v119
    v_pk_mul_f32 v[112:113], v[112:113], v[172:173]
    v_pk_mul_f32 v[114:115], v[114:115], v[174:175]
    v_pk_mul_f32 v[116:117], v[116:117], v[188:189]
    v_pk_mul_f32 v[118:119], v[118:119], v[190:191]
    v_cvt_pk_bf16_f32 v120, v112, v113
    v_cvt_pk_bf16_f32 v121, v114, v115
    v_cvt_pk_bf16_f32 v122, v116, v117
    v_cvt_pk_bf16_f32 v123, v118, v119
    ds_write_b128 v56, v[120:123] offset:7168
    s_waitcnt lgkmcnt(0)
    s_barrier
    ds_read_b128 v[64:67], v19 offset:0
    ds_read_b128 v[68:71], v19 offset:1024
    ds_read_b128 v[72:75], v19 offset:2048
    ds_read_b128 v[76:79], v19 offset:3072
    s_waitcnt vmcnt(21)
    ds_read_b64_tr_b16 v[96:97], v36 offset:0
    ds_read_b64_tr_b16 v[98:99], v36 offset:3584
    ds_read_b64_tr_b16 v[100:101], v36 offset:32
    ds_read_b64_tr_b16 v[102:103], v36 offset:3616
    ds_read_b64_tr_b16 v[104:105], v36 offset:64
    ds_read_b64_tr_b16 v[106:107], v36 offset:3648
    ds_read_b64_tr_b16 v[108:109], v36 offset:96
    ds_read_b64_tr_b16 v[110:111], v36 offset:3680
    ds_read_b64_tr_b16 v[112:113], v36 offset:128
    ds_read_b64_tr_b16 v[114:115], v36 offset:3712
    s_waitcnt lgkmcnt(8)
    v_mfma_f32_16x16x32_bf16 v[128:131], v[96:99], v[64:67], 0
    ds_read_b64_tr_b16 v[116:117], v36 offset:160
    ds_read_b64_tr_b16 v[118:119], v36 offset:3744
    v_mfma_f32_16x16x32_bf16 v[132:135], v[96:99], v[68:71], 0
    v_mfma_f32_16x16x32_bf16 v[136:139], v[96:99], v[72:75], 0
    ds_read_b128 v[80:83], v19 offset:4096
    v_mfma_f32_16x16x32_bf16 v[140:143], v[96:99], v[76:79], 0
    ds_read_b128 v[84:87], v19 offset:5120
    s_waitcnt lgkmcnt(10)
    v_mfma_f32_16x16x32_bf16 v[144:147], v[100:103], v[64:67], 0
    ds_read_b64_tr_b16 v[120:121], v36 offset:192
    ds_read_b64_tr_b16 v[122:123], v36 offset:3776
    v_mfma_f32_16x16x32_bf16 v[148:151], v[100:103], v[68:71], 0
    v_mfma_f32_16x16x32_bf16 v[152:155], v[100:103], v[72:75], 0
    ds_read_b128 v[88:91], v19 offset:6144
    v_mfma_f32_16x16x32_bf16 v[156:159], v[100:103], v[76:79], 0
    ds_read_b128 v[92:95], v19 offset:7168
    s_waitcnt lgkmcnt(12)
    v_mfma_f32_16x16x32_bf16 v[160:163], v[104:107], v[64:67], 0
    s_waitcnt vmcnt(14)
    ds_read_b64_tr_b16 v[124:125], v37 offset:0
    ds_read_b64_tr_b16 v[126:127], v37 offset:3584
    v_mfma_f32_16x16x32_bf16 v[164:167], v[104:107], v[68:71], 0
    v_mfma_f32_16x16x32_bf16 v[168:171], v[104:107], v[72:75], 0
    v_mfma_f32_16x16x32_bf16 v[172:175], v[104:107], v[76:79], 0
    s_waitcnt lgkmcnt(12)
    v_mfma_f32_16x16x32_bf16 v[176:179], v[108:111], v[64:67], 0
    ds_read_b64_tr_b16 v[96:97], v37 offset:32
    ds_read_b64_tr_b16 v[98:99], v37 offset:3616
    v_mfma_f32_16x16x32_bf16 v[180:183], v[108:111], v[68:71], 0
    v_mfma_f32_16x16x32_bf16 v[184:187], v[108:111], v[72:75], 0
    v_mfma_f32_16x16x32_bf16 v[188:191], v[108:111], v[76:79], 0
    s_waitcnt lgkmcnt(12)
    v_mfma_f32_16x16x32_bf16 v[192:195], v[112:115], v[64:67], 0
    ds_read_b64_tr_b16 v[100:101], v37 offset:64
    ds_read_b64_tr_b16 v[102:103], v37 offset:3648
    v_mfma_f32_16x16x32_bf16 v[196:199], v[112:115], v[68:71], 0
    v_mfma_f32_16x16x32_bf16 v[200:203], v[112:115], v[72:75], 0
    v_mfma_f32_16x16x32_bf16 v[204:207], v[112:115], v[76:79], 0
    s_waitcnt lgkmcnt(12)
    v_mfma_f32_16x16x32_bf16 v[208:211], v[116:119], v[64:67], 0
    ds_read_b64_tr_b16 v[104:105], v37 offset:96
    ds_read_b64_tr_b16 v[106:107], v37 offset:3680
    v_mfma_f32_16x16x32_bf16 v[212:215], v[116:119], v[68:71], 0
    v_mfma_f32_16x16x32_bf16 v[216:219], v[116:119], v[72:75], 0
    v_mfma_f32_16x16x32_bf16 v[220:223], v[116:119], v[76:79], 0
    s_waitcnt lgkmcnt(10)
    v_mfma_f32_16x16x32_bf16 v[224:227], v[120:123], v[64:67], 0
    ds_read_b64_tr_b16 v[108:109], v37 offset:128
    ds_read_b64_tr_b16 v[110:111], v37 offset:3712
    v_mfma_f32_16x16x32_bf16 v[228:231], v[120:123], v[68:71], 0
    v_mfma_f32_16x16x32_bf16 v[232:235], v[120:123], v[72:75], 0
    v_mfma_f32_16x16x32_bf16 v[236:239], v[120:123], v[76:79], 0
    s_waitcnt lgkmcnt(8)
    v_mfma_f32_16x16x32_bf16 v[128:131], v[124:127], v[80:83], v[128:131]
    ds_read_b64_tr_b16 v[112:113], v37 offset:160
    ds_read_b64_tr_b16 v[114:115], v37 offset:3744
    v_mfma_f32_16x16x32_bf16 v[132:135], v[124:127], v[84:87], v[132:135]
    s_add_u32 m0, s47, 0
    s_add_u32 s36, s51, 114688
    v_mfma_f32_16x16x32_bf16 v[136:139], v[124:127], v[88:91], v[136:139]
    ds_read_b128 v[64:67], v19 offset:8192
    buffer_load_dwordx4 v20, s[20:23], s36 offen lds
    v_mfma_f32_16x16x32_bf16 v[140:143], v[124:127], v[92:95], v[140:143]
    ds_read_b128 v[68:71], v19 offset:9216
    s_waitcnt lgkmcnt(10)
    v_mfma_f32_16x16x32_bf16 v[144:147], v[96:99], v[80:83], v[144:147]
    ds_read_b64_tr_b16 v[116:117], v37 offset:192
    ds_read_b64_tr_b16 v[118:119], v37 offset:3776
    v_mfma_f32_16x16x32_bf16 v[148:151], v[96:99], v[84:87], v[148:151]
    s_add_u32 m0, s47, 1024
    v_mfma_f32_16x16x32_bf16 v[152:155], v[96:99], v[88:91], v[152:155]
    ds_read_b128 v[72:75], v19 offset:10240
    buffer_load_dwordx4 v21, s[20:23], s36 offen lds
    v_mfma_f32_16x16x32_bf16 v[156:159], v[96:99], v[92:95], v[156:159]
    ds_read_b128 v[76:79], v19 offset:11264
    s_waitcnt lgkmcnt(12)
    v_mfma_f32_16x16x32_bf16 v[160:163], v[100:103], v[80:83], v[160:163]
    s_waitcnt vmcnt(9)
    ds_read_b64_tr_b16 v[120:121], v38 offset:0
    ds_read_b64_tr_b16 v[122:123], v38 offset:3584
    v_mfma_f32_16x16x32_bf16 v[164:167], v[100:103], v[84:87], v[164:167]
    s_add_u32 m0, s47, 2048
    v_mfma_f32_16x16x32_bf16 v[168:171], v[100:103], v[88:91], v[168:171]
    buffer_load_dwordx4 v22, s[20:23], s36 offen lds
    v_mfma_f32_16x16x32_bf16 v[172:175], v[100:103], v[92:95], v[172:175]
    s_waitcnt lgkmcnt(12)
    v_mfma_f32_16x16x32_bf16 v[176:179], v[104:107], v[80:83], v[176:179]
    ds_read_b64_tr_b16 v[124:125], v38 offset:32
    ds_read_b64_tr_b16 v[126:127], v38 offset:3616
    v_mfma_f32_16x16x32_bf16 v[180:183], v[104:107], v[84:87], v[180:183]
    s_add_u32 m0, s47, 3072
    v_mfma_f32_16x16x32_bf16 v[184:187], v[104:107], v[88:91], v[184:187]
    buffer_load_dwordx4 v23, s[20:23], s36 offen lds
    v_mfma_f32_16x16x32_bf16 v[188:191], v[104:107], v[92:95], v[188:191]
    s_waitcnt lgkmcnt(12)
    v_mfma_f32_16x16x32_bf16 v[192:195], v[108:111], v[80:83], v[192:195]
    ds_read_b64_tr_b16 v[96:97], v38 offset:64
    ds_read_b64_tr_b16 v[98:99], v38 offset:3648
    v_mfma_f32_16x16x32_bf16 v[196:199], v[108:111], v[84:87], v[196:199]
    s_add_u32 m0, s47, 4096
    v_mfma_f32_16x16x32_bf16 v[200:203], v[108:111], v[88:91], v[200:203]
    buffer_load_dwordx4 v24, s[20:23], s36 offen lds
    v_mfma_f32_16x16x32_bf16 v[204:207], v[108:111], v[92:95], v[204:207]
    s_waitcnt lgkmcnt(12)
    v_mfma_f32_16x16x32_bf16 v[208:211], v[112:115], v[80:83], v[208:211]
    ds_read_b64_tr_b16 v[100:101], v38 offset:96
    ds_read_b64_tr_b16 v[102:103], v38 offset:3680
    v_mfma_f32_16x16x32_bf16 v[212:215], v[112:115], v[84:87], v[212:215]
    s_add_u32 m0, s47, 5120
    v_mfma_f32_16x16x32_bf16 v[216:219], v[112:115], v[88:91], v[216:219]
    buffer_load_dwordx4 v25, s[20:23], s36 offen lds
    v_mfma_f32_16x16x32_bf16 v[220:223], v[112:115], v[92:95], v[220:223]
    s_waitcnt lgkmcnt(10)
    v_mfma_f32_16x16x32_bf16 v[224:227], v[116:119], v[80:83], v[224:227]
    ds_read_b64_tr_b16 v[104:105], v38 offset:128
    ds_read_b64_tr_b16 v[106:107], v38 offset:3712
    v_mfma_f32_16x16x32_bf16 v[228:231], v[116:119], v[84:87], v[228:231]
    s_add_u32 m0, s47, 6144
    v_mfma_f32_16x16x32_bf16 v[232:235], v[116:119], v[88:91], v[232:235]
    buffer_load_dwordx4 v26, s[20:23], s36 offen lds
    v_mfma_f32_16x16x32_bf16 v[236:239], v[116:119], v[92:95], v[236:239]
    s_waitcnt lgkmcnt(8)
    v_mfma_f32_16x16x32_bf16 v[128:131], v[120:123], v[64:67], v[128:131]
    ds_read_b64_tr_b16 v[108:109], v38 offset:160
    ds_read_b64_tr_b16 v[110:111], v38 offset:3744
    v_mfma_f32_16x16x32_bf16 v[132:135], v[120:123], v[68:71], v[132:135]
    s_add_u32 m0, s48, 0
    s_add_u32 s36, s51, 143360
    v_mfma_f32_16x16x32_bf16 v[136:139], v[120:123], v[72:75], v[136:139]
    ds_read_b128 v[80:83], v19 offset:12288
    buffer_load_dwordx4 v20, s[20:23], s36 offen lds
    v_mfma_f32_16x16x32_bf16 v[140:143], v[120:123], v[76:79], v[140:143]
    ds_read_b128 v[84:87], v19 offset:13312
    s_waitcnt lgkmcnt(10)
    v_mfma_f32_16x16x32_bf16 v[144:147], v[124:127], v[64:67], v[144:147]
    ds_read_b64_tr_b16 v[112:113], v38 offset:192
    ds_read_b64_tr_b16 v[114:115], v38 offset:3776
    v_mfma_f32_16x16x32_bf16 v[148:151], v[124:127], v[68:71], v[148:151]
    s_add_u32 m0, s48, 1024
    v_mfma_f32_16x16x32_bf16 v[152:155], v[124:127], v[72:75], v[152:155]
    ds_read_b128 v[88:91], v19 offset:14336
    buffer_load_dwordx4 v21, s[20:23], s36 offen lds
    v_mfma_f32_16x16x32_bf16 v[156:159], v[124:127], v[76:79], v[156:159]
    ds_read_b128 v[92:95], v19 offset:15360
    s_waitcnt lgkmcnt(12)
    v_mfma_f32_16x16x32_bf16 v[160:163], v[96:99], v[64:67], v[160:163]
    s_waitcnt vmcnt(9)
    ds_read_b64_tr_b16 v[116:117], v39 offset:0
    ds_read_b64_tr_b16 v[118:119], v39 offset:3584
    v_mfma_f32_16x16x32_bf16 v[164:167], v[96:99], v[68:71], v[164:167]
    s_add_u32 m0, s48, 2048
    v_mfma_f32_16x16x32_bf16 v[168:171], v[96:99], v[72:75], v[168:171]
    buffer_load_dwordx4 v22, s[20:23], s36 offen lds
    v_mfma_f32_16x16x32_bf16 v[172:175], v[96:99], v[76:79], v[172:175]
    s_waitcnt lgkmcnt(12)
    v_mfma_f32_16x16x32_bf16 v[176:179], v[100:103], v[64:67], v[176:179]
    ds_read_b64_tr_b16 v[120:121], v39 offset:32
    ds_read_b64_tr_b16 v[122:123], v39 offset:3616
    v_mfma_f32_16x16x32_bf16 v[180:183], v[100:103], v[68:71], v[180:183]
    s_add_u32 m0, s48, 3072
    v_mfma_f32_16x16x32_bf16 v[184:187], v[100:103], v[72:75], v[184:187]
    buffer_load_dwordx4 v23, s[20:23], s36 offen lds
    v_mfma_f32_16x16x32_bf16 v[188:191], v[100:103], v[76:79], v[188:191]
    s_waitcnt lgkmcnt(12)
    v_mfma_f32_16x16x32_bf16 v[192:195], v[104:107], v[64:67], v[192:195]
    ds_read_b64_tr_b16 v[124:125], v39 offset:64
    ds_read_b64_tr_b16 v[126:127], v39 offset:3648
    v_mfma_f32_16x16x32_bf16 v[196:199], v[104:107], v[68:71], v[196:199]
    s_add_u32 m0, s48, 4096
    v_mfma_f32_16x16x32_bf16 v[200:203], v[104:107], v[72:75], v[200:203]
    buffer_load_dwordx4 v24, s[20:23], s36 offen lds
    v_mfma_f32_16x16x32_bf16 v[204:207], v[104:107], v[76:79], v[204:207]
    s_waitcnt lgkmcnt(12)
    v_mfma_f32_16x16x32_bf16 v[208:211], v[108:111], v[64:67], v[208:211]
    ds_read_b64_tr_b16 v[96:97], v39 offset:96
    ds_read_b64_tr_b16 v[98:99], v39 offset:3680
    v_mfma_f32_16x16x32_bf16 v[212:215], v[108:111], v[68:71], v[212:215]
    s_add_u32 m0, s48, 5120
    v_mfma_f32_16x16x32_bf16 v[216:219], v[108:111], v[72:75], v[216:219]
    buffer_load_dwordx4 v25, s[20:23], s36 offen lds
    v_mfma_f32_16x16x32_bf16 v[220:223], v[108:111], v[76:79], v[220:223]
    s_waitcnt lgkmcnt(10)
    v_mfma_f32_16x16x32_bf16 v[224:227], v[112:115], v[64:67], v[224:227]
    ds_read_b64_tr_b16 v[100:101], v39 offset:128
    ds_read_b64_tr_b16 v[102:103], v39 offset:3712
    v_mfma_f32_16x16x32_bf16 v[228:231], v[112:115], v[68:71], v[228:231]
    s_add_u32 m0, s48, 6144
    v_mfma_f32_16x16x32_bf16 v[232:235], v[112:115], v[72:75], v[232:235]
    buffer_load_dwordx4 v26, s[20:23], s36 offen lds
    v_mfma_f32_16x16x32_bf16 v[236:239], v[112:115], v[76:79], v[236:239]
    s_waitcnt lgkmcnt(8)
    v_mfma_f32_16x16x32_bf16 v[128:131], v[116:119], v[80:83], v[128:131]
    ds_read_b64_tr_b16 v[104:105], v39 offset:160
    ds_read_b64_tr_b16 v[106:107], v39 offset:3744
    v_mfma_f32_16x16x32_bf16 v[132:135], v[116:119], v[84:87], v[132:135]
    s_add_u32 m0, s49, 0
    s_add_u32 s36, s51, 172032
    v_mfma_f32_16x16x32_bf16 v[136:139], v[116:119], v[88:91], v[136:139]
    ds_read_b128 v[64:67], v19 offset:16384
    buffer_load_dwordx4 v20, s[20:23], s36 offen lds
    v_mfma_f32_16x16x32_bf16 v[140:143], v[116:119], v[92:95], v[140:143]
    ds_read_b128 v[68:71], v19 offset:17408
    s_waitcnt lgkmcnt(10)
    v_mfma_f32_16x16x32_bf16 v[144:147], v[120:123], v[80:83], v[144:147]
    ds_read_b64_tr_b16 v[108:109], v39 offset:192
    ds_read_b64_tr_b16 v[110:111], v39 offset:3776
    v_mfma_f32_16x16x32_bf16 v[148:151], v[120:123], v[84:87], v[148:151]
    s_add_u32 m0, s49, 1024
    v_mfma_f32_16x16x32_bf16 v[152:155], v[120:123], v[88:91], v[152:155]
    ds_read_b128 v[72:75], v19 offset:18432
    buffer_load_dwordx4 v21, s[20:23], s36 offen lds
    v_mfma_f32_16x16x32_bf16 v[156:159], v[120:123], v[92:95], v[156:159]
    ds_read_b128 v[76:79], v19 offset:19456
    s_waitcnt lgkmcnt(12)
    v_mfma_f32_16x16x32_bf16 v[160:163], v[124:127], v[80:83], v[160:163]
    s_waitcnt vmcnt(9)
    ds_read_b64_tr_b16 v[112:113], v36 offset:0
    ds_read_b64_tr_b16 v[114:115], v36 offset:3584
    v_mfma_f32_16x16x32_bf16 v[164:167], v[124:127], v[84:87], v[164:167]
    s_add_u32 m0, s49, 2048
    v_mfma_f32_16x16x32_bf16 v[168:171], v[124:127], v[88:91], v[168:171]
    buffer_load_dwordx4 v22, s[20:23], s36 offen lds
    v_mfma_f32_16x16x32_bf16 v[172:175], v[124:127], v[92:95], v[172:175]
    s_waitcnt lgkmcnt(12)
    v_mfma_f32_16x16x32_bf16 v[176:179], v[96:99], v[80:83], v[176:179]
    ds_read_b64_tr_b16 v[116:117], v36 offset:32
    ds_read_b64_tr_b16 v[118:119], v36 offset:3616
    v_mfma_f32_16x16x32_bf16 v[180:183], v[96:99], v[84:87], v[180:183]
    s_add_u32 m0, s49, 3072
    v_mfma_f32_16x16x32_bf16 v[184:187], v[96:99], v[88:91], v[184:187]
    buffer_load_dwordx4 v23, s[20:23], s36 offen lds
    v_mfma_f32_16x16x32_bf16 v[188:191], v[96:99], v[92:95], v[188:191]
    s_waitcnt lgkmcnt(12)
    v_mfma_f32_16x16x32_bf16 v[192:195], v[100:103], v[80:83], v[192:195]
    ds_read_b64_tr_b16 v[120:121], v36 offset:64
    ds_read_b64_tr_b16 v[122:123], v36 offset:3648
    v_mfma_f32_16x16x32_bf16 v[196:199], v[100:103], v[84:87], v[196:199]
    s_add_u32 m0, s49, 4096
    v_mfma_f32_16x16x32_bf16 v[200:203], v[100:103], v[88:91], v[200:203]
    buffer_load_dwordx4 v24, s[20:23], s36 offen lds
    v_mfma_f32_16x16x32_bf16 v[204:207], v[100:103], v[92:95], v[204:207]
    s_waitcnt lgkmcnt(12)
    v_mfma_f32_16x16x32_bf16 v[208:211], v[104:107], v[80:83], v[208:211]
    ds_read_b64_tr_b16 v[124:125], v36 offset:96
    ds_read_b64_tr_b16 v[126:127], v36 offset:3680
    v_mfma_f32_16x16x32_bf16 v[212:215], v[104:107], v[84:87], v[212:215]
    s_add_u32 m0, s49, 5120
    v_mfma_f32_16x16x32_bf16 v[216:219], v[104:107], v[88:91], v[216:219]
    buffer_load_dwordx4 v25, s[20:23], s36 offen lds
    v_mfma_f32_16x16x32_bf16 v[220:223], v[104:107], v[92:95], v[220:223]
    s_waitcnt lgkmcnt(10)
    v_mfma_f32_16x16x32_bf16 v[224:227], v[108:111], v[80:83], v[224:227]
    ds_read_b64_tr_b16 v[96:97], v36 offset:128
    ds_read_b64_tr_b16 v[98:99], v36 offset:3712
    v_mfma_f32_16x16x32_bf16 v[228:231], v[108:111], v[84:87], v[228:231]
    s_add_u32 m0, s49, 6144
    v_mfma_f32_16x16x32_bf16 v[232:235], v[108:111], v[88:91], v[232:235]
    buffer_load_dwordx4 v26, s[20:23], s36 offen lds
    v_mfma_f32_16x16x32_bf16 v[236:239], v[108:111], v[92:95], v[236:239]
    s_waitcnt lgkmcnt(8)
    v_mfma_f32_16x16x32_bf16 v[128:131], v[112:115], v[64:67], v[128:131]
    ds_read_b64_tr_b16 v[100:101], v36 offset:160
    ds_read_b64_tr_b16 v[102:103], v36 offset:3744
    v_mfma_f32_16x16x32_bf16 v[132:135], v[112:115], v[68:71], v[132:135]
    v_mfma_f32_16x16x32_bf16 v[136:139], v[112:115], v[72:75], v[136:139]
    ds_read_b128 v[80:83], v19 offset:20480
    v_mfma_f32_16x16x32_bf16 v[140:143], v[112:115], v[76:79], v[140:143]
    ds_read_b128 v[84:87], v19 offset:21504
    s_waitcnt lgkmcnt(10)
    v_mfma_f32_16x16x32_bf16 v[144:147], v[116:119], v[64:67], v[144:147]
    ds_read_b64_tr_b16 v[104:105], v36 offset:192
    ds_read_b64_tr_b16 v[106:107], v36 offset:3776
    v_mfma_f32_16x16x32_bf16 v[148:151], v[116:119], v[68:71], v[148:151]
    v_mfma_f32_16x16x32_bf16 v[152:155], v[116:119], v[72:75], v[152:155]
    ds_read_b128 v[88:91], v19 offset:22528
    v_mfma_f32_16x16x32_bf16 v[156:159], v[116:119], v[76:79], v[156:159]
    ds_read_b128 v[92:95], v19 offset:23552
    s_waitcnt lgkmcnt(12)
    v_mfma_f32_16x16x32_bf16 v[160:163], v[120:123], v[64:67], v[160:163]
    s_waitcnt vmcnt(7)
    ds_read_b64_tr_b16 v[108:109], v37 offset:0
    ds_read_b64_tr_b16 v[110:111], v37 offset:3584
    v_mfma_f32_16x16x32_bf16 v[164:167], v[120:123], v[68:71], v[164:167]
    v_mfma_f32_16x16x32_bf16 v[168:171], v[120:123], v[72:75], v[168:171]
    v_mfma_f32_16x16x32_bf16 v[172:175], v[120:123], v[76:79], v[172:175]
    s_waitcnt lgkmcnt(12)
    v_mfma_f32_16x16x32_bf16 v[176:179], v[124:127], v[64:67], v[176:179]
    ds_read_b64_tr_b16 v[112:113], v37 offset:32
    ds_read_b64_tr_b16 v[114:115], v37 offset:3616
    v_mfma_f32_16x16x32_bf16 v[180:183], v[124:127], v[68:71], v[180:183]
    v_mfma_f32_16x16x32_bf16 v[184:187], v[124:127], v[72:75], v[184:187]
    v_mfma_f32_16x16x32_bf16 v[188:191], v[124:127], v[76:79], v[188:191]
    s_waitcnt lgkmcnt(12)
    v_mfma_f32_16x16x32_bf16 v[192:195], v[96:99], v[64:67], v[192:195]
    ds_read_b64_tr_b16 v[116:117], v37 offset:64
    ds_read_b64_tr_b16 v[118:119], v37 offset:3648
    v_mfma_f32_16x16x32_bf16 v[196:199], v[96:99], v[68:71], v[196:199]
    v_mfma_f32_16x16x32_bf16 v[200:203], v[96:99], v[72:75], v[200:203]
    v_mfma_f32_16x16x32_bf16 v[204:207], v[96:99], v[76:79], v[204:207]
    s_waitcnt lgkmcnt(12)
    v_mfma_f32_16x16x32_bf16 v[208:211], v[100:103], v[64:67], v[208:211]
    ds_read_b64_tr_b16 v[120:121], v37 offset:96
    ds_read_b64_tr_b16 v[122:123], v37 offset:3680
    v_mfma_f32_16x16x32_bf16 v[212:215], v[100:103], v[68:71], v[212:215]
    v_mfma_f32_16x16x32_bf16 v[216:219], v[100:103], v[72:75], v[216:219]
    v_mfma_f32_16x16x32_bf16 v[220:223], v[100:103], v[76:79], v[220:223]
    s_waitcnt lgkmcnt(10)
    v_mfma_f32_16x16x32_bf16 v[224:227], v[104:107], v[64:67], v[224:227]
    ds_read_b64_tr_b16 v[124:125], v37 offset:128
    ds_read_b64_tr_b16 v[126:127], v37 offset:3712
    v_mfma_f32_16x16x32_bf16 v[228:231], v[104:107], v[68:71], v[228:231]
    v_mfma_f32_16x16x32_bf16 v[232:235], v[104:107], v[72:75], v[232:235]
    v_mfma_f32_16x16x32_bf16 v[236:239], v[104:107], v[76:79], v[236:239]
    s_waitcnt lgkmcnt(8)
    v_mfma_f32_16x16x32_bf16 v[128:131], v[108:111], v[80:83], v[128:131]
    ds_read_b64_tr_b16 v[96:97], v37 offset:160
    ds_read_b64_tr_b16 v[98:99], v37 offset:3744
    v_mfma_f32_16x16x32_bf16 v[132:135], v[108:111], v[84:87], v[132:135]
    v_mfma_f32_16x16x32_bf16 v[136:139], v[108:111], v[88:91], v[136:139]
    ds_read_b128 v[64:67], v19 offset:24576
    v_mfma_f32_16x16x32_bf16 v[140:143], v[108:111], v[92:95], v[140:143]
    ds_read_b128 v[68:71], v19 offset:25600
    s_waitcnt lgkmcnt(10)
    v_mfma_f32_16x16x32_bf16 v[144:147], v[112:115], v[80:83], v[144:147]
    ds_read_b64_tr_b16 v[100:101], v37 offset:192
    ds_read_b64_tr_b16 v[102:103], v37 offset:3776
    v_mfma_f32_16x16x32_bf16 v[148:151], v[112:115], v[84:87], v[148:151]
    v_mfma_f32_16x16x32_bf16 v[152:155], v[112:115], v[88:91], v[152:155]
    ds_read_b128 v[72:75], v19 offset:26624
    v_mfma_f32_16x16x32_bf16 v[156:159], v[112:115], v[92:95], v[156:159]
    ds_read_b128 v[76:79], v19 offset:27648
    s_waitcnt lgkmcnt(12)
    v_mfma_f32_16x16x32_bf16 v[160:163], v[116:119], v[80:83], v[160:163]
    s_waitcnt vmcnt(0)
    ds_read_b64_tr_b16 v[104:105], v38 offset:0
    ds_read_b64_tr_b16 v[106:107], v38 offset:3584
    v_mfma_f32_16x16x32_bf16 v[164:167], v[116:119], v[84:87], v[164:167]
    v_mfma_f32_16x16x32_bf16 v[168:171], v[116:119], v[88:91], v[168:171]
    v_mfma_f32_16x16x32_bf16 v[172:175], v[116:119], v[92:95], v[172:175]
    s_waitcnt lgkmcnt(12)
    v_mfma_f32_16x16x32_bf16 v[176:179], v[120:123], v[80:83], v[176:179]
    ds_read_b64_tr_b16 v[108:109], v38 offset:32
    ds_read_b64_tr_b16 v[110:111], v38 offset:3616
    v_mfma_f32_16x16x32_bf16 v[180:183], v[120:123], v[84:87], v[180:183]
    v_mfma_f32_16x16x32_bf16 v[184:187], v[120:123], v[88:91], v[184:187]
    v_mfma_f32_16x16x32_bf16 v[188:191], v[120:123], v[92:95], v[188:191]
    s_waitcnt lgkmcnt(12)
    v_mfma_f32_16x16x32_bf16 v[192:195], v[124:127], v[80:83], v[192:195]
    ds_read_b64_tr_b16 v[112:113], v38 offset:64
    ds_read_b64_tr_b16 v[114:115], v38 offset:3648
    v_mfma_f32_16x16x32_bf16 v[196:199], v[124:127], v[84:87], v[196:199]
    v_mfma_f32_16x16x32_bf16 v[200:203], v[124:127], v[88:91], v[200:203]
    v_mfma_f32_16x16x32_bf16 v[204:207], v[124:127], v[92:95], v[204:207]
    s_waitcnt lgkmcnt(12)
    v_mfma_f32_16x16x32_bf16 v[208:211], v[96:99], v[80:83], v[208:211]
    ds_read_b64_tr_b16 v[116:117], v38 offset:96
    ds_read_b64_tr_b16 v[118:119], v38 offset:3680
    v_mfma_f32_16x16x32_bf16 v[212:215], v[96:99], v[84:87], v[212:215]
    v_mfma_f32_16x16x32_bf16 v[216:219], v[96:99], v[88:91], v[216:219]
    v_mfma_f32_16x16x32_bf16 v[220:223], v[96:99], v[92:95], v[220:223]
    s_waitcnt lgkmcnt(10)
    v_mfma_f32_16x16x32_bf16 v[224:227], v[100:103], v[80:83], v[224:227]
    ds_read_b64_tr_b16 v[120:121], v38 offset:128
    ds_read_b64_tr_b16 v[122:123], v38 offset:3712
    s_add_u32 s37, s46, 0
    v_mfma_f32_16x16x32_bf16 v[228:231], v[100:103], v[84:87], v[228:231]
    s_add_u32 s38, s46, 114688
    s_add_u32 s39, s46, 229376
    s_add_u32 s54, s46, 344064
    v_mfma_f32_16x16x32_bf16 v[232:235], v[100:103], v[88:91], v[232:235]
    v_mfma_f32_16x16x32_bf16 v[236:239], v[100:103], v[92:95], v[236:239]
    s_waitcnt lgkmcnt(8)
    v_mfma_f32_16x16x32_bf16 v[128:131], v[104:107], v[64:67], v[128:131]
    ds_read_b64_tr_b16 v[124:125], v38 offset:160
    ds_read_b64_tr_b16 v[126:127], v38 offset:3744
    v_mfma_f32_16x16x32_bf16 v[132:135], v[104:107], v[68:71], v[132:135]
    v_mfma_f32_16x16x32_bf16 v[136:139], v[104:107], v[72:75], v[136:139]
    v_mfma_f32_16x16x32_bf16 v[140:143], v[104:107], v[76:79], v[140:143]
    s_waitcnt lgkmcnt(8)
    v_mfma_f32_16x16x32_bf16 v[144:147], v[108:111], v[64:67], v[144:147]
    ds_read_b64_tr_b16 v[96:97], v38 offset:192
    ds_read_b64_tr_b16 v[98:99], v38 offset:3776
    v_mfma_f32_16x16x32_bf16 v[148:151], v[108:111], v[68:71], v[148:151]
    v_mfma_f32_16x16x32_bf16 v[152:155], v[108:111], v[72:75], v[152:155]
    v_mfma_f32_16x16x32_bf16 v[156:159], v[108:111], v[76:79], v[156:159]
    s_waitcnt lgkmcnt(8)
    v_mfma_f32_16x16x32_bf16 v[160:163], v[112:115], v[64:67], v[160:163]
    v_mfma_f32_16x16x32_bf16 v[164:167], v[112:115], v[68:71], v[164:167]
    v_cvt_pk_bf16_f32 v128, v128, v129
    v_cvt_pk_bf16_f32 v129, v130, v131
    v_cvt_pk_bf16_f32 v130, v144, v145
    v_mfma_f32_16x16x32_bf16 v[168:171], v[112:115], v[72:75], v[168:171]
    v_cvt_pk_bf16_f32 v131, v146, v147
    buffer_store_dwordx4 v[128:131], v28, s[76:79], s37 offen offset:0 sc0 sc1
    v_cvt_pk_bf16_f32 v132, v132, v133
    v_mfma_f32_16x16x32_bf16 v[172:175], v[112:115], v[76:79], v[172:175]
    v_cvt_pk_bf16_f32 v133, v134, v135
    v_cvt_pk_bf16_f32 v134, v148, v149
    v_cvt_pk_bf16_f32 v135, v150, v151
    s_waitcnt lgkmcnt(6)
    v_mfma_f32_16x16x32_bf16 v[176:179], v[116:119], v[64:67], v[176:179]
    buffer_store_dwordx4 v[132:135], v28, s[76:79], s38 offen offset:0 sc0 sc1
    v_cvt_pk_bf16_f32 v136, v136, v137
    v_cvt_pk_bf16_f32 v137, v138, v139
    v_mfma_f32_16x16x32_bf16 v[180:183], v[116:119], v[68:71], v[180:183]
    v_cvt_pk_bf16_f32 v138, v152, v153
    v_cvt_pk_bf16_f32 v139, v154, v155
    buffer_store_dwordx4 v[136:139], v28, s[76:79], s39 offen offset:0 sc0 sc1
    v_mfma_f32_16x16x32_bf16 v[184:187], v[116:119], v[72:75], v[184:187]
    v_cvt_pk_bf16_f32 v140, v140, v141
    v_cvt_pk_bf16_f32 v141, v142, v143
    v_cvt_pk_bf16_f32 v142, v156, v157
    v_mfma_f32_16x16x32_bf16 v[188:191], v[116:119], v[76:79], v[188:191]
    v_cvt_pk_bf16_f32 v143, v158, v159
    buffer_store_dwordx4 v[140:143], v28, s[76:79], s54 offen offset:0 sc0 sc1
    s_waitcnt lgkmcnt(4)
    v_mfma_f32_16x16x32_bf16 v[192:195], v[120:123], v[64:67], v[192:195]
    v_mfma_f32_16x16x32_bf16 v[196:199], v[120:123], v[68:71], v[196:199]
    v_cvt_pk_bf16_f32 v160, v160, v161
    v_cvt_pk_bf16_f32 v161, v162, v163
    v_cvt_pk_bf16_f32 v162, v176, v177
    v_mfma_f32_16x16x32_bf16 v[200:203], v[120:123], v[72:75], v[200:203]
    v_cvt_pk_bf16_f32 v163, v178, v179
    buffer_store_dwordx4 v[160:163], v28, s[76:79], s37 offen offset:512 sc0 sc1
    v_cvt_pk_bf16_f32 v164, v164, v165
    v_mfma_f32_16x16x32_bf16 v[204:207], v[120:123], v[76:79], v[204:207]
    v_cvt_pk_bf16_f32 v165, v166, v167
    v_cvt_pk_bf16_f32 v166, v180, v181
    v_cvt_pk_bf16_f32 v167, v182, v183
    s_waitcnt lgkmcnt(2)
    v_mfma_f32_16x16x32_bf16 v[208:211], v[124:127], v[64:67], v[208:211]
    buffer_store_dwordx4 v[164:167], v28, s[76:79], s38 offen offset:512 sc0 sc1
    v_cvt_pk_bf16_f32 v168, v168, v169
    v_cvt_pk_bf16_f32 v169, v170, v171
    v_mfma_f32_16x16x32_bf16 v[212:215], v[124:127], v[68:71], v[212:215]
    v_cvt_pk_bf16_f32 v170, v184, v185
    v_cvt_pk_bf16_f32 v171, v186, v187
    buffer_store_dwordx4 v[168:171], v28, s[76:79], s39 offen offset:512 sc0 sc1
    v_mfma_f32_16x16x32_bf16 v[216:219], v[124:127], v[72:75], v[216:219]
    v_cvt_pk_bf16_f32 v172, v172, v173
    v_cvt_pk_bf16_f32 v173, v174, v175
    v_cvt_pk_bf16_f32 v174, v188, v189
    v_mfma_f32_16x16x32_bf16 v[220:223], v[124:127], v[76:79], v[220:223]
    v_cvt_pk_bf16_f32 v175, v190, v191
    buffer_store_dwordx4 v[172:175], v28, s[76:79], s54 offen offset:512 sc0 sc1
    s_waitcnt lgkmcnt(0)
    v_mfma_f32_16x16x32_bf16 v[224:227], v[96:99], v[64:67], v[224:227]
    v_mfma_f32_16x16x32_bf16 v[228:231], v[96:99], v[68:71], v[228:231]
    v_mfma_f32_16x16x32_bf16 v[232:235], v[96:99], v[72:75], v[232:235]
    v_mfma_f32_16x16x32_bf16 v[236:239], v[96:99], v[76:79], v[236:239]
    v_cvt_pk_bf16_f32 v192, v192, v193
    v_cvt_pk_bf16_f32 v193, v194, v195
    v_cvt_pk_bf16_f32 v194, v208, v209
    v_cvt_pk_bf16_f32 v195, v210, v211
    buffer_store_dwordx4 v[192:195], v28, s[76:79], s37 offen offset:1024 sc0 sc1
    v_cvt_pk_bf16_f32 v196, v196, v197
    v_cvt_pk_bf16_f32 v197, v198, v199
    v_cvt_pk_bf16_f32 v198, v212, v213
    v_cvt_pk_bf16_f32 v199, v214, v215
    buffer_store_dwordx4 v[196:199], v28, s[76:79], s38 offen offset:1024 sc0 sc1
    v_cvt_pk_bf16_f32 v200, v200, v201
    v_cvt_pk_bf16_f32 v201, v202, v203
    v_cvt_pk_bf16_f32 v202, v216, v217
    v_cvt_pk_bf16_f32 v203, v218, v219
    buffer_store_dwordx4 v[200:203], v28, s[76:79], s39 offen offset:1024 sc0 sc1
    v_cvt_pk_bf16_f32 v204, v204, v205
    v_cvt_pk_bf16_f32 v205, v206, v207
    v_cvt_pk_bf16_f32 v206, v220, v221
    v_cvt_pk_bf16_f32 v207, v222, v223
    buffer_store_dwordx4 v[204:207], v28, s[76:79], s54 offen offset:1024 sc0 sc1
    v_cvt_pk_bf16_f32 v224, v224, v225
    v_cvt_pk_bf16_f32 v225, v226, v227
    buffer_store_dwordx2 v[224:225], v29, s[76:79], s37 offen sc0 sc1
    v_cvt_pk_bf16_f32 v228, v228, v229
    v_cvt_pk_bf16_f32 v229, v230, v231
    buffer_store_dwordx2 v[228:229], v29, s[76:79], s38 offen sc0 sc1
    v_cvt_pk_bf16_f32 v232, v232, v233
    v_cvt_pk_bf16_f32 v233, v234, v235
    buffer_store_dwordx2 v[232:233], v29, s[76:79], s39 offen sc0 sc1
    v_cvt_pk_bf16_f32 v236, v236, v237
    v_cvt_pk_bf16_f32 v237, v238, v239
    buffer_store_dwordx2 v[236:237], v29, s[76:79], s54 offen sc0 sc1
    s_mov_b32 s24, s64
    s_mov_b32 s25, s65
    s_mov_b32 s26, 896
    s_mov_b32 s27, 0x00020000
    s_mov_b32 s12, s62
    s_mov_b32 s13, s63
    s_mov_b32 s14, 1835008
    s_mov_b32 s15, 0x00020000
    s_lshl_b32 s36, s4, 9
    s_lshl_b32 s37, s5, 7
    s_add_u32 s36, s36, s37
    s_add_u32 s36, s36, 32768
    buffer_load_dword v56, v9, s[72:75], s36 offen sc0 sc1
    s_mul_i32 s39, s5, 224
    v_lshlrev_b32 v57, 3, v3
    v_lshl_add_u32 v57, v4, 7, v57
    buffer_load_dwordx2 v[16:17], v57, s[24:27], s39 offen offset:0
    buffer_load_dwordx2 v[18:19], v57, s[24:27], s39 offen offset:32
    buffer_load_dwordx2 v[20:21], v57, s[24:27], s39 offen offset:64
    buffer_load_dwordx2 v[22:23], v57, s[24:27], s39 offen offset:96
    s_mul_i32 s38, s5, 448
    s_add_u32 s38, s38, 8960
    buffer_load_dwordx4 v[24:27], v8, s[16:19], s38 offen offset:0 sc0 sc1
    buffer_load_dwordx4 v[28:31], v8, s[16:19], s38 offen offset:64 sc0 sc1
    buffer_load_dwordx4 v[32:35], v8, s[16:19], s38 offen offset:128 sc0 sc1
    buffer_load_dwordx4 v[36:39], v8, s[16:19], s38 offen offset:192 sc0 sc1
    s_lshl_b32 s38, s3, 2
    s_add_u32 s38, s38, s36
    s_lshl_b32 s40, 1, s3
    s_mov_b32 s54, 0
    s_mov_b32 s37, 65536
    v_mov_b32 v14, 0
    v_mov_b32 v15, s60
    v_mov_b32 v58, 0x00003f80
    v_mov_b32 v59, 0x3f800000
    s_waitcnt vmcnt(9)
    s_mov_b64 exec, 1
    buffer_store_dword v15, v14, s[72:75], s38 offen sc0 sc1
    s_mov_b64 exec, -1
    s_waitcnt vmcnt(9)
    s_branch L_poll2_in
L_poll2_l:
    s_sleep 1
    buffer_load_dword v56, v9, s[72:75], s36 offen sc0 sc1
    s_waitcnt vmcnt(0)
L_poll2_in:
    v_cmp_eq_u32 vcc, s60, v56
    s_sub_u32 s37, s37, 1
    s_cmp_eq_u32 s37, 0
    s_cselect_b32 s45, -1, vcc_lo
    s_or_b32 s45, s45, s40
    s_andn2_b32 s45, s45, s54
    s_bitcmp0_b32 s45, 0
    s_cbranch_scc1 L_pr2_0
    s_add_u32 s38, s53, 0
    buffer_load_dwordx4 v[64:67], v5, s[76:79], s38 offen sc0 sc1
    buffer_load_dwordx4 v[68:71], v6, s[76:79], s38 offen sc0 sc1
L_pr2_0:
    s_bitcmp0_b32 s45, 1
    s_cbranch_scc1 L_pr2_1
    s_add_u32 s38, s53, 7168
    buffer_load_dwordx4 v[72:75], v5, s[76:79], s38 offen sc0 sc1
    buffer_load_dwordx4 v[76:79], v6, s[76:79], s38 offen sc0 sc1
L_pr2_1:
    s_bitcmp0_b32 s45, 2
    s_cbranch_scc1 L_pr2_2
    s_add_u32 s38, s53, 14336
    buffer_load_dwordx4 v[80:83], v5, s[76:79], s38 offen sc0 sc1
    buffer_load_dwordx4 v[84:87], v6, s[76:79], s38 offen sc0 sc1
L_pr2_2:
    s_bitcmp0_b32 s45, 3
    s_cbranch_scc1 L_pr2_3
    s_add_u32 s38, s53, 21504
    buffer_load_dwordx4 v[88:91], v5, s[76:79], s38 offen sc0 sc1
    buffer_load_dwordx4 v[92:95], v6, s[76:79], s38 offen sc0 sc1
L_pr2_3:
    s_bitcmp0_b32 s45, 4
    s_cbranch_scc1 L_pr2_4
    s_add_u32 s38, s53, 28672
    buffer_load_dwordx4 v[96:99], v5, s[76:79], s38 offen sc0 sc1
    buffer_load_dwordx4 v[100:103], v6, s[76:79], s38 offen sc0 sc1
L_pr2_4:
    s_bitcmp0_b32 s45, 5
    s_cbranch_scc1 L_pr2_5
    s_add_u32 s38, s53, 35840
    buffer_load_dwordx4 v[104:107], v5, s[76:79], s38 offen sc0 sc1
    buffer_load_dwordx4 v[108:111], v6, s[76:79], s38 offen sc0 sc1
L_pr2_5:
    s_bitcmp0_b32 s45, 6
    s_cbranch_scc1 L_pr2_6
    s_add_u32 s38, s53, 43008
    buffer_load_dwordx4 v[112:115], v5, s[76:79], s38 offen sc0 sc1
    buffer_load_dwordx4 v[116:119], v6, s[76:79], s38 offen sc0 sc1
L_pr2_6:
    s_bitcmp0_b32 s45, 7
    s_cbranch_scc1 L_pr2_7
    s_add_u32 s38, s53, 50176
    buffer_load_dwordx4 v[120:123], v5, s[76:79], s38 offen sc0 sc1
    buffer_load_dwordx4 v[124:127], v6, s[76:79], s38 offen sc0 sc1
L_pr2_7:
    s_or_b32 s54, s54, s45
    s_and_b32 s54, s54, 0xff
    s_cmp_lg_u32 s54, 0xff
    s_cbranch_scc1 L_poll2_l
    s_waitcnt vmcnt(0)
    v_lshlrev_b32 v40, 16, v64
    v_and_b32 v41, 0xffff0000, v64
    v_lshlrev_b32_e64 v42, 16, v65
    v_and_b32 v43, 0xffff0000, v65
    v_lshlrev_b32_e64 v44, 16, v66
    v_and_b32 v45, 0xffff0000, v66
    v_lshlrev_b32_e64 v46, 16, v67
    v_and_b32 v47, 0xffff0000, v67
    v_lshlrev_b32_e64 v48, 16, v68
    v_and_b32 v49, 0xffff0000, v68
    v_lshlrev_b32_e64 v50, 16, v69
    v_and_b32 v51, 0xffff0000, v69
    v_lshlrev_b32_e64 v52, 16, v70
    v_and_b32 v53, 0xffff0000, v70
    v_lshlrev_b32_e64 v54, 16, v71
    v_and_b32 v55, 0xffff0000, v71
    v_dot2c_f32_bf16 v40, v72, v58
    v_dot2c_f32_bf16 v41, v72, v59
    v_dot2c_f32_bf16 v42, v73, v58
    v_dot2c_f32_bf16 v43, v73, v59
    v_dot2c_f32_bf16 v44, v74, v58
    v_dot2c_f32_bf16 v45, v74, v59
    v_dot2c_f32_bf16 v46, v75, v58
    v_dot2c_f32_bf16 v47, v75, v59
    v_dot2c_f32_bf16 v48, v76, v58
    v_dot2c_f32_bf16 v49, v76, v59
    v_dot2c_f32_bf16 v50, v77, v58
    v_dot2c_f32_bf16 v51, v77, v59
    v_dot2c_f32_bf16 v52, v78, v58
    v_dot2c_f32_bf16 v53, v78, v59
    v_dot2c_f32_bf16 v54, v79, v58
    v_dot2c_f32_bf16 v55, v79, v59
    v_dot2c_f32_bf16 v40, v80, v58
    v_dot2c_f32_bf16 v41, v80, v59
    v_dot2c_f32_bf16 v42, v81, v58
    v_dot2c_f32_bf16 v43, v81, v59
    v_dot2c_f32_bf16 v44, v82, v58
    v_dot2c_f32_bf16 v45, v82, v59
    v_dot2c_f32_bf16 v46, v83, v58
    v_dot2c_f32_bf16 v47, v83, v59
    v_dot2c_f32_bf16 v48, v84, v58
    v_dot2c_f32_bf16 v49, v84, v59
    v_dot2c_f32_bf16 v50, v85, v58
    v_dot2c_f32_bf16 v51, v85, v59
    v_dot2c_f32_bf16 v52, v86, v58
    v_dot2c_f32_bf16 v53, v86, v59
    v_dot2c_f32_bf16 v54, v87, v58
    v_dot2c_f32_bf16 v55, v87, v59
    v_dot2c_f32_bf16 v40, v88, v58
    v_dot2c_f32_bf16 v41, v88, v59
    v_dot2c_f32_bf16 v42, v89, v58
    v_dot2c_f32_bf16 v43, v89, v59
    v_dot2c_f32_bf16 v44, v90, v58
    v_dot2c_f32_bf16 v45, v90, v59
    v_dot2c_f32_bf16 v46, v91, v58
    v_dot2c_f32_bf16 v47, v91, v59
    v_dot2c_f32_bf16 v48, v92, v58
    v_dot2c_f32_bf16 v49, v92, v59
    v_dot2c_f32_bf16 v50, v93, v58
    v_dot2c_f32_bf16 v51, v93, v59
    v_dot2c_f32_bf16 v52, v94, v58
    v_dot2c_f32_bf16 v53, v94, v59
    v_dot2c_f32_bf16 v54, v95, v58
    v_dot2c_f32_bf16 v55, v95, v59
    v_dot2c_f32_bf16 v40, v96, v58
    v_dot2c_f32_bf16 v41, v96, v59
    v_dot2c_f32_bf16 v42, v97, v58
    v_dot2c_f32_bf16 v43, v97, v59
    v_dot2c_f32_bf16 v44, v98, v58
    v_dot2c_f32_bf16 v45, v98, v59
    v_dot2c_f32_bf16 v46, v99, v58
    v_dot2c_f32_bf16 v47, v99, v59
    v_dot2c_f32_bf16 v48, v100, v58
    v_dot2c_f32_bf16 v49, v100, v59
    v_dot2c_f32_bf16 v50, v101, v58
    v_dot2c_f32_bf16 v51, v101, v59
    v_dot2c_f32_bf16 v52, v102, v58
    v_dot2c_f32_bf16 v53, v102, v59
    v_dot2c_f32_bf16 v54, v103, v58
    v_dot2c_f32_bf16 v55, v103, v59
    v_dot2c_f32_bf16 v40, v104, v58
    v_dot2c_f32_bf16 v41, v104, v59
    v_dot2c_f32_bf16 v42, v105, v58
    v_dot2c_f32_bf16 v43, v105, v59
    v_dot2c_f32_bf16 v44, v106, v58
    v_dot2c_f32_bf16 v45, v106, v59
    v_dot2c_f32_bf16 v46, v107, v58
    v_dot2c_f32_bf16 v47, v107, v59
    v_dot2c_f32_bf16 v48, v108, v58
    v_dot2c_f32_bf16 v49, v108, v59
    v_dot2c_f32_bf16 v50, v109, v58
    v_dot2c_f32_bf16 v51, v109, v59
    v_dot2c_f32_bf16 v52, v110, v58
    v_dot2c_f32_bf16 v53, v110, v59
    v_dot2c_f32_bf16 v54, v111, v58
    v_dot2c_f32_bf16 v55, v111, v59
    v_dot2c_f32_bf16 v40, v112, v58
    v_dot2c_f32_bf16 v41, v112, v59
    v_dot2c_f32_bf16 v42, v113, v58
    v_dot2c_f32_bf16 v43, v113, v59
    v_dot2c_f32_bf16 v44, v114, v58
    v_dot2c_f32_bf16 v45, v114, v59
    v_dot2c_f32_bf16 v46, v115, v58
    v_dot2c_f32_bf16 v47, v115, v59
    v_dot2c_f32_bf16 v48, v116, v58
    v_dot2c_f32_bf16 v49, v116, v59
    v_dot2c_f32_bf16 v50, v117, v58
    v_dot2c_f32_bf16 v51, v117, v59
    v_dot2c_f32_bf16 v52, v118, v58
    v_dot2c_f32_bf16 v53, v118, v59
    v_dot2c_f32_bf16 v54, v119, v58
    v_dot2c_f32_bf16 v55, v119, v59
    v_dot2c_f32_bf16 v40, v120, v58
    v_dot2c_f32_bf16 v41, v120, v59
    v_dot2c_f32_bf16 v42, v121, v58
    v_dot2c_f32_bf16 v43, v121, v59
    v_dot2c_f32_bf16 v44, v122, v58
    v_dot2c_f32_bf16 v45, v122, v59
    v_dot2c_f32_bf16 v46, v123, v58
    v_dot2c_f32_bf16 v47, v123, v59
    v_dot2c_f32_bf16 v48, v124, v58
    v_dot2c_f32_bf16 v49, v124, v59
    v_dot2c_f32_bf16 v50, v125, v58
    v_dot2c_f32_bf16 v51, v125, v59
    v_dot2c_f32_bf16 v52, v126, v58
    v_dot2c_f32_bf16 v53, v126, v59
    v_dot2c_f32_bf16 v54, v127, v58
    v_dot2c_f32_bf16 v55, v127, v59
    s_nop 2
    v_lshlrev_b32 v14, 16, v16
    v_and_b32 v15, 0xffff0000, v16
    v_pk_add_f32 v[40:41], v[40:41], v[14:15]
    v_pk_fma_f32 v[40:41], v[40:41], v[24:25], v[240:241]
    v_cvt_pk_bf16_f32 v64, v40, v41
    v_lshlrev_b32_e64 v14, 16, v17
    v_and_b32 v15, 0xffff0000, v17
    v_pk_add_f32 v[42:43], v[42:43], v[14:15]
    v_pk_fma_f32 v[42:43], v[42:43], v[26:27], v[242:243]
    v_cvt_pk_bf16_f32 v65, v42, v43
    v_lshlrev_b32_e64 v14, 16, v18
    v_and_b32 v15, 0xffff0000, v18
    v_pk_add_f32 v[44:45], v[44:45], v[14:15]
    v_pk_fma_f32 v[44:45], v[44:45], v[28:29], v[244:245]
    v_cvt_pk_bf16_f32 v66, v44, v45
    v_lshlrev_b32_e64 v14, 16, v19
    v_and_b32 v15, 0xffff0000, v19
    v_pk_add_f32 v[46:47], v[46:47], v[14:15]
    v_pk_fma_f32 v[46:47], v[46:47], v[30:31], v[246:247]
    v_cvt_pk_bf16_f32 v67, v46, v47
    v_lshlrev_b32_e64 v14, 16, v20
    v_and_b32 v15, 0xffff0000, v20
    v_pk_add_f32 v[48:49], v[48:49], v[14:15]
    v_pk_fma_f32 v[48:49], v[48:49], v[32:33], v[248:249]
    v_cvt_pk_bf16_f32 v68, v48, v49
    v_lshlrev_b32_e64 v14, 16, v21
    v_and_b32 v15, 0xffff0000, v21
    v_pk_add_f32 v[50:51], v[50:51], v[14:15]
    v_pk_fma_f32 v[50:51], v[50:51], v[34:35], v[250:251]
    v_cvt_pk_bf16_f32 v69, v50, v51
    v_lshlrev_b32_e64 v14, 16, v22
    v_and_b32 v15, 0xffff0000, v22
    v_pk_add_f32 v[52:53], v[52:53], v[14:15]
    v_pk_fma_f32 v[52:53], v[52:53], v[36:37], v[252:253]
    v_cvt_pk_bf16_f32 v70, v52, v53
    v_lshlrev_b32_e64 v14, 16, v23
    v_and_b32 v15, 0xffff0000, v23
    v_pk_add_f32 v[54:55], v[54:55], v[14:15]
    v_pk_fma_f32 v[54:55], v[54:55], v[38:39], v[254:255]
    v_cvt_pk_bf16_f32 v71, v54, v55
    s_mul_i32 s38, s52, 7168
    s_add_u32 s38, s38, s39
    buffer_store_dwordx2 v[64:65], v7, s[12:15], s38 offen offset:0
    buffer_store_dwordx2 v[66:67], v7, s[12:15], s38 offen offset:32
    buffer_store_dwordx2 v[68:69], v7, s[12:15], s38 offen offset:64
    s_mov_b32 exec_hi, 0
    buffer_store_dwordx2 v[70:71], v7, s[12:15], s38 offen offset:96
L_k2_end:
    s_endpgm
L_rare_f:
    s_mov_b32 s54, 0
    s_branch L_renorm_1
L_rare_g:
    s_mov_b32 s54, 1
    s_branch L_renorm_0
L_rare_a:
    s_mov_b32 s54, 2
    s_branch L_renorm_1
L_rare_b:
    s_mov_b32 s54, 3
    s_branch L_renorm_0
L_rare_c:
    s_mov_b32 s54, 4
    s_branch L_renorm_1
L_rare_d:
    s_mov_b32 s54, 5
    s_branch L_renorm_0
L_rare_e:
    s_mov_b32 s54, 6
    s_branch L_renorm_1
L_renorm_0:
    s_nop 15
    v_max3_f32 v120, v16, v17, v18
    v_max3_f32 v120, v120, v19, v32
    v_max3_f32 v120, v120, v33, v34
    v_max_f32 v120, v120, v35
    v_mov_b32 v121, v120
    s_nop 1
    v_permlane16_swap_b32 v120, v121
    v_max_f32 v120, v120, v121
    v_mov_b32 v121, v120
    s_nop 1
    v_permlane32_swap_b32 v120, v121
    v_max_f32 v120, v120, v121
    v_max_f32 v120, 0, v120
    v_sub_f32 v80, v80, v120
    v_sub_f32 v81, v81, v120
    v_sub_f32 v82, v82, v120
    v_sub_f32 v83, v83, v120
    v_sub_f32 v121, 0, v120
    v_exp_f32 v121, v121
    s_nop 0
    v_mul_f32 v8, v8, v121
    v_accvgpr_read_b32 v122, a0
    v_accvgpr_read_b32 v123, a1
    v_accvgpr_read_b32 v124, a2
    v_accvgpr_read_b32 v125, a3
    v_mul_f32 v122, v122, v121
    v_mul_f32 v123, v123, v121
    v_mul_f32 v124, v124, v121
    v_mul_f32 v125, v125, v121
    v_accvgpr_write_b32 a0, v122
    v_accvgpr_write_b32 a1, v123
    v_accvgpr_write_b32 a2, v124
    v_accvgpr_write_b32 a3, v125
    v_accvgpr_read_b32 v122, a16
    v_accvgpr_read_b32 v123, a17
    v_accvgpr_read_b32 v124, a18
    v_accvgpr_read_b32 v125, a19
    v_mul_f32 v122, v122, v121
    v_mul_f32 v123, v123, v121
    v_mul_f32 v124, v124, v121
    v_mul_f32 v125, v125, v121
    v_accvgpr_write_b32 a16, v122
    v_accvgpr_write_b32 a17, v123
    v_accvgpr_write_b32 a18, v124
    v_accvgpr_write_b32 a19, v125
    v_accvgpr_read_b32 v122, a32
    v_accvgpr_read_b32 v123, a33
    v_accvgpr_read_b32 v124, a34
    v_accvgpr_read_b32 v125, a35
    v_mul_f32 v122, v122, v121
    v_mul_f32 v123, v123, v121
    v_mul_f32 v124, v124, v121
    v_mul_f32 v125, v125, v121
    v_accvgpr_write_b32 a32, v122
    v_accvgpr_write_b32 a33, v123
    v_accvgpr_write_b32 a34, v124
    v_accvgpr_write_b32 a35, v125
    v_accvgpr_read_b32 v122, a48
    v_accvgpr_read_b32 v123, a49
    v_accvgpr_read_b32 v124, a50
    v_accvgpr_read_b32 v125, a51
    v_mul_f32 v122, v122, v121
    v_mul_f32 v123, v123, v121
    v_mul_f32 v124, v124, v121
    v_mul_f32 v125, v125, v121
    v_accvgpr_write_b32 a48, v122
    v_accvgpr_write_b32 a49, v123
    v_accvgpr_write_b32 a50, v124
    v_accvgpr_write_b32 a51, v125
    v_accvgpr_read_b32 v122, a64
    v_accvgpr_read_b32 v123, a65
    v_accvgpr_read_b32 v124, a66
    v_accvgpr_read_b32 v125, a67
    v_mul_f32 v122, v122, v121
    v_mul_f32 v123, v123, v121
    v_mul_f32 v124, v124, v121
    v_mul_f32 v125, v125, v121
    v_accvgpr_write_b32 a64, v122
    v_accvgpr_write_b32 a65, v123
    v_accvgpr_write_b32 a66, v124
    v_accvgpr_write_b32 a67, v125
    v_accvgpr_read_b32 v122, a80
    v_accvgpr_read_b32 v123, a81
    v_accvgpr_read_b32 v124, a82
    v_accvgpr_read_b32 v125, a83
    v_mul_f32 v122, v122, v121
    v_mul_f32 v123, v123, v121
    v_mul_f32 v124, v124, v121
    v_mul_f32 v125, v125, v121
    v_accvgpr_write_b32 a80, v122
    v_accvgpr_write_b32 a81, v123
    v_accvgpr_write_b32 a82, v124
    v_accvgpr_write_b32 a83, v125
    v_accvgpr_read_b32 v122, a96
    v_accvgpr_read_b32 v123, a97
    v_accvgpr_read_b32 v124, a98
    v_accvgpr_read_b32 v125, a99
    v_mul_f32 v122, v122, v121
    v_mul_f32 v123, v123, v121
    v_mul_f32 v124, v124, v121
    v_mul_f32 v125, v125, v121
    v_accvgpr_write_b32 a96, v122
    v_accvgpr_write_b32 a97, v123
    v_accvgpr_write_b32 a98, v124
    v_accvgpr_write_b32 a99, v125
    v_accvgpr_read_b32 v122, a112
    v_accvgpr_read_b32 v123, a113
    v_accvgpr_read_b32 v124, a114
    v_accvgpr_read_b32 v125, a115
    v_mul_f32 v122, v122, v121
    v_mul_f32 v123, v123, v121
    v_mul_f32 v124, v124, v121
    v_mul_f32 v125, v125, v121
    v_accvgpr_write_b32 a112, v122
    v_accvgpr_write_b32 a113, v123
    v_accvgpr_write_b32 a114, v124
    v_accvgpr_write_b32 a115, v125
    v_accvgpr_read_b32 v122, a128
    v_accvgpr_read_b32 v123, a129
    v_accvgpr_read_b32 v124, a130
    v_accvgpr_read_b32 v125, a131
    v_mul_f32 v122, v122, v121
    v_mul_f32 v123, v123, v121
    v_mul_f32 v124, v124, v121
    v_mul_f32 v125, v125, v121
    v_accvgpr_write_b32 a128, v122
    v_accvgpr_write_b32 a129, v123
    v_accvgpr_write_b32 a130, v124
    v_accvgpr_write_b32 a131, v125
    v_accvgpr_read_b32 v122, a144
    v_accvgpr_read_b32 v123, a145
    v_accvgpr_read_b32 v124, a146
    v_accvgpr_read_b32 v125, a147
    v_mul_f32 v122, v122, v121
    v_mul_f32 v123, v123, v121
    v_mul_f32 v124, v124, v121
    v_mul_f32 v125, v125, v121
    v_accvgpr_write_b32 a144, v122
    v_accvgpr_write_b32 a145, v123
    v_accvgpr_write_b32 a146, v124
    v_accvgpr_write_b32 a147, v125
    v_accvgpr_read_b32 v122, a160
    v_accvgpr_read_b32 v123, a161
    v_accvgpr_read_b32 v124, a162
    v_accvgpr_read_b32 v125, a163
    v_mul_f32 v122, v122, v121
    v_mul_f32 v123, v123, v121
    v_mul_f32 v124, v124, v121
    v_mul_f32 v125, v125, v121
    v_accvgpr_write_b32 a160, v122
    v_accvgpr_write_b32 a161, v123
    v_accvgpr_write_b32 a162, v124
    v_accvgpr_write_b32 a163, v125
    v_accvgpr_read_b32 v122, a176
    v_accvgpr_read_b32 v123, a177
    v_accvgpr_read_b32 v124, a178
    v_accvgpr_read_b32 v125, a179
    v_mul_f32 v122, v122, v121
    v_mul_f32 v123, v123, v121
    v_mul_f32 v124, v124, v121
    v_mul_f32 v125, v125, v121
    v_accvgpr_write_b32 a176, v122
    v_accvgpr_write_b32 a177, v123
    v_accvgpr_write_b32 a178, v124
    v_accvgpr_write_b32 a179, v125
    v_accvgpr_read_b32 v122, a192
    v_accvgpr_read_b32 v123, a193
    v_accvgpr_read_b32 v124, a194
    v_accvgpr_read_b32 v125, a195
    v_mul_f32 v122, v122, v121
    v_mul_f32 v123, v123, v121
    v_mul_f32 v124, v124, v121
    v_mul_f32 v125, v125, v121
    v_accvgpr_write_b32 a192, v122
    v_accvgpr_write_b32 a193, v123
    v_accvgpr_write_b32 a194, v124
    v_accvgpr_write_b32 a195, v125
    v_accvgpr_read_b32 v122, a208
    v_accvgpr_read_b32 v123, a209
    v_accvgpr_read_b32 v124, a210
    v_accvgpr_read_b32 v125, a211
    v_mul_f32 v122, v122, v121
    v_mul_f32 v123, v123, v121
    v_mul_f32 v124, v124, v121
    v_mul_f32 v125, v125, v121
    v_accvgpr_write_b32 a208, v122
    v_accvgpr_write_b32 a209, v123
    v_accvgpr_write_b32 a210, v124
    v_accvgpr_write_b32 a211, v125
    v_accvgpr_read_b32 v122, a224
    v_accvgpr_read_b32 v123, a225
    v_accvgpr_read_b32 v124, a226
    v_accvgpr_read_b32 v125, a227
    v_mul_f32 v122, v122, v121
    v_mul_f32 v123, v123, v121
    v_mul_f32 v124, v124, v121
    v_mul_f32 v125, v125, v121
    v_accvgpr_write_b32 a224, v122
    v_accvgpr_write_b32 a225, v123
    v_accvgpr_write_b32 a226, v124
    v_accvgpr_write_b32 a227, v125
    v_accvgpr_read_b32 v122, a240
    v_accvgpr_read_b32 v123, a241
    v_accvgpr_read_b32 v124, a242
    v_accvgpr_read_b32 v125, a243
    v_mul_f32 v122, v122, v121
    v_mul_f32 v123, v123, v121
    v_mul_f32 v124, v124, v121
    v_mul_f32 v125, v125, v121
    v_accvgpr_write_b32 a240, v122
    v_accvgpr_write_b32 a241, v123
    v_accvgpr_write_b32 a242, v124
    v_accvgpr_write_b32 a243, v125
    v_sub_f32 v16, v16, v120
    v_sub_f32 v17, v17, v120
    v_sub_f32 v18, v18, v120
    v_sub_f32 v19, v19, v120
    v_sub_f32 v32, v32, v120
    v_sub_f32 v33, v33, v120
    v_sub_f32 v34, v34, v120
    v_sub_f32 v35, v35, v120
    v_exp_f32 v122, v16
    v_exp_f32 v123, v17
    v_exp_f32 v124, v18
    v_exp_f32 v125, v19
    v_add_f32 v12, v122, v123
    v_cvt_pk_bf16_f32 v48, v122, v123
    v_add_f32 v12, v12, v124
    v_cvt_pk_bf16_f32 v49, v124, v125
    v_add_f32 v12, v12, v125
    v_exp_f32 v122, v32
    v_exp_f32 v123, v33
    v_exp_f32 v124, v34
    v_exp_f32 v125, v35
    v_add_f32 v12, v12, v122
    v_add_f32 v12, v12, v123
    v_cvt_pk_bf16_f32 v50, v122, v123
    v_add_f32 v12, v12, v124
    v_cvt_pk_bf16_f32 v51, v124, v125
    v_add_f32 v12, v12, v125
    v_max3_f32 v120, v20, v21, v22
    v_max3_f32 v120, v120, v23, v36
    v_max3_f32 v120, v120, v37, v38
    v_max_f32 v120, v120, v39
    v_mov_b32 v121, v120
    s_nop 1
    v_permlane16_swap_b32 v120, v121
    v_max_f32 v120, v120, v121
    v_mov_b32 v121, v120
    s_nop 1
    v_permlane32_swap_b32 v120, v121
    v_max_f32 v120, v120, v121
    v_max_f32 v120, 0, v120
    v_sub_f32 v84, v84, v120
    v_sub_f32 v85, v85, v120
    v_sub_f32 v86, v86, v120
    v_sub_f32 v87, v87, v120
    v_sub_f32 v121, 0, v120
    v_exp_f32 v121, v121
    s_nop 0
    v_mul_f32 v9, v9, v121
    v_accvgpr_read_b32 v122, a4
    v_accvgpr_read_b32 v123, a5
    v_accvgpr_read_b32 v124, a6
    v_accvgpr_read_b32 v125, a7
    v_mul_f32 v122, v122, v121
    v_mul_f32 v123, v123, v121
    v_mul_f32 v124, v124, v121
    v_mul_f32 v125, v125, v121
    v_accvgpr_write_b32 a4, v122
    v_accvgpr_write_b32 a5, v123
    v_accvgpr_write_b32 a6, v124
    v_accvgpr_write_b32 a7, v125
    v_accvgpr_read_b32 v122, a20
    v_accvgpr_read_b32 v123, a21
    v_accvgpr_read_b32 v124, a22
    v_accvgpr_read_b32 v125, a23
    v_mul_f32 v122, v122, v121
    v_mul_f32 v123, v123, v121
    v_mul_f32 v124, v124, v121
    v_mul_f32 v125, v125, v121
    v_accvgpr_write_b32 a20, v122
    v_accvgpr_write_b32 a21, v123
    v_accvgpr_write_b32 a22, v124
    v_accvgpr_write_b32 a23, v125
    v_accvgpr_read_b32 v122, a36
    v_accvgpr_read_b32 v123, a37
    v_accvgpr_read_b32 v124, a38
    v_accvgpr_read_b32 v125, a39
    v_mul_f32 v122, v122, v121
    v_mul_f32 v123, v123, v121
    v_mul_f32 v124, v124, v121
    v_mul_f32 v125, v125, v121
    v_accvgpr_write_b32 a36, v122
    v_accvgpr_write_b32 a37, v123
    v_accvgpr_write_b32 a38, v124
    v_accvgpr_write_b32 a39, v125
    v_accvgpr_read_b32 v122, a52
    v_accvgpr_read_b32 v123, a53
    v_accvgpr_read_b32 v124, a54
    v_accvgpr_read_b32 v125, a55
    v_mul_f32 v122, v122, v121
    v_mul_f32 v123, v123, v121
    v_mul_f32 v124, v124, v121
    v_mul_f32 v125, v125, v121
    v_accvgpr_write_b32 a52, v122
    v_accvgpr_write_b32 a53, v123
    v_accvgpr_write_b32 a54, v124
    v_accvgpr_write_b32 a55, v125
    v_accvgpr_read_b32 v122, a68
    v_accvgpr_read_b32 v123, a69
    v_accvgpr_read_b32 v124, a70
    v_accvgpr_read_b32 v125, a71
    v_mul_f32 v122, v122, v121
    v_mul_f32 v123, v123, v121
    v_mul_f32 v124, v124, v121
    v_mul_f32 v125, v125, v121
    v_accvgpr_write_b32 a68, v122
    v_accvgpr_write_b32 a69, v123
    v_accvgpr_write_b32 a70, v124
    v_accvgpr_write_b32 a71, v125
    v_accvgpr_read_b32 v122, a84
    v_accvgpr_read_b32 v123, a85
    v_accvgpr_read_b32 v124, a86
    v_accvgpr_read_b32 v125, a87
    v_mul_f32 v122, v122, v121
    v_mul_f32 v123, v123, v121
    v_mul_f32 v124, v124, v121
    v_mul_f32 v125, v125, v121
    v_accvgpr_write_b32 a84, v122
    v_accvgpr_write_b32 a85, v123
    v_accvgpr_write_b32 a86, v124
    v_accvgpr_write_b32 a87, v125
    v_accvgpr_read_b32 v122, a100
    v_accvgpr_read_b32 v123, a101
    v_accvgpr_read_b32 v124, a102
    v_accvgpr_read_b32 v125, a103
    v_mul_f32 v122, v122, v121
    v_mul_f32 v123, v123, v121
    v_mul_f32 v124, v124, v121
    v_mul_f32 v125, v125, v121
    v_accvgpr_write_b32 a100, v122
    v_accvgpr_write_b32 a101, v123
    v_accvgpr_write_b32 a102, v124
    v_accvgpr_write_b32 a103, v125
    v_accvgpr_read_b32 v122, a116
    v_accvgpr_read_b32 v123, a117
    v_accvgpr_read_b32 v124, a118
    v_accvgpr_read_b32 v125, a119
    v_mul_f32 v122, v122, v121
    v_mul_f32 v123, v123, v121
    v_mul_f32 v124, v124, v121
    v_mul_f32 v125, v125, v121
    v_accvgpr_write_b32 a116, v122
    v_accvgpr_write_b32 a117, v123
    v_accvgpr_write_b32 a118, v124
    v_accvgpr_write_b32 a119, v125
    v_accvgpr_read_b32 v122, a132
    v_accvgpr_read_b32 v123, a133
    v_accvgpr_read_b32 v124, a134
    v_accvgpr_read_b32 v125, a135
    v_mul_f32 v122, v122, v121
    v_mul_f32 v123, v123, v121
    v_mul_f32 v124, v124, v121
    v_mul_f32 v125, v125, v121
    v_accvgpr_write_b32 a132, v122
    v_accvgpr_write_b32 a133, v123
    v_accvgpr_write_b32 a134, v124
    v_accvgpr_write_b32 a135, v125
    v_accvgpr_read_b32 v122, a148
    v_accvgpr_read_b32 v123, a149
    v_accvgpr_read_b32 v124, a150
    v_accvgpr_read_b32 v125, a151
    v_mul_f32 v122, v122, v121
    v_mul_f32 v123, v123, v121
    v_mul_f32 v124, v124, v121
    v_mul_f32 v125, v125, v121
    v_accvgpr_write_b32 a148, v122
    v_accvgpr_write_b32 a149, v123
    v_accvgpr_write_b32 a150, v124
    v_accvgpr_write_b32 a151, v125
    v_accvgpr_read_b32 v122, a164
    v_accvgpr_read_b32 v123, a165
    v_accvgpr_read_b32 v124, a166
    v_accvgpr_read_b32 v125, a167
    v_mul_f32 v122, v122, v121
    v_mul_f32 v123, v123, v121
    v_mul_f32 v124, v124, v121
    v_mul_f32 v125, v125, v121
    v_accvgpr_write_b32 a164, v122
    v_accvgpr_write_b32 a165, v123
    v_accvgpr_write_b32 a166, v124
    v_accvgpr_write_b32 a167, v125
    v_accvgpr_read_b32 v122, a180
    v_accvgpr_read_b32 v123, a181
    v_accvgpr_read_b32 v124, a182
    v_accvgpr_read_b32 v125, a183
    v_mul_f32 v122, v122, v121
    v_mul_f32 v123, v123, v121
    v_mul_f32 v124, v124, v121
    v_mul_f32 v125, v125, v121
    v_accvgpr_write_b32 a180, v122
    v_accvgpr_write_b32 a181, v123
    v_accvgpr_write_b32 a182, v124
    v_accvgpr_write_b32 a183, v125
    v_accvgpr_read_b32 v122, a196
    v_accvgpr_read_b32 v123, a197
    v_accvgpr_read_b32 v124, a198
    v_accvgpr_read_b32 v125, a199
    v_mul_f32 v122, v122, v121
    v_mul_f32 v123, v123, v121
    v_mul_f32 v124, v124, v121
    v_mul_f32 v125, v125, v121
    v_accvgpr_write_b32 a196, v122
    v_accvgpr_write_b32 a197, v123
    v_accvgpr_write_b32 a198, v124
    v_accvgpr_write_b32 a199, v125
    v_accvgpr_read_b32 v122, a212
    v_accvgpr_read_b32 v123, a213
    v_accvgpr_read_b32 v124, a214
    v_accvgpr_read_b32 v125, a215
    v_mul_f32 v122, v122, v121
    v_mul_f32 v123, v123, v121
    v_mul_f32 v124, v124, v121
    v_mul_f32 v125, v125, v121
    v_accvgpr_write_b32 a212, v122
    v_accvgpr_write_b32 a213, v123
    v_accvgpr_write_b32 a214, v124
    v_accvgpr_write_b32 a215, v125
    v_accvgpr_read_b32 v122, a228
    v_accvgpr_read_b32 v123, a229
    v_accvgpr_read_b32 v124, a230
    v_accvgpr_read_b32 v125, a231
    v_mul_f32 v122, v122, v121
    v_mul_f32 v123, v123, v121
    v_mul_f32 v124, v124, v121
    v_mul_f32 v125, v125, v121
    v_accvgpr_write_b32 a228, v122
    v_accvgpr_write_b32 a229, v123
    v_accvgpr_write_b32 a230, v124
    v_accvgpr_write_b32 a231, v125
    v_accvgpr_read_b32 v122, a244
    v_accvgpr_read_b32 v123, a245
    v_accvgpr_read_b32 v124, a246
    v_accvgpr_read_b32 v125, a247
    v_mul_f32 v122, v122, v121
    v_mul_f32 v123, v123, v121
    v_mul_f32 v124, v124, v121
    v_mul_f32 v125, v125, v121
    v_accvgpr_write_b32 a244, v122
    v_accvgpr_write_b32 a245, v123
    v_accvgpr_write_b32 a246, v124
    v_accvgpr_write_b32 a247, v125
    v_sub_f32 v20, v20, v120
    v_sub_f32 v21, v21, v120
    v_sub_f32 v22, v22, v120
    v_sub_f32 v23, v23, v120
    v_sub_f32 v36, v36, v120
    v_sub_f32 v37, v37, v120
    v_sub_f32 v38, v38, v120
    v_sub_f32 v39, v39, v120
    v_exp_f32 v122, v20
    v_exp_f32 v123, v21
    v_exp_f32 v124, v22
    v_exp_f32 v125, v23
    v_add_f32 v13, v122, v123
    v_cvt_pk_bf16_f32 v52, v122, v123
    v_add_f32 v13, v13, v124
    v_cvt_pk_bf16_f32 v53, v124, v125
    v_add_f32 v13, v13, v125
    v_exp_f32 v122, v36
    v_exp_f32 v123, v37
    v_exp_f32 v124, v38
    v_exp_f32 v125, v39
    v_add_f32 v13, v13, v122
    v_add_f32 v13, v13, v123
    v_cvt_pk_bf16_f32 v54, v122, v123
    v_add_f32 v13, v13, v124
    v_cvt_pk_bf16_f32 v55, v124, v125
    v_add_f32 v13, v13, v125
    v_max3_f32 v120, v24, v25, v26
    v_max3_f32 v120, v120, v27, v40
    v_max3_f32 v120, v120, v41, v42
    v_max_f32 v120, v120, v43
    v_mov_b32 v121, v120
    s_nop 1
    v_permlane16_swap_b32 v120, v121
    v_max_f32 v120, v120, v121
    v_mov_b32 v121, v120
    s_nop 1
    v_permlane32_swap_b32 v120, v121
    v_max_f32 v120, v120, v121
    v_max_f32 v120, 0, v120
    v_sub_f32 v88, v88, v120
    v_sub_f32 v89, v89, v120
    v_sub_f32 v90, v90, v120
    v_sub_f32 v91, v91, v120
    v_sub_f32 v121, 0, v120
    v_exp_f32 v121, v121
    s_nop 0
    v_mul_f32 v10, v10, v121
    v_accvgpr_read_b32 v122, a8
    v_accvgpr_read_b32 v123, a9
    v_accvgpr_read_b32 v124, a10
    v_accvgpr_read_b32 v125, a11
    v_mul_f32 v122, v122, v121
    v_mul_f32 v123, v123, v121
    v_mul_f32 v124, v124, v121
    v_mul_f32 v125, v125, v121
    v_accvgpr_write_b32 a8, v122
    v_accvgpr_write_b32 a9, v123
    v_accvgpr_write_b32 a10, v124
    v_accvgpr_write_b32 a11, v125
    v_accvgpr_read_b32 v122, a24
    v_accvgpr_read_b32 v123, a25
    v_accvgpr_read_b32 v124, a26
    v_accvgpr_read_b32 v125, a27
    v_mul_f32 v122, v122, v121
    v_mul_f32 v123, v123, v121
    v_mul_f32 v124, v124, v121
    v_mul_f32 v125, v125, v121
    v_accvgpr_write_b32 a24, v122
    v_accvgpr_write_b32 a25, v123
    v_accvgpr_write_b32 a26, v124
    v_accvgpr_write_b32 a27, v125
    v_accvgpr_read_b32 v122, a40
    v_accvgpr_read_b32 v123, a41
    v_accvgpr_read_b32 v124, a42
    v_accvgpr_read_b32 v125, a43
    v_mul_f32 v122, v122, v121
    v_mul_f32 v123, v123, v121
    v_mul_f32 v124, v124, v121
    v_mul_f32 v125, v125, v121
    v_accvgpr_write_b32 a40, v122
    v_accvgpr_write_b32 a41, v123
    v_accvgpr_write_b32 a42, v124
    v_accvgpr_write_b32 a43, v125
    v_accvgpr_read_b32 v122, a56
    v_accvgpr_read_b32 v123, a57
    v_accvgpr_read_b32 v124, a58
    v_accvgpr_read_b32 v125, a59
    v_mul_f32 v122, v122, v121
    v_mul_f32 v123, v123, v121
    v_mul_f32 v124, v124, v121
    v_mul_f32 v125, v125, v121
    v_accvgpr_write_b32 a56, v122
    v_accvgpr_write_b32 a57, v123
    v_accvgpr_write_b32 a58, v124
    v_accvgpr_write_b32 a59, v125
    v_accvgpr_read_b32 v122, a72
    v_accvgpr_read_b32 v123, a73
    v_accvgpr_read_b32 v124, a74
    v_accvgpr_read_b32 v125, a75
    v_mul_f32 v122, v122, v121
    v_mul_f32 v123, v123, v121
    v_mul_f32 v124, v124, v121
    v_mul_f32 v125, v125, v121
    v_accvgpr_write_b32 a72, v122
    v_accvgpr_write_b32 a73, v123
    v_accvgpr_write_b32 a74, v124
    v_accvgpr_write_b32 a75, v125
    v_accvgpr_read_b32 v122, a88
    v_accvgpr_read_b32 v123, a89
    v_accvgpr_read_b32 v124, a90
    v_accvgpr_read_b32 v125, a91
    v_mul_f32 v122, v122, v121
    v_mul_f32 v123, v123, v121
    v_mul_f32 v124, v124, v121
    v_mul_f32 v125, v125, v121
    v_accvgpr_write_b32 a88, v122
    v_accvgpr_write_b32 a89, v123
    v_accvgpr_write_b32 a90, v124
    v_accvgpr_write_b32 a91, v125
    v_accvgpr_read_b32 v122, a104
    v_accvgpr_read_b32 v123, a105
    v_accvgpr_read_b32 v124, a106
    v_accvgpr_read_b32 v125, a107
    v_mul_f32 v122, v122, v121
    v_mul_f32 v123, v123, v121
    v_mul_f32 v124, v124, v121
    v_mul_f32 v125, v125, v121
    v_accvgpr_write_b32 a104, v122
    v_accvgpr_write_b32 a105, v123
    v_accvgpr_write_b32 a106, v124
    v_accvgpr_write_b32 a107, v125
    v_accvgpr_read_b32 v122, a120
    v_accvgpr_read_b32 v123, a121
    v_accvgpr_read_b32 v124, a122
    v_accvgpr_read_b32 v125, a123
    v_mul_f32 v122, v122, v121
    v_mul_f32 v123, v123, v121
    v_mul_f32 v124, v124, v121
    v_mul_f32 v125, v125, v121
    v_accvgpr_write_b32 a120, v122
    v_accvgpr_write_b32 a121, v123
    v_accvgpr_write_b32 a122, v124
    v_accvgpr_write_b32 a123, v125
    v_accvgpr_read_b32 v122, a136
    v_accvgpr_read_b32 v123, a137
    v_accvgpr_read_b32 v124, a138
    v_accvgpr_read_b32 v125, a139
    v_mul_f32 v122, v122, v121
    v_mul_f32 v123, v123, v121
    v_mul_f32 v124, v124, v121
    v_mul_f32 v125, v125, v121
    v_accvgpr_write_b32 a136, v122
    v_accvgpr_write_b32 a137, v123
    v_accvgpr_write_b32 a138, v124
    v_accvgpr_write_b32 a139, v125
    v_accvgpr_read_b32 v122, a152
    v_accvgpr_read_b32 v123, a153
    v_accvgpr_read_b32 v124, a154
    v_accvgpr_read_b32 v125, a155
    v_mul_f32 v122, v122, v121
    v_mul_f32 v123, v123, v121
    v_mul_f32 v124, v124, v121
    v_mul_f32 v125, v125, v121
    v_accvgpr_write_b32 a152, v122
    v_accvgpr_write_b32 a153, v123
    v_accvgpr_write_b32 a154, v124
    v_accvgpr_write_b32 a155, v125
    v_accvgpr_read_b32 v122, a168
    v_accvgpr_read_b32 v123, a169
    v_accvgpr_read_b32 v124, a170
    v_accvgpr_read_b32 v125, a171
    v_mul_f32 v122, v122, v121
    v_mul_f32 v123, v123, v121
    v_mul_f32 v124, v124, v121
    v_mul_f32 v125, v125, v121
    v_accvgpr_write_b32 a168, v122
    v_accvgpr_write_b32 a169, v123
    v_accvgpr_write_b32 a170, v124
    v_accvgpr_write_b32 a171, v125
    v_accvgpr_read_b32 v122, a184
    v_accvgpr_read_b32 v123, a185
    v_accvgpr_read_b32 v124, a186
    v_accvgpr_read_b32 v125, a187
    v_mul_f32 v122, v122, v121
    v_mul_f32 v123, v123, v121
    v_mul_f32 v124, v124, v121
    v_mul_f32 v125, v125, v121
    v_accvgpr_write_b32 a184, v122
    v_accvgpr_write_b32 a185, v123
    v_accvgpr_write_b32 a186, v124
    v_accvgpr_write_b32 a187, v125
    v_accvgpr_read_b32 v122, a200
    v_accvgpr_read_b32 v123, a201
    v_accvgpr_read_b32 v124, a202
    v_accvgpr_read_b32 v125, a203
    v_mul_f32 v122, v122, v121
    v_mul_f32 v123, v123, v121
    v_mul_f32 v124, v124, v121
    v_mul_f32 v125, v125, v121
    v_accvgpr_write_b32 a200, v122
    v_accvgpr_write_b32 a201, v123
    v_accvgpr_write_b32 a202, v124
    v_accvgpr_write_b32 a203, v125
    v_accvgpr_read_b32 v122, a216
    v_accvgpr_read_b32 v123, a217
    v_accvgpr_read_b32 v124, a218
    v_accvgpr_read_b32 v125, a219
    v_mul_f32 v122, v122, v121
    v_mul_f32 v123, v123, v121
    v_mul_f32 v124, v124, v121
    v_mul_f32 v125, v125, v121
    v_accvgpr_write_b32 a216, v122
    v_accvgpr_write_b32 a217, v123
    v_accvgpr_write_b32 a218, v124
    v_accvgpr_write_b32 a219, v125
    v_accvgpr_read_b32 v122, a232
    v_accvgpr_read_b32 v123, a233
    v_accvgpr_read_b32 v124, a234
    v_accvgpr_read_b32 v125, a235
    v_mul_f32 v122, v122, v121
    v_mul_f32 v123, v123, v121
    v_mul_f32 v124, v124, v121
    v_mul_f32 v125, v125, v121
    v_accvgpr_write_b32 a232, v122
    v_accvgpr_write_b32 a233, v123
    v_accvgpr_write_b32 a234, v124
    v_accvgpr_write_b32 a235, v125
    v_accvgpr_read_b32 v122, a248
    v_accvgpr_read_b32 v123, a249
    v_accvgpr_read_b32 v124, a250
    v_accvgpr_read_b32 v125, a251
    v_mul_f32 v122, v122, v121
    v_mul_f32 v123, v123, v121
    v_mul_f32 v124, v124, v121
    v_mul_f32 v125, v125, v121
    v_accvgpr_write_b32 a248, v122
    v_accvgpr_write_b32 a249, v123
    v_accvgpr_write_b32 a250, v124
    v_accvgpr_write_b32 a251, v125
    v_sub_f32 v24, v24, v120
    v_sub_f32 v25, v25, v120
    v_sub_f32 v26, v26, v120
    v_sub_f32 v27, v27, v120
    v_sub_f32 v40, v40, v120
    v_sub_f32 v41, v41, v120
    v_sub_f32 v42, v42, v120
    v_sub_f32 v43, v43, v120
    v_exp_f32 v122, v24
    v_exp_f32 v123, v25
    v_exp_f32 v124, v26
    v_exp_f32 v125, v27
    v_add_f32 v14, v122, v123
    v_cvt_pk_bf16_f32 v56, v122, v123
    v_add_f32 v14, v14, v124
    v_cvt_pk_bf16_f32 v57, v124, v125
    v_add_f32 v14, v14, v125
    v_exp_f32 v122, v40
    v_exp_f32 v123, v41
    v_exp_f32 v124, v42
    v_exp_f32 v125, v43
    v_add_f32 v14, v14, v122
    v_add_f32 v14, v14, v123
    v_cvt_pk_bf16_f32 v58, v122, v123
    v_add_f32 v14, v14, v124
    v_cvt_pk_bf16_f32 v59, v124, v125
    v_add_f32 v14, v14, v125
    v_max3_f32 v120, v28, v29, v30
    v_max3_f32 v120, v120, v31, v44
    v_max3_f32 v120, v120, v45, v46
    v_max_f32 v120, v120, v47
    v_mov_b32 v121, v120
    s_nop 1
    v_permlane16_swap_b32 v120, v121
    v_max_f32 v120, v120, v121
    v_mov_b32 v121, v120
    s_nop 1
    v_permlane32_swap_b32 v120, v121
    v_max_f32 v120, v120, v121
    v_max_f32 v120, 0, v120
    v_sub_f32 v92, v92, v120
    v_sub_f32 v93, v93, v120
    v_sub_f32 v94, v94, v120
    v_sub_f32 v95, v95, v120
    v_sub_f32 v121, 0, v120
    v_exp_f32 v121, v121
    s_nop 0
    v_mul_f32 v11, v11, v121
    v_accvgpr_read_b32 v122, a12
    v_accvgpr_read_b32 v123, a13
    v_accvgpr_read_b32 v124, a14
    v_accvgpr_read_b32 v125, a15
    v_mul_f32 v122, v122, v121
    v_mul_f32 v123, v123, v121
    v_mul_f32 v124, v124, v121
    v_mul_f32 v125, v125, v121
    v_accvgpr_write_b32 a12, v122
    v_accvgpr_write_b32 a13, v123
    v_accvgpr_write_b32 a14, v124
    v_accvgpr_write_b32 a15, v125
    v_accvgpr_read_b32 v122, a28
    v_accvgpr_read_b32 v123, a29
    v_accvgpr_read_b32 v124, a30
    v_accvgpr_read_b32 v125, a31
    v_mul_f32 v122, v122, v121
    v_mul_f32 v123, v123, v121
    v_mul_f32 v124, v124, v121
    v_mul_f32 v125, v125, v121
    v_accvgpr_write_b32 a28, v122
    v_accvgpr_write_b32 a29, v123
    v_accvgpr_write_b32 a30, v124
    v_accvgpr_write_b32 a31, v125
    v_accvgpr_read_b32 v122, a44
    v_accvgpr_read_b32 v123, a45
    v_accvgpr_read_b32 v124, a46
    v_accvgpr_read_b32 v125, a47
    v_mul_f32 v122, v122, v121
    v_mul_f32 v123, v123, v121
    v_mul_f32 v124, v124, v121
    v_mul_f32 v125, v125, v121
    v_accvgpr_write_b32 a44, v122
    v_accvgpr_write_b32 a45, v123
    v_accvgpr_write_b32 a46, v124
    v_accvgpr_write_b32 a47, v125
    v_accvgpr_read_b32 v122, a60
    v_accvgpr_read_b32 v123, a61
    v_accvgpr_read_b32 v124, a62
    v_accvgpr_read_b32 v125, a63
    v_mul_f32 v122, v122, v121
    v_mul_f32 v123, v123, v121
    v_mul_f32 v124, v124, v121
    v_mul_f32 v125, v125, v121
    v_accvgpr_write_b32 a60, v122
    v_accvgpr_write_b32 a61, v123
    v_accvgpr_write_b32 a62, v124
    v_accvgpr_write_b32 a63, v125
    v_accvgpr_read_b32 v122, a76
    v_accvgpr_read_b32 v123, a77
    v_accvgpr_read_b32 v124, a78
    v_accvgpr_read_b32 v125, a79
    v_mul_f32 v122, v122, v121
    v_mul_f32 v123, v123, v121
    v_mul_f32 v124, v124, v121
    v_mul_f32 v125, v125, v121
    v_accvgpr_write_b32 a76, v122
    v_accvgpr_write_b32 a77, v123
    v_accvgpr_write_b32 a78, v124
    v_accvgpr_write_b32 a79, v125
    v_accvgpr_read_b32 v122, a92
    v_accvgpr_read_b32 v123, a93
    v_accvgpr_read_b32 v124, a94
    v_accvgpr_read_b32 v125, a95
    v_mul_f32 v122, v122, v121
    v_mul_f32 v123, v123, v121
    v_mul_f32 v124, v124, v121
    v_mul_f32 v125, v125, v121
    v_accvgpr_write_b32 a92, v122
    v_accvgpr_write_b32 a93, v123
    v_accvgpr_write_b32 a94, v124
    v_accvgpr_write_b32 a95, v125
    v_accvgpr_read_b32 v122, a108
    v_accvgpr_read_b32 v123, a109
    v_accvgpr_read_b32 v124, a110
    v_accvgpr_read_b32 v125, a111
    v_mul_f32 v122, v122, v121
    v_mul_f32 v123, v123, v121
    v_mul_f32 v124, v124, v121
    v_mul_f32 v125, v125, v121
    v_accvgpr_write_b32 a108, v122
    v_accvgpr_write_b32 a109, v123
    v_accvgpr_write_b32 a110, v124
    v_accvgpr_write_b32 a111, v125
    v_accvgpr_read_b32 v122, a124
    v_accvgpr_read_b32 v123, a125
    v_accvgpr_read_b32 v124, a126
    v_accvgpr_read_b32 v125, a127
    v_mul_f32 v122, v122, v121
    v_mul_f32 v123, v123, v121
    v_mul_f32 v124, v124, v121
    v_mul_f32 v125, v125, v121
    v_accvgpr_write_b32 a124, v122
    v_accvgpr_write_b32 a125, v123
    v_accvgpr_write_b32 a126, v124
    v_accvgpr_write_b32 a127, v125
    v_accvgpr_read_b32 v122, a140
    v_accvgpr_read_b32 v123, a141
    v_accvgpr_read_b32 v124, a142
    v_accvgpr_read_b32 v125, a143
    v_mul_f32 v122, v122, v121
    v_mul_f32 v123, v123, v121
    v_mul_f32 v124, v124, v121
    v_mul_f32 v125, v125, v121
    v_accvgpr_write_b32 a140, v122
    v_accvgpr_write_b32 a141, v123
    v_accvgpr_write_b32 a142, v124
    v_accvgpr_write_b32 a143, v125
    v_accvgpr_read_b32 v122, a156
    v_accvgpr_read_b32 v123, a157
    v_accvgpr_read_b32 v124, a158
    v_accvgpr_read_b32 v125, a159
    v_mul_f32 v122, v122, v121
    v_mul_f32 v123, v123, v121
    v_mul_f32 v124, v124, v121
    v_mul_f32 v125, v125, v121
    v_accvgpr_write_b32 a156, v122
    v_accvgpr_write_b32 a157, v123
    v_accvgpr_write_b32 a158, v124
    v_accvgpr_write_b32 a159, v125
    v_accvgpr_read_b32 v122, a172
    v_accvgpr_read_b32 v123, a173
    v_accvgpr_read_b32 v124, a174
    v_accvgpr_read_b32 v125, a175
    v_mul_f32 v122, v122, v121
    v_mul_f32 v123, v123, v121
    v_mul_f32 v124, v124, v121
    v_mul_f32 v125, v125, v121
    v_accvgpr_write_b32 a172, v122
    v_accvgpr_write_b32 a173, v123
    v_accvgpr_write_b32 a174, v124
    v_accvgpr_write_b32 a175, v125
    v_accvgpr_read_b32 v122, a188
    v_accvgpr_read_b32 v123, a189
    v_accvgpr_read_b32 v124, a190
    v_accvgpr_read_b32 v125, a191
    v_mul_f32 v122, v122, v121
    v_mul_f32 v123, v123, v121
    v_mul_f32 v124, v124, v121
    v_mul_f32 v125, v125, v121
    v_accvgpr_write_b32 a188, v122
    v_accvgpr_write_b32 a189, v123
    v_accvgpr_write_b32 a190, v124
    v_accvgpr_write_b32 a191, v125
    v_accvgpr_read_b32 v122, a204
    v_accvgpr_read_b32 v123, a205
    v_accvgpr_read_b32 v124, a206
    v_accvgpr_read_b32 v125, a207
    v_mul_f32 v122, v122, v121
    v_mul_f32 v123, v123, v121
    v_mul_f32 v124, v124, v121
    v_mul_f32 v125, v125, v121
    v_accvgpr_write_b32 a204, v122
    v_accvgpr_write_b32 a205, v123
    v_accvgpr_write_b32 a206, v124
    v_accvgpr_write_b32 a207, v125
    v_accvgpr_read_b32 v122, a220
    v_accvgpr_read_b32 v123, a221
    v_accvgpr_read_b32 v124, a222
    v_accvgpr_read_b32 v125, a223
    v_mul_f32 v122, v122, v121
    v_mul_f32 v123, v123, v121
    v_mul_f32 v124, v124, v121
    v_mul_f32 v125, v125, v121
    v_accvgpr_write_b32 a220, v122
    v_accvgpr_write_b32 a221, v123
    v_accvgpr_write_b32 a222, v124
    v_accvgpr_write_b32 a223, v125
    v_accvgpr_read_b32 v122, a236
    v_accvgpr_read_b32 v123, a237
    v_accvgpr_read_b32 v124, a238
    v_accvgpr_read_b32 v125, a239
    v_mul_f32 v122, v122, v121
    v_mul_f32 v123, v123, v121
    v_mul_f32 v124, v124, v121
    v_mul_f32 v125, v125, v121
    v_accvgpr_write_b32 a236, v122
    v_accvgpr_write_b32 a237, v123
    v_accvgpr_write_b32 a238, v124
    v_accvgpr_write_b32 a239, v125
    v_accvgpr_read_b32 v122, a252
    v_accvgpr_read_b32 v123, a253
    v_accvgpr_read_b32 v124, a254
    v_accvgpr_read_b32 v125, a255
    v_mul_f32 v122, v122, v121
    v_mul_f32 v123, v123, v121
    v_mul_f32 v124, v124, v121
    v_mul_f32 v125, v125, v121
    v_accvgpr_write_b32 a252, v122
    v_accvgpr_write_b32 a253, v123
    v_accvgpr_write_b32 a254, v124
    v_accvgpr_write_b32 a255, v125
    v_sub_f32 v28, v28, v120
    v_sub_f32 v29, v29, v120
    v_sub_f32 v30, v30, v120
    v_sub_f32 v31, v31, v120
    v_sub_f32 v44, v44, v120
    v_sub_f32 v45, v45, v120
    v_sub_f32 v46, v46, v120
    v_sub_f32 v47, v47, v120
    v_exp_f32 v122, v28
    v_exp_f32 v123, v29
    v_exp_f32 v124, v30
    v_exp_f32 v125, v31
    v_add_f32 v15, v122, v123
    v_cvt_pk_bf16_f32 v60, v122, v123
    v_add_f32 v15, v15, v124
    v_cvt_pk_bf16_f32 v61, v124, v125
    v_add_f32 v15, v15, v125
    v_exp_f32 v122, v44
    v_exp_f32 v123, v45
    v_exp_f32 v124, v46
    v_exp_f32 v125, v47
    v_add_f32 v15, v15, v122
    v_add_f32 v15, v15, v123
    v_cvt_pk_bf16_f32 v62, v122, v123
    v_add_f32 v15, v15, v124
    v_cvt_pk_bf16_f32 v63, v124, v125
    v_add_f32 v15, v15, v125
    s_nop 3
    s_cmp_eq_u32 s54, 1
    s_cbranch_scc1 L_back_g
    s_cmp_eq_u32 s54, 5
    s_cbranch_scc1 L_back_d
    s_cmp_lt_u32 s51, 13
    s_branch L_back_b
L_renorm_1:
    s_nop 15
    v_max3_f32 v120, v16, v17, v18
    v_max3_f32 v120, v120, v19, v32
    v_max3_f32 v120, v120, v33, v34
    v_max_f32 v120, v120, v35
    v_mov_b32 v121, v120
    s_nop 1
    v_permlane16_swap_b32 v120, v121
    v_max_f32 v120, v120, v121
    v_mov_b32 v121, v120
    s_nop 1
    v_permlane32_swap_b32 v120, v121
    v_max_f32 v120, v120, v121
    v_max_f32 v120, 0, v120
    v_sub_f32 v80, v80, v120
    v_sub_f32 v81, v81, v120
    v_sub_f32 v82, v82, v120
    v_sub_f32 v83, v83, v120
    v_sub_f32 v121, 0, v120
    v_exp_f32 v121, v121
    s_nop 0
    v_mul_f32 v8, v8, v121
    v_accvgpr_read_b32 v122, a0
    v_accvgpr_read_b32 v123, a1
    v_accvgpr_read_b32 v124, a2
    v_accvgpr_read_b32 v125, a3
    v_mul_f32 v122, v122, v121
    v_mul_f32 v123, v123, v121
    v_mul_f32 v124, v124, v121
    v_mul_f32 v125, v125, v121
    v_accvgpr_write_b32 a0, v122
    v_accvgpr_write_b32 a1, v123
    v_accvgpr_write_b32 a2, v124
    v_accvgpr_write_b32 a3, v125
    v_accvgpr_read_b32 v122, a16
    v_accvgpr_read_b32 v123, a17
    v_accvgpr_read_b32 v124, a18
    v_accvgpr_read_b32 v125, a19
    v_mul_f32 v122, v122, v121
    v_mul_f32 v123, v123, v121
    v_mul_f32 v124, v124, v121
    v_mul_f32 v125, v125, v121
    v_accvgpr_write_b32 a16, v122
    v_accvgpr_write_b32 a17, v123
    v_accvgpr_write_b32 a18, v124
    v_accvgpr_write_b32 a19, v125
    v_accvgpr_read_b32 v122, a32
    v_accvgpr_read_b32 v123, a33
    v_accvgpr_read_b32 v124, a34
    v_accvgpr_read_b32 v125, a35
    v_mul_f32 v122, v122, v121
    v_mul_f32 v123, v123, v121
    v_mul_f32 v124, v124, v121
    v_mul_f32 v125, v125, v121
    v_accvgpr_write_b32 a32, v122
    v_accvgpr_write_b32 a33, v123
    v_accvgpr_write_b32 a34, v124
    v_accvgpr_write_b32 a35, v125
    v_accvgpr_read_b32 v122, a48
    v_accvgpr_read_b32 v123, a49
    v_accvgpr_read_b32 v124, a50
    v_accvgpr_read_b32 v125, a51
    v_mul_f32 v122, v122, v121
    v_mul_f32 v123, v123, v121
    v_mul_f32 v124, v124, v121
    v_mul_f32 v125, v125, v121
    v_accvgpr_write_b32 a48, v122
    v_accvgpr_write_b32 a49, v123
    v_accvgpr_write_b32 a50, v124
    v_accvgpr_write_b32 a51, v125
    v_accvgpr_read_b32 v122, a64
    v_accvgpr_read_b32 v123, a65
    v_accvgpr_read_b32 v124, a66
    v_accvgpr_read_b32 v125, a67
    v_mul_f32 v122, v122, v121
    v_mul_f32 v123, v123, v121
    v_mul_f32 v124, v124, v121
    v_mul_f32 v125, v125, v121
    v_accvgpr_write_b32 a64, v122
    v_accvgpr_write_b32 a65, v123
    v_accvgpr_write_b32 a66, v124
    v_accvgpr_write_b32 a67, v125
    v_accvgpr_read_b32 v122, a80
    v_accvgpr_read_b32 v123, a81
    v_accvgpr_read_b32 v124, a82
    v_accvgpr_read_b32 v125, a83
    v_mul_f32 v122, v122, v121
    v_mul_f32 v123, v123, v121
    v_mul_f32 v124, v124, v121
    v_mul_f32 v125, v125, v121
    v_accvgpr_write_b32 a80, v122
    v_accvgpr_write_b32 a81, v123
    v_accvgpr_write_b32 a82, v124
    v_accvgpr_write_b32 a83, v125
    v_accvgpr_read_b32 v122, a96
    v_accvgpr_read_b32 v123, a97
    v_accvgpr_read_b32 v124, a98
    v_accvgpr_read_b32 v125, a99
    v_mul_f32 v122, v122, v121
    v_mul_f32 v123, v123, v121
    v_mul_f32 v124, v124, v121
    v_mul_f32 v125, v125, v121
    v_accvgpr_write_b32 a96, v122
    v_accvgpr_write_b32 a97, v123
    v_accvgpr_write_b32 a98, v124
    v_accvgpr_write_b32 a99, v125
    v_accvgpr_read_b32 v122, a112
    v_accvgpr_read_b32 v123, a113
    v_accvgpr_read_b32 v124, a114
    v_accvgpr_read_b32 v125, a115
    v_mul_f32 v122, v122, v121
    v_mul_f32 v123, v123, v121
    v_mul_f32 v124, v124, v121
    v_mul_f32 v125, v125, v121
    v_accvgpr_write_b32 a112, v122
    v_accvgpr_write_b32 a113, v123
    v_accvgpr_write_b32 a114, v124
    v_accvgpr_write_b32 a115, v125
    v_accvgpr_read_b32 v122, a128
    v_accvgpr_read_b32 v123, a129
    v_accvgpr_read_b32 v124, a130
    v_accvgpr_read_b32 v125, a131
    v_mul_f32 v122, v122, v121
    v_mul_f32 v123, v123, v121
    v_mul_f32 v124, v124, v121
    v_mul_f32 v125, v125, v121
    v_accvgpr_write_b32 a128, v122
    v_accvgpr_write_b32 a129, v123
    v_accvgpr_write_b32 a130, v124
    v_accvgpr_write_b32 a131, v125
    v_accvgpr_read_b32 v122, a144
    v_accvgpr_read_b32 v123, a145
    v_accvgpr_read_b32 v124, a146
    v_accvgpr_read_b32 v125, a147
    v_mul_f32 v122, v122, v121
    v_mul_f32 v123, v123, v121
    v_mul_f32 v124, v124, v121
    v_mul_f32 v125, v125, v121
    v_accvgpr_write_b32 a144, v122
    v_accvgpr_write_b32 a145, v123
    v_accvgpr_write_b32 a146, v124
    v_accvgpr_write_b32 a147, v125
    v_accvgpr_read_b32 v122, a160
    v_accvgpr_read_b32 v123, a161
    v_accvgpr_read_b32 v124, a162
    v_accvgpr_read_b32 v125, a163
    v_mul_f32 v122, v122, v121
    v_mul_f32 v123, v123, v121
    v_mul_f32 v124, v124, v121
    v_mul_f32 v125, v125, v121
    v_accvgpr_write_b32 a160, v122
    v_accvgpr_write_b32 a161, v123
    v_accvgpr_write_b32 a162, v124
    v_accvgpr_write_b32 a163, v125
    v_accvgpr_read_b32 v122, a176
    v_accvgpr_read_b32 v123, a177
    v_accvgpr_read_b32 v124, a178
    v_accvgpr_read_b32 v125, a179
    v_mul_f32 v122, v122, v121
    v_mul_f32 v123, v123, v121
    v_mul_f32 v124, v124, v121
    v_mul_f32 v125, v125, v121
    v_accvgpr_write_b32 a176, v122
    v_accvgpr_write_b32 a177, v123
    v_accvgpr_write_b32 a178, v124
    v_accvgpr_write_b32 a179, v125
    v_accvgpr_read_b32 v122, a192
    v_accvgpr_read_b32 v123, a193
    v_accvgpr_read_b32 v124, a194
    v_accvgpr_read_b32 v125, a195
    v_mul_f32 v122, v122, v121
    v_mul_f32 v123, v123, v121
    v_mul_f32 v124, v124, v121
    v_mul_f32 v125, v125, v121
    v_accvgpr_write_b32 a192, v122
    v_accvgpr_write_b32 a193, v123
    v_accvgpr_write_b32 a194, v124
    v_accvgpr_write_b32 a195, v125
    v_accvgpr_read_b32 v122, a208
    v_accvgpr_read_b32 v123, a209
    v_accvgpr_read_b32 v124, a210
    v_accvgpr_read_b32 v125, a211
    v_mul_f32 v122, v122, v121
    v_mul_f32 v123, v123, v121
    v_mul_f32 v124, v124, v121
    v_mul_f32 v125, v125, v121
    v_accvgpr_write_b32 a208, v122
    v_accvgpr_write_b32 a209, v123
    v_accvgpr_write_b32 a210, v124
    v_accvgpr_write_b32 a211, v125
    v_accvgpr_read_b32 v122, a224
    v_accvgpr_read_b32 v123, a225
    v_accvgpr_read_b32 v124, a226
    v_accvgpr_read_b32 v125, a227
    v_mul_f32 v122, v122, v121
    v_mul_f32 v123, v123, v121
    v_mul_f32 v124, v124, v121
    v_mul_f32 v125, v125, v121
    v_accvgpr_write_b32 a224, v122
    v_accvgpr_write_b32 a225, v123
    v_accvgpr_write_b32 a226, v124
    v_accvgpr_write_b32 a227, v125
    v_accvgpr_read_b32 v122, a240
    v_accvgpr_read_b32 v123, a241
    v_accvgpr_read_b32 v124, a242
    v_accvgpr_read_b32 v125, a243
    v_mul_f32 v122, v122, v121
    v_mul_f32 v123, v123, v121
    v_mul_f32 v124, v124, v121
    v_mul_f32 v125, v125, v121
    v_accvgpr_write_b32 a240, v122
    v_accvgpr_write_b32 a241, v123
    v_accvgpr_write_b32 a242, v124
    v_accvgpr_write_b32 a243, v125
    v_sub_f32 v16, v16, v120
    v_sub_f32 v17, v17, v120
    v_sub_f32 v18, v18, v120
    v_sub_f32 v19, v19, v120
    v_sub_f32 v32, v32, v120
    v_sub_f32 v33, v33, v120
    v_sub_f32 v34, v34, v120
    v_sub_f32 v35, v35, v120
    v_exp_f32 v122, v16
    v_exp_f32 v123, v17
    v_exp_f32 v124, v18
    v_exp_f32 v125, v19
    v_add_f32 v12, v122, v123
    v_cvt_pk_bf16_f32 v64, v122, v123
    v_add_f32 v12, v12, v124
    v_cvt_pk_bf16_f32 v65, v124, v125
    v_add_f32 v12, v12, v125
    v_exp_f32 v122, v32
    v_exp_f32 v123, v33
    v_exp_f32 v124, v34
    v_exp_f32 v125, v35
    v_add_f32 v12, v12, v122
    v_add_f32 v12, v12, v123
    v_cvt_pk_bf16_f32 v66, v122, v123
    v_add_f32 v12, v12, v124
    v_cvt_pk_bf16_f32 v67, v124, v125
    v_add_f32 v12, v12, v125
    v_max3_f32 v120, v20, v21, v22
    v_max3_f32 v120, v120, v23, v36
    v_max3_f32 v120, v120, v37, v38
    v_max_f32 v120, v120, v39
    v_mov_b32 v121, v120
    s_nop 1
    v_permlane16_swap_b32 v120, v121
    v_max_f32 v120, v120, v121
    v_mov_b32 v121, v120
    s_nop 1
    v_permlane32_swap_b32 v120, v121
    v_max_f32 v120, v120, v121
    v_max_f32 v120, 0, v120
    v_sub_f32 v84, v84, v120
    v_sub_f32 v85, v85, v120
    v_sub_f32 v86, v86, v120
    v_sub_f32 v87, v87, v120
    v_sub_f32 v121, 0, v120
    v_exp_f32 v121, v121
    s_nop 0
    v_mul_f32 v9, v9, v121
    v_accvgpr_read_b32 v122, a4
    v_accvgpr_read_b32 v123, a5
    v_accvgpr_read_b32 v124, a6
    v_accvgpr_read_b32 v125, a7
    v_mul_f32 v122, v122, v121
    v_mul_f32 v123, v123, v121
    v_mul_f32 v124, v124, v121
    v_mul_f32 v125, v125, v121
    v_accvgpr_write_b32 a4, v122
    v_accvgpr_write_b32 a5, v123
    v_accvgpr_write_b32 a6, v124
    v_accvgpr_write_b32 a7, v125
    v_accvgpr_read_b32 v122, a20
    v_accvgpr_read_b32 v123, a21
    v_accvgpr_read_b32 v124, a22
    v_accvgpr_read_b32 v125, a23
    v_mul_f32 v122, v122, v121
    v_mul_f32 v123, v123, v121
    v_mul_f32 v124, v124, v121
    v_mul_f32 v125, v125, v121
    v_accvgpr_write_b32 a20, v122
    v_accvgpr_write_b32 a21, v123
    v_accvgpr_write_b32 a22, v124
    v_accvgpr_write_b32 a23, v125
    v_accvgpr_read_b32 v122, a36
    v_accvgpr_read_b32 v123, a37
    v_accvgpr_read_b32 v124, a38
    v_accvgpr_read_b32 v125, a39
    v_mul_f32 v122, v122, v121
    v_mul_f32 v123, v123, v121
    v_mul_f32 v124, v124, v121
    v_mul_f32 v125, v125, v121
    v_accvgpr_write_b32 a36, v122
    v_accvgpr_write_b32 a37, v123
    v_accvgpr_write_b32 a38, v124
    v_accvgpr_write_b32 a39, v125
    v_accvgpr_read_b32 v122, a52
    v_accvgpr_read_b32 v123, a53
    v_accvgpr_read_b32 v124, a54
    v_accvgpr_read_b32 v125, a55
    v_mul_f32 v122, v122, v121
    v_mul_f32 v123, v123, v121
    v_mul_f32 v124, v124, v121
    v_mul_f32 v125, v125, v121
    v_accvgpr_write_b32 a52, v122
    v_accvgpr_write_b32 a53, v123
    v_accvgpr_write_b32 a54, v124
    v_accvgpr_write_b32 a55, v125
    v_accvgpr_read_b32 v122, a68
    v_accvgpr_read_b32 v123, a69
    v_accvgpr_read_b32 v124, a70
    v_accvgpr_read_b32 v125, a71
    v_mul_f32 v122, v122, v121
    v_mul_f32 v123, v123, v121
    v_mul_f32 v124, v124, v121
    v_mul_f32 v125, v125, v121
    v_accvgpr_write_b32 a68, v122
    v_accvgpr_write_b32 a69, v123
    v_accvgpr_write_b32 a70, v124
    v_accvgpr_write_b32 a71, v125
    v_accvgpr_read_b32 v122, a84
    v_accvgpr_read_b32 v123, a85
    v_accvgpr_read_b32 v124, a86
    v_accvgpr_read_b32 v125, a87
    v_mul_f32 v122, v122, v121
    v_mul_f32 v123, v123, v121
    v_mul_f32 v124, v124, v121
    v_mul_f32 v125, v125, v121
    v_accvgpr_write_b32 a84, v122
    v_accvgpr_write_b32 a85, v123
    v_accvgpr_write_b32 a86, v124
    v_accvgpr_write_b32 a87, v125
    v_accvgpr_read_b32 v122, a100
    v_accvgpr_read_b32 v123, a101
    v_accvgpr_read_b32 v124, a102
    v_accvgpr_read_b32 v125, a103
    v_mul_f32 v122, v122, v121
    v_mul_f32 v123, v123, v121
    v_mul_f32 v124, v124, v121
    v_mul_f32 v125, v125, v121
    v_accvgpr_write_b32 a100, v122
    v_accvgpr_write_b32 a101, v123
    v_accvgpr_write_b32 a102, v124
    v_accvgpr_write_b32 a103, v125
    v_accvgpr_read_b32 v122, a116
    v_accvgpr_read_b32 v123, a117
    v_accvgpr_read_b32 v124, a118
    v_accvgpr_read_b32 v125, a119
    v_mul_f32 v122, v122, v121
    v_mul_f32 v123, v123, v121
    v_mul_f32 v124, v124, v121
    v_mul_f32 v125, v125, v121
    v_accvgpr_write_b32 a116, v122
    v_accvgpr_write_b32 a117, v123
    v_accvgpr_write_b32 a118, v124
    v_accvgpr_write_b32 a119, v125
    v_accvgpr_read_b32 v122, a132
    v_accvgpr_read_b32 v123, a133
    v_accvgpr_read_b32 v124, a134
    v_accvgpr_read_b32 v125, a135
    v_mul_f32 v122, v122, v121
    v_mul_f32 v123, v123, v121
    v_mul_f32 v124, v124, v121
    v_mul_f32 v125, v125, v121
    v_accvgpr_write_b32 a132, v122
    v_accvgpr_write_b32 a133, v123
    v_accvgpr_write_b32 a134, v124
    v_accvgpr_write_b32 a135, v125
    v_accvgpr_read_b32 v122, a148
    v_accvgpr_read_b32 v123, a149
    v_accvgpr_read_b32 v124, a150
    v_accvgpr_read_b32 v125, a151
    v_mul_f32 v122, v122, v121
    v_mul_f32 v123, v123, v121
    v_mul_f32 v124, v124, v121
    v_mul_f32 v125, v125, v121
    v_accvgpr_write_b32 a148, v122
    v_accvgpr_write_b32 a149, v123
    v_accvgpr_write_b32 a150, v124
    v_accvgpr_write_b32 a151, v125
    v_accvgpr_read_b32 v122, a164
    v_accvgpr_read_b32 v123, a165
    v_accvgpr_read_b32 v124, a166
    v_accvgpr_read_b32 v125, a167
    v_mul_f32 v122, v122, v121
    v_mul_f32 v123, v123, v121
    v_mul_f32 v124, v124, v121
    v_mul_f32 v125, v125, v121
    v_accvgpr_write_b32 a164, v122
    v_accvgpr_write_b32 a165, v123
    v_accvgpr_write_b32 a166, v124
    v_accvgpr_write_b32 a167, v125
    v_accvgpr_read_b32 v122, a180
    v_accvgpr_read_b32 v123, a181
    v_accvgpr_read_b32 v124, a182
    v_accvgpr_read_b32 v125, a183
    v_mul_f32 v122, v122, v121
    v_mul_f32 v123, v123, v121
    v_mul_f32 v124, v124, v121
    v_mul_f32 v125, v125, v121
    v_accvgpr_write_b32 a180, v122
    v_accvgpr_write_b32 a181, v123
    v_accvgpr_write_b32 a182, v124
    v_accvgpr_write_b32 a183, v125
    v_accvgpr_read_b32 v122, a196
    v_accvgpr_read_b32 v123, a197
    v_accvgpr_read_b32 v124, a198
    v_accvgpr_read_b32 v125, a199
    v_mul_f32 v122, v122, v121
    v_mul_f32 v123, v123, v121
    v_mul_f32 v124, v124, v121
    v_mul_f32 v125, v125, v121
    v_accvgpr_write_b32 a196, v122
    v_accvgpr_write_b32 a197, v123
    v_accvgpr_write_b32 a198, v124
    v_accvgpr_write_b32 a199, v125
    v_accvgpr_read_b32 v122, a212
    v_accvgpr_read_b32 v123, a213
    v_accvgpr_read_b32 v124, a214
    v_accvgpr_read_b32 v125, a215
    v_mul_f32 v122, v122, v121
    v_mul_f32 v123, v123, v121
    v_mul_f32 v124, v124, v121
    v_mul_f32 v125, v125, v121
    v_accvgpr_write_b32 a212, v122
    v_accvgpr_write_b32 a213, v123
    v_accvgpr_write_b32 a214, v124
    v_accvgpr_write_b32 a215, v125
    v_accvgpr_read_b32 v122, a228
    v_accvgpr_read_b32 v123, a229
    v_accvgpr_read_b32 v124, a230
    v_accvgpr_read_b32 v125, a231
    v_mul_f32 v122, v122, v121
    v_mul_f32 v123, v123, v121
    v_mul_f32 v124, v124, v121
    v_mul_f32 v125, v125, v121
    v_accvgpr_write_b32 a228, v122
    v_accvgpr_write_b32 a229, v123
    v_accvgpr_write_b32 a230, v124
    v_accvgpr_write_b32 a231, v125
    v_accvgpr_read_b32 v122, a244
    v_accvgpr_read_b32 v123, a245
    v_accvgpr_read_b32 v124, a246
    v_accvgpr_read_b32 v125, a247
    v_mul_f32 v122, v122, v121
    v_mul_f32 v123, v123, v121
    v_mul_f32 v124, v124, v121
    v_mul_f32 v125, v125, v121
    v_accvgpr_write_b32 a244, v122
    v_accvgpr_write_b32 a245, v123
    v_accvgpr_write_b32 a246, v124
    v_accvgpr_write_b32 a247, v125
    v_sub_f32 v20, v20, v120
    v_sub_f32 v21, v21, v120
    v_sub_f32 v22, v22, v120
    v_sub_f32 v23, v23, v120
    v_sub_f32 v36, v36, v120
    v_sub_f32 v37, v37, v120
    v_sub_f32 v38, v38, v120
    v_sub_f32 v39, v39, v120
    v_exp_f32 v122, v20
    v_exp_f32 v123, v21
    v_exp_f32 v124, v22
    v_exp_f32 v125, v23
    v_add_f32 v13, v122, v123
    v_cvt_pk_bf16_f32 v68, v122, v123
    v_add_f32 v13, v13, v124
    v_cvt_pk_bf16_f32 v69, v124, v125
    v_add_f32 v13, v13, v125
    v_exp_f32 v122, v36
    v_exp_f32 v123, v37
    v_exp_f32 v124, v38
    v_exp_f32 v125, v39
    v_add_f32 v13, v13, v122
    v_add_f32 v13, v13, v123
    v_cvt_pk_bf16_f32 v70, v122, v123
    v_add_f32 v13, v13, v124
    v_cvt_pk_bf16_f32 v71, v124, v125
    v_add_f32 v13, v13, v125
    v_max3_f32 v120, v24, v25, v26
    v_max3_f32 v120, v120, v27, v40
    v_max3_f32 v120, v120, v41, v42
    v_max_f32 v120, v120, v43
    v_mov_b32 v121, v120
    s_nop 1
    v_permlane16_swap_b32 v120, v121
    v_max_f32 v120, v120, v121
    v_mov_b32 v121, v120
    s_nop 1
    v_permlane32_swap_b32 v120, v121
    v_max_f32 v120, v120, v121
    v_max_f32 v120, 0, v120
    v_sub_f32 v88, v88, v120
    v_sub_f32 v89, v89, v120
    v_sub_f32 v90, v90, v120
    v_sub_f32 v91, v91, v120
    v_sub_f32 v121, 0, v120
    v_exp_f32 v121, v121
    s_nop 0
    v_mul_f32 v10, v10, v121
    v_accvgpr_read_b32 v122, a8
    v_accvgpr_read_b32 v123, a9
    v_accvgpr_read_b32 v124, a10
    v_accvgpr_read_b32 v125, a11
    v_mul_f32 v122, v122, v121
    v_mul_f32 v123, v123, v121
    v_mul_f32 v124, v124, v121
    v_mul_f32 v125, v125, v121
    v_accvgpr_write_b32 a8, v122
    v_accvgpr_write_b32 a9, v123
    v_accvgpr_write_b32 a10, v124
    v_accvgpr_write_b32 a11, v125
    v_accvgpr_read_b32 v122, a24
    v_accvgpr_read_b32 v123, a25
    v_accvgpr_read_b32 v124, a26
    v_accvgpr_read_b32 v125, a27
    v_mul_f32 v122, v122, v121
    v_mul_f32 v123, v123, v121
    v_mul_f32 v124, v124, v121
    v_mul_f32 v125, v125, v121
    v_accvgpr_write_b32 a24, v122
    v_accvgpr_write_b32 a25, v123
    v_accvgpr_write_b32 a26, v124
    v_accvgpr_write_b32 a27, v125
    v_accvgpr_read_b32 v122, a40
    v_accvgpr_read_b32 v123, a41
    v_accvgpr_read_b32 v124, a42
    v_accvgpr_read_b32 v125, a43
    v_mul_f32 v122, v122, v121
    v_mul_f32 v123, v123, v121
    v_mul_f32 v124, v124, v121
    v_mul_f32 v125, v125, v121
    v_accvgpr_write_b32 a40, v122
    v_accvgpr_write_b32 a41, v123
    v_accvgpr_write_b32 a42, v124
    v_accvgpr_write_b32 a43, v125
    v_accvgpr_read_b32 v122, a56
    v_accvgpr_read_b32 v123, a57
    v_accvgpr_read_b32 v124, a58
    v_accvgpr_read_b32 v125, a59
    v_mul_f32 v122, v122, v121
    v_mul_f32 v123, v123, v121
    v_mul_f32 v124, v124, v121
    v_mul_f32 v125, v125, v121
    v_accvgpr_write_b32 a56, v122
    v_accvgpr_write_b32 a57, v123
    v_accvgpr_write_b32 a58, v124
    v_accvgpr_write_b32 a59, v125
    v_accvgpr_read_b32 v122, a72
    v_accvgpr_read_b32 v123, a73
    v_accvgpr_read_b32 v124, a74
    v_accvgpr_read_b32 v125, a75
    v_mul_f32 v122, v122, v121
    v_mul_f32 v123, v123, v121
    v_mul_f32 v124, v124, v121
    v_mul_f32 v125, v125, v121
    v_accvgpr_write_b32 a72, v122
    v_accvgpr_write_b32 a73, v123
    v_accvgpr_write_b32 a74, v124
    v_accvgpr_write_b32 a75, v125
    v_accvgpr_read_b32 v122, a88
    v_accvgpr_read_b32 v123, a89
    v_accvgpr_read_b32 v124, a90
    v_accvgpr_read_b32 v125, a91
    v_mul_f32 v122, v122, v121
    v_mul_f32 v123, v123, v121
    v_mul_f32 v124, v124, v121
    v_mul_f32 v125, v125, v121
    v_accvgpr_write_b32 a88, v122
    v_accvgpr_write_b32 a89, v123
    v_accvgpr_write_b32 a90, v124
    v_accvgpr_write_b32 a91, v125
    v_accvgpr_read_b32 v122, a104
    v_accvgpr_read_b32 v123, a105
    v_accvgpr_read_b32 v124, a106
    v_accvgpr_read_b32 v125, a107
    v_mul_f32 v122, v122, v121
    v_mul_f32 v123, v123, v121
    v_mul_f32 v124, v124, v121
    v_mul_f32 v125, v125, v121
    v_accvgpr_write_b32 a104, v122
    v_accvgpr_write_b32 a105, v123
    v_accvgpr_write_b32 a106, v124
    v_accvgpr_write_b32 a107, v125
    v_accvgpr_read_b32 v122, a120
    v_accvgpr_read_b32 v123, a121
    v_accvgpr_read_b32 v124, a122
    v_accvgpr_read_b32 v125, a123
    v_mul_f32 v122, v122, v121
    v_mul_f32 v123, v123, v121
    v_mul_f32 v124, v124, v121
    v_mul_f32 v125, v125, v121
    v_accvgpr_write_b32 a120, v122
    v_accvgpr_write_b32 a121, v123
    v_accvgpr_write_b32 a122, v124
    v_accvgpr_write_b32 a123, v125
    v_accvgpr_read_b32 v122, a136
    v_accvgpr_read_b32 v123, a137
    v_accvgpr_read_b32 v124, a138
    v_accvgpr_read_b32 v125, a139
    v_mul_f32 v122, v122, v121
    v_mul_f32 v123, v123, v121
    v_mul_f32 v124, v124, v121
    v_mul_f32 v125, v125, v121
    v_accvgpr_write_b32 a136, v122
    v_accvgpr_write_b32 a137, v123
    v_accvgpr_write_b32 a138, v124
    v_accvgpr_write_b32 a139, v125
    v_accvgpr_read_b32 v122, a152
    v_accvgpr_read_b32 v123, a153
    v_accvgpr_read_b32 v124, a154
    v_accvgpr_read_b32 v125, a155
    v_mul_f32 v122, v122, v121
    v_mul_f32 v123, v123, v121
    v_mul_f32 v124, v124, v121
    v_mul_f32 v125, v125, v121
    v_accvgpr_write_b32 a152, v122
    v_accvgpr_write_b32 a153, v123
    v_accvgpr_write_b32 a154, v124
    v_accvgpr_write_b32 a155, v125
    v_accvgpr_read_b32 v122, a168
    v_accvgpr_read_b32 v123, a169
    v_accvgpr_read_b32 v124, a170
    v_accvgpr_read_b32 v125, a171
    v_mul_f32 v122, v122, v121
    v_mul_f32 v123, v123, v121
    v_mul_f32 v124, v124, v121
    v_mul_f32 v125, v125, v121
    v_accvgpr_write_b32 a168, v122
    v_accvgpr_write_b32 a169, v123
    v_accvgpr_write_b32 a170, v124
    v_accvgpr_write_b32 a171, v125
    v_accvgpr_read_b32 v122, a184
    v_accvgpr_read_b32 v123, a185
    v_accvgpr_read_b32 v124, a186
    v_accvgpr_read_b32 v125, a187
    v_mul_f32 v122, v122, v121
    v_mul_f32 v123, v123, v121
    v_mul_f32 v124, v124, v121
    v_mul_f32 v125, v125, v121
    v_accvgpr_write_b32 a184, v122
    v_accvgpr_write_b32 a185, v123
    v_accvgpr_write_b32 a186, v124
    v_accvgpr_write_b32 a187, v125
    v_accvgpr_read_b32 v122, a200
    v_accvgpr_read_b32 v123, a201
    v_accvgpr_read_b32 v124, a202
    v_accvgpr_read_b32 v125, a203
    v_mul_f32 v122, v122, v121
    v_mul_f32 v123, v123, v121
    v_mul_f32 v124, v124, v121
    v_mul_f32 v125, v125, v121
    v_accvgpr_write_b32 a200, v122
    v_accvgpr_write_b32 a201, v123
    v_accvgpr_write_b32 a202, v124
    v_accvgpr_write_b32 a203, v125
    v_accvgpr_read_b32 v122, a216
    v_accvgpr_read_b32 v123, a217
    v_accvgpr_read_b32 v124, a218
    v_accvgpr_read_b32 v125, a219
    v_mul_f32 v122, v122, v121
    v_mul_f32 v123, v123, v121
    v_mul_f32 v124, v124, v121
    v_mul_f32 v125, v125, v121
    v_accvgpr_write_b32 a216, v122
    v_accvgpr_write_b32 a217, v123
    v_accvgpr_write_b32 a218, v124
    v_accvgpr_write_b32 a219, v125
    v_accvgpr_read_b32 v122, a232
    v_accvgpr_read_b32 v123, a233
    v_accvgpr_read_b32 v124, a234
    v_accvgpr_read_b32 v125, a235
    v_mul_f32 v122, v122, v121
    v_mul_f32 v123, v123, v121
    v_mul_f32 v124, v124, v121
    v_mul_f32 v125, v125, v121
    v_accvgpr_write_b32 a232, v122
    v_accvgpr_write_b32 a233, v123
    v_accvgpr_write_b32 a234, v124
    v_accvgpr_write_b32 a235, v125
    v_accvgpr_read_b32 v122, a248
    v_accvgpr_read_b32 v123, a249
    v_accvgpr_read_b32 v124, a250
    v_accvgpr_read_b32 v125, a251
    v_mul_f32 v122, v122, v121
    v_mul_f32 v123, v123, v121
    v_mul_f32 v124, v124, v121
    v_mul_f32 v125, v125, v121
    v_accvgpr_write_b32 a248, v122
    v_accvgpr_write_b32 a249, v123
    v_accvgpr_write_b32 a250, v124
    v_accvgpr_write_b32 a251, v125
    v_sub_f32 v24, v24, v120
    v_sub_f32 v25, v25, v120
    v_sub_f32 v26, v26, v120
    v_sub_f32 v27, v27, v120
    v_sub_f32 v40, v40, v120
    v_sub_f32 v41, v41, v120
    v_sub_f32 v42, v42, v120
    v_sub_f32 v43, v43, v120
    v_exp_f32 v122, v24
    v_exp_f32 v123, v25
    v_exp_f32 v124, v26
    v_exp_f32 v125, v27
    v_add_f32 v14, v122, v123
    v_cvt_pk_bf16_f32 v72, v122, v123
    v_add_f32 v14, v14, v124
    v_cvt_pk_bf16_f32 v73, v124, v125
    v_add_f32 v14, v14, v125
    v_exp_f32 v122, v40
    v_exp_f32 v123, v41
    v_exp_f32 v124, v42
    v_exp_f32 v125, v43
    v_add_f32 v14, v14, v122
    v_add_f32 v14, v14, v123
    v_cvt_pk_bf16_f32 v74, v122, v123
    v_add_f32 v14, v14, v124
    v_cvt_pk_bf16_f32 v75, v124, v125
    v_add_f32 v14, v14, v125
    v_max3_f32 v120, v28, v29, v30
    v_max3_f32 v120, v120, v31, v44
    v_max3_f32 v120, v120, v45, v46
    v_max_f32 v120, v120, v47
    v_mov_b32 v121, v120
    s_nop 1
    v_permlane16_swap_b32 v120, v121
    v_max_f32 v120, v120, v121
    v_mov_b32 v121, v120
    s_nop 1
    v_permlane32_swap_b32 v120, v121
    v_max_f32 v120, v120, v121
    v_max_f32 v120, 0, v120
    v_sub_f32 v92, v92, v120
    v_sub_f32 v93, v93, v120
    v_sub_f32 v94, v94, v120
    v_sub_f32 v95, v95, v120
    v_sub_f32 v121, 0, v120
    v_exp_f32 v121, v121
    s_nop 0
    v_mul_f32 v11, v11, v121
    v_accvgpr_read_b32 v122, a12
    v_accvgpr_read_b32 v123, a13
    v_accvgpr_read_b32 v124, a14
    v_accvgpr_read_b32 v125, a15
    v_mul_f32 v122, v122, v121
    v_mul_f32 v123, v123, v121
    v_mul_f32 v124, v124, v121
    v_mul_f32 v125, v125, v121
    v_accvgpr_write_b32 a12, v122
    v_accvgpr_write_b32 a13, v123
    v_accvgpr_write_b32 a14, v124
    v_accvgpr_write_b32 a15, v125
    v_accvgpr_read_b32 v122, a28
    v_accvgpr_read_b32 v123, a29
    v_accvgpr_read_b32 v124, a30
    v_accvgpr_read_b32 v125, a31
    v_mul_f32 v122, v122, v121
    v_mul_f32 v123, v123, v121
    v_mul_f32 v124, v124, v121
    v_mul_f32 v125, v125, v121
    v_accvgpr_write_b32 a28, v122
    v_accvgpr_write_b32 a29, v123
    v_accvgpr_write_b32 a30, v124
    v_accvgpr_write_b32 a31, v125
    v_accvgpr_read_b32 v122, a44
    v_accvgpr_read_b32 v123, a45
    v_accvgpr_read_b32 v124, a46
    v_accvgpr_read_b32 v125, a47
    v_mul_f32 v122, v122, v121
    v_mul_f32 v123, v123, v121
    v_mul_f32 v124, v124, v121
    v_mul_f32 v125, v125, v121
    v_accvgpr_write_b32 a44, v122
    v_accvgpr_write_b32 a45, v123
    v_accvgpr_write_b32 a46, v124
    v_accvgpr_write_b32 a47, v125
    v_accvgpr_read_b32 v122, a60
    v_accvgpr_read_b32 v123, a61
    v_accvgpr_read_b32 v124, a62
    v_accvgpr_read_b32 v125, a63
    v_mul_f32 v122, v122, v121
    v_mul_f32 v123, v123, v121
    v_mul_f32 v124, v124, v121
    v_mul_f32 v125, v125, v121
    v_accvgpr_write_b32 a60, v122
    v_accvgpr_write_b32 a61, v123
    v_accvgpr_write_b32 a62, v124
    v_accvgpr_write_b32 a63, v125
    v_accvgpr_read_b32 v122, a76
    v_accvgpr_read_b32 v123, a77
    v_accvgpr_read_b32 v124, a78
    v_accvgpr_read_b32 v125, a79
    v_mul_f32 v122, v122, v121
    v_mul_f32 v123, v123, v121
    v_mul_f32 v124, v124, v121
    v_mul_f32 v125, v125, v121
    v_accvgpr_write_b32 a76, v122
    v_accvgpr_write_b32 a77, v123
    v_accvgpr_write_b32 a78, v124
    v_accvgpr_write_b32 a79, v125
    v_accvgpr_read_b32 v122, a92
    v_accvgpr_read_b32 v123, a93
    v_accvgpr_read_b32 v124, a94
    v_accvgpr_read_b32 v125, a95
    v_mul_f32 v122, v122, v121
    v_mul_f32 v123, v123, v121
    v_mul_f32 v124, v124, v121
    v_mul_f32 v125, v125, v121
    v_accvgpr_write_b32 a92, v122
    v_accvgpr_write_b32 a93, v123
    v_accvgpr_write_b32 a94, v124
    v_accvgpr_write_b32 a95, v125
    v_accvgpr_read_b32 v122, a108
    v_accvgpr_read_b32 v123, a109
    v_accvgpr_read_b32 v124, a110
    v_accvgpr_read_b32 v125, a111
    v_mul_f32 v122, v122, v121
    v_mul_f32 v123, v123, v121
    v_mul_f32 v124, v124, v121
    v_mul_f32 v125, v125, v121
    v_accvgpr_write_b32 a108, v122
    v_accvgpr_write_b32 a109, v123
    v_accvgpr_write_b32 a110, v124
    v_accvgpr_write_b32 a111, v125
    v_accvgpr_read_b32 v122, a124
    v_accvgpr_read_b32 v123, a125
    v_accvgpr_read_b32 v124, a126
    v_accvgpr_read_b32 v125, a127
    v_mul_f32 v122, v122, v121
    v_mul_f32 v123, v123, v121
    v_mul_f32 v124, v124, v121
    v_mul_f32 v125, v125, v121
    v_accvgpr_write_b32 a124, v122
    v_accvgpr_write_b32 a125, v123
    v_accvgpr_write_b32 a126, v124
    v_accvgpr_write_b32 a127, v125
    v_accvgpr_read_b32 v122, a140
    v_accvgpr_read_b32 v123, a141
    v_accvgpr_read_b32 v124, a142
    v_accvgpr_read_b32 v125, a143
    v_mul_f32 v122, v122, v121
    v_mul_f32 v123, v123, v121
    v_mul_f32 v124, v124, v121
    v_mul_f32 v125, v125, v121
    v_accvgpr_write_b32 a140, v122
    v_accvgpr_write_b32 a141, v123
    v_accvgpr_write_b32 a142, v124
    v_accvgpr_write_b32 a143, v125
    v_accvgpr_read_b32 v122, a156
    v_accvgpr_read_b32 v123, a157
    v_accvgpr_read_b32 v124, a158
    v_accvgpr_read_b32 v125, a159
    v_mul_f32 v122, v122, v121
    v_mul_f32 v123, v123, v121
    v_mul_f32 v124, v124, v121
    v_mul_f32 v125, v125, v121
    v_accvgpr_write_b32 a156, v122
    v_accvgpr_write_b32 a157, v123
    v_accvgpr_write_b32 a158, v124
    v_accvgpr_write_b32 a159, v125
    v_accvgpr_read_b32 v122, a172
    v_accvgpr_read_b32 v123, a173
    v_accvgpr_read_b32 v124, a174
    v_accvgpr_read_b32 v125, a175
    v_mul_f32 v122, v122, v121
    v_mul_f32 v123, v123, v121
    v_mul_f32 v124, v124, v121
    v_mul_f32 v125, v125, v121
    v_accvgpr_write_b32 a172, v122
    v_accvgpr_write_b32 a173, v123
    v_accvgpr_write_b32 a174, v124
    v_accvgpr_write_b32 a175, v125
    v_accvgpr_read_b32 v122, a188
    v_accvgpr_read_b32 v123, a189
    v_accvgpr_read_b32 v124, a190
    v_accvgpr_read_b32 v125, a191
    v_mul_f32 v122, v122, v121
    v_mul_f32 v123, v123, v121
    v_mul_f32 v124, v124, v121
    v_mul_f32 v125, v125, v121
    v_accvgpr_write_b32 a188, v122
    v_accvgpr_write_b32 a189, v123
    v_accvgpr_write_b32 a190, v124
    v_accvgpr_write_b32 a191, v125
    v_accvgpr_read_b32 v122, a204
    v_accvgpr_read_b32 v123, a205
    v_accvgpr_read_b32 v124, a206
    v_accvgpr_read_b32 v125, a207
    v_mul_f32 v122, v122, v121
    v_mul_f32 v123, v123, v121
    v_mul_f32 v124, v124, v121
    v_mul_f32 v125, v125, v121
    v_accvgpr_write_b32 a204, v122
    v_accvgpr_write_b32 a205, v123
    v_accvgpr_write_b32 a206, v124
    v_accvgpr_write_b32 a207, v125
    v_accvgpr_read_b32 v122, a220
    v_accvgpr_read_b32 v123, a221
    v_accvgpr_read_b32 v124, a222
    v_accvgpr_read_b32 v125, a223
    v_mul_f32 v122, v122, v121
    v_mul_f32 v123, v123, v121
    v_mul_f32 v124, v124, v121
    v_mul_f32 v125, v125, v121
    v_accvgpr_write_b32 a220, v122
    v_accvgpr_write_b32 a221, v123
    v_accvgpr_write_b32 a222, v124
    v_accvgpr_write_b32 a223, v125
    v_accvgpr_read_b32 v122, a236
    v_accvgpr_read_b32 v123, a237
    v_accvgpr_read_b32 v124, a238
    v_accvgpr_read_b32 v125, a239
    v_mul_f32 v122, v122, v121
    v_mul_f32 v123, v123, v121
    v_mul_f32 v124, v124, v121
    v_mul_f32 v125, v125, v121
    v_accvgpr_write_b32 a236, v122
    v_accvgpr_write_b32 a237, v123
    v_accvgpr_write_b32 a238, v124
    v_accvgpr_write_b32 a239, v125
    v_accvgpr_read_b32 v122, a252
    v_accvgpr_read_b32 v123, a253
    v_accvgpr_read_b32 v124, a254
    v_accvgpr_read_b32 v125, a255
    v_mul_f32 v122, v122, v121
    v_mul_f32 v123, v123, v121
    v_mul_f32 v124, v124, v121
    v_mul_f32 v125, v125, v121
    v_accvgpr_write_b32 a252, v122
    v_accvgpr_write_b32 a253, v123
    v_accvgpr_write_b32 a254, v124
    v_accvgpr_write_b32 a255, v125
    v_sub_f32 v28, v28, v120
    v_sub_f32 v29, v29, v120
    v_sub_f32 v30, v30, v120
    v_sub_f32 v31, v31, v120
    v_sub_f32 v44, v44, v120
    v_sub_f32 v45, v45, v120
    v_sub_f32 v46, v46, v120
    v_sub_f32 v47, v47, v120
    v_exp_f32 v122, v28
    v_exp_f32 v123, v29
    v_exp_f32 v124, v30
    v_exp_f32 v125, v31
    v_add_f32 v15, v122, v123
    v_cvt_pk_bf16_f32 v76, v122, v123
    v_add_f32 v15, v15, v124
    v_cvt_pk_bf16_f32 v77, v124, v125
    v_add_f32 v15, v15, v125
    v_exp_f32 v122, v44
    v_exp_f32 v123, v45
    v_exp_f32 v124, v46
    v_exp_f32 v125, v47
    v_add_f32 v15, v15, v122
    v_add_f32 v15, v15, v123
    v_cvt_pk_bf16_f32 v78, v122, v123
    v_add_f32 v15, v15, v124
    v_cvt_pk_bf16_f32 v79, v124, v125
    v_add_f32 v15, v15, v125
    s_nop 3
    s_cmp_eq_u32 s54, 0
    s_cbranch_scc1 L_back_f
    s_cmp_eq_u32 s54, 2
    s_cbranch_scc1 L_back_a
    s_cmp_eq_u32 s54, 4
    s_cbranch_scc1 L_back_c
    s_branch L_back_e
L_code_end:
.section .rodata,"a"
.p2align 6
.amdhsa_kernel adaLN_cond__gqa_block_cached__mixer_channel_mlp__prompt_kernel
  .amdhsa_next_free_vgpr 512
  .amdhsa_next_free_sgpr 102
  .amdhsa_accum_offset 256
  .amdhsa_group_segment_fixed_size 0
  .amdhsa_kernarg_size 120
  .amdhsa_user_sgpr_count 2
  .amdhsa_user_sgpr_kernarg_segment_ptr 1
  .amdhsa_system_sgpr_workgroup_id_x 1
.end_amdhsa_kernel
```
